```python
import torch

def _softmax(x, axis=-1):
    return torch.softmax(x, dim=axis)
def _gelu(x):
    return torch.nn.functional.gelu(x, approximate="tanh")
def _silu(x):
    return torch.nn.functional.silu(x)
def _sigmoid(x):
    return torch.sigmoid(x)
def _layernorm(x, axis=-1, eps=1e-5):
    m = x.mean(dim=axis, keepdim=True)
    v = x.var(dim=axis, keepdim=True, unbiased=False)
    return (x - m) / torch.sqrt(v + eps)
def _scatter_add(tgt, idx, src, axis=0):
    return tgt.clone().index_add_(axis, idx, src)
def _segment_sum(src, seg, n):
    out = torch.zeros((n,) + src.shape[1:], dtype=src.dtype)
    return out.index_add_(0, seg, src)
def _pad(x, pw):
    flat = tuple(v for pair in reversed(pw) for v in pair)
    return torch.nn.functional.pad(x, flat)

kernel_name = 'concat_heads__compressed_kv_cla__linear_attn_block__prompt'

def setup_inputs():

    _w = (lambda a: (lambda t: t.to(torch.bfloat16) if t.is_floating_point() else t)(torch.as_tensor(a)))
    def _A_setup():
        B, H, Sq, Sk, D, M = 1, 32, 2048, 2048, 128, 576
        Dc = 4 * D
        return {
            "x": _w((lambda *s: torch.randn(*s, dtype=torch.bfloat16) * 1.6)(B, Sq, M)),
            "c_kv": _w((lambda *s: torch.randn(*s, dtype=torch.bfloat16) * 0.2)(B, Sk, Dc)),
            "w_q": _w((lambda *s: torch.randn(*s, dtype=torch.bfloat16) * 3.2)(M, H, D) * (M ** -0.5)),
            "w_uk": _w((lambda *s: torch.randn(*s, dtype=torch.bfloat16) * 3.2)(Dc, H, D) * (Dc ** -0.5)),
            "w_uv": _w((lambda *s: torch.randn(*s, dtype=torch.bfloat16) * 0.2)(Dc, H, D) * (Dc ** -0.5)),
            "w_o": _w((lambda *s: torch.randn(*s, dtype=torch.bfloat16) * 0.2)(H, D, M) * ((H * D) ** -0.5)),
        }
    _A_in = _A_setup()

    def _B_setup():
        B, S, D = 1, 2048, 576
        return {
            "x": _w((lambda *s: torch.randn(*s, dtype=torch.bfloat16) * 0.05)(B, S, D)),
            "wqkv": _w((lambda *s: torch.randn(*s, dtype=torch.bfloat16) * 0.4)(D, 3 * D)),
            "wo": _w((lambda *s: torch.randn(*s, dtype=torch.bfloat16) * 0.05)(D, D)),
        }
    _B_in = _B_setup()

    return {
        "A_x": _A_in["x"],
        "A_c_kv": _A_in["c_kv"],
        "A_w_q": _A_in["w_q"],
        "A_w_uk": _A_in["w_uk"],
        "A_w_uv": _A_in["w_uv"],
        "A_w_o": _A_in["w_o"],
        "B_x": _B_in["x"],
        "B_wqkv": _B_in["wqkv"],
        "B_wo": _B_in["wo"],
    }

def reference(A_x, A_c_kv, A_w_q, A_w_uk, A_w_uv, A_w_o, B_x, B_wqkv, B_wo):
    def _A_ref(x, c_kv, w_q, w_uk, w_uv, w_o):
        B, Sq, M = x.shape[0], x.shape[1], x.shape[2]
        Sk = c_kv.shape[1]
        H, D = w_q.shape[1], w_q.shape[2]
        q = torch.einsum("bqm,mhd->bhqd", x, w_q)
        k = torch.einsum("bkc,chd->bhkd", c_kv, w_uk)
        v = torch.einsum("bkc,chd->bhkd", c_kv, w_uv)
        scores = torch.einsum("bhqd,bhkd->bhqk", q, k) * (D ** -0.5)
        off = Sk - Sq
        qi = torch.arange(Sq)[:, None]
        kj = torch.arange(Sk)[None, :]
        cmask = kj <= (qi + off)
        scores = torch.where(cmask[None, None], scores, -1e9)
        p = _softmax(scores, axis=-1)
        ctx = torch.einsum("bhqk,bhkd->bhqd", p, v)
        return torch.einsum("bhqd,hdm->bqm", ctx, w_o)

    def _B_ref(x, wqkv, wo):
        B, S, D = x.shape
        H = 32; Dh = D // H
        qkv = (lambda x, *d: x.permute(*d))((x @ wqkv).reshape(B, S, 3, H, Dh), 2, 0, 3, 1, 4)
        q, k, v = qkv[0], qkv[1], qkv[2]
        phi = lambda t: torch.where(t > 0, t + 1, torch.exp(t)) + 1e-6
        pq, pk = phi(q), phi(k)
        kv = torch.einsum("bhsd,bhse->bhde", pk, v)
        z = torch.einsum("bhsd->bhd", pk)
        num = torch.einsum("bhqd,bhde->bhqe", pq, kv)
        den = torch.einsum("bhqd,bhd->bhq", pq, z)[..., None] + 1e-6
        o = num / den
        return (lambda x, *d: x.permute(*d))(o, 0, 2, 1, 3).reshape(B, S, D) @ wo

    a = _A_ref(A_x, A_c_kv, A_w_q, A_w_uk, A_w_uv, A_w_o)
    b = _B_ref(B_x, B_wqkv, B_wo)
    return torch.concatenate([a, b], axis=-1)
```

```asm
; @launch grid=(256,1,1) block=(256,1,1) lds=163840
.amdgcn_target "amdgcn-amd-amdhsa--gfx950"
.text
.globl concat_heads__compressed_kv_cla__linear_attn_block__prompt_kernel
.p2align 8
.type concat_heads__compressed_kv_cla__linear_attn_block__prompt_kernel,@function
concat_heads__compressed_kv_cla__linear_attn_block__prompt_kernel:
    s_load_dwordx2 s[40:41], s[0:1], 8
    s_load_dwordx2 s[44:45], s[0:1], 24
    s_cmp_ge_u32 s2, 256
    s_cbranch_scc1 L_END
    v_lshrrev_b32 v1, 6, v0
    v_and_b32 v2, 63, v0
    v_readfirstlane_b32 s3, v1
    s_mov_b32 s42, 2097152
    s_mov_b32 s43, 0x20000
    s_mov_b32 s46, 4194304
    s_mov_b32 s47, 0x20000
    v_lshrrev_b32 v3, 3, v2
    v_and_b32 v4, 7, v2
    v_lshrrev_b32 v5, 4, v2
    v_xor_b32 v10, v4, v5
    v_lshlrev_b32 v10, 4, v10
    v_xor_b32 v11, 64, v10
    v_lshl_add_u32 v226, v3, 10, v10
    v_lshl_add_u32 v8, v3, 10, v11
    v_add_u32 v227, 7168, v8
    v_add_u32 v228, 14336, v226
    v_add_u32 v229, 21504, v8
    v_lshrrev_b32 v6, 1, v4
    v_and_b32 v7, 1, v5
    v_xor_b32 v6, v6, v7
    v_lshlrev_b32 v6, 5, v6
    v_and_b32 v7, 1, v2
    v_lshl_add_u32 v6, v7, 4, v6
    v_lshl_add_u32 v234, v3, 13, v6
    v_xor_b32 v8, 64, v234
    v_add_u32 v235, 64512, v8
    v_add_u32 v236, 129024, v234
    v_add_u32 v237, 193536, v8
    s_and_b32 s8, s2, 7
    s_lshr_b32 s10, s2, 6
    s_lshl_b32 s4, s8, 2
    s_add_u32 s4, s4, s10
    s_bfe_u32 s5, s2, 0x30003
    s_lshl_b32 s16, s3, 12
    s_and_b32 s8, s3, 1
    s_lshr_b32 s9, s3, 1
    s_lshl_b32 s17, s8, 13
    s_lshl_b32 s10, s9, 12
    s_add_u32 s17, s17, s10
    s_lshl_b32 s18, s5, 18
    s_lshl_b32 s10, s3, 16
    s_add_u32 s18, s18, s10
    s_lshl_b32 s11, s4, 8
    s_lshl_b32 s19, s9, 18
    s_lshl_b32 s10, s8, 7
    s_add_u32 s19, s19, s10
    s_add_u32 s19, s19, s11
    s_add_u32 s34, s18, 32768
    s_add_u32 s8, s5, s4
    s_and_b32 s8, s8, 0
    s_lshl_b32 s36, s8, 8
    s_lshl_b32 s37, s8, 20
    v_lshlrev_b32 v224, 4, v2
    s_waitcnt lgkmcnt(0)
    v_lshlrev_b32 v255, 3, v224
    v_subrev_u32 v220, 2048, v255
    v_not_b32 v220, v220
    s_lshl_b32 s93, s2, 2
    v_and_b32 v220, 0x80000000, v220
    v_or_b32 v255, v255, v220
    s_add_u32 s93, s93, s3
    s_mul_i32 s93, s93, 2048
    buffer_load_dword v220, v255, s[40:43], s93 offen offset:0
    s_add_u32 m0, s16, 0
    s_add_u32 s14, s18, s36
    buffer_load_dwordx4 v226, s[40:43], s14 offen offset:0 lds
    buffer_load_dwordx4 v227, s[40:43], s14 offen offset:1024 lds
    buffer_load_dwordx4 v228, s[40:43], s14 offen offset:2048 lds
    buffer_load_dwordx4 v229, s[40:43], s14 offen offset:3072 lds
    s_add_u32 m0, s16, 16384
    s_add_u32 s14, s34, s36
    buffer_load_dwordx4 v226, s[40:43], s14 offen offset:0 lds
    s_add_u32 s36, s36, 128
    s_and_b32 s36, s36, 1023
    buffer_load_dwordx4 v227, s[40:43], s14 offen offset:1024 lds
    buffer_load_dwordx4 v228, s[40:43], s14 offen offset:2048 lds
    buffer_load_dwordx4 v229, s[40:43], s14 offen offset:3072 lds
    s_add_u32 m0, s17, 32768
    s_add_u32 s14, s19, s37
    buffer_load_dwordx4 v234, s[44:47], s14 offen offset:0 nt lds
    s_add_u32 s37, s37, 524288
    s_and_b32 s37, s37, 4194303
    buffer_load_dwordx4 v235, s[44:47], s14 offen offset:1024 nt lds
    buffer_load_dwordx4 v236, s[44:47], s14 offen offset:2048 nt lds
    buffer_load_dwordx4 v237, s[44:47], s14 offen offset:3072 nt lds
    s_load_dwordx2 s[64:65], s[0:1], 88
    s_load_dwordx2 s[48:49], s[0:1], 32
    s_load_dwordx2 s[56:57], s[0:1], 0
    s_load_dwordx2 s[60:61], s[0:1], 16
    s_load_dwordx2 s[76:77], s[0:1], 40
    s_load_dwordx2 s[52:53], s[0:1], 48
    s_load_dwordx2 s[68:69], s[0:1], 56
    s_load_dwordx2 s[72:73], s[0:1], 64
    s_load_dwordx2 s[80:81], s[0:1], 72
    s_load_dwordx2 s[84:85], s[0:1], 80
    s_mov_b32 s66, 268435456
    s_mov_b32 s67, 0x20000
    s_mov_b32 s50, 4194304
    s_mov_b32 s51, 0x20000
    s_mov_b32 s58, 2359296
    s_mov_b32 s59, 0x20000
    s_mov_b32 s62, 4718592
    s_mov_b32 s63, 0x20000
    s_mov_b32 s78, 4718592
    s_mov_b32 s79, 0x20000
    s_mov_b32 s54, 2359296
    s_mov_b32 s55, 0x20000
    s_mov_b32 s70, 1990656
    s_mov_b32 s71, 0x20000
    s_mov_b32 s74, 663552
    s_mov_b32 s75, 0x20000
    s_mov_b32 s82, 4718592
    s_mov_b32 s83, 0x20000
    s_mov_b32 s86, 256
    s_mov_b32 s87, 0x20000
    v_lshl_add_u32 v225, v1, 12, v224
    v_mul_u32_u24 v9, 1152, v3
    v_add_u32 v230, v9, v10
    v_add_u32 v9, v9, v11
    v_add_u32 v231, 8192, v9
    v_add_u32 v232, 16384, v230
    v_add_u32 v233, 24576, v9
    v_and_b32 v6, 15, v2
    v_lshrrev_b32 v7, 1, v6
    v_xor_b32 v7, v7, v5
    v_lshlrev_b32 v7, 4, v7
    v_lshl_add_u32 v7, v6, 7, v7
    v_lshl_add_u32 v238, v1, 12, v7
    v_xor_b32 v239, 64, v238
    v_lshrrev_b32 v7, 2, v6
    v_lshl_add_u32 v7, v5, 3, v7
    v_lshlrev_b32 v7, 7, v7
    v_and_b32 v8, 3, v6
    v_lshl_add_u32 v7, v8, 3, v7
    v_lshrrev_b32 v8, 3, v6
    v_and_b32 v9, 1, v5
    v_lshl_or_b32 v8, v9, 1, v8
    v_xor_b32 v9, 0, v8
    v_lshl_add_u32 v240, v9, 5, v7
    v_xor_b32 v9, 1, v8
    v_lshl_add_u32 v241, v9, 5, v7
    v_xor_b32 v9, 2, v8
    v_lshl_add_u32 v242, v9, 5, v7
    v_xor_b32 v9, 3, v8
    v_lshl_add_u32 v243, v9, 5, v7
    v_mov_b32 v244, v224
    v_mov_b32 v246, 1
    v_bfrev_b32 v245, 1
    v_cmp_eq_u32 vcc, 0, v0
    s_and_b32 s8, s2, 7
    s_lshr_b32 s9, s2, 3
    v_cndmask_b32 v245, v245, 0, vcc
    s_lshr_b32 s10, s8, 1
    s_lshl_b32 s10, s10, 2
    s_and_b32 s6, s9, 3
    s_add_u32 s6, s6, s10
    s_and_b32 s10, s8, 1
    s_lshl_b32 s10, s10, 3
    s_lshr_b32 s7, s9, 2
    s_add_u32 s7, s7, s10
    s_lshl_b32 s20, s3, 18
    s_lshl_b32 s11, s4, 8
    s_add_u32 s20, s20, s11
    s_waitcnt lgkmcnt(0)
    s_getpc_b64 s[0:1]
L_PC:
    s_sub_u32 s0, s0, L_PC-concat_heads__compressed_kv_cla__linear_attn_block__prompt_kernel
    s_subb_u32 s1, s1, 0
    s_lshr_b32 s89, s2, 1
    s_and_b32 s89, s89, 12
    s_add_u32 s89, s89, s3
    s_lshl_b32 s89, s89, 13
    v_lshl_add_u32 v253, v224, 3, s89
    v_min_u32 v253, L_LAST-concat_heads__compressed_kv_cla__linear_attn_block__prompt_kernel-4, v253
    global_load_dword v253, v253, s[0:1]
    s_add_u32 m0, s16, 49152
    s_add_u32 s14, s18, s36
    buffer_load_dwordx4 v226, s[40:43], s14 offen offset:0 lds
    buffer_load_dwordx4 v227, s[40:43], s14 offen offset:1024 lds
    buffer_load_dwordx4 v228, s[40:43], s14 offen offset:2048 lds
    buffer_load_dwordx4 v229, s[40:43], s14 offen offset:3072 lds
    s_add_u32 m0, s16, 65536
    s_add_u32 s14, s34, s36
    buffer_load_dwordx4 v226, s[40:43], s14 offen offset:0 lds
    s_add_u32 s36, s36, 128
    s_and_b32 s36, s36, 1023
    buffer_load_dwordx4 v227, s[40:43], s14 offen offset:1024 lds
    buffer_load_dwordx4 v228, s[40:43], s14 offen offset:2048 lds
    buffer_load_dwordx4 v229, s[40:43], s14 offen offset:3072 lds
    s_add_u32 m0, s17, 81920
    s_add_u32 s14, s19, s37
    buffer_load_dwordx4 v234, s[44:47], s14 offen offset:0 nt lds
    s_add_u32 s37, s37, 524288
    s_and_b32 s37, s37, 4194303
    buffer_load_dwordx4 v235, s[44:47], s14 offen offset:1024 nt lds
    buffer_load_dwordx4 v236, s[44:47], s14 offen offset:2048 nt lds
    buffer_load_dwordx4 v237, s[44:47], s14 offen offset:3072 nt lds
    s_add_u32 m0, s16, 98304
    s_add_u32 s14, s18, s36
    buffer_load_dwordx4 v226, s[40:43], s14 offen offset:0 lds
    buffer_load_dwordx4 v227, s[40:43], s14 offen offset:1024 lds
    buffer_load_dwordx4 v228, s[40:43], s14 offen offset:2048 lds
    buffer_load_dwordx4 v229, s[40:43], s14 offen offset:3072 lds
    s_add_u32 m0, s16, 114688
    s_add_u32 s14, s34, s36
    buffer_load_dwordx4 v226, s[40:43], s14 offen offset:0 lds
    s_add_u32 s36, s36, 128
    s_and_b32 s36, s36, 1023
    buffer_load_dwordx4 v227, s[40:43], s14 offen offset:1024 lds
    buffer_load_dwordx4 v228, s[40:43], s14 offen offset:2048 lds
    buffer_load_dwordx4 v229, s[40:43], s14 offen offset:3072 lds
    s_add_u32 m0, s17, 131072
    s_add_u32 s14, s19, s37
    buffer_load_dwordx4 v234, s[44:47], s14 offen offset:0 nt lds
    s_add_u32 s37, s37, 524288
    s_and_b32 s37, s37, 4194303
    buffer_load_dwordx4 v235, s[44:47], s14 offen offset:1024 nt lds
    buffer_load_dwordx4 v236, s[44:47], s14 offen offset:2048 nt lds
    buffer_load_dwordx4 v237, s[44:47], s14 offen offset:3072 nt lds
    s_add_u32 m0, s16, 147456
    s_add_u32 s14, s18, s36
    buffer_load_dwordx4 v226, s[40:43], s14 offen offset:0 lds
    buffer_load_dwordx4 v227, s[40:43], s14 offen offset:1024 lds
    buffer_load_dwordx4 v228, s[40:43], s14 offen offset:2048 lds
    buffer_load_dwordx4 v229, s[40:43], s14 offen offset:3072 lds
    s_mul_i32 s25, s4, 1064960
    s_mul_i32 s8, s5, 131072
    s_add_u32 s25, s25, s8
    s_mul_i32 s8, s3, 32768
    s_add_u32 s25, s25, s8
    s_add_u32 s25, s25, 0
    s_lshl_b32 s8, s4, 7
    s_lshl_b32 s9, s5, 2
    s_add_u32 s26, s8, s9
    s_add_u32 s26, s26, 59047936
    s_and_b32 s8, s4, 3
    s_lshr_b32 s8, 0, s8
    s_and_b32 s8, s8, 1
    s_lshl_b32 s39, s8, 12
    s_lshl_b32 s8, s8, 7
    s_add_u32 s20, s20, s8
    s_mov_b32 s99, s4
    s_and_b32 s8, s2, 7
    s_lshr_b32 s10, s2, 6
    s_lshl_b32 s4, s8, 2
    s_add_u32 s4, s4, s10
    s_bfe_u32 s5, s2, 0x30003
    s_sub_u32 s99, s4, s99
    s_lshl_b32 s99, s99, 8
    s_lshl_b32 s32, s5, 2
    s_add_u32 s32, s32, s3
    s_sub_u32 s33, 63, s32
    s_mul_i32 s21, s32, 36864
    s_mul_i32 s22, s33, 36864
    s_lshl_b32 s8, s6, 2
    s_add_u32 s8, s8, s3
    s_mul_i32 s23, s8, 36864
    s_mul_i32 s24, s7, 147456
    s_add_u32 s24, s24, 52428800
    s_lshl_b32 s8, s7, 7
    s_lshl_b32 s9, s6, 2
    s_add_u32 s27, s8, s9
    s_add_u32 s27, s27, 59052032
    s_lshr_b32 s8, s4, 3
    s_lshl_b32 s8, s8, 7
    s_and_b32 s9, s4, 7
    s_lshl_b32 s9, s9, 2
    s_add_u32 s8, s8, s9
    s_add_u32 s8, s8, 59056128
    s_lshl_b32 s9, s5, 9
    s_add_u32 s28, s8, s9
    s_add_u32 s8, s8, 7680
    s_sub_u32 s29, s8, s9
    s_lshr_b32 s8, s2, 4
    s_lshl_b32 s8, s8, 7
    s_and_b32 s9, s2, 15
    s_lshl_b32 s9, s9, 2
    s_add_u32 s8, s8, s9
    s_add_u32 s30, s8, 59064320
    s_add_u32 s38, s8, 59054080
    s_lshl_b32 s8, s2, 2
    s_add_u32 s8, s8, s3
    s_lshl_b32 s9, s8, 10
    s_add_u32 s9, s9, 59047936
    s_cmp_lt_u32 s8, 20
    s_cselect_b32 s9, s9, 0x80000000
    v_mov_b64 v[216:217], 0
    v_mov_b64 v[218:219], 0
    s_lshl_b32 s8, s2, 2
    s_min_u32 s35, s8, 256
    buffer_store_dwordx4 v[216:219], v224, s[64:67], s9 offen sc1
    s_mov_b32 s31, 0x3e0293ee
    s_and_b32 s8, s6, 3
    s_lshl_b32 s8, s8, 1
    s_and_b32 s9, s7, 7
    s_add_u32 s8, s8, s9
    s_sub_u32 s9, s8, 9
    s_min_u32 s94, s8, s9
    s_and_b32 s8, s4, 3
    s_lshl_b32 s8, s8, 1
    s_and_b32 s9, s5, 7
    s_add_u32 s8, s8, s9
    s_sub_u32 s9, s8, 9
    s_min_u32 s95, s8, s9
    s_waitcnt vmcnt(30)
    s_waitcnt lgkmcnt(0)
    s_barrier
    ds_read_b64_tr_b16 v[128:129], v240 offset:32768
    ds_read_b64_tr_b16 v[130:131], v240 offset:33280
    ds_read_b64_tr_b16 v[132:133], v240 offset:36864
    ds_read_b64_tr_b16 v[134:135], v240 offset:37376
    ds_read_b128 a[0:3], v238 offset:0
    ds_read_b128 a[16:19], v239 offset:0
    ds_read_b128 a[4:7], v238 offset:2048
    ds_read_b128 a[20:23], v239 offset:2048
    ds_read_b128 a[8:11], v238 offset:16384
    ds_read_b128 a[24:27], v239 offset:16384
    ds_read_b128 a[12:15], v238 offset:18432
    ds_read_b128 a[28:31], v239 offset:18432
    ds_read_b64_tr_b16 v[136:137], v241 offset:32768
    ds_read_b64_tr_b16 v[138:139], v241 offset:33280
    ds_read_b64_tr_b16 v[140:141], v241 offset:36864
    ds_read_b64_tr_b16 v[142:143], v241 offset:37376
    s_waitcnt lgkmcnt(4)
    v_mfma_f32_16x16x32_bf16 v[0:3], v[128:131], a[0:3], 0
    ds_read_b64_tr_b16 v[144:145], v242 offset:32768
    ds_read_b64_tr_b16 v[146:147], v242 offset:33280
    v_mfma_f32_16x16x32_bf16 v[0:3], v[132:135], a[16:19], v[0:3]
    ds_read_b64_tr_b16 v[148:149], v242 offset:36864
    ds_read_b64_tr_b16 v[150:151], v242 offset:37376
    v_mfma_f32_16x16x32_bf16 v[32:35], v[132:135], a[20:23], 0
    ds_read_b64_tr_b16 v[152:153], v243 offset:32768
    ds_read_b64_tr_b16 v[154:155], v243 offset:33280
    ds_read_b64_tr_b16 v[156:157], v243 offset:36864
    ds_read_b64_tr_b16 v[158:159], v243 offset:37376
    ds_read_b64_tr_b16 v[160:161], v240 offset:40960
    ds_read_b64_tr_b16 v[162:163], v240 offset:41472
    ds_read_b64_tr_b16 v[164:165], v240 offset:45056
    ds_read_b64_tr_b16 v[166:167], v240 offset:45568
    ds_read_b64_tr_b16 v[168:169], v241 offset:40960
    ds_read_b64_tr_b16 v[170:171], v241 offset:41472
    ds_read_b64_tr_b16 v[172:173], v241 offset:45056
    ds_read_b64_tr_b16 v[174:175], v241 offset:45568
    ds_read_b64_tr_b16 v[176:177], v242 offset:40960
    ds_read_b64_tr_b16 v[178:179], v242 offset:41472
    ds_read_b64_tr_b16 v[180:181], v242 offset:45056
    ds_read_b64_tr_b16 v[182:183], v242 offset:45568
    ds_read_b64_tr_b16 v[184:185], v243 offset:40960
    ds_read_b64_tr_b16 v[186:187], v243 offset:41472
    ds_read_b64_tr_b16 v[188:189], v243 offset:45056
    ds_read_b64_tr_b16 v[190:191], v243 offset:45568
    v_mfma_f32_16x16x32_bf16 v[32:35], v[128:131], a[4:7], v[32:35]
    v_mfma_f32_16x16x32_bf16 v[64:67], v[128:131], a[8:11], 0
    v_mfma_f32_16x16x32_bf16 v[64:67], v[132:135], a[24:27], v[64:67]
    v_mfma_f32_16x16x32_bf16 v[96:99], v[132:135], a[28:31], 0
    v_mfma_f32_16x16x32_bf16 v[96:99], v[128:131], a[12:15], v[96:99]
    s_waitcnt lgkmcnt(15)
    v_mfma_f32_16x16x32_bf16 v[100:103], v[136:139], a[12:15], 0
    v_mfma_f32_16x16x32_bf16 v[100:103], v[140:143], a[28:31], v[100:103]
    v_mfma_f32_16x16x32_bf16 v[68:71], v[140:143], a[24:27], 0
    s_waitcnt vmcnt(17)
    s_waitcnt lgkmcnt(0)
    s_barrier
    v_mfma_f32_16x16x32_bf16 v[68:71], v[136:139], a[8:11], v[68:71]
    s_add_u32 m0, s16, 0
    s_add_u32 s14, s34, s36
    v_mfma_f32_16x16x32_bf16 v[36:39], v[136:139], a[4:7], 0
    s_lshr_b32 s8, s2, 4
    s_and_b32 s9, s2, 15
    s_mul_i32 s9, s9, 9
    v_mfma_f32_16x16x32_bf16 v[36:39], v[140:143], a[20:23], v[36:39]
    s_add_u32 s9, s9, s3
    s_mul_i32 s10, s8, 72
    v_add_u32 v240, 0x14000, v240
    v_mfma_f32_16x16x32_bf16 v[4:7], v[140:143], a[16:19], 0
    buffer_load_dwordx4 v226, s[40:43], s14 offen offset:0 lds
    v_mfma_f32_16x16x32_bf16 v[4:7], v[136:139], a[0:3], v[4:7]
    ds_read_b64_tr_b16 v[128:129], v240 offset:0
    v_bfe_u32 v248, v224, 4, 4
    v_mfma_f32_16x16x32_bf16 v[8:11], v[144:147], a[0:3], 0
    s_add_u32 s36, s36, 128
    s_and_b32 s36, s36, 1023
    ds_read_b64_tr_b16 v[130:131], v240 offset:512
    v_mfma_f32_16x16x32_bf16 v[8:11], v[148:151], a[16:19], v[8:11]
    buffer_load_dwordx4 v227, s[40:43], s14 offen offset:1024 lds
    v_mfma_f32_16x16x32_bf16 v[40:43], v[148:151], a[20:23], 0
    ds_read_b64_tr_b16 v[132:133], v240 offset:4096
    v_lshrrev_b32 v249, 8, v224
    v_mfma_f32_16x16x32_bf16 v[40:43], v[144:147], a[4:7], v[40:43]
    ds_read_b64_tr_b16 v[134:135], v240 offset:4608
    v_mul_u32_u24 v249, 27648, v249
    v_mfma_f32_16x16x32_bf16 v[72:75], v[144:147], a[8:11], 0
    s_add_u32 s11, s9, 0
    s_and_b32 s12, s11, 7
    s_lshr_b32 s13, s11, 3
    v_mfma_f32_16x16x32_bf16 v[72:75], v[148:151], a[24:27], v[72:75]
    s_lshl_b32 s96, s11, 10
    s_mul_i32 s11, s8, 147456
    s_add_u32 s96, s96, s11
    v_mfma_f32_16x16x32_bf16 v[104:107], v[148:151], a[28:31], 0
    s_add_u32 s96, s96, 52428800
    s_lshl_b32 s12, s12, 4
    ds_read_b128 a[32:35], v238 offset:49152
    v_mfma_f32_16x16x32_bf16 v[104:107], v[144:147], a[12:15], v[104:107]
    buffer_load_dwordx4 v228, s[40:43], s14 offen offset:2048 lds
    v_mfma_f32_16x16x32_bf16 v[108:111], v[152:155], a[12:15], 0
    ds_read_b128 a[48:51], v239 offset:49152
    v_add_u32 v250, s12, v248
    v_mfma_f32_16x16x32_bf16 v[108:111], v[156:159], a[28:31], v[108:111]
    ds_read_b128 a[36:39], v238 offset:51200
    v_add_u32 v251, 576, v250
    v_mfma_f32_16x16x32_bf16 v[76:79], v[156:159], a[24:27], 0
    buffer_load_dwordx4 v229, s[40:43], s14 offen offset:3072 lds
    v_mfma_f32_16x16x32_bf16 v[76:79], v[152:155], a[8:11], v[76:79]
    ds_read_b128 a[52:55], v239 offset:51200
    v_add_u32 v238, 0x10000, v238
    v_mfma_f32_16x16x32_bf16 v[44:47], v[152:155], a[4:7], 0
    ds_read_b128 a[40:43], v238 offset:0
    v_add_u32 v239, 0x10000, v239
    v_mfma_f32_16x16x32_bf16 v[44:47], v[156:159], a[20:23], v[44:47]
    ds_read_b128 a[56:59], v239 offset:0
    v_add_u32 v252, 1116, v250
    v_mfma_f32_16x16x32_bf16 v[12:15], v[156:159], a[16:19], 0
    ds_read_b128 a[44:47], v238 offset:2048
    v_cmp_gt_u32 vcc, 36, v250
    v_mfma_f32_16x16x32_bf16 v[12:15], v[152:155], a[0:3], v[12:15]
    s_add_u32 m0, s17, 16384
    s_add_u32 s14, s19, s37
    v_mfma_f32_16x16x32_bf16 v[16:19], v[160:163], a[0:3], 0
    buffer_load_dwordx4 v234, s[44:47], s14 offen offset:0 nt lds
    v_mfma_f32_16x16x32_bf16 v[16:19], v[164:167], a[16:19], v[16:19]
    ds_read_b128 a[60:63], v239 offset:2048
    v_add_u32 v241, 0x14000, v241
    v_mfma_f32_16x16x32_bf16 v[48:51], v[164:167], a[20:23], 0
    ds_read_b64_tr_b16 v[136:137], v241 offset:0
    v_subrev_u32 v253, 80, v250
    v_mfma_f32_16x16x32_bf16 v[48:51], v[160:163], a[4:7], v[48:51]
    s_nop 0
    ds_read_b64_tr_b16 v[138:139], v241 offset:512
    v_cndmask_b32 v251, v252, v251, vcc
    v_mfma_f32_16x16x32_bf16 v[80:83], v[160:163], a[8:11], 0
    s_add_u32 s37, s37, 524288
    s_and_b32 s37, s37, 4194303
    ds_read_b64_tr_b16 v[140:141], v241 offset:4096
    v_mfma_f32_16x16x32_bf16 v[80:83], v[164:167], a[24:27], v[80:83]
    buffer_load_dwordx4 v235, s[44:47], s14 offen offset:1024 nt lds
    v_mfma_f32_16x16x32_bf16 v[112:115], v[164:167], a[28:31], 0
    ds_read_b64_tr_b16 v[142:143], v241 offset:4608
    v_add_u32 v242, 0x14000, v242
    v_mfma_f32_16x16x32_bf16 v[112:115], v[160:163], a[12:15], v[112:115]
    ds_read_b64_tr_b16 v[144:145], v242 offset:0
    v_cmp_gt_u32 vcc, 72, v250
    v_mfma_f32_16x16x32_bf16 v[116:119], v[168:171], a[12:15], 0
    ds_read_b64_tr_b16 v[146:147], v242 offset:512
    v_mov_b32 v252, 0x20000000
    v_mfma_f32_16x16x32_bf16 v[116:119], v[172:175], a[28:31], v[116:119]
    s_nop 0
    buffer_load_dwordx4 v236, s[44:47], s14 offen offset:2048 nt lds
    v_mfma_f32_16x16x32_bf16 v[84:87], v[172:175], a[24:27], 0
    ds_read_b64_tr_b16 v[148:149], v242 offset:4096
    v_cndmask_b32 v251, v252, v251, vcc
    v_mfma_f32_16x16x32_bf16 v[84:87], v[168:171], a[8:11], v[84:87]
    ds_read_b64_tr_b16 v[150:151], v242 offset:4608
    v_add_u32 v243, 0x14000, v243
    v_mfma_f32_16x16x32_bf16 v[52:55], v[168:171], a[4:7], 0
    ds_read_b64_tr_b16 v[152:153], v243 offset:0
    v_cmp_gt_u32 vcc, 36, v253
    v_mfma_f32_16x16x32_bf16 v[52:55], v[172:175], a[20:23], v[52:55]
    s_mul_i32 s13, s13, 110592
    s_add_u32 s13, s13, s10
    ds_read_b64_tr_b16 v[154:155], v243 offset:512
    v_mfma_f32_16x16x32_bf16 v[20:23], v[172:175], a[16:19], 0
    buffer_load_dwordx4 v237, s[44:47], s14 offen offset:3072 nt lds
    v_mfma_f32_16x16x32_bf16 v[20:23], v[168:171], a[0:3], v[20:23]
    ds_read_b64_tr_b16 v[156:157], v243 offset:4096
    v_cndmask_b32 v251, v251, v253, vcc
    v_mfma_f32_16x16x32_bf16 v[24:27], v[176:179], a[0:3], 0
    ds_read_b64_tr_b16 v[158:159], v243 offset:4608
    v_lshl_add_u32 v251, v251, 1, v249
    v_mfma_f32_16x16x32_bf16 v[24:27], v[180:183], a[16:19], v[24:27]
    ds_read_b64_tr_b16 v[160:161], v240 offset:8192
    v_mfma_f32_16x16x32_bf16 v[56:59], v[180:183], a[20:23], 0
    ds_read_b64_tr_b16 v[162:163], v240 offset:8704
    v_mfma_f32_16x16x32_bf16 v[56:59], v[176:179], a[4:7], v[56:59]
    s_add_u32 m0, s16, 32768
    s_add_u32 s14, s18, s36
    ds_read_b64_tr_b16 v[164:165], v240 offset:12288
    v_mfma_f32_16x16x32_bf16 v[88:91], v[176:179], a[8:11], 0
    buffer_load_dwordx4 v226, s[40:43], s14 offen offset:0 lds
    v_mfma_f32_16x16x32_bf16 v[88:91], v[180:183], a[24:27], v[88:91]
    ds_read_b64_tr_b16 v[166:167], v240 offset:12800
    v_mfma_f32_16x16x32_bf16 v[120:123], v[180:183], a[28:31], 0
    ds_read_b64_tr_b16 v[168:169], v241 offset:8192
    v_mfma_f32_16x16x32_bf16 v[120:123], v[176:179], a[12:15], v[120:123]
    ds_read_b64_tr_b16 v[170:171], v241 offset:8704
    v_mfma_f32_16x16x32_bf16 v[124:127], v[184:187], a[12:15], 0
    buffer_load_dwordx4 v227, s[40:43], s14 offen offset:1024 lds
    v_mfma_f32_16x16x32_bf16 v[124:127], v[188:191], a[28:31], v[124:127]
    ds_read_b64_tr_b16 v[172:173], v241 offset:12288
    v_mfma_f32_16x16x32_bf16 v[92:95], v[188:191], a[24:27], 0
    ds_read_b64_tr_b16 v[174:175], v241 offset:12800
    v_mfma_f32_16x16x32_bf16 v[92:95], v[184:187], a[8:11], v[92:95]
    ds_read_b64_tr_b16 v[176:177], v242 offset:8192
    v_mfma_f32_16x16x32_bf16 v[60:63], v[184:187], a[4:7], 0
    ds_read_b64_tr_b16 v[178:179], v242 offset:8704
    v_mfma_f32_16x16x32_bf16 v[60:63], v[188:191], a[20:23], v[60:63]
    ds_read_b64_tr_b16 v[180:181], v242 offset:12288
    v_mfma_f32_16x16x32_bf16 v[28:31], v[188:191], a[16:19], 0
    ds_read_b64_tr_b16 v[182:183], v242 offset:12800
    v_mfma_f32_16x16x32_bf16 v[28:31], v[184:187], a[0:3], v[28:31]
    s_waitcnt lgkmcnt(15)
    ds_read_b64_tr_b16 v[184:185], v243 offset:8192
    v_mfma_f32_16x16x32_bf16 v[0:3], v[128:131], a[32:35], v[0:3]
    ds_read_b64_tr_b16 v[186:187], v243 offset:8704
    ds_read_b64_tr_b16 v[188:189], v243 offset:12288
    v_mfma_f32_16x16x32_bf16 v[0:3], v[132:135], a[48:51], v[0:3]
    ds_read_b64_tr_b16 v[190:191], v243 offset:12800
    v_mfma_f32_16x16x32_bf16 v[32:35], v[132:135], a[52:55], v[32:35]
    buffer_load_dwordx4 v228, s[40:43], s14 offen offset:2048 lds
    v_mfma_f32_16x16x32_bf16 v[32:35], v[128:131], a[36:39], v[32:35]
    v_mfma_f32_16x16x32_bf16 v[64:67], v[128:131], a[40:43], v[64:67]
    v_mfma_f32_16x16x32_bf16 v[64:67], v[132:135], a[56:59], v[64:67]
    buffer_load_ushort v192, v251, s[68:71], s13 offen
    s_add_u32 s13, s13, 3456
    v_mfma_f32_16x16x32_bf16 v[96:99], v[132:135], a[60:63], v[96:99]
    v_mfma_f32_16x16x32_bf16 v[96:99], v[128:131], a[44:47], v[96:99]
    buffer_load_ushort v193, v251, s[68:71], s13 offen
    s_add_u32 s13, s13, 3456
    buffer_load_ushort v194, v251, s[68:71], s13 offen
    s_add_u32 s13, s13, 3456
    buffer_load_ushort v195, v251, s[68:71], s13 offen
    s_add_u32 s13, s13, 3456
    buffer_load_ushort v196, v251, s[68:71], s13 offen
    s_add_u32 s13, s13, 3456
    buffer_load_ushort v197, v251, s[68:71], s13 offen
    s_add_u32 s13, s13, 3456
    buffer_load_ushort v198, v251, s[68:71], s13 offen
    s_add_u32 s13, s13, 3456
    buffer_load_ushort v199, v251, s[68:71], s13 offen
    s_add_u32 s11, s9, 4
    s_and_b32 s12, s11, 7
    s_lshr_b32 s13, s11, 3
    s_lshl_b32 s97, s11, 10
    s_mul_i32 s11, s8, 147456
    s_add_u32 s97, s97, s11
    s_add_u32 s97, s97, 52428800
    s_lshl_b32 s12, s12, 4
    v_add_u32 v250, s12, v248
    v_add_u32 v251, 576, v250
    v_add_u32 v252, 1116, v250
    v_cmp_gt_u32 vcc, 36, v250
    v_subrev_u32 v253, 80, v250
    s_nop 0
    v_cndmask_b32 v251, v252, v251, vcc
    v_cmp_gt_u32 vcc, 72, v250
    v_mov_b32 v252, 0x20000000
    s_nop 0
    v_cndmask_b32 v251, v252, v251, vcc
    v_cmp_gt_u32 vcc, 36, v253
    s_mul_i32 s13, s13, 110592
    s_add_u32 s13, s13, s10
    v_cndmask_b32 v251, v251, v253, vcc
    v_lshl_add_u32 v251, v251, 1, v249
    buffer_load_ushort v200, v251, s[68:71], s13 offen
    s_add_u32 s13, s13, 3456
    buffer_load_ushort v201, v251, s[68:71], s13 offen
    s_add_u32 s13, s13, 3456
    buffer_load_ushort v202, v251, s[68:71], s13 offen
    s_add_u32 s13, s13, 3456
    buffer_load_ushort v203, v251, s[68:71], s13 offen
    s_add_u32 s13, s13, 3456
    buffer_load_ushort v204, v251, s[68:71], s13 offen
    s_add_u32 s13, s13, 3456
    buffer_load_ushort v205, v251, s[68:71], s13 offen
    s_add_u32 s13, s13, 3456
    buffer_load_ushort v206, v251, s[68:71], s13 offen
    s_add_u32 s13, s13, 3456
    buffer_load_ushort v207, v251, s[68:71], s13 offen
    s_add_u32 s11, s9, 8
    s_and_b32 s12, s11, 7
    s_lshr_b32 s13, s11, 3
    s_lshl_b32 s98, s11, 10
    s_mul_i32 s11, s8, 147456
    s_add_u32 s98, s98, s11
    s_add_u32 s98, s98, 52428800
    s_min_u32 s11, s3, 1
    s_lshl_b32 s11, s11, 31
    s_or_b32 s98, s98, s11
    s_lshl_b32 s12, s12, 4
    v_add_u32 v250, s12, v248
    v_add_u32 v251, 576, v250
    v_add_u32 v252, 1116, v250
    v_cmp_gt_u32 vcc, 36, v250
    v_subrev_u32 v253, 80, v250
    s_nop 0
    v_cndmask_b32 v251, v252, v251, vcc
    v_cmp_gt_u32 vcc, 72, v250
    v_mov_b32 v252, 0x20000000
    s_nop 0
    v_cndmask_b32 v251, v252, v251, vcc
    v_cmp_gt_u32 vcc, 36, v253
    s_mul_i32 s13, s13, 110592
    s_add_u32 s13, s13, s10
    v_cndmask_b32 v251, v251, v253, vcc
    v_lshl_add_u32 v251, v251, 1, v249
    buffer_load_ushort v208, v251, s[68:71], s13 offen
    s_add_u32 s13, s13, 3456
    buffer_load_ushort v209, v251, s[68:71], s13 offen
    s_add_u32 s13, s13, 3456
    buffer_load_ushort v210, v251, s[68:71], s13 offen
    s_add_u32 s13, s13, 3456
    buffer_load_ushort v211, v251, s[68:71], s13 offen
    s_add_u32 s13, s13, 3456
    buffer_load_ushort v212, v251, s[68:71], s13 offen
    s_add_u32 s13, s13, 3456
    buffer_load_ushort v213, v251, s[68:71], s13 offen
    s_add_u32 s13, s13, 3456
    buffer_load_ushort v214, v251, s[68:71], s13 offen
    s_add_u32 s13, s13, 3456
    buffer_load_ushort v215, v251, s[68:71], s13 offen
    v_mfma_f32_16x16x32_bf16 v[100:103], v[136:139], a[44:47], v[100:103]
    buffer_load_dwordx4 v229, s[40:43], s14 offen offset:3072 lds
    v_mfma_f32_16x16x32_bf16 v[100:103], v[140:143], a[60:63], v[100:103]
    v_mfma_f32_16x16x32_bf16 v[68:71], v[140:143], a[56:59], v[68:71]
    s_waitcnt vmcnt(36)
    s_waitcnt lgkmcnt(0)
    s_barrier
    v_mfma_f32_16x16x32_bf16 v[68:71], v[136:139], a[40:43], v[68:71]
    s_cmp_lt_u32 s2, 5
    s_cselect_b32 s35, s35, 256
    ds_read_b64_tr_b16 v[128:129], v240 offset:49152
    v_mfma_f32_16x16x32_bf16 v[36:39], v[136:139], a[36:39], v[36:39]
    buffer_store_dword v246, v245, s[84:87], s35 offen sc1
    v_mfma_f32_16x16x32_bf16 v[36:39], v[140:143], a[52:55], v[36:39]
    ds_read_b64_tr_b16 v[130:131], v240 offset:49664
    v_mfma_f32_16x16x32_bf16 v[4:7], v[140:143], a[48:51], v[4:7]
    ds_read_b64_tr_b16 v[132:133], v240 offset:53248
    v_mfma_f32_16x16x32_bf16 v[4:7], v[136:139], a[32:35], v[4:7]
    ds_read_b64_tr_b16 v[134:135], v240 offset:53760
    v_mfma_f32_16x16x32_bf16 v[8:11], v[144:147], a[32:35], v[8:11]
    s_add_u32 m0, s16, 49152
    s_add_u32 s14, s34, s36
    ds_read_b128 a[64:67], v238 offset:32768
    v_mfma_f32_16x16x32_bf16 v[8:11], v[148:151], a[48:51], v[8:11]
    buffer_load_dwordx4 v226, s[40:43], s14 offen offset:0 lds
    v_mfma_f32_16x16x32_bf16 v[40:43], v[148:151], a[52:55], v[40:43]
    ds_read_b128 a[80:83], v239 offset:32768
    v_mfma_f32_16x16x32_bf16 v[40:43], v[144:147], a[36:39], v[40:43]
    ds_read_b128 a[68:71], v238 offset:34816
    v_mfma_f32_16x16x32_bf16 v[72:75], v[144:147], a[40:43], v[72:75]
    ds_read_b128 a[84:87], v239 offset:34816
    v_mfma_f32_16x16x32_bf16 v[72:75], v[148:151], a[56:59], v[72:75]
    s_add_u32 s36, s36, 128
    s_and_b32 s36, s36, 1023
    ds_read_b128 a[72:75], v238 offset:49152
    v_mfma_f32_16x16x32_bf16 v[104:107], v[148:151], a[60:63], v[104:107]
    buffer_load_dwordx4 v227, s[40:43], s14 offen offset:1024 lds
    v_mfma_f32_16x16x32_bf16 v[104:107], v[144:147], a[44:47], v[104:107]
    ds_read_b128 a[88:91], v239 offset:49152
    v_mfma_f32_16x16x32_bf16 v[108:111], v[152:155], a[44:47], v[108:111]
    ds_read_b128 a[76:79], v238 offset:51200
    v_mfma_f32_16x16x32_bf16 v[108:111], v[156:159], a[60:63], v[108:111]
    ds_read_b128 a[92:95], v239 offset:51200
    v_mfma_f32_16x16x32_bf16 v[76:79], v[156:159], a[56:59], v[76:79]
    buffer_load_dwordx4 v228, s[40:43], s14 offen offset:2048 lds
    v_mfma_f32_16x16x32_bf16 v[76:79], v[152:155], a[40:43], v[76:79]
    ds_read_b64_tr_b16 v[136:137], v241 offset:49152
    v_mfma_f32_16x16x32_bf16 v[44:47], v[152:155], a[36:39], v[44:47]
    ds_read_b64_tr_b16 v[138:139], v241 offset:49664
    v_mfma_f32_16x16x32_bf16 v[44:47], v[156:159], a[52:55], v[44:47]
    ds_read_b64_tr_b16 v[140:141], v241 offset:53248
    v_mfma_f32_16x16x32_bf16 v[12:15], v[156:159], a[48:51], v[12:15]
    ds_read_b64_tr_b16 v[142:143], v241 offset:53760
    v_mfma_f32_16x16x32_bf16 v[12:15], v[152:155], a[32:35], v[12:15]
    buffer_load_dwordx4 v229, s[40:43], s14 offen offset:3072 lds
    v_mfma_f32_16x16x32_bf16 v[16:19], v[160:163], a[32:35], v[16:19]
    ds_read_b64_tr_b16 v[144:145], v242 offset:49152
    v_mfma_f32_16x16x32_bf16 v[16:19], v[164:167], a[48:51], v[16:19]
    ds_read_b64_tr_b16 v[146:147], v242 offset:49664
    v_mfma_f32_16x16x32_bf16 v[48:51], v[164:167], a[52:55], v[48:51]
    ds_read_b64_tr_b16 v[148:149], v242 offset:53248
    v_mfma_f32_16x16x32_bf16 v[48:51], v[160:163], a[36:39], v[48:51]
    ds_read_b64_tr_b16 v[150:151], v242 offset:53760
    v_mfma_f32_16x16x32_bf16 v[80:83], v[160:163], a[40:43], v[80:83]
    s_add_u32 m0, s17, 65536
    s_add_u32 s14, s19, s37
    ds_read_b64_tr_b16 v[152:153], v243 offset:49152
    v_mfma_f32_16x16x32_bf16 v[80:83], v[164:167], a[56:59], v[80:83]
    buffer_load_dwordx4 v234, s[44:47], s14 offen offset:0 nt lds
    v_mfma_f32_16x16x32_bf16 v[112:115], v[164:167], a[60:63], v[112:115]
    ds_read_b64_tr_b16 v[154:155], v243 offset:49664
    v_mfma_f32_16x16x32_bf16 v[112:115], v[160:163], a[44:47], v[112:115]
    ds_read_b64_tr_b16 v[156:157], v243 offset:53248
    v_mfma_f32_16x16x32_bf16 v[116:119], v[168:171], a[44:47], v[116:119]
    ds_read_b64_tr_b16 v[158:159], v243 offset:53760
    v_mfma_f32_16x16x32_bf16 v[116:119], v[172:175], a[60:63], v[116:119]
    s_add_u32 s37, s37, 524288
    s_and_b32 s37, s37, 4194303
    ds_read_b64_tr_b16 v[160:161], v240 offset:57344
    v_mfma_f32_16x16x32_bf16 v[84:87], v[172:175], a[56:59], v[84:87]
    buffer_load_dwordx4 v235, s[44:47], s14 offen offset:1024 nt lds
    v_mfma_f32_16x16x32_bf16 v[84:87], v[168:171], a[40:43], v[84:87]
    ds_read_b64_tr_b16 v[162:163], v240 offset:57856
    v_mfma_f32_16x16x32_bf16 v[52:55], v[168:171], a[36:39], v[52:55]
    ds_read_b64_tr_b16 v[164:165], v240 offset:61440
    v_mfma_f32_16x16x32_bf16 v[52:55], v[172:175], a[52:55], v[52:55]
    ds_read_b64_tr_b16 v[166:167], v240 offset:61952
    v_mfma_f32_16x16x32_bf16 v[20:23], v[172:175], a[48:51], v[20:23]
    buffer_load_dwordx4 v236, s[44:47], s14 offen offset:2048 nt lds
    v_mfma_f32_16x16x32_bf16 v[20:23], v[168:171], a[32:35], v[20:23]
    ds_read_b64_tr_b16 v[168:169], v241 offset:57344
    v_mfma_f32_16x16x32_bf16 v[24:27], v[176:179], a[32:35], v[24:27]
    ds_read_b64_tr_b16 v[170:171], v241 offset:57856
    v_mfma_f32_16x16x32_bf16 v[24:27], v[180:183], a[48:51], v[24:27]
    ds_read_b64_tr_b16 v[172:173], v241 offset:61440
    v_mfma_f32_16x16x32_bf16 v[56:59], v[180:183], a[52:55], v[56:59]
    ds_read_b64_tr_b16 v[174:175], v241 offset:61952
    v_mfma_f32_16x16x32_bf16 v[56:59], v[176:179], a[36:39], v[56:59]
    buffer_load_dwordx4 v237, s[44:47], s14 offen offset:3072 nt lds
    v_mfma_f32_16x16x32_bf16 v[88:91], v[176:179], a[40:43], v[88:91]
    v_mfma_f32_16x16x32_bf16 v[88:91], v[180:183], a[56:59], v[88:91]
    v_mfma_f32_16x16x32_bf16 v[120:123], v[180:183], a[60:63], v[120:123]
    v_mfma_f32_16x16x32_bf16 v[120:123], v[176:179], a[44:47], v[120:123]
    ds_read_b64_tr_b16 v[176:177], v242 offset:57344
    v_mfma_f32_16x16x32_bf16 v[124:127], v[184:187], a[44:47], v[124:127]
    s_add_u32 m0, s16, 81920
    s_add_u32 s14, s18, s36
    ds_read_b64_tr_b16 v[178:179], v242 offset:57856
    v_mfma_f32_16x16x32_bf16 v[124:127], v[188:191], a[60:63], v[124:127]
    buffer_load_dwordx4 v226, s[40:43], s14 offen offset:0 lds
    v_mfma_f32_16x16x32_bf16 v[92:95], v[188:191], a[56:59], v[92:95]
    ds_read_b64_tr_b16 v[180:181], v242 offset:61440
    v_mfma_f32_16x16x32_bf16 v[92:95], v[184:187], a[40:43], v[92:95]
    ds_read_b64_tr_b16 v[182:183], v242 offset:61952
    v_mfma_f32_16x16x32_bf16 v[60:63], v[184:187], a[36:39], v[60:63]
    v_mfma_f32_16x16x32_bf16 v[60:63], v[188:191], a[52:55], v[60:63]
    buffer_load_dwordx4 v227, s[40:43], s14 offen offset:1024 lds
    v_mfma_f32_16x16x32_bf16 v[28:31], v[188:191], a[48:51], v[28:31]
    v_mfma_f32_16x16x32_bf16 v[28:31], v[184:187], a[32:35], v[28:31]
    s_waitcnt lgkmcnt(15)
    ds_read_b64_tr_b16 v[184:185], v243 offset:57344
    v_mfma_f32_16x16x32_bf16 v[0:3], v[128:131], a[64:67], v[0:3]
    ds_read_b64_tr_b16 v[186:187], v243 offset:57856
    ds_read_b64_tr_b16 v[188:189], v243 offset:61440
    v_mfma_f32_16x16x32_bf16 v[0:3], v[132:135], a[80:83], v[0:3]
    ds_read_b64_tr_b16 v[190:191], v243 offset:61952
    v_mfma_f32_16x16x32_bf16 v[32:35], v[132:135], a[84:87], v[32:35]
    buffer_load_dwordx4 v228, s[40:43], s14 offen offset:2048 lds
    v_mfma_f32_16x16x32_bf16 v[32:35], v[128:131], a[68:71], v[32:35]
    v_mfma_f32_16x16x32_bf16 v[64:67], v[128:131], a[72:75], v[64:67]
    v_mfma_f32_16x16x32_bf16 v[64:67], v[132:135], a[88:91], v[64:67]
    v_mfma_f32_16x16x32_bf16 v[96:99], v[132:135], a[92:95], v[96:99]
    v_mfma_f32_16x16x32_bf16 v[96:99], v[128:131], a[76:79], v[96:99]
    buffer_load_dwordx4 v229, s[40:43], s14 offen offset:3072 lds
    v_mfma_f32_16x16x32_bf16 v[100:103], v[136:139], a[76:79], v[100:103]
    v_mfma_f32_16x16x32_bf16 v[100:103], v[140:143], a[92:95], v[100:103]
    v_mfma_f32_16x16x32_bf16 v[68:71], v[140:143], a[88:91], v[68:71]
    s_waitcnt vmcnt(41)
    s_waitcnt lgkmcnt(0)
    s_barrier
    v_mfma_f32_16x16x32_bf16 v[68:71], v[136:139], a[72:75], v[68:71]
    s_waitcnt vmcnt(14)
    v_lshl_or_b32 v192, v193, 16, v192
    v_lshl_or_b32 v193, v195, 16, v194
    v_mfma_f32_16x16x32_bf16 v[36:39], v[136:139], a[68:71], v[36:39]
    s_add_u32 m0, s16, 98304
    s_add_u32 s14, s34, s36
    v_lshl_or_b32 v194, v197, 16, v196
    v_mfma_f32_16x16x32_bf16 v[36:39], v[140:143], a[84:87], v[36:39]
    buffer_load_dwordx4 v226, s[40:43], s14 offen offset:0 lds
    v_mfma_f32_16x16x32_bf16 v[4:7], v[140:143], a[80:83], v[4:7]
    v_lshl_or_b32 v195, v199, 16, v198
    v_add_u32 v240, 0xffff0000, v240
    v_mfma_f32_16x16x32_bf16 v[4:7], v[136:139], a[64:67], v[4:7]
    ds_read_b64_tr_b16 v[128:129], v240 offset:0
    v_mfma_f32_16x16x32_bf16 v[8:11], v[144:147], a[64:67], v[8:11]
    buffer_store_dwordx4 v[192:195], v224, s[64:67], s96 offen sc1
    v_mfma_f32_16x16x32_bf16 v[8:11], v[148:151], a[80:83], v[8:11]
    s_add_u32 s36, s36, 128
    s_and_b32 s36, s36, 1023
    ds_read_b64_tr_b16 v[130:131], v240 offset:512
    v_mfma_f32_16x16x32_bf16 v[40:43], v[148:151], a[84:87], v[40:43]
    ds_read_b64_tr_b16 v[132:133], v240 offset:4096
    v_lshl_or_b32 v200, v201, 16, v200
    v_mfma_f32_16x16x32_bf16 v[40:43], v[144:147], a[68:71], v[40:43]
    buffer_load_dwordx4 v227, s[40:43], s14 offen offset:1024 lds
    v_mfma_f32_16x16x32_bf16 v[72:75], v[144:147], a[72:75], v[72:75]
    ds_read_b64_tr_b16 v[134:135], v240 offset:4608
    v_lshl_or_b32 v201, v203, 16, v202
    v_mfma_f32_16x16x32_bf16 v[72:75], v[148:151], a[88:91], v[72:75]
    v_lshl_or_b32 v202, v205, 16, v204
    v_lshl_or_b32 v203, v207, 16, v206
    v_mfma_f32_16x16x32_bf16 v[104:107], v[148:151], a[92:95], v[104:107]
    buffer_load_dwordx4 v228, s[40:43], s14 offen offset:2048 lds
    v_mfma_f32_16x16x32_bf16 v[104:107], v[144:147], a[76:79], v[104:107]
    v_add_u32 v238, 0x14000, v238
    v_mfma_f32_16x16x32_bf16 v[108:111], v[152:155], a[76:79], v[108:111]
    ds_read_b128 a[96:99], v238 offset:0
    v_add_u32 v239, 0x14000, v239
    v_mfma_f32_16x16x32_bf16 v[108:111], v[156:159], a[92:95], v[108:111]
    buffer_store_dwordx4 v[200:203], v224, s[64:67], s97 offen sc1
    v_mfma_f32_16x16x32_bf16 v[76:79], v[156:159], a[88:91], v[76:79]
    ds_read_b128 a[112:115], v239 offset:0
    v_lshl_or_b32 v208, v209, 16, v208
    v_mfma_f32_16x16x32_bf16 v[76:79], v[152:155], a[72:75], v[76:79]
    ds_read_b128 a[100:103], v238 offset:2048
    v_lshl_or_b32 v209, v211, 16, v210
    v_mfma_f32_16x16x32_bf16 v[44:47], v[152:155], a[68:71], v[44:47]
    buffer_load_dwordx4 v229, s[40:43], s14 offen offset:3072 lds
    v_mfma_f32_16x16x32_bf16 v[44:47], v[156:159], a[84:87], v[44:47]
    ds_read_b128 a[116:119], v239 offset:2048
    v_lshl_or_b32 v210, v213, 16, v212
    v_mfma_f32_16x16x32_bf16 v[12:15], v[156:159], a[80:83], v[12:15]
    v_lshl_or_b32 v211, v215, 16, v214
    v_add_u32 v238, 0xfffdc000, v238
    v_mfma_f32_16x16x32_bf16 v[12:15], v[152:155], a[64:67], v[12:15]
    buffer_store_dwordx4 v[208:211], v224, s[64:67], s98 offen sc1
    v_mfma_f32_16x16x32_bf16 v[16:19], v[160:163], a[64:67], v[16:19]
    s_add_u32 m0, s17, 114688
    s_add_u32 s14, s19, s37
    ds_read_b128 a[104:107], v238 offset:0
    v_mfma_f32_16x16x32_bf16 v[16:19], v[164:167], a[80:83], v[16:19]
    v_add_u32 v239, 0xfffdc000, v239
    v_mfma_f32_16x16x32_bf16 v[48:51], v[164:167], a[84:87], v[48:51]
    buffer_load_dwordx4 v234, s[44:47], s14 offen offset:0 nt lds
    v_mfma_f32_16x16x32_bf16 v[48:51], v[160:163], a[68:71], v[48:51]
    ds_read_b128 a[120:123], v239 offset:0
    v_mfma_f32_16x16x32_bf16 v[80:83], v[160:163], a[72:75], v[80:83]
    ds_read_b128 a[108:111], v238 offset:2048
    v_mfma_f32_16x16x32_bf16 v[80:83], v[164:167], a[88:91], v[80:83]
    s_add_u32 s37, s37, 524288
    s_and_b32 s37, s37, 4194303
    ds_read_b128 a[124:127], v239 offset:2048
    v_mfma_f32_16x16x32_bf16 v[112:115], v[164:167], a[92:95], v[112:115]
    buffer_load_dwordx4 v235, s[44:47], s14 offen offset:1024 nt lds
    v_mfma_f32_16x16x32_bf16 v[112:115], v[160:163], a[76:79], v[112:115]
    v_add_u32 v241, 0xffff0000, v241
    v_mfma_f32_16x16x32_bf16 v[116:119], v[168:171], a[76:79], v[116:119]
    ds_read_b64_tr_b16 v[136:137], v241 offset:0
    v_mfma_f32_16x16x32_bf16 v[116:119], v[172:175], a[92:95], v[116:119]
    ds_read_b64_tr_b16 v[138:139], v241 offset:512
    v_mfma_f32_16x16x32_bf16 v[84:87], v[172:175], a[88:91], v[84:87]
    buffer_load_dwordx4 v236, s[44:47], s14 offen offset:2048 nt lds
    v_mfma_f32_16x16x32_bf16 v[84:87], v[168:171], a[72:75], v[84:87]
    ds_read_b64_tr_b16 v[140:141], v241 offset:4096
    v_mfma_f32_16x16x32_bf16 v[52:55], v[168:171], a[68:71], v[52:55]
    ds_read_b64_tr_b16 v[142:143], v241 offset:4608
    v_add_u32 v242, 0xffff0000, v242
    v_mfma_f32_16x16x32_bf16 v[52:55], v[172:175], a[84:87], v[52:55]
    ds_read_b64_tr_b16 v[144:145], v242 offset:0
    v_mfma_f32_16x16x32_bf16 v[20:23], v[172:175], a[80:83], v[20:23]
    ds_read_b64_tr_b16 v[146:147], v242 offset:512
    v_mfma_f32_16x16x32_bf16 v[20:23], v[168:171], a[64:67], v[20:23]
    buffer_load_dwordx4 v237, s[44:47], s14 offen offset:3072 nt lds
    v_mfma_f32_16x16x32_bf16 v[24:27], v[176:179], a[64:67], v[24:27]
    ds_read_b64_tr_b16 v[148:149], v242 offset:4096
    v_mfma_f32_16x16x32_bf16 v[24:27], v[180:183], a[80:83], v[24:27]
    ds_read_b64_tr_b16 v[150:151], v242 offset:4608
    v_add_u32 v243, 0xffff0000, v243
    v_mfma_f32_16x16x32_bf16 v[56:59], v[180:183], a[84:87], v[56:59]
    ds_read_b64_tr_b16 v[152:153], v243 offset:0
    v_mfma_f32_16x16x32_bf16 v[56:59], v[176:179], a[68:71], v[56:59]
    ds_read_b64_tr_b16 v[154:155], v243 offset:512
    v_mfma_f32_16x16x32_bf16 v[88:91], v[176:179], a[72:75], v[88:91]
    s_add_u32 m0, s16, 131072
    s_add_u32 s14, s18, s36
    ds_read_b64_tr_b16 v[156:157], v243 offset:4096
    v_mfma_f32_16x16x32_bf16 v[88:91], v[180:183], a[88:91], v[88:91]
    buffer_load_dwordx4 v226, s[40:43], s14 offen offset:0 lds
    v_mfma_f32_16x16x32_bf16 v[120:123], v[180:183], a[92:95], v[120:123]
    ds_read_b64_tr_b16 v[158:159], v243 offset:4608
    v_mfma_f32_16x16x32_bf16 v[120:123], v[176:179], a[76:79], v[120:123]
    ds_read_b64_tr_b16 v[160:161], v240 offset:8192
    v_mfma_f32_16x16x32_bf16 v[124:127], v[184:187], a[76:79], v[124:127]
    ds_read_b64_tr_b16 v[162:163], v240 offset:8704
    v_mfma_f32_16x16x32_bf16 v[124:127], v[188:191], a[92:95], v[124:127]
    buffer_load_dwordx4 v227, s[40:43], s14 offen offset:1024 lds
    v_mfma_f32_16x16x32_bf16 v[92:95], v[188:191], a[88:91], v[92:95]
    ds_read_b64_tr_b16 v[164:165], v240 offset:12288
    v_mfma_f32_16x16x32_bf16 v[92:95], v[184:187], a[72:75], v[92:95]
    ds_read_b64_tr_b16 v[166:167], v240 offset:12800
    v_mfma_f32_16x16x32_bf16 v[60:63], v[184:187], a[68:71], v[60:63]
    ds_read_b64_tr_b16 v[168:169], v241 offset:8192
    v_mfma_f32_16x16x32_bf16 v[60:63], v[188:191], a[84:87], v[60:63]
    ds_read_b64_tr_b16 v[170:171], v241 offset:8704
    v_mfma_f32_16x16x32_bf16 v[28:31], v[188:191], a[80:83], v[28:31]
    ds_read_b64_tr_b16 v[172:173], v241 offset:12288
    v_mfma_f32_16x16x32_bf16 v[28:31], v[184:187], a[64:67], v[28:31]
    s_waitcnt lgkmcnt(15)
    ds_read_b64_tr_b16 v[174:175], v241 offset:12800
    v_mfma_f32_16x16x32_bf16 v[0:3], v[128:131], a[96:99], v[0:3]
    ds_read_b64_tr_b16 v[176:177], v242 offset:8192
    ds_read_b64_tr_b16 v[178:179], v242 offset:8704
    v_mfma_f32_16x16x32_bf16 v[0:3], v[132:135], a[112:115], v[0:3]
    ds_read_b64_tr_b16 v[180:181], v242 offset:12288
    ds_read_b64_tr_b16 v[182:183], v242 offset:12800
    v_mfma_f32_16x16x32_bf16 v[32:35], v[132:135], a[116:119], v[32:35]
    ds_read_b64_tr_b16 v[184:185], v243 offset:8192
    ds_read_b64_tr_b16 v[186:187], v243 offset:8704
    ds_read_b64_tr_b16 v[188:189], v243 offset:12288
    ds_read_b64_tr_b16 v[190:191], v243 offset:12800
    v_mfma_f32_16x16x32_bf16 v[32:35], v[128:131], a[100:103], v[32:35]
    buffer_load_dwordx4 v228, s[40:43], s14 offen offset:2048 lds
    v_mfma_f32_16x16x32_bf16 v[64:67], v[128:131], a[104:107], v[64:67]
    v_mfma_f32_16x16x32_bf16 v[64:67], v[132:135], a[120:123], v[64:67]
    v_mfma_f32_16x16x32_bf16 v[96:99], v[132:135], a[124:127], v[96:99]
    buffer_load_dwordx4 v229, s[40:43], s14 offen offset:3072 lds
    v_mfma_f32_16x16x32_bf16 v[96:99], v[128:131], a[108:111], v[96:99]
    v_mfma_f32_16x16x32_bf16 v[100:103], v[136:139], a[108:111], v[100:103]
    v_mfma_f32_16x16x32_bf16 v[100:103], v[140:143], a[124:127], v[100:103]
    v_mfma_f32_16x16x32_bf16 v[68:71], v[140:143], a[120:123], v[68:71]
    s_waitcnt vmcnt(19)
    s_waitcnt lgkmcnt(0)
    s_barrier
    v_mfma_f32_16x16x32_bf16 v[68:71], v[136:139], a[104:107], v[68:71]
    ds_read_b64_tr_b16 v[128:129], v240 offset:49152
    v_lshrrev_b32 v254, 2, v224
    v_mfma_f32_16x16x32_bf16 v[36:39], v[136:139], a[100:103], v[36:39]
    ds_read_b64_tr_b16 v[130:131], v240 offset:49664
    v_min_u32 v254, 16, v254
    v_mfma_f32_16x16x32_bf16 v[36:39], v[140:143], a[116:119], v[36:39]
    buffer_load_dword v247, v254, s[84:87], 0 offen sc1
    v_mfma_f32_16x16x32_bf16 v[4:7], v[140:143], a[112:115], v[4:7]
    ds_read_b64_tr_b16 v[132:133], v240 offset:53248
    v_mfma_f32_16x16x32_bf16 v[4:7], v[136:139], a[96:99], v[4:7]
    ds_read_b64_tr_b16 v[134:135], v240 offset:53760
    v_mfma_f32_16x16x32_bf16 v[8:11], v[144:147], a[96:99], v[8:11]
    s_add_u32 m0, s16, 147456
    s_add_u32 s14, s34, s36
    ds_read_b128 a[128:131], v238 offset:32768
    v_mfma_f32_16x16x32_bf16 v[8:11], v[148:151], a[112:115], v[8:11]
    buffer_load_dwordx4 v226, s[40:43], s14 offen offset:0 lds
    v_mfma_f32_16x16x32_bf16 v[40:43], v[148:151], a[116:119], v[40:43]
    ds_read_b128 a[144:147], v239 offset:32768
    v_mfma_f32_16x16x32_bf16 v[40:43], v[144:147], a[100:103], v[40:43]
    ds_read_b128 a[132:135], v238 offset:34816
    v_mfma_f32_16x16x32_bf16 v[72:75], v[144:147], a[104:107], v[72:75]
    ds_read_b128 a[148:151], v239 offset:34816
    v_mfma_f32_16x16x32_bf16 v[72:75], v[148:151], a[120:123], v[72:75]
    s_add_u32 s36, s36, 128
    s_and_b32 s36, s36, 1023
    ds_read_b128 a[136:139], v238 offset:49152
    v_mfma_f32_16x16x32_bf16 v[104:107], v[148:151], a[124:127], v[104:107]
    buffer_load_dwordx4 v227, s[40:43], s14 offen offset:1024 lds
    v_mfma_f32_16x16x32_bf16 v[104:107], v[144:147], a[108:111], v[104:107]
    ds_read_b128 a[152:155], v239 offset:49152
    v_mfma_f32_16x16x32_bf16 v[108:111], v[152:155], a[108:111], v[108:111]
    ds_read_b128 a[140:143], v238 offset:51200
    v_mfma_f32_16x16x32_bf16 v[108:111], v[156:159], a[124:127], v[108:111]
    ds_read_b128 a[156:159], v239 offset:51200
    v_mfma_f32_16x16x32_bf16 v[76:79], v[156:159], a[120:123], v[76:79]
    buffer_load_dwordx4 v228, s[40:43], s14 offen offset:2048 lds
    v_mfma_f32_16x16x32_bf16 v[76:79], v[152:155], a[104:107], v[76:79]
    ds_read_b64_tr_b16 v[136:137], v241 offset:49152
    v_mfma_f32_16x16x32_bf16 v[44:47], v[152:155], a[100:103], v[44:47]
    ds_read_b64_tr_b16 v[138:139], v241 offset:49664
    v_mfma_f32_16x16x32_bf16 v[44:47], v[156:159], a[116:119], v[44:47]
    ds_read_b64_tr_b16 v[140:141], v241 offset:53248
    v_mfma_f32_16x16x32_bf16 v[12:15], v[156:159], a[112:115], v[12:15]
    ds_read_b64_tr_b16 v[142:143], v241 offset:53760
    v_mfma_f32_16x16x32_bf16 v[12:15], v[152:155], a[96:99], v[12:15]
    buffer_load_dwordx4 v229, s[40:43], s14 offen offset:3072 lds
    v_mfma_f32_16x16x32_bf16 v[16:19], v[160:163], a[96:99], v[16:19]
    ds_read_b64_tr_b16 v[144:145], v242 offset:49152
    v_mfma_f32_16x16x32_bf16 v[16:19], v[164:167], a[112:115], v[16:19]
    ds_read_b64_tr_b16 v[146:147], v242 offset:49664
    v_mfma_f32_16x16x32_bf16 v[48:51], v[164:167], a[116:119], v[48:51]
    ds_read_b64_tr_b16 v[148:149], v242 offset:53248
    v_mfma_f32_16x16x32_bf16 v[48:51], v[160:163], a[100:103], v[48:51]
    ds_read_b64_tr_b16 v[150:151], v242 offset:53760
    v_mfma_f32_16x16x32_bf16 v[80:83], v[160:163], a[104:107], v[80:83]
    s_add_u32 m0, s17, 0
    s_add_u32 s14, s19, s37
    ds_read_b64_tr_b16 v[152:153], v243 offset:49152
    v_mfma_f32_16x16x32_bf16 v[80:83], v[164:167], a[120:123], v[80:83]
    buffer_load_dwordx4 v234, s[44:47], s14 offen offset:0 nt lds
    v_mfma_f32_16x16x32_bf16 v[112:115], v[164:167], a[124:127], v[112:115]
    ds_read_b64_tr_b16 v[154:155], v243 offset:49664
    v_mfma_f32_16x16x32_bf16 v[112:115], v[160:163], a[108:111], v[112:115]
    ds_read_b64_tr_b16 v[156:157], v243 offset:53248
    v_mfma_f32_16x16x32_bf16 v[116:119], v[168:171], a[108:111], v[116:119]
    ds_read_b64_tr_b16 v[158:159], v243 offset:53760
    v_mfma_f32_16x16x32_bf16 v[116:119], v[172:175], a[124:127], v[116:119]
    s_add_u32 s37, s37, 524288
    s_and_b32 s37, s37, 4194303
    ds_read_b64_tr_b16 v[160:161], v240 offset:57344
    v_mfma_f32_16x16x32_bf16 v[84:87], v[172:175], a[120:123], v[84:87]
    buffer_load_dwordx4 v235, s[44:47], s14 offen offset:1024 nt lds
    v_mfma_f32_16x16x32_bf16 v[84:87], v[168:171], a[104:107], v[84:87]
    ds_read_b64_tr_b16 v[162:163], v240 offset:57856
    v_mfma_f32_16x16x32_bf16 v[52:55], v[168:171], a[100:103], v[52:55]
    ds_read_b64_tr_b16 v[164:165], v240 offset:61440
    v_mfma_f32_16x16x32_bf16 v[52:55], v[172:175], a[116:119], v[52:55]
    ds_read_b64_tr_b16 v[166:167], v240 offset:61952
    v_mfma_f32_16x16x32_bf16 v[20:23], v[172:175], a[112:115], v[20:23]
    buffer_load_dwordx4 v236, s[44:47], s14 offen offset:2048 nt lds
    v_mfma_f32_16x16x32_bf16 v[20:23], v[168:171], a[96:99], v[20:23]
    ds_read_b64_tr_b16 v[168:169], v241 offset:57344
    v_mfma_f32_16x16x32_bf16 v[24:27], v[176:179], a[96:99], v[24:27]
    ds_read_b64_tr_b16 v[170:171], v241 offset:57856
    v_mfma_f32_16x16x32_bf16 v[24:27], v[180:183], a[112:115], v[24:27]
    ds_read_b64_tr_b16 v[172:173], v241 offset:61440
    v_mfma_f32_16x16x32_bf16 v[56:59], v[180:183], a[116:119], v[56:59]
    ds_read_b64_tr_b16 v[174:175], v241 offset:61952
    v_mfma_f32_16x16x32_bf16 v[56:59], v[176:179], a[100:103], v[56:59]
    buffer_load_dwordx4 v237, s[44:47], s14 offen offset:3072 nt lds
    v_mfma_f32_16x16x32_bf16 v[88:91], v[176:179], a[104:107], v[88:91]
    v_mfma_f32_16x16x32_bf16 v[88:91], v[180:183], a[120:123], v[88:91]
    v_mfma_f32_16x16x32_bf16 v[120:123], v[180:183], a[124:127], v[120:123]
    v_mfma_f32_16x16x32_bf16 v[120:123], v[176:179], a[108:111], v[120:123]
    ds_read_b64_tr_b16 v[176:177], v242 offset:57344
    v_mfma_f32_16x16x32_bf16 v[124:127], v[184:187], a[108:111], v[124:127]
    s_add_u32 m0, s16, 16384
    s_add_u32 s14, s18, s36
    ds_read_b64_tr_b16 v[178:179], v242 offset:57856
    v_mfma_f32_16x16x32_bf16 v[124:127], v[188:191], a[124:127], v[124:127]
    buffer_load_dwordx4 v226, s[40:43], s14 offen offset:0 lds
    v_mfma_f32_16x16x32_bf16 v[92:95], v[188:191], a[120:123], v[92:95]
    ds_read_b64_tr_b16 v[180:181], v242 offset:61440
    v_mfma_f32_16x16x32_bf16 v[92:95], v[184:187], a[104:107], v[92:95]
    ds_read_b64_tr_b16 v[182:183], v242 offset:61952
    v_mfma_f32_16x16x32_bf16 v[60:63], v[184:187], a[100:103], v[60:63]
    v_mfma_f32_16x16x32_bf16 v[60:63], v[188:191], a[116:119], v[60:63]
    buffer_load_dwordx4 v227, s[40:43], s14 offen offset:1024 lds
    v_mfma_f32_16x16x32_bf16 v[28:31], v[188:191], a[112:115], v[28:31]
    v_mfma_f32_16x16x32_bf16 v[28:31], v[184:187], a[96:99], v[28:31]
    s_waitcnt lgkmcnt(15)
    ds_read_b64_tr_b16 v[184:185], v243 offset:57344
    v_mfma_f32_16x16x32_bf16 v[0:3], v[128:131], a[128:131], v[0:3]
    ds_read_b64_tr_b16 v[186:187], v243 offset:57856
    ds_read_b64_tr_b16 v[188:189], v243 offset:61440
    v_mfma_f32_16x16x32_bf16 v[0:3], v[132:135], a[144:147], v[0:3]
    ds_read_b64_tr_b16 v[190:191], v243 offset:61952
    v_mfma_f32_16x16x32_bf16 v[32:35], v[132:135], a[148:151], v[32:35]
    buffer_load_dwordx4 v228, s[40:43], s14 offen offset:2048 lds
    v_mfma_f32_16x16x32_bf16 v[32:35], v[128:131], a[132:135], v[32:35]
    v_mfma_f32_16x16x32_bf16 v[64:67], v[128:131], a[136:139], v[64:67]
    v_mfma_f32_16x16x32_bf16 v[64:67], v[132:135], a[152:155], v[64:67]
    v_mfma_f32_16x16x32_bf16 v[96:99], v[132:135], a[156:159], v[96:99]
    v_mfma_f32_16x16x32_bf16 v[96:99], v[128:131], a[140:143], v[96:99]
    buffer_load_dwordx4 v229, s[40:43], s14 offen offset:3072 lds
    v_mfma_f32_16x16x32_bf16 v[100:103], v[136:139], a[140:143], v[100:103]
    v_mfma_f32_16x16x32_bf16 v[100:103], v[140:143], a[156:159], v[100:103]
    v_mfma_f32_16x16x32_bf16 v[68:71], v[140:143], a[152:155], v[68:71]
    s_waitcnt vmcnt(17)
    s_waitcnt lgkmcnt(0)
    s_barrier
    v_mfma_f32_16x16x32_bf16 v[68:71], v[136:139], a[136:139], v[68:71]
    v_add_u32 v240, 0x18000, v240
    v_mfma_f32_16x16x32_bf16 v[36:39], v[136:139], a[132:135], v[36:39]
    s_add_u32 m0, s16, 32768
    s_add_u32 s14, s34, s36
    ds_read_b64_tr_b16 v[128:129], v240 offset:0
    v_mfma_f32_16x16x32_bf16 v[36:39], v[140:143], a[148:151], v[36:39]
    buffer_load_dwordx4 v226, s[40:43], s14 offen offset:0 lds
    v_mfma_f32_16x16x32_bf16 v[4:7], v[140:143], a[144:147], v[4:7]
    ds_read_b64_tr_b16 v[130:131], v240 offset:512
    v_mfma_f32_16x16x32_bf16 v[4:7], v[136:139], a[128:131], v[4:7]
    ds_read_b64_tr_b16 v[132:133], v240 offset:4096
    v_mfma_f32_16x16x32_bf16 v[8:11], v[144:147], a[128:131], v[8:11]
    ds_read_b64_tr_b16 v[134:135], v240 offset:4608
    v_add_u32 v238, 0x14000, v238
    v_mfma_f32_16x16x32_bf16 v[8:11], v[148:151], a[144:147], v[8:11]
    s_add_u32 s36, s36, 128
    s_and_b32 s36, s36, 1023
    ds_read_b128 a[160:163], v238 offset:0
    v_mfma_f32_16x16x32_bf16 v[40:43], v[148:151], a[148:151], v[40:43]
    buffer_load_dwordx4 v227, s[40:43], s14 offen offset:1024 lds
    v_mfma_f32_16x16x32_bf16 v[40:43], v[144:147], a[132:135], v[40:43]
    v_add_u32 v239, 0x14000, v239
    v_mfma_f32_16x16x32_bf16 v[72:75], v[144:147], a[136:139], v[72:75]
    ds_read_b128 a[176:179], v239 offset:0
    v_mfma_f32_16x16x32_bf16 v[72:75], v[148:151], a[152:155], v[72:75]
    ds_read_b128 a[164:167], v238 offset:2048
    v_mfma_f32_16x16x32_bf16 v[104:107], v[148:151], a[156:159], v[104:107]
    buffer_load_dwordx4 v228, s[40:43], s14 offen offset:2048 lds
    v_mfma_f32_16x16x32_bf16 v[104:107], v[144:147], a[140:143], v[104:107]
    ds_read_b128 a[180:183], v239 offset:2048
    v_mfma_f32_16x16x32_bf16 v[108:111], v[152:155], a[140:143], v[108:111]
    ds_read_b128 a[168:171], v238 offset:16384
    v_mfma_f32_16x16x32_bf16 v[108:111], v[156:159], a[156:159], v[108:111]
    ds_read_b128 a[184:187], v239 offset:16384
    v_mfma_f32_16x16x32_bf16 v[76:79], v[156:159], a[152:155], v[76:79]
    ds_read_b128 a[172:175], v238 offset:18432
    v_mfma_f32_16x16x32_bf16 v[76:79], v[152:155], a[136:139], v[76:79]
    buffer_load_dwordx4 v229, s[40:43], s14 offen offset:3072 lds
    v_mfma_f32_16x16x32_bf16 v[44:47], v[152:155], a[132:135], v[44:47]
    ds_read_b128 a[188:191], v239 offset:18432
    v_add_u32 v241, 0x18000, v241
    v_mfma_f32_16x16x32_bf16 v[44:47], v[156:159], a[148:151], v[44:47]
    ds_read_b64_tr_b16 v[136:137], v241 offset:0
    v_mfma_f32_16x16x32_bf16 v[12:15], v[156:159], a[144:147], v[12:15]
    ds_read_b64_tr_b16 v[138:139], v241 offset:512
    v_mfma_f32_16x16x32_bf16 v[12:15], v[152:155], a[128:131], v[12:15]
    ds_read_b64_tr_b16 v[140:141], v241 offset:4096
    v_mfma_f32_16x16x32_bf16 v[16:19], v[160:163], a[128:131], v[16:19]
    s_add_u32 m0, s17, 49152
    s_add_u32 s14, s19, s37
    ds_read_b64_tr_b16 v[142:143], v241 offset:4608
    v_mfma_f32_16x16x32_bf16 v[16:19], v[164:167], a[144:147], v[16:19]
    buffer_load_dwordx4 v234, s[44:47], s14 offen offset:0 nt lds
    v_mfma_f32_16x16x32_bf16 v[48:51], v[164:167], a[148:151], v[48:51]
    v_add_u32 v242, 0x18000, v242
    v_mfma_f32_16x16x32_bf16 v[48:51], v[160:163], a[132:135], v[48:51]
    ds_read_b64_tr_b16 v[144:145], v242 offset:0
    v_mfma_f32_16x16x32_bf16 v[80:83], v[160:163], a[136:139], v[80:83]
    ds_read_b64_tr_b16 v[146:147], v242 offset:512
    v_mfma_f32_16x16x32_bf16 v[80:83], v[164:167], a[152:155], v[80:83]
    s_add_u32 s37, s37, 524288
    s_and_b32 s37, s37, 4194303
    ds_read_b64_tr_b16 v[148:149], v242 offset:4096
    v_mfma_f32_16x16x32_bf16 v[112:115], v[164:167], a[156:159], v[112:115]
    buffer_load_dwordx4 v235, s[44:47], s14 offen offset:1024 nt lds
    v_mfma_f32_16x16x32_bf16 v[112:115], v[160:163], a[140:143], v[112:115]
    ds_read_b64_tr_b16 v[150:151], v242 offset:4608
    v_add_u32 v243, 0x18000, v243
    v_mfma_f32_16x16x32_bf16 v[116:119], v[168:171], a[140:143], v[116:119]
    ds_read_b64_tr_b16 v[152:153], v243 offset:0
    v_mfma_f32_16x16x32_bf16 v[116:119], v[172:175], a[156:159], v[116:119]
    ds_read_b64_tr_b16 v[154:155], v243 offset:512
    v_mfma_f32_16x16x32_bf16 v[84:87], v[172:175], a[152:155], v[84:87]
    buffer_load_dwordx4 v236, s[44:47], s14 offen offset:2048 nt lds
    v_mfma_f32_16x16x32_bf16 v[84:87], v[168:171], a[136:139], v[84:87]
    ds_read_b64_tr_b16 v[156:157], v243 offset:4096
    v_mfma_f32_16x16x32_bf16 v[52:55], v[168:171], a[132:135], v[52:55]
    ds_read_b64_tr_b16 v[158:159], v243 offset:4608
    v_mfma_f32_16x16x32_bf16 v[52:55], v[172:175], a[148:151], v[52:55]
    ds_read_b64_tr_b16 v[160:161], v240 offset:8192
    v_mfma_f32_16x16x32_bf16 v[20:23], v[172:175], a[144:147], v[20:23]
    ds_read_b64_tr_b16 v[162:163], v240 offset:8704
    v_mfma_f32_16x16x32_bf16 v[20:23], v[168:171], a[128:131], v[20:23]
    buffer_load_dwordx4 v237, s[44:47], s14 offen offset:3072 nt lds
    v_mfma_f32_16x16x32_bf16 v[24:27], v[176:179], a[128:131], v[24:27]
    ds_read_b64_tr_b16 v[164:165], v240 offset:12288
    v_mfma_f32_16x16x32_bf16 v[24:27], v[180:183], a[144:147], v[24:27]
    ds_read_b64_tr_b16 v[166:167], v240 offset:12800
    v_mfma_f32_16x16x32_bf16 v[56:59], v[180:183], a[148:151], v[56:59]
    ds_read_b64_tr_b16 v[168:169], v241 offset:8192
    v_mfma_f32_16x16x32_bf16 v[56:59], v[176:179], a[132:135], v[56:59]
    ds_read_b64_tr_b16 v[170:171], v241 offset:8704
    v_mfma_f32_16x16x32_bf16 v[88:91], v[176:179], a[136:139], v[88:91]
    s_add_u32 s19, s19, s99
    s_add_u32 m0, s16, 65536
    s_add_u32 s14, s20, s37
    v_mfma_f32_16x16x32_bf16 v[88:91], v[180:183], a[152:155], v[88:91]
    buffer_load_dwordx4 v234, s[48:51], s14 offen offset:0 nt lds
    v_mfma_f32_16x16x32_bf16 v[120:123], v[180:183], a[156:159], v[120:123]
    ds_read_b64_tr_b16 v[172:173], v241 offset:12288
    v_mfma_f32_16x16x32_bf16 v[120:123], v[176:179], a[140:143], v[120:123]
    ds_read_b64_tr_b16 v[174:175], v241 offset:12800
    v_mfma_f32_16x16x32_bf16 v[124:127], v[184:187], a[140:143], v[124:127]
    ds_read_b64_tr_b16 v[176:177], v242 offset:8192
    v_mfma_f32_16x16x32_bf16 v[124:127], v[188:191], a[156:159], v[124:127]
    s_add_u32 s37, s37, 1048576
    s_and_b32 s37, s37, 4194303
    ds_read_b64_tr_b16 v[178:179], v242 offset:8704
    v_mfma_f32_16x16x32_bf16 v[92:95], v[188:191], a[152:155], v[92:95]
    buffer_load_dwordx4 v235, s[48:51], s14 offen offset:1024 nt lds
    v_mfma_f32_16x16x32_bf16 v[92:95], v[184:187], a[136:139], v[92:95]
    ds_read_b64_tr_b16 v[180:181], v242 offset:12288
    v_mfma_f32_16x16x32_bf16 v[60:63], v[184:187], a[132:135], v[60:63]
    ds_read_b64_tr_b16 v[182:183], v242 offset:12800
    v_mfma_f32_16x16x32_bf16 v[60:63], v[188:191], a[148:151], v[60:63]
    v_mfma_f32_16x16x32_bf16 v[28:31], v[188:191], a[144:147], v[28:31]
    buffer_load_dwordx4 v236, s[48:51], s14 offen offset:2048 nt lds
    v_mfma_f32_16x16x32_bf16 v[28:31], v[184:187], a[128:131], v[28:31]
    s_waitcnt lgkmcnt(15)
    ds_read_b64_tr_b16 v[184:185], v243 offset:8192
    v_mfma_f32_16x16x32_bf16 v[0:3], v[128:131], a[160:163], v[0:3]
    ds_read_b64_tr_b16 v[186:187], v243 offset:8704
    ds_read_b64_tr_b16 v[188:189], v243 offset:12288
    v_mfma_f32_16x16x32_bf16 v[0:3], v[132:135], a[176:179], v[0:3]
    ds_read_b64_tr_b16 v[190:191], v243 offset:12800
    v_mfma_f32_16x16x32_bf16 v[32:35], v[132:135], a[180:183], v[32:35]
    v_mfma_f32_16x16x32_bf16 v[32:35], v[128:131], a[164:167], v[32:35]
    buffer_load_dwordx4 v237, s[48:51], s14 offen offset:3072 nt lds
    v_mfma_f32_16x16x32_bf16 v[64:67], v[128:131], a[168:171], v[64:67]
    v_mfma_f32_16x16x32_bf16 v[64:67], v[132:135], a[184:187], v[64:67]
    v_mfma_f32_16x16x32_bf16 v[96:99], v[132:135], a[188:191], v[96:99]
    v_mfma_f32_16x16x32_bf16 v[96:99], v[128:131], a[172:175], v[96:99]
    v_mfma_f32_16x16x32_bf16 v[100:103], v[136:139], a[172:175], v[100:103]
    v_mfma_f32_16x16x32_bf16 v[100:103], v[140:143], a[188:191], v[100:103]
    v_mfma_f32_16x16x32_bf16 v[68:71], v[140:143], a[184:187], v[68:71]
    s_waitcnt vmcnt(16)
    s_waitcnt lgkmcnt(0)
    s_barrier
    v_mfma_f32_16x16x32_bf16 v[68:71], v[136:139], a[168:171], v[68:71]
    v_cmp_ne_u32 vcc, 1, v247
    v_add_u32 v240, 0xfffe4000, v240
    v_mfma_f32_16x16x32_bf16 v[36:39], v[136:139], a[164:167], v[36:39]
    s_nop 0
    s_cbranch_vccnz L_SPIN_A
L_BACK_A:
    ds_read_b64_tr_b16 v[128:129], v240 offset:0
    v_mfma_f32_16x16x32_bf16 v[36:39], v[140:143], a[180:183], v[36:39]
    buffer_store_dword v246, v245, s[64:67], s38 offen sc1
    v_mfma_f32_16x16x32_bf16 v[4:7], v[140:143], a[176:179], v[4:7]
    ds_read_b64_tr_b16 v[130:131], v240 offset:512
    v_mfma_f32_16x16x32_bf16 v[4:7], v[136:139], a[160:163], v[4:7]
    ds_read_b64_tr_b16 v[132:133], v240 offset:4096
    v_mfma_f32_16x16x32_bf16 v[8:11], v[144:147], a[160:163], v[8:11]
    s_add_u32 m0, s16, 81920
    s_add_u32 s14, s20, s37
    ds_read_b64_tr_b16 v[134:135], v240 offset:4608
    v_mfma_f32_16x16x32_bf16 v[8:11], v[148:151], a[176:179], v[8:11]
    buffer_load_dwordx4 v234, s[48:51], s14 offen offset:0 nt lds
    v_mfma_f32_16x16x32_bf16 v[40:43], v[148:151], a[180:183], v[40:43]
    ds_read_b128 a[192:195], v238 offset:49152
    v_mfma_f32_16x16x32_bf16 v[40:43], v[144:147], a[164:167], v[40:43]
    ds_read_b128 a[208:211], v239 offset:49152
    v_mfma_f32_16x16x32_bf16 v[72:75], v[144:147], a[168:171], v[72:75]
    ds_read_b128 a[196:199], v238 offset:51200
    v_mfma_f32_16x16x32_bf16 v[72:75], v[148:151], a[184:187], v[72:75]
    s_add_u32 s37, s37, 1048576
    s_and_b32 s37, s37, 4194303
    ds_read_b128 a[212:215], v239 offset:51200
    v_mfma_f32_16x16x32_bf16 v[104:107], v[148:151], a[188:191], v[104:107]
    buffer_load_dwordx4 v235, s[48:51], s14 offen offset:1024 nt lds
    v_mfma_f32_16x16x32_bf16 v[104:107], v[144:147], a[172:175], v[104:107]
    v_add_u32 v238, 0x10000, v238
    v_mfma_f32_16x16x32_bf16 v[108:111], v[152:155], a[172:175], v[108:111]
    ds_read_b128 a[200:203], v238 offset:0
    v_add_u32 v239, 0x10000, v239
    v_mfma_f32_16x16x32_bf16 v[108:111], v[156:159], a[188:191], v[108:111]
    ds_read_b128 a[216:219], v239 offset:0
    v_mfma_f32_16x16x32_bf16 v[76:79], v[156:159], a[184:187], v[76:79]
    buffer_load_dwordx4 v236, s[48:51], s14 offen offset:2048 nt lds
    v_mfma_f32_16x16x32_bf16 v[76:79], v[152:155], a[168:171], v[76:79]
    ds_read_b128 a[204:207], v238 offset:2048
    v_mfma_f32_16x16x32_bf16 v[44:47], v[152:155], a[164:167], v[44:47]
    ds_read_b128 a[220:223], v239 offset:2048
    v_add_u32 v241, 0xfffe4000, v241
    v_mfma_f32_16x16x32_bf16 v[44:47], v[156:159], a[180:183], v[44:47]
    ds_read_b64_tr_b16 v[136:137], v241 offset:0
    v_mfma_f32_16x16x32_bf16 v[12:15], v[156:159], a[176:179], v[12:15]
    ds_read_b64_tr_b16 v[138:139], v241 offset:512
    v_mfma_f32_16x16x32_bf16 v[12:15], v[152:155], a[160:163], v[12:15]
    buffer_load_dwordx4 v237, s[48:51], s14 offen offset:3072 nt lds
    v_mfma_f32_16x16x32_bf16 v[16:19], v[160:163], a[160:163], v[16:19]
    ds_read_b64_tr_b16 v[140:141], v241 offset:4096
    v_mfma_f32_16x16x32_bf16 v[16:19], v[164:167], a[176:179], v[16:19]
    ds_read_b64_tr_b16 v[142:143], v241 offset:4608
    v_add_u32 v242, 0xfffe4000, v242
    v_mfma_f32_16x16x32_bf16 v[48:51], v[164:167], a[180:183], v[48:51]
    ds_read_b64_tr_b16 v[144:145], v242 offset:0
    v_mfma_f32_16x16x32_bf16 v[48:51], v[160:163], a[164:167], v[48:51]
    ds_read_b64_tr_b16 v[146:147], v242 offset:512
    v_mfma_f32_16x16x32_bf16 v[80:83], v[160:163], a[168:171], v[80:83]
    s_add_u32 m0, s16, 98304
    s_add_u32 s14, s20, s37
    ds_read_b64_tr_b16 v[148:149], v242 offset:4096
    v_mfma_f32_16x16x32_bf16 v[80:83], v[164:167], a[184:187], v[80:83]
    buffer_load_dwordx4 v234, s[48:51], s14 offen offset:0 nt lds
    v_mfma_f32_16x16x32_bf16 v[112:115], v[164:167], a[188:191], v[112:115]
    ds_read_b64_tr_b16 v[150:151], v242 offset:4608
    v_add_u32 v243, 0xfffe4000, v243
    v_mfma_f32_16x16x32_bf16 v[112:115], v[160:163], a[172:175], v[112:115]
    ds_read_b64_tr_b16 v[152:153], v243 offset:0
    v_mfma_f32_16x16x32_bf16 v[116:119], v[168:171], a[172:175], v[116:119]
    ds_read_b64_tr_b16 v[154:155], v243 offset:512
    v_mfma_f32_16x16x32_bf16 v[116:119], v[172:175], a[188:191], v[116:119]
    s_add_u32 s37, s37, 1048576
    s_and_b32 s37, s37, 4194303
    ds_read_b64_tr_b16 v[156:157], v243 offset:4096
    v_mfma_f32_16x16x32_bf16 v[84:87], v[172:175], a[184:187], v[84:87]
    buffer_load_dwordx4 v235, s[48:51], s14 offen offset:1024 nt lds
    v_mfma_f32_16x16x32_bf16 v[84:87], v[168:171], a[168:171], v[84:87]
    ds_read_b64_tr_b16 v[158:159], v243 offset:4608
    v_mfma_f32_16x16x32_bf16 v[52:55], v[168:171], a[164:167], v[52:55]
    ds_read_b64_tr_b16 v[160:161], v240 offset:8192
    v_mfma_f32_16x16x32_bf16 v[52:55], v[172:175], a[180:183], v[52:55]
    ds_read_b64_tr_b16 v[162:163], v240 offset:8704
    v_mfma_f32_16x16x32_bf16 v[20:23], v[172:175], a[176:179], v[20:23]
    buffer_load_dwordx4 v236, s[48:51], s14 offen offset:2048 nt lds
    v_mfma_f32_16x16x32_bf16 v[20:23], v[168:171], a[160:163], v[20:23]
    ds_read_b64_tr_b16 v[164:165], v240 offset:12288
    v_mfma_f32_16x16x32_bf16 v[24:27], v[176:179], a[160:163], v[24:27]
    ds_read_b64_tr_b16 v[166:167], v240 offset:12800
    v_mfma_f32_16x16x32_bf16 v[24:27], v[180:183], a[176:179], v[24:27]
    ds_read_b64_tr_b16 v[168:169], v241 offset:8192
    v_mfma_f32_16x16x32_bf16 v[56:59], v[180:183], a[180:183], v[56:59]
    ds_read_b64_tr_b16 v[170:171], v241 offset:8704
    v_mfma_f32_16x16x32_bf16 v[56:59], v[176:179], a[164:167], v[56:59]
    buffer_load_dwordx4 v237, s[48:51], s14 offen offset:3072 nt lds
    v_mfma_f32_16x16x32_bf16 v[88:91], v[176:179], a[168:171], v[88:91]
    ds_read_b64_tr_b16 v[172:173], v241 offset:12288
    v_mfma_f32_16x16x32_bf16 v[88:91], v[180:183], a[184:187], v[88:91]
    ds_read_b64_tr_b16 v[174:175], v241 offset:12800
    v_mfma_f32_16x16x32_bf16 v[120:123], v[180:183], a[188:191], v[120:123]
    v_mfma_f32_16x16x32_bf16 v[120:123], v[176:179], a[172:175], v[120:123]
    ds_read_b64_tr_b16 v[176:177], v242 offset:8192
    v_mfma_f32_16x16x32_bf16 v[124:127], v[184:187], a[172:175], v[124:127]
    s_add_u32 m0, s16, 114688
    s_add_u32 s14, s20, s37
    ds_read_b64_tr_b16 v[178:179], v242 offset:8704
    v_mfma_f32_16x16x32_bf16 v[124:127], v[188:191], a[188:191], v[124:127]
    buffer_load_dwordx4 v234, s[48:51], s14 offen offset:0 nt lds
    v_mfma_f32_16x16x32_bf16 v[92:95], v[188:191], a[184:187], v[92:95]
    ds_read_b64_tr_b16 v[180:181], v242 offset:12288
    v_mfma_f32_16x16x32_bf16 v[92:95], v[184:187], a[168:171], v[92:95]
    ds_read_b64_tr_b16 v[182:183], v242 offset:12800
    v_mfma_f32_16x16x32_bf16 v[60:63], v[184:187], a[164:167], v[60:63]
    v_mfma_f32_16x16x32_bf16 v[60:63], v[188:191], a[180:183], v[60:63]
    s_add_u32 s37, s37, 1048576
    s_and_b32 s37, s37, 4194303
    v_mfma_f32_16x16x32_bf16 v[28:31], v[188:191], a[176:179], v[28:31]
    buffer_load_dwordx4 v235, s[48:51], s14 offen offset:1024 nt lds
    v_mfma_f32_16x16x32_bf16 v[28:31], v[184:187], a[160:163], v[28:31]
    s_waitcnt lgkmcnt(15)
    ds_read_b64_tr_b16 v[184:185], v243 offset:8192
    v_mfma_f32_16x16x32_bf16 v[0:3], v[128:131], a[192:195], v[0:3]
    ds_read_b64_tr_b16 v[186:187], v243 offset:8704
    ds_read_b64_tr_b16 v[188:189], v243 offset:12288
    v_mfma_f32_16x16x32_bf16 v[0:3], v[132:135], a[208:211], v[0:3]
    ds_read_b64_tr_b16 v[190:191], v243 offset:12800
    v_mfma_f32_16x16x32_bf16 v[32:35], v[132:135], a[212:215], v[32:35]
    buffer_load_dwordx4 v236, s[48:51], s14 offen offset:2048 nt lds
    v_mfma_f32_16x16x32_bf16 v[32:35], v[128:131], a[196:199], v[32:35]
    v_mfma_f32_16x16x32_bf16 v[64:67], v[128:131], a[200:203], v[64:67]
    v_mfma_f32_16x16x32_bf16 v[64:67], v[132:135], a[216:219], v[64:67]
    v_mfma_f32_16x16x32_bf16 v[96:99], v[132:135], a[220:223], v[96:99]
    v_mfma_f32_16x16x32_bf16 v[96:99], v[128:131], a[204:207], v[96:99]
    buffer_load_dwordx4 v237, s[48:51], s14 offen offset:3072 nt lds
    v_mfma_f32_16x16x32_bf16 v[100:103], v[136:139], a[204:207], v[100:103]
    v_mfma_f32_16x16x32_bf16 v[100:103], v[140:143], a[220:223], v[100:103]
    v_mfma_f32_16x16x32_bf16 v[68:71], v[140:143], a[216:219], v[68:71]
    s_waitcnt vmcnt(17)
    s_waitcnt lgkmcnt(0)
    s_barrier
    v_mfma_f32_16x16x32_bf16 v[68:71], v[136:139], a[200:203], v[68:71]
    ds_read_b64_tr_b16 v[128:129], v240 offset:49152
    v_mfma_f32_16x16x32_bf16 v[36:39], v[136:139], a[196:199], v[36:39]
    s_xor_b32 s20, s20, 128
    s_add_u32 m0, s16, 131072
    s_add_u32 s14, s20, s37
    v_mfma_f32_16x16x32_bf16 v[36:39], v[140:143], a[212:215], v[36:39]
    buffer_load_dwordx4 v234, s[48:51], s14 offen offset:0 nt lds
    v_mfma_f32_16x16x32_bf16 v[4:7], v[140:143], a[208:211], v[4:7]
    ds_read_b64_tr_b16 v[130:131], v240 offset:49664
    v_mfma_f32_16x16x32_bf16 v[4:7], v[136:139], a[192:195], v[4:7]
    ds_read_b64_tr_b16 v[132:133], v240 offset:53248
    v_mfma_f32_16x16x32_bf16 v[8:11], v[144:147], a[192:195], v[8:11]
    ds_read_b64_tr_b16 v[134:135], v240 offset:53760
    v_add_u32 v238, 0xfffe0000, v238
    v_mfma_f32_16x16x32_bf16 v[8:11], v[148:151], a[208:211], v[8:11]
    s_add_u32 s37, s37, 1048576
    s_and_b32 s37, s37, 4194303
    ds_read_b128 a[224:227], v238 offset:0
    v_mfma_f32_16x16x32_bf16 v[40:43], v[148:151], a[212:215], v[40:43]
    buffer_load_dwordx4 v235, s[48:51], s14 offen offset:1024 nt lds
    v_mfma_f32_16x16x32_bf16 v[40:43], v[144:147], a[196:199], v[40:43]
    v_add_u32 v239, 0xfffe0000, v239
    v_mfma_f32_16x16x32_bf16 v[72:75], v[144:147], a[200:203], v[72:75]
    ds_read_b128 a[240:243], v239 offset:0
    v_mfma_f32_16x16x32_bf16 v[72:75], v[148:151], a[216:219], v[72:75]
    ds_read_b128 a[228:231], v238 offset:2048
    v_mfma_f32_16x16x32_bf16 v[104:107], v[148:151], a[220:223], v[104:107]
    buffer_load_dwordx4 v236, s[48:51], s14 offen offset:2048 nt lds
    v_mfma_f32_16x16x32_bf16 v[104:107], v[144:147], a[204:207], v[104:107]
    ds_read_b128 a[244:247], v239 offset:2048
    v_mfma_f32_16x16x32_bf16 v[108:111], v[152:155], a[204:207], v[108:111]
    ds_read_b128 a[232:235], v238 offset:16384
    v_mfma_f32_16x16x32_bf16 v[108:111], v[156:159], a[220:223], v[108:111]
    ds_read_b128 a[248:251], v239 offset:16384
    v_mfma_f32_16x16x32_bf16 v[76:79], v[156:159], a[216:219], v[76:79]
    ds_read_b128 a[236:239], v238 offset:18432
    v_mfma_f32_16x16x32_bf16 v[76:79], v[152:155], a[200:203], v[76:79]
    buffer_load_dwordx4 v237, s[48:51], s14 offen offset:3072 nt lds
    v_mfma_f32_16x16x32_bf16 v[44:47], v[152:155], a[196:199], v[44:47]
    ds_read_b128 a[252:255], v239 offset:18432
    v_mfma_f32_16x16x32_bf16 v[44:47], v[156:159], a[212:215], v[44:47]
    ds_read_b64_tr_b16 v[136:137], v241 offset:49152
    v_mfma_f32_16x16x32_bf16 v[12:15], v[156:159], a[208:211], v[12:15]
    ds_read_b64_tr_b16 v[138:139], v241 offset:49664
    v_mfma_f32_16x16x32_bf16 v[12:15], v[152:155], a[192:195], v[12:15]
    ds_read_b64_tr_b16 v[140:141], v241 offset:53248
    v_mfma_f32_16x16x32_bf16 v[16:19], v[160:163], a[192:195], v[16:19]
    s_add_u32 m0, s16, 147456
    s_add_u32 s14, s20, s37
    ds_read_b64_tr_b16 v[142:143], v241 offset:53760
    v_mfma_f32_16x16x32_bf16 v[16:19], v[164:167], a[208:211], v[16:19]
    buffer_load_dwordx4 v234, s[48:51], s14 offen offset:0 nt lds
    v_mfma_f32_16x16x32_bf16 v[48:51], v[164:167], a[212:215], v[48:51]
    ds_read_b64_tr_b16 v[144:145], v242 offset:49152
    v_mfma_f32_16x16x32_bf16 v[48:51], v[160:163], a[196:199], v[48:51]
    ds_read_b64_tr_b16 v[146:147], v242 offset:49664
    v_mfma_f32_16x16x32_bf16 v[80:83], v[160:163], a[200:203], v[80:83]
    ds_read_b64_tr_b16 v[148:149], v242 offset:53248
    v_mfma_f32_16x16x32_bf16 v[80:83], v[164:167], a[216:219], v[80:83]
    s_add_u32 s37, s37, 1048576
    s_and_b32 s37, s37, 4194303
    ds_read_b64_tr_b16 v[150:151], v242 offset:53760
    v_mfma_f32_16x16x32_bf16 v[112:115], v[164:167], a[220:223], v[112:115]
    buffer_load_dwordx4 v235, s[48:51], s14 offen offset:1024 nt lds
    v_mfma_f32_16x16x32_bf16 v[112:115], v[160:163], a[204:207], v[112:115]
    ds_read_b64_tr_b16 v[152:153], v243 offset:49152
    v_mfma_f32_16x16x32_bf16 v[116:119], v[168:171], a[204:207], v[116:119]
    ds_read_b64_tr_b16 v[154:155], v243 offset:49664
    v_mfma_f32_16x16x32_bf16 v[116:119], v[172:175], a[220:223], v[116:119]
    ds_read_b64_tr_b16 v[156:157], v243 offset:53248
    v_mfma_f32_16x16x32_bf16 v[84:87], v[172:175], a[216:219], v[84:87]
    buffer_load_dwordx4 v236, s[48:51], s14 offen offset:2048 nt lds
    v_mfma_f32_16x16x32_bf16 v[84:87], v[168:171], a[200:203], v[84:87]
    ds_read_b64_tr_b16 v[158:159], v243 offset:53760
    v_mfma_f32_16x16x32_bf16 v[52:55], v[168:171], a[196:199], v[52:55]
    ds_read_b64_tr_b16 v[160:161], v240 offset:57344
    v_mfma_f32_16x16x32_bf16 v[52:55], v[172:175], a[212:215], v[52:55]
    ds_read_b64_tr_b16 v[162:163], v240 offset:57856
    v_mfma_f32_16x16x32_bf16 v[20:23], v[172:175], a[208:211], v[20:23]
    ds_read_b64_tr_b16 v[164:165], v240 offset:61440
    v_mfma_f32_16x16x32_bf16 v[20:23], v[168:171], a[192:195], v[20:23]
    buffer_load_dwordx4 v237, s[48:51], s14 offen offset:3072 nt lds
    v_mfma_f32_16x16x32_bf16 v[24:27], v[176:179], a[192:195], v[24:27]
    ds_read_b64_tr_b16 v[166:167], v240 offset:61952
    v_mfma_f32_16x16x32_bf16 v[24:27], v[180:183], a[208:211], v[24:27]
    ds_read_b64_tr_b16 v[168:169], v241 offset:57344
    v_mfma_f32_16x16x32_bf16 v[56:59], v[180:183], a[212:215], v[56:59]
    ds_read_b64_tr_b16 v[170:171], v241 offset:57856
    v_mfma_f32_16x16x32_bf16 v[56:59], v[176:179], a[196:199], v[56:59]
    ds_read_b64_tr_b16 v[172:173], v241 offset:61440
    v_mfma_f32_16x16x32_bf16 v[88:91], v[176:179], a[200:203], v[88:91]
    s_add_u32 m0, s16, 0
    s_add_u32 s14, s20, s37
    ds_read_b64_tr_b16 v[174:175], v241 offset:61952
    v_mfma_f32_16x16x32_bf16 v[88:91], v[180:183], a[216:219], v[88:91]
    buffer_load_dwordx4 v234, s[48:51], s14 offen offset:0 nt lds
    v_mfma_f32_16x16x32_bf16 v[120:123], v[180:183], a[220:223], v[120:123]
    v_mfma_f32_16x16x32_bf16 v[120:123], v[176:179], a[204:207], v[120:123]
    ds_read_b64_tr_b16 v[176:177], v242 offset:57344
    v_mfma_f32_16x16x32_bf16 v[124:127], v[184:187], a[204:207], v[124:127]
    ds_read_b64_tr_b16 v[178:179], v242 offset:57856
    v_mfma_f32_16x16x32_bf16 v[124:127], v[188:191], a[220:223], v[124:127]
    s_add_u32 s37, s37, 1048576
    s_and_b32 s37, s37, 4194303
    ds_read_b64_tr_b16 v[180:181], v242 offset:61440
    v_mfma_f32_16x16x32_bf16 v[92:95], v[188:191], a[216:219], v[92:95]
    buffer_load_dwordx4 v235, s[48:51], s14 offen offset:1024 nt lds
    v_mfma_f32_16x16x32_bf16 v[92:95], v[184:187], a[200:203], v[92:95]
    ds_read_b64_tr_b16 v[182:183], v242 offset:61952
    v_mfma_f32_16x16x32_bf16 v[60:63], v[184:187], a[196:199], v[60:63]
    v_mfma_f32_16x16x32_bf16 v[60:63], v[188:191], a[212:215], v[60:63]
    v_mfma_f32_16x16x32_bf16 v[28:31], v[188:191], a[208:211], v[28:31]
    buffer_load_dwordx4 v236, s[48:51], s14 offen offset:2048 nt lds
    v_mfma_f32_16x16x32_bf16 v[28:31], v[184:187], a[192:195], v[28:31]
    s_waitcnt lgkmcnt(15)
    ds_read_b64_tr_b16 v[184:185], v243 offset:57344
    v_mfma_f32_16x16x32_bf16 v[0:3], v[128:131], a[224:227], v[0:3]
    ds_read_b64_tr_b16 v[186:187], v243 offset:57856
    ds_read_b64_tr_b16 v[188:189], v243 offset:61440
    v_mfma_f32_16x16x32_bf16 v[0:3], v[132:135], a[240:243], v[0:3]
    ds_read_b64_tr_b16 v[190:191], v243 offset:61952
    v_mfma_f32_16x16x32_bf16 v[32:35], v[132:135], a[244:247], v[32:35]
    v_mfma_f32_16x16x32_bf16 v[32:35], v[128:131], a[228:231], v[32:35]
    buffer_load_dwordx4 v237, s[48:51], s14 offen offset:3072 nt lds
    v_mfma_f32_16x16x32_bf16 v[64:67], v[128:131], a[232:235], v[64:67]
    v_mfma_f32_16x16x32_bf16 v[64:67], v[132:135], a[248:251], v[64:67]
    v_mfma_f32_16x16x32_bf16 v[96:99], v[132:135], a[252:255], v[96:99]
    v_mfma_f32_16x16x32_bf16 v[96:99], v[128:131], a[236:239], v[96:99]
    v_mfma_f32_16x16x32_bf16 v[100:103], v[136:139], a[236:239], v[100:103]
    v_mfma_f32_16x16x32_bf16 v[100:103], v[140:143], a[252:255], v[100:103]
    v_mfma_f32_16x16x32_bf16 v[68:71], v[140:143], a[248:251], v[68:71]
    s_waitcnt vmcnt(25)
    s_waitcnt lgkmcnt(0)
    s_barrier
    v_mfma_f32_16x16x32_bf16 v[68:71], v[136:139], a[232:235], v[68:71]
    s_add_u32 m0, s16, 16384
    s_add_u32 s14, s20, s37
    v_mfma_f32_16x16x32_bf16 v[36:39], v[136:139], a[228:231], v[36:39]
    buffer_load_dwordx4 v234, s[48:51], s14 offen offset:0 nt lds
    v_mfma_f32_16x16x32_bf16 v[36:39], v[140:143], a[244:247], v[36:39]
    v_mfma_f32_16x16x32_bf16 v[4:7], v[140:143], a[240:243], v[4:7]
    v_mfma_f32_16x16x32_bf16 v[4:7], v[136:139], a[224:227], v[4:7]
    v_mfma_f32_16x16x32_bf16 v[8:11], v[144:147], a[224:227], v[8:11]
    s_add_u32 s37, s37, 1048576
    s_and_b32 s37, s37, 4194303
    v_mfma_f32_16x16x32_bf16 v[8:11], v[148:151], a[240:243], v[8:11]
    buffer_load_dwordx4 v235, s[48:51], s14 offen offset:1024 nt lds
    v_mfma_f32_16x16x32_bf16 v[40:43], v[148:151], a[244:247], v[40:43]
    v_mfma_f32_16x16x32_bf16 v[40:43], v[144:147], a[228:231], v[40:43]
    v_mfma_f32_16x16x32_bf16 v[72:75], v[144:147], a[232:235], v[72:75]
    v_mfma_f32_16x16x32_bf16 v[72:75], v[148:151], a[248:251], v[72:75]
    buffer_load_dwordx4 v236, s[48:51], s14 offen offset:2048 nt lds
    v_mfma_f32_16x16x32_bf16 v[104:107], v[148:151], a[252:255], v[104:107]
    v_mfma_f32_16x16x32_bf16 v[104:107], v[144:147], a[236:239], v[104:107]
    v_mfma_f32_16x16x32_bf16 v[108:111], v[152:155], a[236:239], v[108:111]
    v_mfma_f32_16x16x32_bf16 v[108:111], v[156:159], a[252:255], v[108:111]
    v_mfma_f32_16x16x32_bf16 v[76:79], v[156:159], a[248:251], v[76:79]
    buffer_load_dwordx4 v237, s[48:51], s14 offen offset:3072 nt lds
    v_mfma_f32_16x16x32_bf16 v[76:79], v[152:155], a[232:235], v[76:79]
    v_mfma_f32_16x16x32_bf16 v[44:47], v[152:155], a[228:231], v[44:47]
    v_mfma_f32_16x16x32_bf16 v[44:47], v[156:159], a[244:247], v[44:47]
    v_mfma_f32_16x16x32_bf16 v[12:15], v[156:159], a[240:243], v[12:15]
    v_mfma_f32_16x16x32_bf16 v[12:15], v[152:155], a[224:227], v[12:15]
    s_lshl_b32 s36, s94, 7
    s_add_u32 m0, s16, 32768
    v_mfma_f32_16x16x32_bf16 v[16:19], v[160:163], a[224:227], v[16:19]
    s_add_u32 s14, s23, s36
    buffer_load_dwordx4 v230, s[52:55], s14 offen offset:0 lds
    v_mfma_f32_16x16x32_bf16 v[16:19], v[164:167], a[240:243], v[16:19]
    v_mfma_f32_16x16x32_bf16 v[48:51], v[164:167], a[244:247], v[48:51]
    v_mfma_f32_16x16x32_bf16 v[48:51], v[160:163], a[228:231], v[48:51]
    v_mfma_f32_16x16x32_bf16 v[80:83], v[160:163], a[232:235], v[80:83]
    s_add_u32 s36, s36, 128
    s_sub_u32 s88, s36, 1152
    s_min_u32 s36, s36, s88
    v_mfma_f32_16x16x32_bf16 v[80:83], v[164:167], a[248:251], v[80:83]
    buffer_load_dwordx4 v231, s[52:55], s14 offen offset:1024 lds
    v_mfma_f32_16x16x32_bf16 v[112:115], v[164:167], a[252:255], v[112:115]
    v_mfma_f32_16x16x32_bf16 v[112:115], v[160:163], a[236:239], v[112:115]
    v_add_u32 v240, 0x10000, v240
    v_mfma_f32_16x16x32_bf16 v[116:119], v[168:171], a[236:239], v[116:119]
    ds_read_b64_tr_b16 v[192:193], v240 offset:0
    v_mfma_f32_16x16x32_bf16 v[116:119], v[172:175], a[252:255], v[116:119]
    buffer_load_dwordx4 v232, s[52:55], s14 offen offset:2048 lds
    v_mfma_f32_16x16x32_bf16 v[84:87], v[172:175], a[248:251], v[84:87]
    ds_read_b64_tr_b16 v[194:195], v240 offset:512
    v_mfma_f32_16x16x32_bf16 v[84:87], v[168:171], a[232:235], v[84:87]
    ds_read_b64_tr_b16 v[196:197], v240 offset:4096
    v_mfma_f32_16x16x32_bf16 v[52:55], v[168:171], a[228:231], v[52:55]
    ds_read_b64_tr_b16 v[198:199], v240 offset:4608
    v_mfma_f32_16x16x32_bf16 v[52:55], v[172:175], a[244:247], v[52:55]
    v_mfma_f32_16x16x32_bf16 v[20:23], v[172:175], a[240:243], v[20:23]
    buffer_load_dwordx4 v233, s[52:55], s14 offen offset:3072 lds
    v_mfma_f32_16x16x32_bf16 v[20:23], v[168:171], a[224:227], v[20:23]
    v_add_u32 v241, 0x10000, v241
    v_mfma_f32_16x16x32_bf16 v[24:27], v[176:179], a[224:227], v[24:27]
    ds_read_b64_tr_b16 v[200:201], v241 offset:0
    v_mfma_f32_16x16x32_bf16 v[24:27], v[180:183], a[240:243], v[24:27]
    ds_read_b64_tr_b16 v[202:203], v241 offset:512
    v_mfma_f32_16x16x32_bf16 v[56:59], v[180:183], a[244:247], v[56:59]
    ds_read_b64_tr_b16 v[204:205], v241 offset:4096
    v_mfma_f32_16x16x32_bf16 v[56:59], v[176:179], a[228:231], v[56:59]
    ds_read_b64_tr_b16 v[206:207], v241 offset:4608
    v_mfma_f32_16x16x32_bf16 v[88:91], v[176:179], a[232:235], v[88:91]
    v_mfma_f32_16x16x32_bf16 v[88:91], v[180:183], a[248:251], v[88:91]
    v_mfma_f32_16x16x32_bf16 v[120:123], v[180:183], a[252:255], v[120:123]
    v_mfma_f32_16x16x32_bf16 v[120:123], v[176:179], a[236:239], v[120:123]
    v_add_u32 v242, 0x10000, v242
    v_mfma_f32_16x16x32_bf16 v[124:127], v[184:187], a[236:239], v[124:127]
    ds_read_b64_tr_b16 v[208:209], v242 offset:0
    v_mfma_f32_16x16x32_bf16 v[124:127], v[188:191], a[252:255], v[124:127]
    ds_read_b64_tr_b16 v[210:211], v242 offset:512
    v_mfma_f32_16x16x32_bf16 v[92:95], v[188:191], a[248:251], v[92:95]
    ds_read_b64_tr_b16 v[212:213], v242 offset:4096
    v_mfma_f32_16x16x32_bf16 v[92:95], v[184:187], a[232:235], v[92:95]
    ds_read_b64_tr_b16 v[214:215], v242 offset:4608
    v_mfma_f32_16x16x32_bf16 v[60:63], v[184:187], a[228:231], v[60:63]
    v_mfma_f32_16x16x32_bf16 v[60:63], v[188:191], a[244:247], v[60:63]
    v_mfma_f32_16x16x32_bf16 v[28:31], v[188:191], a[240:243], v[28:31]
    v_mfma_f32_16x16x32_bf16 v[28:31], v[184:187], a[224:227], v[28:31]
    s_waitcnt lgkmcnt(8)
    v_add_u32 v243, 0x10000, v243
    v_mfma_f32_16x16x32_bf16 v[128:131], a[0:3], v[192:195], 0
    ds_read_b64_tr_b16 v[216:217], v243 offset:0
    v_mfma_f32_16x16x32_bf16 v[128:131], a[16:19], v[196:199], v[128:131]
    ds_read_b64_tr_b16 v[218:219], v243 offset:512
    v_mfma_f32_16x16x32_bf16 v[132:135], a[20:23], v[196:199], 0
    ds_read_b64_tr_b16 v[220:221], v243 offset:4096
    v_mfma_f32_16x16x32_bf16 v[132:135], a[4:7], v[192:195], v[132:135]
    ds_read_b64_tr_b16 v[222:223], v243 offset:4608
    v_mfma_f32_16x16x32_bf16 v[160:163], a[8:11], v[192:195], 0
    v_mfma_f32_16x16x32_bf16 v[160:163], a[24:27], v[196:199], v[160:163]
    v_mfma_f32_16x16x32_bf16 v[164:167], a[28:31], v[196:199], 0
    v_mfma_f32_16x16x32_bf16 v[164:167], a[12:15], v[192:195], v[164:167]
    s_waitcnt lgkmcnt(8)
    ds_read_b64_tr_b16 v[192:193], v240 offset:8192
    v_mfma_f32_16x16x32_bf16 v[172:175], a[12:15], v[200:203], 0
    ds_read_b64_tr_b16 v[194:195], v240 offset:8704
    v_mul_f32 v64, s31, v64
    v_mfma_f32_16x16x32_bf16 v[172:175], a[28:31], v[204:207], v[172:175]
    ds_read_b64_tr_b16 v[196:197], v240 offset:12288
    v_mul_f32 v65, s31, v65
    v_mfma_f32_16x16x32_bf16 v[168:171], a[24:27], v[204:207], 0
    ds_read_b64_tr_b16 v[198:199], v240 offset:12800
    v_mul_f32 v66, s31, v66
    v_mfma_f32_16x16x32_bf16 v[168:171], a[8:11], v[200:203], v[168:171]
    v_mul_f32 v67, s31, v67
    v_mul_f32 v68, s31, v68
    v_mfma_f32_16x16x32_bf16 v[140:143], a[4:7], v[200:203], 0
    v_mul_f32 v69, s31, v69
    v_mul_f32 v70, s31, v70
    v_mfma_f32_16x16x32_bf16 v[140:143], a[20:23], v[204:207], v[140:143]
    v_mul_f32 v71, s31, v71
    v_cvt_pk_bf16_f32 v64, v64, v65
    v_mfma_f32_16x16x32_bf16 v[136:139], a[16:19], v[204:207], 0
    v_cvt_pk_bf16_f32 v65, v66, v67
    v_cvt_pk_bf16_f32 v66, v68, v69
    v_mfma_f32_16x16x32_bf16 v[136:139], a[0:3], v[200:203], v[136:139]
    s_waitcnt lgkmcnt(8)
    ds_read_b64_tr_b16 v[200:201], v241 offset:8192
    v_cvt_pk_bf16_f32 v67, v70, v71
    v_mfma_f32_16x16x32_bf16 v[144:147], a[0:3], v[208:211], 0
    ds_read_b64_tr_b16 v[202:203], v241 offset:8704
    v_mfma_f32_16x16x32_bf16 v[144:147], a[16:19], v[212:215], v[144:147]
    ds_read_b64_tr_b16 v[204:205], v241 offset:12288
    v_mfma_f32_16x16x32_bf16 v[148:151], a[20:23], v[212:215], 0
    ds_read_b64_tr_b16 v[206:207], v241 offset:12800
    v_mfma_f32_16x16x32_bf16 v[148:151], a[4:7], v[208:211], v[148:151]
    v_mfma_f32_16x16x32_bf16 v[176:179], a[8:11], v[208:211], 0
    v_mfma_f32_16x16x32_bf16 v[176:179], a[24:27], v[212:215], v[176:179]
    v_mfma_f32_16x16x32_bf16 v[180:183], a[28:31], v[212:215], 0
    v_mul_f32 v72, s31, v72
    v_mul_f32 v73, s31, v73
    v_mfma_f32_16x16x32_bf16 v[180:183], a[12:15], v[208:211], v[180:183]
    s_waitcnt lgkmcnt(8)
    ds_read_b64_tr_b16 v[208:209], v242 offset:8192
    v_mul_f32 v74, s31, v74
    v_mfma_f32_16x16x32_bf16 v[188:191], a[12:15], v[216:219], 0
    ds_read_b64_tr_b16 v[210:211], v242 offset:8704
    v_mul_f32 v75, s31, v75
    v_mfma_f32_16x16x32_bf16 v[188:191], a[28:31], v[220:223], v[188:191]
    ds_read_b64_tr_b16 v[212:213], v242 offset:12288
    v_mul_f32 v76, s31, v76
    v_mfma_f32_16x16x32_bf16 v[184:187], a[24:27], v[220:223], 0
    ds_read_b64_tr_b16 v[214:215], v242 offset:12800
    v_mul_f32 v77, s31, v77
    v_mfma_f32_16x16x32_bf16 v[184:187], a[8:11], v[216:219], v[184:187]
    v_mul_f32 v78, s31, v78
    v_mul_f32 v79, s31, v79
    v_mfma_f32_16x16x32_bf16 v[156:159], a[4:7], v[216:219], 0
    v_cvt_pk_bf16_f32 v72, v72, v73
    v_cvt_pk_bf16_f32 v73, v74, v75
    v_mfma_f32_16x16x32_bf16 v[156:159], a[20:23], v[220:223], v[156:159]
    v_cvt_pk_bf16_f32 v74, v76, v77
    v_cvt_pk_bf16_f32 v75, v78, v79
    v_mfma_f32_16x16x32_bf16 v[152:155], a[16:19], v[220:223], 0
    s_add_u32 s15, s25, 16384
    buffer_store_dwordx4 v[64:67], v224, s[64:67], s15 offen offset:0 sc1
    v_mfma_f32_16x16x32_bf16 v[152:155], a[0:3], v[216:219], v[152:155]
    s_waitcnt lgkmcnt(8)
    ds_read_b64_tr_b16 v[216:217], v243 offset:8192
    v_mfma_f32_16x16x32_bf16 v[128:131], a[32:35], v[192:195], v[128:131]
    ds_read_b64_tr_b16 v[218:219], v243 offset:8704
    ds_read_b64_tr_b16 v[220:221], v243 offset:12288
    v_mfma_f32_16x16x32_bf16 v[128:131], a[48:51], v[196:199], v[128:131]
    ds_read_b64_tr_b16 v[222:223], v243 offset:12800
    v_mfma_f32_16x16x32_bf16 v[132:135], a[52:55], v[196:199], v[132:135]
    v_mfma_f32_16x16x32_bf16 v[132:135], a[36:39], v[192:195], v[132:135]
    v_mfma_f32_16x16x32_bf16 v[160:163], a[40:43], v[192:195], v[160:163]
    v_mul_f32 v80, s31, v80
    v_mul_f32 v81, s31, v81
    v_mfma_f32_16x16x32_bf16 v[160:163], a[56:59], v[196:199], v[160:163]
    v_mul_f32 v82, s31, v82
    v_mul_f32 v83, s31, v83
    v_mfma_f32_16x16x32_bf16 v[164:167], a[60:63], v[196:199], v[164:167]
    v_mul_f32 v84, s31, v84
    v_mul_f32 v85, s31, v85
    v_mfma_f32_16x16x32_bf16 v[164:167], a[44:47], v[192:195], v[164:167]
    s_waitcnt lgkmcnt(8)
    v_mul_f32 v86, s31, v86
    v_mul_f32 v87, s31, v87
    v_mfma_f32_16x16x32_bf16 v[172:175], a[44:47], v[200:203], v[172:175]
    v_cvt_pk_bf16_f32 v80, v80, v81
    v_cvt_pk_bf16_f32 v81, v82, v83
    v_mfma_f32_16x16x32_bf16 v[172:175], a[60:63], v[204:207], v[172:175]
    v_cvt_pk_bf16_f32 v82, v84, v85
    v_cvt_pk_bf16_f32 v83, v86, v87
    v_mfma_f32_16x16x32_bf16 v[168:171], a[56:59], v[204:207], v[168:171]
    s_waitcnt vmcnt(29)
    s_waitcnt lgkmcnt(0)
    s_barrier
    v_mfma_f32_16x16x32_bf16 v[168:171], a[40:43], v[200:203], v[168:171]
    s_add_u32 m0, s16, 65536
    s_add_u32 s14, s23, s36
    ds_read_b64_tr_b16 v[192:193], v240 offset:16384
    v_mfma_f32_16x16x32_bf16 v[140:143], a[36:39], v[200:203], v[140:143]
    buffer_load_dwordx4 v230, s[52:55], s14 offen offset:0 lds
    v_mfma_f32_16x16x32_bf16 v[140:143], a[52:55], v[204:207], v[140:143]
    ds_read_b64_tr_b16 v[194:195], v240 offset:16896
    v_mfma_f32_16x16x32_bf16 v[136:139], a[48:51], v[204:207], v[136:139]
    s_add_u32 s15, s25, 16384
    ds_read_b64_tr_b16 v[196:197], v240 offset:20480
    v_mfma_f32_16x16x32_bf16 v[136:139], a[32:35], v[200:203], v[136:139]
    ds_read_b64_tr_b16 v[198:199], v240 offset:20992
    v_mfma_f32_16x16x32_bf16 v[144:147], a[32:35], v[208:211], v[144:147]
    s_add_u32 s36, s36, 128
    s_sub_u32 s88, s36, 1152
    s_min_u32 s36, s36, s88
    v_mfma_f32_16x16x32_bf16 v[144:147], a[48:51], v[212:215], v[144:147]
    buffer_load_dwordx4 v231, s[52:55], s14 offen offset:1024 lds
    v_mfma_f32_16x16x32_bf16 v[148:151], a[52:55], v[212:215], v[148:151]
    ds_read_b64_tr_b16 v[200:201], v241 offset:16384
    v_mul_f32 v88, s31, v88
    v_mfma_f32_16x16x32_bf16 v[148:151], a[36:39], v[208:211], v[148:151]
    ds_read_b64_tr_b16 v[202:203], v241 offset:16896
    v_mul_f32 v89, s31, v89
    v_mfma_f32_16x16x32_bf16 v[176:179], a[40:43], v[208:211], v[176:179]
    buffer_store_dwordx4 v[72:75], v224, s[64:67], s15 offen offset:1024 sc1
    v_mfma_f32_16x16x32_bf16 v[176:179], a[56:59], v[212:215], v[176:179]
    ds_read_b64_tr_b16 v[204:205], v241 offset:20480
    v_mul_f32 v90, s31, v90
    v_mfma_f32_16x16x32_bf16 v[180:183], a[60:63], v[212:215], v[180:183]
    ds_read_b64_tr_b16 v[206:207], v241 offset:20992
    v_mul_f32 v91, s31, v91
    v_mfma_f32_16x16x32_bf16 v[180:183], a[44:47], v[208:211], v[180:183]
    buffer_load_dwordx4 v232, s[52:55], s14 offen offset:2048 lds
    v_mfma_f32_16x16x32_bf16 v[188:191], a[44:47], v[216:219], v[188:191]
    ds_read_b64_tr_b16 v[208:209], v242 offset:16384
    v_mul_f32 v92, s31, v92
    v_mfma_f32_16x16x32_bf16 v[188:191], a[60:63], v[220:223], v[188:191]
    ds_read_b64_tr_b16 v[210:211], v242 offset:16896
    v_mul_f32 v93, s31, v93
    v_mfma_f32_16x16x32_bf16 v[184:187], a[56:59], v[220:223], v[184:187]
    buffer_load_dwordx4 v233, s[52:55], s14 offen offset:3072 lds
    v_mfma_f32_16x16x32_bf16 v[184:187], a[40:43], v[216:219], v[184:187]
    ds_read_b64_tr_b16 v[212:213], v242 offset:20480
    v_mul_f32 v94, s31, v94
    v_mfma_f32_16x16x32_bf16 v[156:159], a[36:39], v[216:219], v[156:159]
    ds_read_b64_tr_b16 v[214:215], v242 offset:20992
    v_mul_f32 v95, s31, v95
    v_mfma_f32_16x16x32_bf16 v[156:159], a[52:55], v[220:223], v[156:159]
    v_cvt_pk_bf16_f32 v88, v88, v89
    v_cvt_pk_bf16_f32 v89, v90, v91
    v_mfma_f32_16x16x32_bf16 v[152:155], a[48:51], v[220:223], v[152:155]
    s_add_u32 s15, s25, 16384
    buffer_store_dwordx4 v[80:83], v224, s[64:67], s15 offen offset:2048 sc1
    v_mfma_f32_16x16x32_bf16 v[152:155], a[32:35], v[216:219], v[152:155]
    s_waitcnt lgkmcnt(8)
    ds_read_b64_tr_b16 v[216:217], v243 offset:16384
    v_cvt_pk_bf16_f32 v90, v92, v93
    v_mfma_f32_16x16x32_bf16 v[128:131], a[64:67], v[192:195], v[128:131]
    ds_read_b64_tr_b16 v[218:219], v243 offset:16896
    v_cvt_pk_bf16_f32 v91, v94, v95
    v_mfma_f32_16x16x32_bf16 v[128:131], a[80:83], v[196:199], v[128:131]
    ds_read_b64_tr_b16 v[220:221], v243 offset:20480
    v_mul_f32 v96, s31, v96
    v_mfma_f32_16x16x32_bf16 v[132:135], a[84:87], v[196:199], v[132:135]
    ds_read_b64_tr_b16 v[222:223], v243 offset:20992
    v_mul_f32 v97, s31, v97
    v_mfma_f32_16x16x32_bf16 v[132:135], a[68:71], v[192:195], v[132:135]
    v_mul_f32 v98, s31, v98
    v_mul_f32 v99, s31, v99
    v_mfma_f32_16x16x32_bf16 v[160:163], a[72:75], v[192:195], v[160:163]
    v_mul_f32 v100, s31, v100
    v_mul_f32 v101, s31, v101
    v_mfma_f32_16x16x32_bf16 v[160:163], a[88:91], v[196:199], v[160:163]
    v_mul_f32 v102, s31, v102
    v_mul_f32 v103, s31, v103
    v_mfma_f32_16x16x32_bf16 v[164:167], a[92:95], v[196:199], v[164:167]
    v_cvt_pk_bf16_f32 v96, v96, v97
    v_cvt_pk_bf16_f32 v97, v98, v99
    v_mfma_f32_16x16x32_bf16 v[164:167], a[76:79], v[192:195], v[164:167]
    s_waitcnt lgkmcnt(8)
    ds_read_b64_tr_b16 v[192:193], v240 offset:24576
    v_cvt_pk_bf16_f32 v98, v100, v101
    v_mfma_f32_16x16x32_bf16 v[172:175], a[76:79], v[200:203], v[172:175]
    ds_read_b64_tr_b16 v[194:195], v240 offset:25088
    v_cvt_pk_bf16_f32 v99, v102, v103
    v_mfma_f32_16x16x32_bf16 v[172:175], a[92:95], v[204:207], v[172:175]
    ds_read_b64_tr_b16 v[196:197], v240 offset:28672
    v_mfma_f32_16x16x32_bf16 v[168:171], a[88:91], v[204:207], v[168:171]
    ds_read_b64_tr_b16 v[198:199], v240 offset:29184
    v_mfma_f32_16x16x32_bf16 v[168:171], a[72:75], v[200:203], v[168:171]
    v_mfma_f32_16x16x32_bf16 v[140:143], a[68:71], v[200:203], v[140:143]
    v_mfma_f32_16x16x32_bf16 v[140:143], a[84:87], v[204:207], v[140:143]
    v_mfma_f32_16x16x32_bf16 v[136:139], a[80:83], v[204:207], v[136:139]
    s_add_u32 s15, s25, 16384
    buffer_store_dwordx4 v[88:91], v224, s[64:67], s15 offen offset:3072 sc1
    v_mfma_f32_16x16x32_bf16 v[136:139], a[64:67], v[200:203], v[136:139]
    s_waitcnt lgkmcnt(8)
    ds_read_b64_tr_b16 v[200:201], v241 offset:24576
    v_mul_f32 v104, s31, v104
    v_mfma_f32_16x16x32_bf16 v[144:147], a[64:67], v[208:211], v[144:147]
    ds_read_b64_tr_b16 v[202:203], v241 offset:25088
    v_mul_f32 v105, s31, v105
    v_mfma_f32_16x16x32_bf16 v[144:147], a[80:83], v[212:215], v[144:147]
    ds_read_b64_tr_b16 v[204:205], v241 offset:28672
    v_mul_f32 v106, s31, v106
    v_mfma_f32_16x16x32_bf16 v[148:151], a[84:87], v[212:215], v[148:151]
    ds_read_b64_tr_b16 v[206:207], v241 offset:29184
    v_mul_f32 v107, s31, v107
    v_mfma_f32_16x16x32_bf16 v[148:151], a[68:71], v[208:211], v[148:151]
    v_mul_f32 v108, s31, v108
    v_mul_f32 v109, s31, v109
    v_mfma_f32_16x16x32_bf16 v[176:179], a[72:75], v[208:211], v[176:179]
    v_mul_f32 v110, s31, v110
    v_mul_f32 v111, s31, v111
    v_mfma_f32_16x16x32_bf16 v[176:179], a[88:91], v[212:215], v[176:179]
    v_cvt_pk_bf16_f32 v104, v104, v105
    v_cvt_pk_bf16_f32 v105, v106, v107
    v_mfma_f32_16x16x32_bf16 v[180:183], a[92:95], v[212:215], v[180:183]
    v_cvt_pk_bf16_f32 v106, v108, v109
    v_cvt_pk_bf16_f32 v107, v110, v111
    v_mfma_f32_16x16x32_bf16 v[180:183], a[76:79], v[208:211], v[180:183]
    s_waitcnt lgkmcnt(8)
    ds_read_b64_tr_b16 v[208:209], v242 offset:24576
    v_mfma_f32_16x16x32_bf16 v[188:191], a[76:79], v[216:219], v[188:191]
    ds_read_b64_tr_b16 v[210:211], v242 offset:25088
    v_mfma_f32_16x16x32_bf16 v[188:191], a[92:95], v[220:223], v[188:191]
    ds_read_b64_tr_b16 v[212:213], v242 offset:28672
    v_mfma_f32_16x16x32_bf16 v[184:187], a[88:91], v[220:223], v[184:187]
    ds_read_b64_tr_b16 v[214:215], v242 offset:29184
    v_mfma_f32_16x16x32_bf16 v[184:187], a[72:75], v[216:219], v[184:187]
    v_mfma_f32_16x16x32_bf16 v[156:159], a[68:71], v[216:219], v[156:159]
    v_mul_f32 v112, s31, v112
    v_mul_f32 v113, s31, v113
    v_mfma_f32_16x16x32_bf16 v[156:159], a[84:87], v[220:223], v[156:159]
    v_mul_f32 v114, s31, v114
    v_mul_f32 v115, s31, v115
    v_mfma_f32_16x16x32_bf16 v[152:155], a[80:83], v[220:223], v[152:155]
    s_add_u32 s15, s25, 20480
    buffer_store_dwordx4 v[96:99], v224, s[64:67], s15 offen offset:0 sc1
    v_mfma_f32_16x16x32_bf16 v[152:155], a[64:67], v[216:219], v[152:155]
    s_waitcnt lgkmcnt(8)
    ds_read_b64_tr_b16 v[216:217], v243 offset:24576
    v_mul_f32 v116, s31, v116
    v_mfma_f32_16x16x32_bf16 v[128:131], a[96:99], v[192:195], v[128:131]
    ds_read_b64_tr_b16 v[218:219], v243 offset:25088
    ds_read_b64_tr_b16 v[220:221], v243 offset:28672
    v_mfma_f32_16x16x32_bf16 v[128:131], a[112:115], v[196:199], v[128:131]
    ds_read_b64_tr_b16 v[222:223], v243 offset:29184
    v_mul_f32 v117, s31, v117
    v_mfma_f32_16x16x32_bf16 v[132:135], a[116:119], v[196:199], v[132:135]
    v_mul_f32 v118, s31, v118
    v_mul_f32 v119, s31, v119
    v_mfma_f32_16x16x32_bf16 v[132:135], a[100:103], v[192:195], v[132:135]
    v_cvt_pk_bf16_f32 v112, v112, v113
    v_cvt_pk_bf16_f32 v113, v114, v115
    v_mfma_f32_16x16x32_bf16 v[160:163], a[104:107], v[192:195], v[160:163]
    v_cvt_pk_bf16_f32 v114, v116, v117
    v_cvt_pk_bf16_f32 v115, v118, v119
    v_mfma_f32_16x16x32_bf16 v[160:163], a[120:123], v[196:199], v[160:163]
    v_mfma_f32_16x16x32_bf16 v[164:167], a[124:127], v[196:199], v[164:167]
    v_mfma_f32_16x16x32_bf16 v[164:167], a[108:111], v[192:195], v[164:167]
    s_waitcnt lgkmcnt(8)
    v_mfma_f32_16x16x32_bf16 v[172:175], a[108:111], v[200:203], v[172:175]
    v_mfma_f32_16x16x32_bf16 v[172:175], a[124:127], v[204:207], v[172:175]
    v_mfma_f32_16x16x32_bf16 v[168:171], a[120:123], v[204:207], v[168:171]
    s_waitcnt vmcnt(33)
    s_waitcnt lgkmcnt(0)
    s_barrier
    v_mfma_f32_16x16x32_bf16 v[168:171], a[104:107], v[200:203], v[168:171]
    ds_read_b64_tr_b16 v[192:193], v240 offset:32768
    v_bfe_u32 v248, v224, 4, 4
    v_mfma_f32_16x16x32_bf16 v[140:143], a[100:103], v[200:203], v[140:143]
    ds_read_b64_tr_b16 v[194:195], v240 offset:33280
    v_lshlrev_b32 v248, 2, v248
    v_mfma_f32_16x16x32_bf16 v[140:143], a[116:119], v[204:207], v[140:143]
    s_lshl_b32 s9, s7, 7
    s_add_u32 s9, s9, 59054080
    ds_read_b64_tr_b16 v[196:197], v240 offset:36864
    v_mfma_f32_16x16x32_bf16 v[136:139], a[112:115], v[204:207], v[136:139]
    s_add_u32 s15, s25, 20480
    buffer_load_dword v247, v248, s[64:67], s9 offen sc1
    v_mfma_f32_16x16x32_bf16 v[136:139], a[96:99], v[200:203], v[136:139]
    ds_read_b64_tr_b16 v[198:199], v240 offset:37376
    v_mul_f32 v120, s31, v120
    v_mfma_f32_16x16x32_bf16 v[144:147], a[96:99], v[208:211], v[144:147]
    ds_read_b64_tr_b16 v[200:201], v241 offset:32768
    v_mul_f32 v121, s31, v121
    v_mfma_f32_16x16x32_bf16 v[144:147], a[112:115], v[212:215], v[144:147]
    buffer_store_dwordx4 v[104:107], v224, s[64:67], s15 offen offset:1024 sc1
    v_mfma_f32_16x16x32_bf16 v[148:151], a[116:119], v[212:215], v[148:151]
    ds_read_b64_tr_b16 v[202:203], v241 offset:33280
    v_mul_f32 v122, s31, v122
    v_mfma_f32_16x16x32_bf16 v[148:151], a[100:103], v[208:211], v[148:151]
    ds_read_b64_tr_b16 v[204:205], v241 offset:36864
    v_mul_f32 v123, s31, v123
    v_mfma_f32_16x16x32_bf16 v[176:179], a[104:107], v[208:211], v[176:179]
    ds_read_b64_tr_b16 v[206:207], v241 offset:37376
    v_mul_f32 v124, s31, v124
    v_mfma_f32_16x16x32_bf16 v[176:179], a[120:123], v[212:215], v[176:179]
    v_mul_f32 v125, s31, v125
    v_mul_f32 v126, s31, v126
    v_mfma_f32_16x16x32_bf16 v[180:183], a[124:127], v[212:215], v[180:183]
    v_mul_f32 v127, s31, v127
    v_cvt_pk_bf16_f32 v120, v120, v121
    v_mfma_f32_16x16x32_bf16 v[180:183], a[108:111], v[208:211], v[180:183]
    ds_read_b64_tr_b16 v[208:209], v242 offset:32768
    v_cvt_pk_bf16_f32 v121, v122, v123
    v_mfma_f32_16x16x32_bf16 v[188:191], a[108:111], v[216:219], v[188:191]
    ds_read_b64_tr_b16 v[210:211], v242 offset:33280
    v_cvt_pk_bf16_f32 v122, v124, v125
    v_mfma_f32_16x16x32_bf16 v[188:191], a[124:127], v[220:223], v[188:191]
    ds_read_b64_tr_b16 v[212:213], v242 offset:36864
    v_cvt_pk_bf16_f32 v123, v126, v127
    v_mfma_f32_16x16x32_bf16 v[184:187], a[120:123], v[220:223], v[184:187]
    ds_read_b64_tr_b16 v[214:215], v242 offset:37376
    v_mul_f32 v0, s31, v0
    v_mfma_f32_16x16x32_bf16 v[184:187], a[104:107], v[216:219], v[184:187]
    v_mul_f32 v1, s31, v1
    v_mul_f32 v2, s31, v2
    v_mfma_f32_16x16x32_bf16 v[156:159], a[100:103], v[216:219], v[156:159]
    v_mul_f32 v3, s31, v3
    v_mul_f32 v4, s31, v4
    v_mfma_f32_16x16x32_bf16 v[156:159], a[116:119], v[220:223], v[156:159]
    v_mul_f32 v5, s31, v5
    v_mul_f32 v6, s31, v6
    v_mfma_f32_16x16x32_bf16 v[152:155], a[112:115], v[220:223], v[152:155]
    s_add_u32 s15, s25, 20480
    buffer_store_dwordx4 v[112:115], v224, s[64:67], s15 offen offset:2048 sc1
    v_mfma_f32_16x16x32_bf16 v[152:155], a[96:99], v[216:219], v[152:155]
    s_waitcnt lgkmcnt(8)
    ds_read_b64_tr_b16 v[216:217], v243 offset:32768
    v_mul_f32 v7, s31, v7
    v_mfma_f32_16x16x32_bf16 v[128:131], a[128:131], v[192:195], v[128:131]
    ds_read_b64_tr_b16 v[218:219], v243 offset:33280
    v_cvt_pk_bf16_f32 v68, v0, v1
    v_mfma_f32_16x16x32_bf16 v[128:131], a[144:147], v[196:199], v[128:131]
    ds_read_b64_tr_b16 v[220:221], v243 offset:36864
    v_cvt_pk_bf16_f32 v69, v2, v3
    v_mfma_f32_16x16x32_bf16 v[132:135], a[148:151], v[196:199], v[132:135]
    ds_read_b64_tr_b16 v[222:223], v243 offset:37376
    v_cvt_pk_bf16_f32 v70, v4, v5
    v_mfma_f32_16x16x32_bf16 v[132:135], a[132:135], v[192:195], v[132:135]
    v_cvt_pk_bf16_f32 v71, v6, v7
    v_mfma_f32_16x16x32_bf16 v[160:163], a[136:139], v[192:195], v[160:163]
    v_mfma_f32_16x16x32_bf16 v[160:163], a[152:155], v[196:199], v[160:163]
    v_mfma_f32_16x16x32_bf16 v[164:167], a[156:159], v[196:199], v[164:167]
    v_mul_f32 v8, s31, v8
    v_mul_f32 v9, s31, v9
    v_mfma_f32_16x16x32_bf16 v[164:167], a[140:143], v[192:195], v[164:167]
    s_waitcnt lgkmcnt(8)
    ds_read_b64_tr_b16 v[192:193], v240 offset:40960
    v_mul_f32 v10, s31, v10
    v_mfma_f32_16x16x32_bf16 v[172:175], a[140:143], v[200:203], v[172:175]
    ds_read_b64_tr_b16 v[194:195], v240 offset:41472
    v_mul_f32 v11, s31, v11
    v_mfma_f32_16x16x32_bf16 v[172:175], a[156:159], v[204:207], v[172:175]
    ds_read_b64_tr_b16 v[196:197], v240 offset:45056
    v_mul_f32 v12, s31, v12
    v_mfma_f32_16x16x32_bf16 v[168:171], a[152:155], v[204:207], v[168:171]
    ds_read_b64_tr_b16 v[198:199], v240 offset:45568
    v_mul_f32 v13, s31, v13
    v_mfma_f32_16x16x32_bf16 v[168:171], a[136:139], v[200:203], v[168:171]
    v_mul_f32 v14, s31, v14
    v_mul_f32 v15, s31, v15
    v_mfma_f32_16x16x32_bf16 v[140:143], a[132:135], v[200:203], v[140:143]
    v_cvt_pk_bf16_f32 v76, v8, v9
    v_cvt_pk_bf16_f32 v77, v10, v11
    v_mfma_f32_16x16x32_bf16 v[140:143], a[148:151], v[204:207], v[140:143]
    v_cvt_pk_bf16_f32 v78, v12, v13
    v_cvt_pk_bf16_f32 v79, v14, v15
    v_mfma_f32_16x16x32_bf16 v[136:139], a[144:147], v[204:207], v[136:139]
    s_add_u32 s15, s25, 20480
    buffer_store_dwordx4 v[120:123], v224, s[64:67], s15 offen offset:3072 sc1
    v_mfma_f32_16x16x32_bf16 v[136:139], a[128:131], v[200:203], v[136:139]
    s_waitcnt lgkmcnt(8)
    ds_read_b64_tr_b16 v[200:201], v241 offset:40960
    v_mfma_f32_16x16x32_bf16 v[144:147], a[128:131], v[208:211], v[144:147]
    ds_read_b64_tr_b16 v[202:203], v241 offset:41472
    v_mfma_f32_16x16x32_bf16 v[144:147], a[144:147], v[212:215], v[144:147]
    ds_read_b64_tr_b16 v[204:205], v241 offset:45056
    v_mfma_f32_16x16x32_bf16 v[148:151], a[148:151], v[212:215], v[148:151]
    ds_read_b64_tr_b16 v[206:207], v241 offset:45568
    v_mfma_f32_16x16x32_bf16 v[148:151], a[132:135], v[208:211], v[148:151]
    v_mfma_f32_16x16x32_bf16 v[176:179], a[136:139], v[208:211], v[176:179]
    v_mul_f32 v16, s31, v16
    v_mul_f32 v17, s31, v17
    v_mfma_f32_16x16x32_bf16 v[176:179], a[152:155], v[212:215], v[176:179]
    v_mul_f32 v18, s31, v18
    v_mul_f32 v19, s31, v19
    v_mfma_f32_16x16x32_bf16 v[180:183], a[156:159], v[212:215], v[180:183]
    v_mul_f32 v20, s31, v20
    v_mul_f32 v21, s31, v21
    v_mfma_f32_16x16x32_bf16 v[180:183], a[140:143], v[208:211], v[180:183]
    s_waitcnt lgkmcnt(8)
    ds_read_b64_tr_b16 v[208:209], v242 offset:40960
    v_mul_f32 v22, s31, v22
    v_mfma_f32_16x16x32_bf16 v[188:191], a[140:143], v[216:219], v[188:191]
    ds_read_b64_tr_b16 v[210:211], v242 offset:41472
    v_mul_f32 v23, s31, v23
    v_mfma_f32_16x16x32_bf16 v[188:191], a[156:159], v[220:223], v[188:191]
    ds_read_b64_tr_b16 v[212:213], v242 offset:45056
    v_cvt_pk_bf16_f32 v84, v16, v17
    v_mfma_f32_16x16x32_bf16 v[184:187], a[152:155], v[220:223], v[184:187]
    ds_read_b64_tr_b16 v[214:215], v242 offset:45568
    v_cvt_pk_bf16_f32 v85, v18, v19
    v_mfma_f32_16x16x32_bf16 v[184:187], a[136:139], v[216:219], v[184:187]
    v_cvt_pk_bf16_f32 v86, v20, v21
    v_cvt_pk_bf16_f32 v87, v22, v23
    v_mfma_f32_16x16x32_bf16 v[156:159], a[132:135], v[216:219], v[156:159]
    v_mfma_f32_16x16x32_bf16 v[156:159], a[148:151], v[220:223], v[156:159]
    v_mfma_f32_16x16x32_bf16 v[152:155], a[144:147], v[220:223], v[152:155]
    s_add_u32 s15, s25, 0
    buffer_store_dwordx4 v[68:71], v224, s[64:67], s15 offen offset:0 sc1
    v_mfma_f32_16x16x32_bf16 v[152:155], a[128:131], v[216:219], v[152:155]
    s_waitcnt lgkmcnt(8)
    ds_read_b64_tr_b16 v[216:217], v243 offset:40960
    v_mfma_f32_16x16x32_bf16 v[128:131], a[160:163], v[192:195], v[128:131]
    ds_read_b64_tr_b16 v[218:219], v243 offset:41472
    ds_read_b64_tr_b16 v[220:221], v243 offset:45056
    v_mfma_f32_16x16x32_bf16 v[128:131], a[176:179], v[196:199], v[128:131]
    ds_read_b64_tr_b16 v[222:223], v243 offset:45568
    v_mfma_f32_16x16x32_bf16 v[132:135], a[180:183], v[196:199], v[132:135]
    v_mul_f32 v24, s31, v24
    v_mul_f32 v25, s31, v25
    v_mfma_f32_16x16x32_bf16 v[132:135], a[164:167], v[192:195], v[132:135]
    v_mul_f32 v26, s31, v26
    v_mul_f32 v27, s31, v27
    v_mfma_f32_16x16x32_bf16 v[160:163], a[168:171], v[192:195], v[160:163]
    v_mul_f32 v28, s31, v28
    v_mul_f32 v29, s31, v29
    v_mfma_f32_16x16x32_bf16 v[160:163], a[184:187], v[196:199], v[160:163]
    v_mul_f32 v30, s31, v30
    v_mul_f32 v31, s31, v31
    v_mfma_f32_16x16x32_bf16 v[164:167], a[188:191], v[196:199], v[164:167]
    v_cvt_pk_bf16_f32 v92, v24, v25
    v_cvt_pk_bf16_f32 v93, v26, v27
    v_mfma_f32_16x16x32_bf16 v[164:167], a[172:175], v[192:195], v[164:167]
    s_waitcnt lgkmcnt(8)
    v_cvt_pk_bf16_f32 v94, v28, v29
    v_cvt_pk_bf16_f32 v95, v30, v31
    v_mfma_f32_16x16x32_bf16 v[172:175], a[172:175], v[200:203], v[172:175]
    v_mfma_f32_16x16x32_bf16 v[172:175], a[188:191], v[204:207], v[172:175]
    v_mfma_f32_16x16x32_bf16 v[168:171], a[184:187], v[204:207], v[168:171]
    s_waitcnt vmcnt(34)
    s_waitcnt lgkmcnt(0)
    s_barrier
    v_mfma_f32_16x16x32_bf16 v[168:171], a[168:171], v[200:203], v[168:171]
    s_add_u32 m0, s16, 98304
    s_add_u32 s14, s23, s36
    ds_read_b64_tr_b16 v[192:193], v240 offset:49152
    v_mfma_f32_16x16x32_bf16 v[140:143], a[164:167], v[200:203], v[140:143]
    buffer_load_dwordx4 v230, s[52:55], s14 offen offset:0 lds
    v_mfma_f32_16x16x32_bf16 v[140:143], a[180:183], v[204:207], v[140:143]
    ds_read_b64_tr_b16 v[194:195], v240 offset:49664
    v_mfma_f32_16x16x32_bf16 v[136:139], a[176:179], v[204:207], v[136:139]
    s_add_u32 s15, s25, 0
    ds_read_b64_tr_b16 v[196:197], v240 offset:53248
    v_mfma_f32_16x16x32_bf16 v[136:139], a[160:163], v[200:203], v[136:139]
    ds_read_b64_tr_b16 v[198:199], v240 offset:53760
    v_mfma_f32_16x16x32_bf16 v[144:147], a[160:163], v[208:211], v[144:147]
    s_add_u32 s36, s36, 128
    s_sub_u32 s88, s36, 1152
    s_min_u32 s36, s36, s88
    v_mfma_f32_16x16x32_bf16 v[144:147], a[176:179], v[212:215], v[144:147]
    buffer_load_dwordx4 v231, s[52:55], s14 offen offset:1024 lds
    v_mfma_f32_16x16x32_bf16 v[148:151], a[180:183], v[212:215], v[148:151]
    ds_read_b64_tr_b16 v[200:201], v241 offset:49152
    v_mul_f32 v32, s31, v32
    v_mfma_f32_16x16x32_bf16 v[148:151], a[164:167], v[208:211], v[148:151]
    ds_read_b64_tr_b16 v[202:203], v241 offset:49664
    v_mul_f32 v33, s31, v33
    v_mfma_f32_16x16x32_bf16 v[176:179], a[168:171], v[208:211], v[176:179]
    buffer_store_dwordx4 v[76:79], v224, s[64:67], s15 offen offset:1024 sc1
    v_mfma_f32_16x16x32_bf16 v[176:179], a[184:187], v[212:215], v[176:179]
    ds_read_b64_tr_b16 v[204:205], v241 offset:53248
    v_mul_f32 v34, s31, v34
    v_mfma_f32_16x16x32_bf16 v[180:183], a[188:191], v[212:215], v[180:183]
    ds_read_b64_tr_b16 v[206:207], v241 offset:53760
    v_mul_f32 v35, s31, v35
    v_mfma_f32_16x16x32_bf16 v[180:183], a[172:175], v[208:211], v[180:183]
    buffer_load_dwordx4 v232, s[52:55], s14 offen offset:2048 lds
    v_mfma_f32_16x16x32_bf16 v[188:191], a[172:175], v[216:219], v[188:191]
    ds_read_b64_tr_b16 v[208:209], v242 offset:49152
    v_mul_f32 v36, s31, v36
    v_mfma_f32_16x16x32_bf16 v[188:191], a[188:191], v[220:223], v[188:191]
    ds_read_b64_tr_b16 v[210:211], v242 offset:49664
    v_mul_f32 v37, s31, v37
    v_mfma_f32_16x16x32_bf16 v[184:187], a[184:187], v[220:223], v[184:187]
    buffer_load_dwordx4 v233, s[52:55], s14 offen offset:3072 lds
    v_mfma_f32_16x16x32_bf16 v[184:187], a[168:171], v[216:219], v[184:187]
    ds_read_b64_tr_b16 v[212:213], v242 offset:53248
    v_mul_f32 v38, s31, v38
    v_mfma_f32_16x16x32_bf16 v[156:159], a[164:167], v[216:219], v[156:159]
    ds_read_b64_tr_b16 v[214:215], v242 offset:53760
    v_mul_f32 v39, s31, v39
    v_mfma_f32_16x16x32_bf16 v[156:159], a[180:183], v[220:223], v[156:159]
    v_cvt_pk_bf16_f32 v100, v32, v33
    v_cvt_pk_bf16_f32 v101, v34, v35
    v_mfma_f32_16x16x32_bf16 v[152:155], a[176:179], v[220:223], v[152:155]
    s_add_u32 s15, s25, 0
    buffer_store_dwordx4 v[84:87], v224, s[64:67], s15 offen offset:2048 sc1
    v_mfma_f32_16x16x32_bf16 v[152:155], a[160:163], v[216:219], v[152:155]
    s_waitcnt lgkmcnt(8)
    ds_read_b64_tr_b16 v[216:217], v243 offset:49152
    v_cvt_pk_bf16_f32 v102, v36, v37
    v_mfma_f32_16x16x32_bf16 v[128:131], a[192:195], v[192:195], v[128:131]
    ds_read_b64_tr_b16 v[218:219], v243 offset:49664
    v_cvt_pk_bf16_f32 v103, v38, v39
    v_mfma_f32_16x16x32_bf16 v[128:131], a[208:211], v[196:199], v[128:131]
    ds_read_b64_tr_b16 v[220:221], v243 offset:53248
    v_mul_f32 v40, s31, v40
    v_mfma_f32_16x16x32_bf16 v[132:135], a[212:215], v[196:199], v[132:135]
    ds_read_b64_tr_b16 v[222:223], v243 offset:53760
    v_mul_f32 v41, s31, v41
    v_mfma_f32_16x16x32_bf16 v[132:135], a[196:199], v[192:195], v[132:135]
    v_mul_f32 v42, s31, v42
    v_mul_f32 v43, s31, v43
    v_mfma_f32_16x16x32_bf16 v[160:163], a[200:203], v[192:195], v[160:163]
    v_mul_f32 v44, s31, v44
    v_mul_f32 v45, s31, v45
    v_mfma_f32_16x16x32_bf16 v[160:163], a[216:219], v[196:199], v[160:163]
    v_mul_f32 v46, s31, v46
    v_mul_f32 v47, s31, v47
    v_mfma_f32_16x16x32_bf16 v[164:167], a[220:223], v[196:199], v[164:167]
    v_cvt_pk_bf16_f32 v108, v40, v41
    v_cvt_pk_bf16_f32 v109, v42, v43
    v_mfma_f32_16x16x32_bf16 v[164:167], a[204:207], v[192:195], v[164:167]
    s_waitcnt lgkmcnt(8)
    ds_read_b64_tr_b16 v[192:193], v240 offset:57344
    v_cvt_pk_bf16_f32 v110, v44, v45
    v_mfma_f32_16x16x32_bf16 v[172:175], a[204:207], v[200:203], v[172:175]
    ds_read_b64_tr_b16 v[194:195], v240 offset:57856
    v_cvt_pk_bf16_f32 v111, v46, v47
    v_mfma_f32_16x16x32_bf16 v[172:175], a[220:223], v[204:207], v[172:175]
    ds_read_b64_tr_b16 v[196:197], v240 offset:61440
    v_mfma_f32_16x16x32_bf16 v[168:171], a[216:219], v[204:207], v[168:171]
    ds_read_b64_tr_b16 v[198:199], v240 offset:61952
    v_mfma_f32_16x16x32_bf16 v[168:171], a[200:203], v[200:203], v[168:171]
    v_mfma_f32_16x16x32_bf16 v[140:143], a[196:199], v[200:203], v[140:143]
    v_mul_f32 v48, s31, v48
    v_mul_f32 v49, s31, v49
    v_mfma_f32_16x16x32_bf16 v[140:143], a[212:215], v[204:207], v[140:143]
    v_mul_f32 v50, s31, v50
    v_mul_f32 v51, s31, v51
    v_mfma_f32_16x16x32_bf16 v[136:139], a[208:211], v[204:207], v[136:139]
    s_add_u32 s15, s25, 0
    buffer_store_dwordx4 v[92:95], v224, s[64:67], s15 offen offset:3072 sc1
    v_mfma_f32_16x16x32_bf16 v[136:139], a[192:195], v[200:203], v[136:139]
    s_waitcnt lgkmcnt(8)
    ds_read_b64_tr_b16 v[200:201], v241 offset:57344
    v_mul_f32 v52, s31, v52
    v_mfma_f32_16x16x32_bf16 v[144:147], a[192:195], v[208:211], v[144:147]
    ds_read_b64_tr_b16 v[202:203], v241 offset:57856
    v_mul_f32 v53, s31, v53
    v_mfma_f32_16x16x32_bf16 v[144:147], a[208:211], v[212:215], v[144:147]
    ds_read_b64_tr_b16 v[204:205], v241 offset:61440
    v_mul_f32 v54, s31, v54
    v_mfma_f32_16x16x32_bf16 v[148:151], a[212:215], v[212:215], v[148:151]
    ds_read_b64_tr_b16 v[206:207], v241 offset:61952
    v_mul_f32 v55, s31, v55
    v_mfma_f32_16x16x32_bf16 v[148:151], a[196:199], v[208:211], v[148:151]
    v_cvt_pk_bf16_f32 v116, v48, v49
    v_cvt_pk_bf16_f32 v117, v50, v51
    v_mfma_f32_16x16x32_bf16 v[176:179], a[200:203], v[208:211], v[176:179]
    v_cvt_pk_bf16_f32 v118, v52, v53
    v_cvt_pk_bf16_f32 v119, v54, v55
    v_mfma_f32_16x16x32_bf16 v[176:179], a[216:219], v[212:215], v[176:179]
    v_mfma_f32_16x16x32_bf16 v[180:183], a[220:223], v[212:215], v[180:183]
    v_mfma_f32_16x16x32_bf16 v[180:183], a[204:207], v[208:211], v[180:183]
    s_waitcnt lgkmcnt(8)
    ds_read_b64_tr_b16 v[208:209], v242 offset:57344
    v_mfma_f32_16x16x32_bf16 v[188:191], a[204:207], v[216:219], v[188:191]
    ds_read_b64_tr_b16 v[210:211], v242 offset:57856
    v_mfma_f32_16x16x32_bf16 v[188:191], a[220:223], v[220:223], v[188:191]
    ds_read_b64_tr_b16 v[212:213], v242 offset:61440
    v_mfma_f32_16x16x32_bf16 v[184:187], a[216:219], v[220:223], v[184:187]
    ds_read_b64_tr_b16 v[214:215], v242 offset:61952
    v_mul_f32 v56, s31, v56
    v_mfma_f32_16x16x32_bf16 v[184:187], a[200:203], v[216:219], v[184:187]
    v_mul_f32 v57, s31, v57
    v_mul_f32 v58, s31, v58
    v_mfma_f32_16x16x32_bf16 v[156:159], a[196:199], v[216:219], v[156:159]
    v_mul_f32 v59, s31, v59
    v_mul_f32 v60, s31, v60
    v_mfma_f32_16x16x32_bf16 v[156:159], a[212:215], v[220:223], v[156:159]
    v_mul_f32 v61, s31, v61
    v_mul_f32 v62, s31, v62
    v_mfma_f32_16x16x32_bf16 v[152:155], a[208:211], v[220:223], v[152:155]
    s_add_u32 s15, s25, 4096
    buffer_store_dwordx4 v[100:103], v224, s[64:67], s15 offen offset:0 sc1
    v_mfma_f32_16x16x32_bf16 v[152:155], a[192:195], v[216:219], v[152:155]
    s_waitcnt lgkmcnt(8)
    ds_read_b64_tr_b16 v[216:217], v243 offset:57344
    v_mul_f32 v63, s31, v63
    v_mfma_f32_16x16x32_bf16 v[128:131], a[224:227], v[192:195], v[128:131]
    ds_read_b64_tr_b16 v[218:219], v243 offset:57856
    ds_read_b64_tr_b16 v[220:221], v243 offset:61440
    v_mfma_f32_16x16x32_bf16 v[128:131], a[240:243], v[196:199], v[128:131]
    ds_read_b64_tr_b16 v[222:223], v243 offset:61952
    v_cvt_pk_bf16_f32 v124, v56, v57
    v_mfma_f32_16x16x32_bf16 v[132:135], a[244:247], v[196:199], v[132:135]
    v_cvt_pk_bf16_f32 v125, v58, v59
    v_cvt_pk_bf16_f32 v126, v60, v61
    v_mfma_f32_16x16x32_bf16 v[132:135], a[228:231], v[192:195], v[132:135]
    v_cvt_pk_bf16_f32 v127, v62, v63
    v_mfma_f32_16x16x32_bf16 v[160:163], a[232:235], v[192:195], v[160:163]
    v_mfma_f32_16x16x32_bf16 v[160:163], a[248:251], v[196:199], v[160:163]
    v_mfma_f32_16x16x32_bf16 v[164:167], a[252:255], v[196:199], v[164:167]
    v_mfma_f32_16x16x32_bf16 v[164:167], a[236:239], v[192:195], v[164:167]
    s_waitcnt lgkmcnt(8)
    v_mfma_f32_16x16x32_bf16 v[172:175], a[236:239], v[200:203], v[172:175]
    v_mfma_f32_16x16x32_bf16 v[172:175], a[252:255], v[204:207], v[172:175]
    v_mfma_f32_16x16x32_bf16 v[168:171], a[248:251], v[204:207], v[168:171]
    s_waitcnt vmcnt(38)
    s_waitcnt lgkmcnt(0)
    s_barrier
    v_mfma_f32_16x16x32_bf16 v[168:171], a[232:235], v[200:203], v[168:171]
    s_waitcnt vmcnt(12)
    v_cmp_ne_u32 vcc, 1, v247
    v_add_u32 v240, 0x10000, v240
    v_mfma_f32_16x16x32_bf16 v[140:143], a[228:231], v[200:203], v[140:143]
    s_nop 0
    s_cbranch_vccnz L_SPIN_F
L_BACK_F:
    s_lshl_b32 s37, s94, 14
    v_mfma_f32_16x16x32_bf16 v[140:143], a[244:247], v[204:207], v[140:143]
    s_add_u32 m0, s16, 49152
    s_add_u32 s14, s24, s37
    ds_read_b64_tr_b16 v[192:193], v240 offset:0
    v_mfma_f32_16x16x32_bf16 v[136:139], a[240:243], v[204:207], v[136:139]
    s_add_u32 s15, s25, 4096
    buffer_load_dwordx4 v225, s[64:67], s14 offen offset:0 sc1 lds
    v_mfma_f32_16x16x32_bf16 v[136:139], a[224:227], v[200:203], v[136:139]
    ds_read_b64_tr_b16 v[194:195], v240 offset:512
    v_mfma_f32_16x16x32_bf16 v[144:147], a[224:227], v[208:211], v[144:147]
    s_add_u32 s37, s37, 16384
    s_sub_u32 s88, s37, 147456
    s_min_u32 s37, s37, s88
    v_mfma_f32_16x16x32_bf16 v[144:147], a[240:243], v[212:215], v[144:147]
    s_and_b32 s8, s2, 7
    s_lshr_b32 s10, s2, 3
    ds_read_b64_tr_b16 v[196:197], v240 offset:4096
    v_mfma_f32_16x16x32_bf16 v[148:151], a[244:247], v[212:215], v[148:151]
    ds_read_b64_tr_b16 v[198:199], v240 offset:4608
    v_add_u32 v241, 0x10000, v241
    v_mfma_f32_16x16x32_bf16 v[148:151], a[228:231], v[208:211], v[148:151]
    s_and_b32 s11, s8, 1
    buffer_load_dwordx4 v225, s[64:67], s14 offen offset:1024 sc1 lds
    v_mfma_f32_16x16x32_bf16 v[176:179], a[232:235], v[208:211], v[176:179]
    ds_read_b64_tr_b16 v[200:201], v241 offset:0
    v_mfma_f32_16x16x32_bf16 v[176:179], a[248:251], v[212:215], v[176:179]
    s_lshl_b32 s11, s11, 5
    ds_read_b64_tr_b16 v[202:203], v241 offset:512
    v_mfma_f32_16x16x32_bf16 v[180:183], a[252:255], v[212:215], v[180:183]
    s_add_u32 s10, s10, s11
    buffer_store_dwordx4 v[108:111], v224, s[64:67], s15 offen offset:1024 sc1
    v_mfma_f32_16x16x32_bf16 v[180:183], a[236:239], v[208:211], v[180:183]
    ds_read_b64_tr_b16 v[204:205], v241 offset:4096
    v_mfma_f32_16x16x32_bf16 v[188:191], a[236:239], v[216:219], v[188:191]
    s_mul_i32 s12, s10, 37
    ds_read_b64_tr_b16 v[206:207], v241 offset:4608
    v_add_u32 v242, 0x10000, v242
    v_mfma_f32_16x16x32_bf16 v[188:191], a[252:255], v[220:223], v[188:191]
    buffer_load_dwordx4 v225, s[64:67], s14 offen offset:2048 sc1 lds
    v_mfma_f32_16x16x32_bf16 v[184:187], a[248:251], v[220:223], v[184:187]
    s_lshr_b32 s12, s12, 8
    ds_read_b64_tr_b16 v[208:209], v242 offset:0
    v_mfma_f32_16x16x32_bf16 v[184:187], a[232:235], v[216:219], v[184:187]
    ds_read_b64_tr_b16 v[210:211], v242 offset:512
    v_mfma_f32_16x16x32_bf16 v[156:159], a[228:231], v[216:219], v[156:159]
    s_mul_i32 s11, s12, 7
    buffer_load_dwordx4 v225, s[64:67], s14 offen offset:3072 sc1 lds
    v_mfma_f32_16x16x32_bf16 v[156:159], a[244:247], v[220:223], v[156:159]
    s_sub_u32 s10, s10, s11
    ds_read_b64_tr_b16 v[212:213], v242 offset:4096
    v_mfma_f32_16x16x32_bf16 v[152:155], a[240:243], v[220:223], v[152:155]
    s_add_u32 s15, s25, 4096
    ds_read_b64_tr_b16 v[214:215], v242 offset:4608
    v_mfma_f32_16x16x32_bf16 v[152:155], a[224:227], v[216:219], v[152:155]
    s_waitcnt lgkmcnt(8)
    s_add_u32 m0, s16, 81920
    s_add_u32 s14, s24, s37
    v_mfma_f32_16x16x32_bf16 v[0:3], a[0:3], v[192:195], 0
    s_lshr_b32 s8, s8, 1
    buffer_load_dwordx4 v225, s[64:67], s14 offen offset:0 sc1 lds
    v_mfma_f32_16x16x32_bf16 v[0:3], a[16:19], v[196:199], v[0:3]
    s_lshl_b32 s8, s8, 5
    v_add_u32 v243, 0x10000, v243
    v_mfma_f32_16x16x32_bf16 v[4:7], a[20:23], v[196:199], 0
    s_min_u32 s11, s10, 4
    ds_read_b64_tr_b16 v[216:217], v243 offset:0
    v_mfma_f32_16x16x32_bf16 v[4:7], a[4:7], v[192:195], v[4:7]
    buffer_store_dwordx4 v[116:119], v224, s[64:67], s15 offen offset:2048 sc1
    v_mfma_f32_16x16x32_bf16 v[32:35], a[8:11], v[192:195], 0
    s_add_u32 s37, s37, 16384
    s_sub_u32 s88, s37, 147456
    s_min_u32 s37, s37, s88
    v_mfma_f32_16x16x32_bf16 v[32:35], a[24:27], v[196:199], v[32:35]
    s_add_u32 s8, s8, s11
    ds_read_b64_tr_b16 v[218:219], v243 offset:512
    v_mfma_f32_16x16x32_bf16 v[36:39], a[28:31], v[196:199], 0
    s_lshl_b32 s11, s10, 2
    buffer_load_dwordx4 v225, s[64:67], s14 offen offset:1024 sc1 lds
    v_mfma_f32_16x16x32_bf16 v[36:39], a[12:15], v[192:195], v[36:39]
    s_waitcnt lgkmcnt(6)
    ds_read_b64_tr_b16 v[220:221], v243 offset:4096
    v_mfma_f32_16x16x32_bf16 v[44:47], a[12:15], v[200:203], 0
    s_add_u32 s8, s8, s11
    ds_read_b64_tr_b16 v[222:223], v243 offset:4608
    v_cvt_pk_bf16_f32 v160, v160, v161
    v_mfma_f32_16x16x32_bf16 v[44:47], a[28:31], v[204:207], v[44:47]
    s_lshr_b32 s10, s10, 2
    buffer_load_dwordx4 v225, s[64:67], s14 offen offset:2048 sc1 lds
    v_mfma_f32_16x16x32_bf16 v[40:43], a[24:27], v[204:207], 0
    ds_read_b64_tr_b16 v[192:193], v240 offset:8192
    v_cvt_pk_bf16_f32 v161, v162, v163
    v_mfma_f32_16x16x32_bf16 v[40:43], a[8:11], v[200:203], v[40:43]
    s_lshl_b32 s43, s10, 31
    ds_read_b64_tr_b16 v[194:195], v240 offset:8704
    v_cvt_pk_bf16_f32 v162, v164, v165
    v_mfma_f32_16x16x32_bf16 v[12:15], a[4:7], v[200:203], 0
    ds_read_b64_tr_b16 v[196:197], v240 offset:12288
    v_cvt_pk_bf16_f32 v163, v166, v167
    v_mfma_f32_16x16x32_bf16 v[12:15], a[20:23], v[204:207], v[12:15]
    s_add_u32 s11, s12, 7
    ds_read_b64_tr_b16 v[198:199], v240 offset:12800
    v_mfma_f32_16x16x32_bf16 v[8:11], a[16:19], v[204:207], 0
    s_add_u32 s15, s25, 4096
    buffer_load_dwordx4 v225, s[64:67], s14 offen offset:3072 sc1 lds
    v_mfma_f32_16x16x32_bf16 v[8:11], a[0:3], v[200:203], v[8:11]
    s_waitcnt lgkmcnt(8)
    s_lshr_b32 s11, s11, 4
    ds_read_b64_tr_b16 v[200:201], v241 offset:8192
    v_mfma_f32_16x16x32_bf16 v[16:19], a[0:3], v[208:211], 0
    s_lshl_b32 s42, s11, 31
    ds_read_b64_tr_b16 v[202:203], v241 offset:8704
    v_mfma_f32_16x16x32_bf16 v[16:19], a[16:19], v[212:215], v[16:19]
    buffer_store_dwordx4 v[124:127], v224, s[64:67], s15 offen offset:3072 sc1
    v_mfma_f32_16x16x32_bf16 v[20:23], a[20:23], v[212:215], 0
    s_lshl_b32 s12, s12, 7
    ds_read_b64_tr_b16 v[204:205], v241 offset:12288
    v_mfma_f32_16x16x32_bf16 v[20:23], a[4:7], v[208:211], v[20:23]
    s_add_u32 m0, s16, 114688
    s_add_u32 s14, s24, s37
    ds_read_b64_tr_b16 v[206:207], v241 offset:12800
    v_mfma_f32_16x16x32_bf16 v[48:51], a[8:11], v[208:211], 0
    s_mul_i32 s40, s3, 40960
    buffer_load_dwordx4 v225, s[64:67], s14 offen offset:0 sc1 lds
    v_mfma_f32_16x16x32_bf16 v[48:51], a[24:27], v[212:215], v[48:51]
    s_mul_i32 s41, s3, 1179648
    v_cvt_pk_bf16_f32 v168, v168, v169
    v_cvt_pk_bf16_f32 v169, v170, v171
    v_mfma_f32_16x16x32_bf16 v[52:55], a[28:31], v[212:215], 0
    v_cvt_pk_bf16_f32 v170, v172, v173
    v_cvt_pk_bf16_f32 v171, v174, v175
    v_mfma_f32_16x16x32_bf16 v[52:55], a[12:15], v[208:211], v[52:55]
    s_waitcnt lgkmcnt(8)
    s_add_u32 s41, s41, s12
    ds_read_b64_tr_b16 v[208:209], v242 offset:8192
    v_mfma_f32_16x16x32_bf16 v[60:63], a[12:15], v[216:219], 0
    s_add_u32 s37, s37, 16384
    s_sub_u32 s88, s37, 147456
    s_min_u32 s37, s37, s88
    v_mfma_f32_16x16x32_bf16 v[60:63], a[28:31], v[220:223], v[60:63]
    s_mul_i32 s44, s8, 136192
    buffer_load_dwordx4 v225, s[64:67], s14 offen offset:1024 sc1 lds
    v_mfma_f32_16x16x32_bf16 v[56:59], a[24:27], v[220:223], 0
    ds_read_b64_tr_b16 v[210:211], v242 offset:8704
    v_mfma_f32_16x16x32_bf16 v[56:59], a[8:11], v[216:219], v[56:59]
    s_mul_i32 s11, s3, 33792
    ds_read_b64_tr_b16 v[212:213], v242 offset:12288
    v_mfma_f32_16x16x32_bf16 v[28:31], a[4:7], v[216:219], 0
    s_add_u32 s44, s44, s11
    ds_read_b64_tr_b16 v[214:215], v242 offset:12800
    v_mfma_f32_16x16x32_bf16 v[28:31], a[20:23], v[220:223], v[28:31]
    buffer_load_dwordx4 v225, s[64:67], s14 offen offset:2048 sc1 lds
    v_mfma_f32_16x16x32_bf16 v[24:27], a[16:19], v[220:223], 0
    s_add_u32 s44, s44, 34603008
    v_mfma_f32_16x16x32_bf16 v[24:27], a[0:3], v[216:219], v[24:27]
    s_waitcnt lgkmcnt(8)
    ds_read_b64_tr_b16 v[216:217], v243 offset:8192
    v_mfma_f32_16x16x32_bf16 v[0:3], a[32:35], v[192:195], v[0:3]
    s_mul_i32 s11, s3, 5120
    ds_read_b64_tr_b16 v[218:219], v243 offset:8704
    ds_read_b64_tr_b16 v[220:221], v243 offset:12288
    v_mfma_f32_16x16x32_bf16 v[0:3], a[48:51], v[196:199], v[0:3]
    ds_read_b64_tr_b16 v[222:223], v243 offset:12800
    v_cvt_pk_bf16_f32 v176, v176, v177
    v_mfma_f32_16x16x32_bf16 v[4:7], a[52:55], v[196:199], v[4:7]
    s_mul_i32 s45, s12, 640
    buffer_load_dwordx4 v225, s[64:67], s14 offen offset:3072 sc1 lds
    v_mfma_f32_16x16x32_bf16 v[4:7], a[36:39], v[192:195], v[4:7]
    s_add_u32 s45, s45, s11
    v_cvt_pk_bf16_f32 v177, v178, v179
    v_cvt_pk_bf16_f32 v178, v180, v181
    v_mfma_f32_16x16x32_bf16 v[32:35], a[40:43], v[192:195], v[32:35]
    v_cvt_pk_bf16_f32 v179, v182, v183
    v_mfma_f32_16x16x32_bf16 v[32:35], a[56:59], v[196:199], v[32:35]
    s_add_u32 s45, s45, 58261504
    v_mfma_f32_16x16x32_bf16 v[36:39], a[60:63], v[196:199], v[36:39]
    v_mfma_f32_16x16x32_bf16 v[36:39], a[44:47], v[192:195], v[36:39]
    s_waitcnt lgkmcnt(8)
    s_mul_i32 s46, s8, 18432
    v_mfma_f32_16x16x32_bf16 v[44:47], a[44:47], v[200:203], v[44:47]
    s_add_u32 s46, s46, s11
    v_mfma_f32_16x16x32_bf16 v[44:47], a[60:63], v[204:207], v[44:47]
    v_mfma_f32_16x16x32_bf16 v[40:43], a[56:59], v[204:207], v[40:43]
    s_waitcnt lgkmcnt(0)
    s_barrier
    v_mfma_f32_16x16x32_bf16 v[40:43], a[40:43], v[200:203], v[40:43]
    s_add_u32 m0, s16, 131072
    s_add_u32 s14, s23, s36
    s_add_u32 s46, s46, 55902208
    v_mfma_f32_16x16x32_bf16 v[12:15], a[36:39], v[200:203], v[12:15]
    s_mul_i32 s48, s8, 36864
    buffer_load_dwordx4 v230, s[52:55], s14 offen offset:0 lds
    v_mfma_f32_16x16x32_bf16 v[12:15], a[52:55], v[204:207], v[12:15]
    ds_read_b64_tr_b16 v[192:193], v240 offset:16384
    v_cvt_pk_bf16_f32 v184, v184, v185
    v_mfma_f32_16x16x32_bf16 v[8:11], a[48:51], v[204:207], v[8:11]
    s_add_u32 s48, s48, s12
    ds_read_b64_tr_b16 v[194:195], v240 offset:16896
    v_cvt_pk_bf16_f32 v185, v186, v187
    v_mfma_f32_16x16x32_bf16 v[8:11], a[32:35], v[200:203], v[8:11]
    s_lshl_b32 s11, s3, 5
    ds_read_b64_tr_b16 v[196:197], v240 offset:20480
    v_mfma_f32_16x16x32_bf16 v[16:19], a[32:35], v[208:211], v[16:19]
    s_add_u32 s36, s36, 128
    s_sub_u32 s88, s36, 1152
    s_min_u32 s36, s36, s88
    v_mfma_f32_16x16x32_bf16 v[16:19], a[48:51], v[212:215], v[16:19]
    s_add_u32 s48, s48, s11
    ds_read_b64_tr_b16 v[198:199], v240 offset:20992
    v_cvt_pk_bf16_f32 v186, v188, v189
    v_mfma_f32_16x16x32_bf16 v[20:23], a[52:55], v[212:215], v[20:23]
    buffer_load_dwordx4 v231, s[52:55], s14 offen offset:1024 lds
    v_mfma_f32_16x16x32_bf16 v[20:23], a[36:39], v[208:211], v[20:23]
    s_sub_u32 s10, s8, s10
    ds_read_b64_tr_b16 v[200:201], v241 offset:16384
    v_cvt_pk_bf16_f32 v187, v190, v191
    v_mfma_f32_16x16x32_bf16 v[48:51], a[40:43], v[208:211], v[48:51]
    s_add_u32 s10, s10, 4
    ds_read_b64_tr_b16 v[202:203], v241 offset:16896
    v_mfma_f32_16x16x32_bf16 v[48:51], a[56:59], v[212:215], v[48:51]
    buffer_load_dwordx4 v232, s[52:55], s14 offen offset:2048 lds
    v_mfma_f32_16x16x32_bf16 v[52:55], a[60:63], v[212:215], v[52:55]
    s_lshr_b32 s10, s10, 3
    ds_read_b64_tr_b16 v[204:205], v241 offset:20480
    v_mfma_f32_16x16x32_bf16 v[52:55], a[44:47], v[208:211], v[52:55]
    ds_read_b64_tr_b16 v[206:207], v241 offset:20992
    v_mfma_f32_16x16x32_bf16 v[60:63], a[44:47], v[216:219], v[60:63]
    s_lshr_b32 s8, s8, 3
    ds_read_b64_tr_b16 v[208:209], v242 offset:16384
    v_cvt_pk_bf16_f32 v164, v128, v129
    v_mfma_f32_16x16x32_bf16 v[60:63], a[60:63], v[220:223], v[60:63]
    ds_read_b64_tr_b16 v[210:211], v242 offset:16896
    v_cvt_pk_bf16_f32 v165, v130, v131
    v_mfma_f32_16x16x32_bf16 v[56:59], a[56:59], v[220:223], v[56:59]
    s_sub_u32 s10, s10, s8
    buffer_load_dwordx4 v233, s[52:55], s14 offen offset:3072 lds
    v_mfma_f32_16x16x32_bf16 v[56:59], a[40:43], v[216:219], v[56:59]
    s_lshl_b32 s10, s10, 9
    ds_read_b64_tr_b16 v[212:213], v242 offset:20480
    v_cvt_pk_bf16_f32 v166, v132, v133
    v_mfma_f32_16x16x32_bf16 v[28:31], a[36:39], v[216:219], v[28:31]
    ds_read_b64_tr_b16 v[214:215], v242 offset:20992
    v_cvt_pk_bf16_f32 v167, v134, v135
    v_mfma_f32_16x16x32_bf16 v[28:31], a[52:55], v[220:223], v[28:31]
    s_lshl_b32 s8, s8, 9
    v_mfma_f32_16x16x32_bf16 v[24:27], a[48:51], v[220:223], v[24:27]
    v_mfma_f32_16x16x32_bf16 v[24:27], a[32:35], v[216:219], v[24:27]
    s_waitcnt lgkmcnt(8)
    s_lshl_b32 s11, s3, 7
    ds_read_b64_tr_b16 v[216:217], v243 offset:16384
    v_mfma_f32_16x16x32_bf16 v[0:3], a[64:67], v[192:195], v[0:3]
    ds_read_b64_tr_b16 v[218:219], v243 offset:16896
    v_mfma_f32_16x16x32_bf16 v[0:3], a[80:83], v[196:199], v[0:3]
    s_add_u32 s8, s8, s11
    ds_read_b64_tr_b16 v[220:221], v243 offset:20480
    v_mfma_f32_16x16x32_bf16 v[4:7], a[84:87], v[196:199], v[4:7]
    s_add_u32 s49, s8, 59056128
    ds_read_b64_tr_b16 v[222:223], v243 offset:20992
    v_mfma_f32_16x16x32_bf16 v[4:7], a[68:71], v[192:195], v[4:7]
    v_mfma_f32_16x16x32_bf16 v[32:35], a[72:75], v[192:195], v[32:35]
    v_bfe_u32 v249, v224, 7, 1
    v_cvt_pk_bf16_f32 v172, v136, v137
    v_mfma_f32_16x16x32_bf16 v[32:35], a[88:91], v[196:199], v[32:35]
    v_cvt_pk_bf16_f32 v173, v138, v139
    v_cvt_pk_bf16_f32 v174, v140, v141
    v_mfma_f32_16x16x32_bf16 v[36:39], a[92:95], v[196:199], v[36:39]
    v_mul_u32_u24 v249, s10, v249
    v_cvt_pk_bf16_f32 v175, v142, v143
    v_mfma_f32_16x16x32_bf16 v[36:39], a[76:79], v[192:195], v[36:39]
    s_waitcnt lgkmcnt(8)
    ds_read_b64_tr_b16 v[192:193], v240 offset:24576
    v_bfe_u32 v250, v224, 4, 3
    v_mfma_f32_16x16x32_bf16 v[44:47], a[76:79], v[200:203], v[44:47]
    ds_read_b64_tr_b16 v[194:195], v240 offset:25088
    v_mfma_f32_16x16x32_bf16 v[44:47], a[92:95], v[204:207], v[44:47]
    ds_read_b64_tr_b16 v[196:197], v240 offset:28672
    v_lshl_add_u32 v228, v250, 2, v249
    v_mfma_f32_16x16x32_bf16 v[40:43], a[88:91], v[204:207], v[40:43]
    ds_read_b64_tr_b16 v[198:199], v240 offset:29184
    v_mfma_f32_16x16x32_bf16 v[40:43], a[72:75], v[200:203], v[40:43]
    v_lshrrev_b32 v249, 7, v224
    v_mfma_f32_16x16x32_bf16 v[12:15], a[68:71], v[200:203], v[12:15]
    v_mfma_f32_16x16x32_bf16 v[12:15], a[84:87], v[204:207], v[12:15]
    v_mul_u32_u24 v249, 1152, v249
    v_mfma_f32_16x16x32_bf16 v[8:11], a[80:83], v[204:207], v[8:11]
    v_bfe_u32 v250, v224, 5, 2
    v_mfma_f32_16x16x32_bf16 v[8:11], a[64:67], v[200:203], v[8:11]
    s_waitcnt lgkmcnt(8)
    ds_read_b64_tr_b16 v[200:201], v241 offset:24576
    v_mfma_f32_16x16x32_bf16 v[16:19], a[64:67], v[208:211], v[16:19]
    ds_read_b64_tr_b16 v[202:203], v241 offset:25088
    v_lshrrev_b32 v251, 8, v224
    v_mfma_f32_16x16x32_bf16 v[16:19], a[80:83], v[212:215], v[16:19]
    ds_read_b64_tr_b16 v[204:205], v241 offset:28672
    v_cvt_pk_bf16_f32 v180, v144, v145
    v_mfma_f32_16x16x32_bf16 v[20:23], a[84:87], v[212:215], v[20:23]
    ds_read_b64_tr_b16 v[206:207], v241 offset:29184
    v_xor_b32 v250, v250, v251
    v_mfma_f32_16x16x32_bf16 v[20:23], a[68:71], v[208:211], v[20:23]
    v_cvt_pk_bf16_f32 v181, v146, v147
    v_cvt_pk_bf16_f32 v182, v148, v149
    v_mfma_f32_16x16x32_bf16 v[48:51], a[72:75], v[208:211], v[48:51]
    v_lshl_add_u32 v249, v250, 5, v249
    v_cvt_pk_bf16_f32 v183, v150, v151
    v_mfma_f32_16x16x32_bf16 v[48:51], a[88:91], v[212:215], v[48:51]
    v_and_or_b32 v249, v224, 16, v249
    v_mfma_f32_16x16x32_bf16 v[52:55], a[92:95], v[212:215], v[52:55]
    v_mfma_f32_16x16x32_bf16 v[52:55], a[76:79], v[208:211], v[52:55]
    s_waitcnt lgkmcnt(8)
    ds_read_b64_tr_b16 v[208:209], v242 offset:24576
    v_or_b32 v226, s42, v249
    v_mfma_f32_16x16x32_bf16 v[60:63], a[76:79], v[216:219], v[60:63]
    ds_read_b64_tr_b16 v[210:211], v242 offset:25088
    v_mfma_f32_16x16x32_bf16 v[60:63], a[92:95], v[220:223], v[60:63]
    ds_read_b64_tr_b16 v[212:213], v242 offset:28672
    v_lshrrev_b32 v249, 6, v224
    v_mfma_f32_16x16x32_bf16 v[56:59], a[88:91], v[220:223], v[56:59]
    ds_read_b64_tr_b16 v[214:215], v242 offset:29184
    v_lshlrev_b32 v249, 7, v249
    v_mfma_f32_16x16x32_bf16 v[56:59], a[72:75], v[216:219], v[56:59]
    v_mfma_f32_16x16x32_bf16 v[28:31], a[68:71], v[216:219], v[28:31]
    v_bfe_u32 v250, v224, 4, 2
    v_cvt_pk_bf16_f32 v188, v152, v153
    v_mfma_f32_16x16x32_bf16 v[28:31], a[84:87], v[220:223], v[28:31]
    v_cvt_pk_bf16_f32 v189, v154, v155
    v_cvt_pk_bf16_f32 v190, v156, v157
    v_mfma_f32_16x16x32_bf16 v[24:27], a[80:83], v[220:223], v[24:27]
    v_lshl_add_u32 v249, v250, 3, v249
    v_cvt_pk_bf16_f32 v191, v158, v159
    v_mfma_f32_16x16x32_bf16 v[24:27], a[64:67], v[216:219], v[24:27]
    s_waitcnt lgkmcnt(8)
    ds_read_b64_tr_b16 v[216:217], v243 offset:24576
    v_mfma_f32_16x16x32_bf16 v[0:3], a[96:99], v[192:195], v[0:3]
    ds_read_b64_tr_b16 v[218:219], v243 offset:25088
    ds_read_b64_tr_b16 v[220:221], v243 offset:28672
    v_mfma_f32_16x16x32_bf16 v[0:3], a[112:115], v[196:199], v[0:3]
    ds_read_b64_tr_b16 v[222:223], v243 offset:29184
    v_add_u32 v229, s40, v249
    v_mfma_f32_16x16x32_bf16 v[4:7], a[116:119], v[196:199], v[4:7]
    s_lshl_b32 s8, s6, 3
    v_mfma_f32_16x16x32_bf16 v[4:7], a[100:103], v[192:195], v[4:7]
    s_lshl_b32 s10, s3, 1
    v_mfma_f32_16x16x32_bf16 v[32:35], a[104:107], v[192:195], v[32:35]
    v_mfma_f32_16x16x32_bf16 v[32:35], a[120:123], v[196:199], v[32:35]
    s_add_u32 s8, s8, s10
    v_mfma_f32_16x16x32_bf16 v[36:39], a[124:127], v[196:199], v[36:39]
    s_mul_i32 s8, s8, 18432
    v_mfma_f32_16x16x32_bf16 v[36:39], a[108:111], v[192:195], v[36:39]
    s_waitcnt lgkmcnt(8)
    v_mfma_f32_16x16x32_bf16 v[44:47], a[108:111], v[200:203], v[44:47]
    s_add_u32 s8, s8, 55902208
    v_mfma_f32_16x16x32_bf16 v[44:47], a[124:127], v[204:207], v[44:47]
    v_mfma_f32_16x16x32_bf16 v[40:43], a[120:123], v[204:207], v[40:43]
    s_waitcnt lgkmcnt(0)
    s_barrier
    v_mfma_f32_16x16x32_bf16 v[40:43], a[104:107], v[200:203], v[40:43]
    s_add_u32 m0, s16, 147456
    s_add_u32 s14, s24, s37
    s_lshl_b32 s10, s7, 10
    v_mfma_f32_16x16x32_bf16 v[12:15], a[100:103], v[200:203], v[12:15]
    s_add_u32 s50, s10, s8
    buffer_load_dwordx4 v225, s[64:67], s14 offen offset:0 sc1 lds
    v_mfma_f32_16x16x32_bf16 v[12:15], a[116:119], v[204:207], v[12:15]
    s_lshl_b32 s11, s7, 7
    v_add_u32 v240, 0xfffe0000, v240
    v_mfma_f32_16x16x32_bf16 v[8:11], a[112:115], v[204:207], v[8:11]
    ds_read_b64_tr_b16 v[192:193], v240 offset:0
    v_mfma_f32_16x16x32_bf16 v[8:11], a[96:99], v[200:203], v[8:11]
    s_add_u32 s8, s8, s11
    ds_read_b64_tr_b16 v[194:195], v240 offset:512
    v_mfma_f32_16x16x32_bf16 v[16:19], a[96:99], v[208:211], v[16:19]
    s_add_u32 s37, s37, 16384
    s_sub_u32 s88, s37, 147456
    s_min_u32 s37, s37, s88
    v_mfma_f32_16x16x32_bf16 v[16:19], a[112:115], v[212:215], v[16:19]
    s_add_u32 s51, s8, 16384
    ds_read_b64_tr_b16 v[196:197], v240 offset:4096
    v_mfma_f32_16x16x32_bf16 v[20:23], a[116:119], v[212:215], v[20:23]
    ds_read_b64_tr_b16 v[198:199], v240 offset:4608
    v_add_u32 v241, 0xfffe0000, v241
    v_mfma_f32_16x16x32_bf16 v[20:23], a[100:103], v[208:211], v[20:23]
    s_lshr_b32 s10, s7, 2
    buffer_load_dwordx4 v225, s[64:67], s14 offen offset:1024 sc1 lds
    v_mfma_f32_16x16x32_bf16 v[48:51], a[104:107], v[208:211], v[48:51]
    s_and_b32 s12, s7, 3
    ds_read_b64_tr_b16 v[200:201], v241 offset:0
    v_mfma_f32_16x16x32_bf16 v[48:51], a[120:123], v[212:215], v[48:51]
    ds_read_b64_tr_b16 v[202:203], v241 offset:512
    v_mfma_f32_16x16x32_bf16 v[52:55], a[124:127], v[212:215], v[52:55]
    s_lshl_b32 s10, s10, 5
    buffer_load_dwordx4 v225, s[64:67], s14 offen offset:2048 sc1 lds
    v_mfma_f32_16x16x32_bf16 v[52:55], a[108:111], v[208:211], v[52:55]
    ds_read_b64_tr_b16 v[204:205], v241 offset:4096
    v_mfma_f32_16x16x32_bf16 v[60:63], a[108:111], v[216:219], v[60:63]
    s_lshl_b32 s12, s12, 2
    ds_read_b64_tr_b16 v[206:207], v241 offset:4608
    v_add_u32 v242, 0xfffe0000, v242
    v_mfma_f32_16x16x32_bf16 v[60:63], a[124:127], v[220:223], v[60:63]
    s_add_u32 s10, s10, s12
    ds_read_b64_tr_b16 v[208:209], v242 offset:0
    v_mfma_f32_16x16x32_bf16 v[56:59], a[120:123], v[220:223], v[56:59]
    buffer_load_dwordx4 v225, s[64:67], s14 offen offset:3072 sc1 lds
    v_mfma_f32_16x16x32_bf16 v[56:59], a[104:107], v[216:219], v[56:59]
    s_add_u32 s10, s10, 512
    ds_read_b64_tr_b16 v[210:211], v242 offset:512
    v_mfma_f32_16x16x32_bf16 v[28:31], a[100:103], v[216:219], v[28:31]
    s_add_u32 s25, s25, s39
    s_add_u32 s15, s25, 40960
    ds_read_b64_tr_b16 v[212:213], v242 offset:4096
    v_mfma_f32_16x16x32_bf16 v[28:31], a[116:119], v[220:223], v[28:31]
    s_and_b32 s8, s6, 3
    ds_read_b64_tr_b16 v[214:215], v242 offset:4608
    v_mfma_f32_16x16x32_bf16 v[24:27], a[112:115], v[220:223], v[24:27]
    buffer_store_dwordx4 v[160:163], v224, s[64:67], s15 offen offset:0 sc1
    v_mfma_f32_16x16x32_bf16 v[24:27], a[96:99], v[216:219], v[24:27]
    s_waitcnt lgkmcnt(8)
    s_min_u32 s11, s8, 1
    v_add_u32 v243, 0xfffe0000, v243
    v_mfma_f32_16x16x32_bf16 v[0:3], a[128:131], v[192:195], v[0:3]
    s_lshl_b32 s11, s11, 4
    ds_read_b64_tr_b16 v[216:217], v243 offset:0
    v_mfma_f32_16x16x32_bf16 v[0:3], a[144:147], v[196:199], v[0:3]
    ds_read_b64_tr_b16 v[218:219], v243 offset:512
    v_mfma_f32_16x16x32_bf16 v[4:7], a[148:151], v[196:199], v[4:7]
    s_lshl_b32 s12, s7, 5
    ds_read_b64_tr_b16 v[220:221], v243 offset:4096
    v_mfma_f32_16x16x32_bf16 v[4:7], a[132:135], v[192:195], v[4:7]
    ds_read_b64_tr_b16 v[222:223], v243 offset:4608
    v_mfma_f32_16x16x32_bf16 v[32:35], a[136:139], v[192:195], v[32:35]
    s_add_u32 s11, s11, s12
    v_mfma_f32_16x16x32_bf16 v[32:35], a[152:155], v[196:199], v[32:35]
    v_mfma_f32_16x16x32_bf16 v[36:39], a[156:159], v[196:199], v[36:39]
    s_add_u32 s12, s8, 1
    v_mfma_f32_16x16x32_bf16 v[36:39], a[140:143], v[192:195], v[36:39]
    s_waitcnt lgkmcnt(8)
    s_lshr_b32 s47, s12, 2
    ds_read_b64_tr_b16 v[192:193], v240 offset:8192
    v_mfma_f32_16x16x32_bf16 v[44:47], a[140:143], v[200:203], v[44:47]
    ds_read_b64_tr_b16 v[194:195], v240 offset:8704
    v_mfma_f32_16x16x32_bf16 v[44:47], a[156:159], v[204:207], v[44:47]
    s_sub_u32 s10, s10, s11
    ds_read_b64_tr_b16 v[196:197], v240 offset:12288
    v_mfma_f32_16x16x32_bf16 v[40:43], a[152:155], v[204:207], v[40:43]
    ds_read_b64_tr_b16 v[198:199], v240 offset:12800
    v_mfma_f32_16x16x32_bf16 v[40:43], a[136:139], v[200:203], v[40:43]
    s_mul_i32 s10, s10, s47
    v_mfma_f32_16x16x32_bf16 v[12:15], a[132:135], v[200:203], v[12:15]
    s_add_u32 s11, s11, s10
    v_mfma_f32_16x16x32_bf16 v[12:15], a[148:151], v[204:207], v[12:15]
    v_mfma_f32_16x16x32_bf16 v[8:11], a[144:147], v[204:207], v[8:11]
    s_lshl_b32 s11, s11, 5
    s_add_u32 s15, s25, 40960
    v_mfma_f32_16x16x32_bf16 v[8:11], a[128:131], v[200:203], v[8:11]
    s_waitcnt lgkmcnt(8)
    buffer_store_dwordx4 v[168:171], v224, s[64:67], s15 offen offset:1024 sc1
    v_mfma_f32_16x16x32_bf16 v[16:19], a[128:131], v[208:211], v[16:19]
    s_lshr_b32 s12, s6, 2
    ds_read_b64_tr_b16 v[200:201], v241 offset:8192
    v_mfma_f32_16x16x32_bf16 v[16:19], a[144:147], v[212:215], v[16:19]
    ds_read_b64_tr_b16 v[202:203], v241 offset:8704
    v_mfma_f32_16x16x32_bf16 v[20:23], a[148:151], v[212:215], v[20:23]
    s_mul_i32 s12, s12, 184320
    ds_read_b64_tr_b16 v[204:205], v241 offset:12288
    v_mfma_f32_16x16x32_bf16 v[20:23], a[132:135], v[208:211], v[20:23]
    s_add_u32 s11, s11, s12
    ds_read_b64_tr_b16 v[206:207], v241 offset:12800
    v_mfma_f32_16x16x32_bf16 v[48:51], a[136:139], v[208:211], v[48:51]
    v_mfma_f32_16x16x32_bf16 v[48:51], a[152:155], v[212:215], v[48:51]
    s_add_u32 s11, s11, 58261504
    v_mfma_f32_16x16x32_bf16 v[52:55], a[156:159], v[212:215], v[52:55]
    v_mfma_f32_16x16x32_bf16 v[52:55], a[140:143], v[208:211], v[52:55]
    s_waitcnt lgkmcnt(8)
    s_mul_i32 s12, s3, 20480
    ds_read_b64_tr_b16 v[208:209], v242 offset:8192
    v_mfma_f32_16x16x32_bf16 v[60:63], a[140:143], v[216:219], v[60:63]
    s_add_u32 s18, s11, s12
    ds_read_b64_tr_b16 v[210:211], v242 offset:8704
    v_mfma_f32_16x16x32_bf16 v[60:63], a[156:159], v[220:223], v[60:63]
    ds_read_b64_tr_b16 v[212:213], v242 offset:12288
    v_mfma_f32_16x16x32_bf16 v[56:59], a[152:155], v[220:223], v[56:59]
    s_min_u32 s12, s3, 1
    ds_read_b64_tr_b16 v[214:215], v242 offset:12800
    v_mfma_f32_16x16x32_bf16 v[56:59], a[136:139], v[216:219], v[56:59]
    v_mfma_f32_16x16x32_bf16 v[28:31], a[132:135], v[216:219], v[28:31]
    s_lshl_b32 s12, s12, 31
    v_mfma_f32_16x16x32_bf16 v[28:31], a[148:151], v[220:223], v[28:31]
    v_mfma_f32_16x16x32_bf16 v[24:27], a[144:147], v[220:223], v[24:27]
    s_add_u32 s11, s11, 163840
    v_mfma_f32_16x16x32_bf16 v[24:27], a[128:131], v[216:219], v[24:27]
    s_waitcnt lgkmcnt(8)
    s_or_b32 s20, s11, s12
    ds_read_b64_tr_b16 v[216:217], v243 offset:8192
    v_mfma_f32_16x16x32_bf16 v[0:3], a[160:163], v[192:195], v[0:3]
    s_add_u32 s15, s25, 40960
    ds_read_b64_tr_b16 v[218:219], v243 offset:8704
    ds_read_b64_tr_b16 v[220:221], v243 offset:12288
    v_mfma_f32_16x16x32_bf16 v[0:3], a[176:179], v[196:199], v[0:3]
    s_lshl_b32 s8, s8, 3
    ds_read_b64_tr_b16 v[222:223], v243 offset:12800
    v_mfma_f32_16x16x32_bf16 v[4:7], a[180:183], v[196:199], v[4:7]
    buffer_store_dwordx4 v[176:179], v224, s[64:67], s15 offen offset:2048 sc1
    v_mfma_f32_16x16x32_bf16 v[4:7], a[164:167], v[192:195], v[4:7]
    s_lshr_b32 s10, 0x00020000, s8
    v_mfma_f32_16x16x32_bf16 v[32:35], a[168:171], v[192:195], v[32:35]
    v_mfma_f32_16x16x32_bf16 v[32:35], a[184:187], v[196:199], v[32:35]
    s_and_b32 s10, s10, 255
    v_mfma_f32_16x16x32_bf16 v[36:39], a[188:191], v[196:199], v[36:39]
    s_lshr_b32 s11, 0x080e0210, s8
    v_mfma_f32_16x16x32_bf16 v[36:39], a[172:175], v[192:195], v[36:39]
    s_waitcnt lgkmcnt(8)
    v_mfma_f32_16x16x32_bf16 v[44:47], a[172:175], v[200:203], v[44:47]
    s_and_b32 s11, s11, 255
    v_mfma_f32_16x16x32_bf16 v[44:47], a[188:191], v[204:207], v[44:47]
    v_mfma_f32_16x16x32_bf16 v[40:43], a[184:187], v[204:207], v[40:43]
    s_waitcnt lgkmcnt(0)
    s_barrier
    v_mfma_f32_16x16x32_bf16 v[40:43], a[168:171], v[200:203], v[40:43]
    s_add_u32 m0, s16, 0
    s_add_u32 s14, s23, s36
    ds_read_b64_tr_b16 v[192:193], v240 offset:16384
    v_mfma_f32_16x16x32_bf16 v[12:15], a[164:167], v[200:203], v[12:15]
    buffer_load_dwordx4 v230, s[52:55], s14 offen offset:0 lds
    v_mfma_f32_16x16x32_bf16 v[12:15], a[180:183], v[204:207], v[12:15]
    ds_read_b64_tr_b16 v[194:195], v240 offset:16896
    v_bfe_u32 v249, v224, 4, 4
    v_mfma_f32_16x16x32_bf16 v[8:11], a[176:179], v[204:207], v[8:11]
    ds_read_b64_tr_b16 v[196:197], v240 offset:20480
    v_subrev_u32 v250, s10, v249
    v_mfma_f32_16x16x32_bf16 v[8:11], a[160:163], v[200:203], v[8:11]
    ds_read_b64_tr_b16 v[198:199], v240 offset:20992
    v_cmp_gt_u32 vcc, s11, v250
    v_mfma_f32_16x16x32_bf16 v[16:19], a[160:163], v[208:211], v[16:19]
    s_add_u32 s36, s36, 128
    s_sub_u32 s88, s36, 1152
    s_min_u32 s36, s36, s88
    v_mfma_f32_16x16x32_bf16 v[16:19], a[176:179], v[212:215], v[16:19]
    s_mul_i32 s10, s47, 12
    buffer_load_dwordx4 v231, s[52:55], s14 offen offset:1024 lds
    v_mfma_f32_16x16x32_bf16 v[20:23], a[180:183], v[212:215], v[20:23]
    s_add_u32 s15, s25, 40960
    ds_read_b64_tr_b16 v[200:201], v241 offset:16384
    v_bfe_u32 v250, v224, 6, 1
    v_mfma_f32_16x16x32_bf16 v[20:23], a[164:167], v[208:211], v[20:23]
    ds_read_b64_tr_b16 v[202:203], v241 offset:16896
    v_mad_u32_u24 v249, v250, s10, v249
    v_mfma_f32_16x16x32_bf16 v[48:51], a[168:171], v[208:211], v[48:51]
    ds_read_b64_tr_b16 v[204:205], v241 offset:20480
    v_lshlrev_b32 v249, 5, v249
    v_mfma_f32_16x16x32_bf16 v[48:51], a[184:187], v[212:215], v[48:51]
    buffer_load_dwordx4 v232, s[52:55], s14 offen offset:2048 lds
    v_mfma_f32_16x16x32_bf16 v[52:55], a[188:191], v[212:215], v[52:55]
    ds_read_b64_tr_b16 v[206:207], v241 offset:20992
    v_lshrrev_b32 v250, 8, v224
    v_mfma_f32_16x16x32_bf16 v[52:55], a[172:175], v[208:211], v[52:55]
    ds_read_b64_tr_b16 v[208:209], v242 offset:16384
    v_mfma_f32_16x16x32_bf16 v[60:63], a[172:175], v[216:219], v[60:63]
    buffer_store_dwordx4 v[184:187], v224, s[64:67], s15 offen offset:3072 sc1
    v_mfma_f32_16x16x32_bf16 v[60:63], a[188:191], v[220:223], v[60:63]
    ds_read_b64_tr_b16 v[210:211], v242 offset:16896
    v_lshl_add_u32 v249, v250, 3, v249
    v_mfma_f32_16x16x32_bf16 v[56:59], a[184:187], v[220:223], v[56:59]
    ds_read_b64_tr_b16 v[212:213], v242 offset:20480
    v_bfrev_b32 v250, 1
    v_mfma_f32_16x16x32_bf16 v[56:59], a[168:171], v[216:219], v[56:59]
    buffer_load_dwordx4 v233, s[52:55], s14 offen offset:3072 lds
    v_mfma_f32_16x16x32_bf16 v[28:31], a[164:167], v[216:219], v[28:31]
    ds_read_b64_tr_b16 v[214:215], v242 offset:20992
    v_cndmask_b32 v227, v250, v249, vcc
    v_mfma_f32_16x16x32_bf16 v[28:31], a[180:183], v[220:223], v[28:31]
    s_lshl_b32 s8, s3, 2
    v_mfma_f32_16x16x32_bf16 v[24:27], a[176:179], v[220:223], v[24:27]
    s_lshr_b32 s10, 0x6430, s8
    v_mfma_f32_16x16x32_bf16 v[24:27], a[160:163], v[216:219], v[24:27]
    s_waitcnt lgkmcnt(8)
    ds_read_b64_tr_b16 v[216:217], v243 offset:16384
    v_mfma_f32_16x16x32_bf16 v[0:3], a[192:195], v[192:195], v[0:3]
    s_and_b32 s10, s10, 15
    ds_read_b64_tr_b16 v[218:219], v243 offset:16896
    v_mfma_f32_16x16x32_bf16 v[0:3], a[208:211], v[196:199], v[0:3]
    ds_read_b64_tr_b16 v[220:221], v243 offset:20480
    v_mfma_f32_16x16x32_bf16 v[4:7], a[212:215], v[196:199], v[4:7]
    s_lshl_b32 s98, s10, 10
    ds_read_b64_tr_b16 v[222:223], v243 offset:20992
    v_mfma_f32_16x16x32_bf16 v[4:7], a[196:199], v[192:195], v[4:7]
    v_mfma_f32_16x16x32_bf16 v[32:35], a[200:203], v[192:195], v[32:35]
    s_lshr_b32 s10, 0x7522, s8
    s_add_u32 s15, s25, 24576
    v_mfma_f32_16x16x32_bf16 v[32:35], a[216:219], v[196:199], v[32:35]
    s_and_b32 s10, s10, 15
    buffer_store_dwordx4 v[164:167], v224, s[64:67], s15 offen offset:0 sc1
    v_mfma_f32_16x16x32_bf16 v[36:39], a[220:223], v[196:199], v[36:39]
    v_mfma_f32_16x16x32_bf16 v[36:39], a[204:207], v[192:195], v[36:39]
    s_waitcnt lgkmcnt(8)
    s_lshl_b32 s99, s10, 10
    ds_read_b64_tr_b16 v[192:193], v240 offset:24576
    v_mfma_f32_16x16x32_bf16 v[44:47], a[204:207], v[200:203], v[44:47]
    ds_read_b64_tr_b16 v[194:195], v240 offset:25088
    v_mfma_f32_16x16x32_bf16 v[44:47], a[220:223], v[204:207], v[44:47]
    s_lshl_b32 s10, s7, 2
    ds_read_b64_tr_b16 v[196:197], v240 offset:28672
    v_mfma_f32_16x16x32_bf16 v[40:43], a[216:219], v[204:207], v[40:43]
    s_add_u32 s10, s10, s3
    ds_read_b64_tr_b16 v[198:199], v240 offset:29184
    v_mfma_f32_16x16x32_bf16 v[40:43], a[200:203], v[200:203], v[40:43]
    v_mfma_f32_16x16x32_bf16 v[12:15], a[196:199], v[200:203], v[12:15]
    s_lshl_b32 s10, s10, 4
    v_mfma_f32_16x16x32_bf16 v[12:15], a[212:215], v[204:207], v[12:15]
    v_mfma_f32_16x16x32_bf16 v[8:11], a[208:211], v[204:207], v[8:11]
    s_add_u32 s10, s10, s6
    v_mfma_f32_16x16x32_bf16 v[8:11], a[192:195], v[200:203], v[8:11]
    s_waitcnt lgkmcnt(8)
    ds_read_b64_tr_b16 v[200:201], v241 offset:24576
    v_mfma_f32_16x16x32_bf16 v[16:19], a[192:195], v[208:211], v[16:19]
    s_lshl_b32 s10, s10, 10
    ds_read_b64_tr_b16 v[202:203], v241 offset:25088
    v_mfma_f32_16x16x32_bf16 v[16:19], a[208:211], v[212:215], v[16:19]
    s_add_u32 s96, s10, 54788096
    ds_read_b64_tr_b16 v[204:205], v241 offset:28672
    v_mfma_f32_16x16x32_bf16 v[20:23], a[212:215], v[212:215], v[20:23]
    ds_read_b64_tr_b16 v[206:207], v241 offset:29184
    v_mfma_f32_16x16x32_bf16 v[20:23], a[196:199], v[208:211], v[20:23]
    s_lshl_b32 s10, s7, 4
    v_mfma_f32_16x16x32_bf16 v[48:51], a[200:203], v[208:211], v[48:51]
    v_mfma_f32_16x16x32_bf16 v[48:51], a[216:219], v[212:215], v[48:51]
    s_add_u32 s10, s10, s6
    v_mfma_f32_16x16x32_bf16 v[52:55], a[220:223], v[212:215], v[52:55]
    s_add_u32 s15, s25, 24576
    buffer_store_dwordx4 v[172:175], v224, s[64:67], s15 offen offset:1024 sc1
    v_mfma_f32_16x16x32_bf16 v[52:55], a[204:207], v[208:211], v[52:55]
    s_waitcnt lgkmcnt(8)
    s_lshl_b32 s10, s10, 8
    ds_read_b64_tr_b16 v[208:209], v242 offset:24576
    v_mfma_f32_16x16x32_bf16 v[60:63], a[204:207], v[216:219], v[60:63]
    s_lshr_b32 s11, 0x2100, s8
    ds_read_b64_tr_b16 v[210:211], v242 offset:25088
    v_mfma_f32_16x16x32_bf16 v[60:63], a[220:223], v[220:223], v[60:63]
    ds_read_b64_tr_b16 v[212:213], v242 offset:28672
    v_mfma_f32_16x16x32_bf16 v[56:59], a[216:219], v[220:223], v[56:59]
    s_and_b32 s11, s11, 15
    ds_read_b64_tr_b16 v[214:215], v242 offset:29184
    v_mfma_f32_16x16x32_bf16 v[56:59], a[200:203], v[216:219], v[56:59]
    v_mfma_f32_16x16x32_bf16 v[28:31], a[196:199], v[216:219], v[28:31]
    s_lshl_b32 s11, s11, 6
    v_mfma_f32_16x16x32_bf16 v[28:31], a[212:215], v[220:223], v[28:31]
    s_add_u32 s10, s10, s11
    v_mfma_f32_16x16x32_bf16 v[24:27], a[208:211], v[220:223], v[24:27]
    v_mfma_f32_16x16x32_bf16 v[24:27], a[192:195], v[216:219], v[24:27]
    s_waitcnt lgkmcnt(8)
    s_add_u32 s10, s10, 55836672
    ds_read_b64_tr_b16 v[216:217], v243 offset:24576
    v_mfma_f32_16x16x32_bf16 v[0:3], a[224:227], v[192:195], v[0:3]
    ds_read_b64_tr_b16 v[218:219], v243 offset:25088
    ds_read_b64_tr_b16 v[220:221], v243 offset:28672
    ds_read_b64_tr_b16 v[222:223], v243 offset:29184
    v_mfma_f32_16x16x32_bf16 v[0:3], a[240:243], v[196:199], v[0:3]
    s_xor_b32 s11, s3, 1
    v_mfma_f32_16x16x32_bf16 v[4:7], a[244:247], v[196:199], v[4:7]
    v_mfma_f32_16x16x32_bf16 v[4:7], a[228:231], v[192:195], v[4:7]
    s_min_u32 s11, s11, 1
    v_mfma_f32_16x16x32_bf16 v[32:35], a[232:235], v[192:195], v[32:35]
    s_xor_b32 s11, s11, 1
    v_mfma_f32_16x16x32_bf16 v[32:35], a[248:251], v[196:199], v[32:35]
    v_mfma_f32_16x16x32_bf16 v[36:39], a[252:255], v[196:199], v[36:39]
    s_lshl_b32 s11, s11, 31
    v_mfma_f32_16x16x32_bf16 v[36:39], a[236:239], v[192:195], v[36:39]
    s_waitcnt lgkmcnt(8)
    v_mfma_f32_16x16x32_bf16 v[44:47], a[236:239], v[200:203], v[44:47]
    s_waitcnt vmcnt(28)
    s_waitcnt lgkmcnt(0)
    s_barrier
    v_mfma_f32_16x16x32_bf16 v[44:47], a[252:255], v[204:207], v[44:47]
    s_add_u32 m0, s16, 16384
    s_add_u32 s14, s24, s37
    s_or_b32 s97, s10, s11
    v_mfma_f32_16x16x32_bf16 v[40:43], a[248:251], v[204:207], v[40:43]
    s_add_u32 s15, s25, 24576
    buffer_load_dwordx4 v225, s[64:67], s14 offen offset:0 sc1 lds
    v_mfma_f32_16x16x32_bf16 v[40:43], a[232:235], v[200:203], v[40:43]
    ds_read_b128 a[0:3], v244 offset:49152
    v_mfma_f32_16x16x32_bf16 v[12:15], a[228:231], v[200:203], v[12:15]
    ds_read_b128 a[4:7], v244 offset:57344
    v_mfma_f32_16x16x32_bf16 v[12:15], a[244:247], v[204:207], v[12:15]
    s_add_u32 s37, s37, 16384
    s_sub_u32 s88, s37, 147456
    s_min_u32 s37, s37, s88
    v_mfma_f32_16x16x32_bf16 v[8:11], a[240:243], v[204:207], v[8:11]
    buffer_load_dwordx4 v225, s[64:67], s14 offen offset:1024 sc1 lds
    v_mfma_f32_16x16x32_bf16 v[8:11], a[224:227], v[200:203], v[8:11]
    ds_read_b128 a[64:67], v238 offset:16384
    v_mfma_f32_16x16x32_bf16 v[16:19], a[224:227], v[208:211], v[16:19]
    ds_read_b128 a[68:71], v239 offset:16384
    v_mfma_f32_16x16x32_bf16 v[16:19], a[240:243], v[212:215], v[16:19]
    ds_read_b128 a[72:75], v238 offset:18432
    v_mfma_f32_16x16x32_bf16 v[20:23], a[244:247], v[212:215], v[20:23]
    ds_read_b128 a[76:79], v239 offset:18432
    v_mfma_f32_16x16x32_bf16 v[20:23], a[228:231], v[208:211], v[20:23]
    buffer_store_dwordx4 v[180:183], v224, s[64:67], s15 offen offset:2048 sc1
    v_mfma_f32_16x16x32_bf16 v[48:51], a[232:235], v[208:211], v[48:51]
    ds_read_b128 a[8:11], v244 offset:50176
    v_mfma_f32_16x16x32_bf16 v[48:51], a[248:251], v[212:215], v[48:51]
    ds_read_b128 a[12:15], v244 offset:58368
    v_mfma_f32_16x16x32_bf16 v[52:55], a[252:255], v[212:215], v[52:55]
    buffer_load_dwordx4 v225, s[64:67], s14 offen offset:2048 sc1 lds
    v_mfma_f32_16x16x32_bf16 v[52:55], a[236:239], v[208:211], v[52:55]
    ds_read_b128 a[16:19], v244 offset:51200
    v_mfma_f32_16x16x32_bf16 v[60:63], a[236:239], v[216:219], v[60:63]
    ds_read_b128 a[20:23], v244 offset:59392
    v_mfma_f32_16x16x32_bf16 v[60:63], a[252:255], v[220:223], v[60:63]
    buffer_load_dwordx4 v225, s[64:67], s14 offen offset:3072 sc1 lds
    v_mfma_f32_16x16x32_bf16 v[56:59], a[248:251], v[220:223], v[56:59]
    s_add_u32 s15, s25, 24576
    ds_read_b128 a[24:27], v244 offset:52224
    v_mfma_f32_16x16x32_bf16 v[56:59], a[232:235], v[216:219], v[56:59]
    ds_read_b128 a[28:31], v244 offset:60416
    v_mfma_f32_16x16x32_bf16 v[28:31], a[228:231], v[216:219], v[28:31]
    ds_read_b128 a[32:35], v244 offset:53248
    v_mfma_f32_16x16x32_bf16 v[28:31], a[244:247], v[220:223], v[28:31]
    ds_read_b128 a[36:39], v244 offset:61440
    v_mfma_f32_16x16x32_bf16 v[24:27], a[240:243], v[220:223], v[24:27]
    ds_read_b128 a[40:43], v244 offset:54272
    ds_read_b128 a[44:47], v244 offset:62464
    v_mfma_f32_16x16x32_bf16 v[24:27], a[224:227], v[216:219], v[24:27]
    s_waitcnt lgkmcnt(10)
    ds_read_b128 a[48:51], v244 offset:55296
    ds_read_b128 a[52:55], v244 offset:63488
    v_mfma_f32_16x16x32_bf16 v[128:131], a[64:67], a[0:3], 0
    ds_read_b128 a[56:59], v244 offset:56320
    ds_read_b128 a[60:63], v244 offset:64512
    v_mfma_f32_16x16x32_bf16 v[128:131], a[68:71], a[4:7], v[128:131]
    buffer_store_dwordx4 v[188:191], v224, s[64:67], s15 offen offset:3072 sc1
    v_mfma_f32_16x16x32_bf16 v[132:135], a[76:79], a[4:7], 0
    v_mfma_f32_16x16x32_bf16 v[132:135], a[72:75], a[0:3], v[132:135]
    s_waitcnt lgkmcnt(12)
    v_mfma_f32_16x16x32_bf16 v[136:139], a[64:67], a[8:11], 0
    v_mfma_f32_16x16x32_bf16 v[136:139], a[68:71], a[12:15], v[136:139]
    v_mfma_f32_16x16x32_bf16 v[140:143], a[76:79], a[12:15], 0
    v_mfma_f32_16x16x32_bf16 v[140:143], a[72:75], a[8:11], v[140:143]
    s_waitcnt lgkmcnt(10)
    v_mfma_f32_16x16x32_bf16 v[144:147], a[64:67], a[16:19], 0
    s_waitcnt vmcnt(29)
    s_waitcnt lgkmcnt(0)
    s_barrier
    v_mfma_f32_16x16x32_bf16 v[144:147], a[68:71], a[20:23], v[144:147]
    s_add_u32 m0, s16, 32768
    s_add_u32 s14, s23, s36
    v_add_u32 v244, 0x14000, v244
    v_mfma_f32_16x16x32_bf16 v[148:151], a[76:79], a[20:23], 0
    buffer_load_dwordx4 v230, s[52:55], s14 offen offset:0 lds
    v_mfma_f32_16x16x32_bf16 v[148:151], a[72:75], a[16:19], v[148:151]
    ds_read_b128 a[0:3], v244 offset:0
    v_cvt_pk_bf16_f32 v0, v0, v1
    v_mfma_f32_16x16x32_bf16 v[152:155], a[64:67], a[24:27], 0
    ds_read_b128 a[4:7], v244 offset:8192
    v_cvt_pk_bf16_f32 v1, v2, v3
    v_mfma_f32_16x16x32_bf16 v[152:155], a[68:71], a[28:31], v[152:155]
    s_add_u32 s36, s36, 128
    s_sub_u32 s88, s36, 1152
    s_min_u32 s36, s36, s88
    v_mfma_f32_16x16x32_bf16 v[156:159], a[76:79], a[28:31], 0
    buffer_load_dwordx4 v231, s[52:55], s14 offen offset:1024 lds
    v_mfma_f32_16x16x32_bf16 v[156:159], a[72:75], a[24:27], v[156:159]
    ds_read_b128 a[80:83], v238 offset:49152
    v_cvt_pk_bf16_f32 v2, v4, v5
    v_mfma_f32_16x16x32_bf16 v[192:195], a[64:67], a[32:35], 0
    ds_read_b128 a[84:87], v239 offset:49152
    v_cvt_pk_bf16_f32 v3, v6, v7
    v_mfma_f32_16x16x32_bf16 v[192:195], a[68:71], a[36:39], v[192:195]
    ds_read_b128 a[88:91], v238 offset:51200
    v_accvgpr_write_b32 a152, v0
    v_mfma_f32_16x16x32_bf16 v[196:199], a[76:79], a[36:39], 0
    ds_read_b128 a[92:95], v239 offset:51200
    v_accvgpr_write_b32 a153, v1
    v_mfma_f32_16x16x32_bf16 v[196:199], a[72:75], a[32:35], v[196:199]
    buffer_load_dwordx4 v232, s[52:55], s14 offen offset:2048 lds
    v_mfma_f32_16x16x32_bf16 a[128:131], a[40:43], a[64:67], 0
    ds_read_b128 a[8:11], v244 offset:1024
    v_accvgpr_write_b32 a154, v2
    v_mfma_f32_16x16x32_bf16 a[128:131], a[44:47], a[68:71], a[128:131]
    ds_read_b128 a[12:15], v244 offset:9216
    v_accvgpr_write_b32 a155, v3
    v_mfma_f32_16x16x32_bf16 a[132:135], a[44:47], a[76:79], 0
    buffer_load_dwordx4 v233, s[52:55], s14 offen offset:3072 lds
    v_mfma_f32_16x16x32_bf16 a[132:135], a[40:43], a[72:75], a[132:135]
    ds_read_b128 a[16:19], v244 offset:2048
    v_mfma_f32_16x16x32_bf16 a[136:139], a[48:51], a[64:67], 0
    ds_read_b128 a[20:23], v244 offset:10240
    v_cvt_pk_bf16_f32 v8, v8, v9
    v_mfma_f32_16x16x32_bf16 a[136:139], a[52:55], a[68:71], a[136:139]
    s_add_u32 m0, s16, 49152
    s_add_u32 s14, s24, s37
    ds_read_b128 a[24:27], v244 offset:3072
    v_mfma_f32_16x16x32_bf16 a[140:143], a[52:55], a[76:79], 0
    buffer_load_dwordx4 v225, s[64:67], s14 offen offset:0 sc1 lds
    v_mfma_f32_16x16x32_bf16 a[140:143], a[48:51], a[72:75], a[140:143]
    ds_read_b128 a[28:31], v244 offset:11264
    v_cvt_pk_bf16_f32 v9, v10, v11
    v_mfma_f32_16x16x32_bf16 a[144:147], a[56:59], a[64:67], 0
    ds_read_b128 a[32:35], v244 offset:4096
    v_cvt_pk_bf16_f32 v10, v12, v13
    v_mfma_f32_16x16x32_bf16 a[144:147], a[60:63], a[68:71], a[144:147]
    s_add_u32 s37, s37, 16384
    s_sub_u32 s88, s37, 147456
    s_min_u32 s37, s37, s88
    v_mfma_f32_16x16x32_bf16 a[148:151], a[60:63], a[76:79], 0
    ds_read_b128 a[36:39], v244 offset:12288
    ds_read_b128 a[40:43], v244 offset:5120
    v_mfma_f32_16x16x32_bf16 a[148:151], a[56:59], a[72:75], a[148:151]
    s_waitcnt lgkmcnt(9)
    ds_read_b128 a[44:47], v244 offset:13312
    ds_read_b128 a[48:51], v244 offset:6144
    v_mfma_f32_16x16x32_bf16 v[128:131], a[80:83], a[0:3], v[128:131]
    ds_read_b128 a[52:55], v244 offset:14336
    ds_read_b128 a[56:59], v244 offset:7168
    ds_read_b128 a[60:63], v244 offset:15360
    v_mfma_f32_16x16x32_bf16 v[128:131], a[84:87], a[4:7], v[128:131]
    buffer_load_dwordx4 v225, s[64:67], s14 offen offset:1024 sc1 lds
    v_mfma_f32_16x16x32_bf16 v[132:135], a[92:95], a[4:7], v[132:135]
    v_cvt_pk_bf16_f32 v11, v14, v15
    v_accvgpr_write_b32 a156, v8
    v_mfma_f32_16x16x32_bf16 v[132:135], a[88:91], a[0:3], v[132:135]
    s_waitcnt lgkmcnt(12)
    v_accvgpr_write_b32 a157, v9
    v_accvgpr_write_b32 a158, v10
    v_mfma_f32_16x16x32_bf16 v[136:139], a[80:83], a[8:11], v[136:139]
    buffer_load_dwordx4 v225, s[64:67], s14 offen offset:2048 sc1 lds
    v_mfma_f32_16x16x32_bf16 v[136:139], a[84:87], a[12:15], v[136:139]
    v_accvgpr_write_b32 a159, v11
    v_mfma_f32_16x16x32_bf16 v[140:143], a[92:95], a[12:15], v[140:143]
    v_mfma_f32_16x16x32_bf16 v[140:143], a[88:91], a[8:11], v[140:143]
    s_waitcnt lgkmcnt(10)
    buffer_load_dwordx4 v225, s[64:67], s14 offen offset:3072 sc1 lds
    v_mfma_f32_16x16x32_bf16 v[144:147], a[80:83], a[16:19], v[144:147]
    s_waitcnt vmcnt(32)
    s_waitcnt lgkmcnt(0)
    s_barrier
    v_mfma_f32_16x16x32_bf16 v[144:147], a[84:87], a[20:23], v[144:147]
    s_add_u32 m0, s16, 65536
    s_add_u32 s14, s23, s36
    ds_read_b128 a[0:3], v244 offset:32768
    v_mfma_f32_16x16x32_bf16 v[148:151], a[92:95], a[20:23], v[148:151]
    buffer_load_dwordx4 v230, s[52:55], s14 offen offset:0 lds
    v_mfma_f32_16x16x32_bf16 v[148:151], a[88:91], a[16:19], v[148:151]
    ds_read_b128 a[4:7], v244 offset:40960
    v_add_u32 v238, 0x14000, v238
    v_mfma_f32_16x16x32_bf16 v[152:155], a[80:83], a[24:27], v[152:155]
    ds_read_b128 a[64:67], v238 offset:0
    v_add_u32 v239, 0x14000, v239
    v_mfma_f32_16x16x32_bf16 v[152:155], a[84:87], a[28:31], v[152:155]
    s_add_u32 s36, s36, 128
    s_sub_u32 s88, s36, 1152
    s_min_u32 s36, s36, s88
    v_mfma_f32_16x16x32_bf16 v[156:159], a[92:95], a[28:31], v[156:159]
    buffer_load_dwordx4 v231, s[52:55], s14 offen offset:1024 lds
    v_mfma_f32_16x16x32_bf16 v[156:159], a[88:91], a[24:27], v[156:159]
    ds_read_b128 a[68:71], v239 offset:0
    v_cvt_pk_bf16_f32 v16, v16, v17
    v_mfma_f32_16x16x32_bf16 v[192:195], a[80:83], a[32:35], v[192:195]
    ds_read_b128 a[72:75], v238 offset:2048
    v_cvt_pk_bf16_f32 v17, v18, v19
    v_mfma_f32_16x16x32_bf16 v[192:195], a[84:87], a[36:39], v[192:195]
    ds_read_b128 a[76:79], v239 offset:2048
    v_cvt_pk_bf16_f32 v18, v20, v21
    v_mfma_f32_16x16x32_bf16 v[196:199], a[92:95], a[36:39], v[196:199]
    buffer_load_dwordx4 v232, s[52:55], s14 offen offset:2048 lds
    v_mfma_f32_16x16x32_bf16 v[196:199], a[88:91], a[32:35], v[196:199]
    ds_read_b128 a[8:11], v244 offset:33792
    v_cvt_pk_bf16_f32 v19, v22, v23
    v_mfma_f32_16x16x32_bf16 a[128:131], a[40:43], a[80:83], a[128:131]
    ds_read_b128 a[12:15], v244 offset:41984
    v_accvgpr_write_b32 a160, v16
    v_mfma_f32_16x16x32_bf16 a[128:131], a[44:47], a[84:87], a[128:131]
    buffer_load_dwordx4 v233, s[52:55], s14 offen offset:3072 lds
    v_mfma_f32_16x16x32_bf16 a[132:135], a[44:47], a[92:95], a[132:135]
    ds_read_b128 a[16:19], v244 offset:34816
    v_accvgpr_write_b32 a161, v17
    v_mfma_f32_16x16x32_bf16 a[132:135], a[40:43], a[88:91], a[132:135]
    ds_read_b128 a[20:23], v244 offset:43008
    v_accvgpr_write_b32 a162, v18
    v_mfma_f32_16x16x32_bf16 a[136:139], a[48:51], a[80:83], a[136:139]
    ds_read_b128 a[24:27], v244 offset:35840
    v_accvgpr_write_b32 a163, v19
    v_mfma_f32_16x16x32_bf16 a[136:139], a[52:55], a[84:87], a[136:139]
    s_add_u32 m0, s16, 81920
    s_add_u32 s14, s24, s37
    ds_read_b128 a[28:31], v244 offset:44032
    v_mfma_f32_16x16x32_bf16 a[140:143], a[52:55], a[92:95], a[140:143]
    buffer_load_dwordx4 v225, s[64:67], s14 offen offset:0 sc1 lds
    v_mfma_f32_16x16x32_bf16 a[140:143], a[48:51], a[88:91], a[140:143]
    ds_read_b128 a[32:35], v244 offset:36864
    v_cvt_pk_bf16_f32 v24, v24, v25
    v_mfma_f32_16x16x32_bf16 a[144:147], a[56:59], a[80:83], a[144:147]
    ds_read_b128 a[36:39], v244 offset:45056
    v_cvt_pk_bf16_f32 v25, v26, v27
    v_mfma_f32_16x16x32_bf16 a[144:147], a[60:63], a[84:87], a[144:147]
    s_add_u32 s37, s37, 16384
    s_sub_u32 s88, s37, 147456
    s_min_u32 s37, s37, s88
    v_mfma_f32_16x16x32_bf16 a[148:151], a[60:63], a[92:95], a[148:151]
    ds_read_b128 a[40:43], v244 offset:37888
    ds_read_b128 a[44:47], v244 offset:46080
    v_mfma_f32_16x16x32_bf16 a[148:151], a[56:59], a[88:91], a[148:151]
    s_waitcnt lgkmcnt(10)
    ds_read_b128 a[48:51], v244 offset:38912
    ds_read_b128 a[52:55], v244 offset:47104
    v_mfma_f32_16x16x32_bf16 v[128:131], a[64:67], a[0:3], v[128:131]
    ds_read_b128 a[56:59], v244 offset:39936
    ds_read_b128 a[60:63], v244 offset:48128
    v_mfma_f32_16x16x32_bf16 v[128:131], a[68:71], a[4:7], v[128:131]
    buffer_load_dwordx4 v225, s[64:67], s14 offen offset:1024 sc1 lds
    v_mfma_f32_16x16x32_bf16 v[132:135], a[76:79], a[4:7], v[132:135]
    v_cvt_pk_bf16_f32 v26, v28, v29
    v_cvt_pk_bf16_f32 v27, v30, v31
    v_mfma_f32_16x16x32_bf16 v[132:135], a[72:75], a[0:3], v[132:135]
    s_waitcnt lgkmcnt(12)
    v_accvgpr_write_b32 a164, v24
    v_accvgpr_write_b32 a165, v25
    v_mfma_f32_16x16x32_bf16 v[136:139], a[64:67], a[8:11], v[136:139]
    buffer_load_dwordx4 v225, s[64:67], s14 offen offset:2048 sc1 lds
    v_mfma_f32_16x16x32_bf16 v[136:139], a[68:71], a[12:15], v[136:139]
    v_accvgpr_write_b32 a166, v26
    v_accvgpr_write_b32 a167, v27
    v_mfma_f32_16x16x32_bf16 v[140:143], a[76:79], a[12:15], v[140:143]
    v_mfma_f32_16x16x32_bf16 v[140:143], a[72:75], a[8:11], v[140:143]
    s_waitcnt lgkmcnt(10)
    buffer_load_dwordx4 v225, s[64:67], s14 offen offset:3072 sc1 lds
    v_mfma_f32_16x16x32_bf16 v[144:147], a[64:67], a[16:19], v[144:147]
    s_waitcnt vmcnt(32)
    s_waitcnt lgkmcnt(0)
    s_barrier
    v_mfma_f32_16x16x32_bf16 v[144:147], a[68:71], a[20:23], v[144:147]
    s_add_u32 m0, s16, 98304
    s_add_u32 s14, s23, s36
    v_add_u32 v244, 0x10000, v244
    v_mfma_f32_16x16x32_bf16 v[148:151], a[76:79], a[20:23], v[148:151]
    buffer_load_dwordx4 v230, s[52:55], s14 offen offset:0 lds
    v_mfma_f32_16x16x32_bf16 v[148:151], a[72:75], a[16:19], v[148:151]
    ds_read_b128 a[0:3], v244 offset:0
    v_cvt_pk_bf16_f32 v32, v32, v33
    v_mfma_f32_16x16x32_bf16 v[152:155], a[64:67], a[24:27], v[152:155]
    ds_read_b128 a[4:7], v244 offset:8192
    v_cvt_pk_bf16_f32 v33, v34, v35
    v_mfma_f32_16x16x32_bf16 v[152:155], a[68:71], a[28:31], v[152:155]
    s_add_u32 s36, s36, 128
    s_sub_u32 s88, s36, 1152
    s_min_u32 s36, s36, s88
    v_mfma_f32_16x16x32_bf16 v[156:159], a[76:79], a[28:31], v[156:159]
    buffer_load_dwordx4 v231, s[52:55], s14 offen offset:1024 lds
    v_mfma_f32_16x16x32_bf16 v[156:159], a[72:75], a[24:27], v[156:159]
    ds_read_b128 a[80:83], v238 offset:32768
    v_cvt_pk_bf16_f32 v34, v36, v37
    v_mfma_f32_16x16x32_bf16 v[192:195], a[64:67], a[32:35], v[192:195]
    ds_read_b128 a[84:87], v239 offset:32768
    v_cvt_pk_bf16_f32 v35, v38, v39
    v_mfma_f32_16x16x32_bf16 v[192:195], a[68:71], a[36:39], v[192:195]
    ds_read_b128 a[88:91], v238 offset:34816
    v_accvgpr_write_b32 a168, v32
    v_mfma_f32_16x16x32_bf16 v[196:199], a[76:79], a[36:39], v[196:199]
    ds_read_b128 a[92:95], v239 offset:34816
    v_accvgpr_write_b32 a169, v33
    v_mfma_f32_16x16x32_bf16 v[196:199], a[72:75], a[32:35], v[196:199]
    buffer_load_dwordx4 v232, s[52:55], s14 offen offset:2048 lds
    v_mfma_f32_16x16x32_bf16 a[128:131], a[40:43], a[64:67], a[128:131]
    ds_read_b128 a[8:11], v244 offset:1024
    v_accvgpr_write_b32 a170, v34
    v_mfma_f32_16x16x32_bf16 a[128:131], a[44:47], a[68:71], a[128:131]
    ds_read_b128 a[12:15], v244 offset:9216
    v_accvgpr_write_b32 a171, v35
    v_mfma_f32_16x16x32_bf16 a[132:135], a[44:47], a[76:79], a[132:135]
    buffer_load_dwordx4 v233, s[52:55], s14 offen offset:3072 lds
    v_mfma_f32_16x16x32_bf16 a[132:135], a[40:43], a[72:75], a[132:135]
    ds_read_b128 a[16:19], v244 offset:2048
    v_mfma_f32_16x16x32_bf16 a[136:139], a[48:51], a[64:67], a[136:139]
    ds_read_b128 a[20:23], v244 offset:10240
    v_cvt_pk_bf16_f32 v40, v40, v41
    v_mfma_f32_16x16x32_bf16 a[136:139], a[52:55], a[68:71], a[136:139]
    s_add_u32 m0, s16, 114688
    s_add_u32 s14, s24, s37
    ds_read_b128 a[24:27], v244 offset:3072
    v_mfma_f32_16x16x32_bf16 a[140:143], a[52:55], a[76:79], a[140:143]
    buffer_load_dwordx4 v225, s[64:67], s14 offen offset:0 sc1 lds
    v_mfma_f32_16x16x32_bf16 a[140:143], a[48:51], a[72:75], a[140:143]
    ds_read_b128 a[28:31], v244 offset:11264
    v_cvt_pk_bf16_f32 v41, v42, v43
    v_mfma_f32_16x16x32_bf16 a[144:147], a[56:59], a[64:67], a[144:147]
    ds_read_b128 a[32:35], v244 offset:4096
    v_cvt_pk_bf16_f32 v42, v44, v45
    v_mfma_f32_16x16x32_bf16 a[144:147], a[60:63], a[68:71], a[144:147]
    s_add_u32 s37, s37, 16384
    s_sub_u32 s88, s37, 147456
    s_min_u32 s37, s37, s88
    v_mfma_f32_16x16x32_bf16 a[148:151], a[60:63], a[76:79], a[148:151]
    ds_read_b128 a[36:39], v244 offset:12288
    ds_read_b128 a[40:43], v244 offset:5120
    v_mfma_f32_16x16x32_bf16 a[148:151], a[56:59], a[72:75], a[148:151]
    s_waitcnt lgkmcnt(9)
    ds_read_b128 a[44:47], v244 offset:13312
    ds_read_b128 a[48:51], v244 offset:6144
    v_mfma_f32_16x16x32_bf16 v[128:131], a[80:83], a[0:3], v[128:131]
    ds_read_b128 a[52:55], v244 offset:14336
    ds_read_b128 a[56:59], v244 offset:7168
    ds_read_b128 a[60:63], v244 offset:15360
    v_mfma_f32_16x16x32_bf16 v[128:131], a[84:87], a[4:7], v[128:131]
    buffer_load_dwordx4 v225, s[64:67], s14 offen offset:1024 sc1 lds
    v_mfma_f32_16x16x32_bf16 v[132:135], a[92:95], a[4:7], v[132:135]
    v_cvt_pk_bf16_f32 v43, v46, v47
    v_accvgpr_write_b32 a172, v40
    v_mfma_f32_16x16x32_bf16 v[132:135], a[88:91], a[0:3], v[132:135]
    s_waitcnt lgkmcnt(12)
    v_accvgpr_write_b32 a173, v41
    v_accvgpr_write_b32 a174, v42
    v_mfma_f32_16x16x32_bf16 v[136:139], a[80:83], a[8:11], v[136:139]
    buffer_load_dwordx4 v225, s[64:67], s14 offen offset:2048 sc1 lds
    v_mfma_f32_16x16x32_bf16 v[136:139], a[84:87], a[12:15], v[136:139]
    v_accvgpr_write_b32 a175, v43
    v_mfma_f32_16x16x32_bf16 v[140:143], a[92:95], a[12:15], v[140:143]
    v_mfma_f32_16x16x32_bf16 v[140:143], a[88:91], a[8:11], v[140:143]
    s_waitcnt lgkmcnt(10)
    buffer_load_dwordx4 v225, s[64:67], s14 offen offset:3072 sc1 lds
    v_mfma_f32_16x16x32_bf16 v[144:147], a[80:83], a[16:19], v[144:147]
    s_waitcnt vmcnt(25)
    s_waitcnt lgkmcnt(0)
    s_barrier
    v_mfma_f32_16x16x32_bf16 v[144:147], a[84:87], a[20:23], v[144:147]
    s_add_u32 m0, s16, 131072
    s_add_u32 s14, s23, s36
    v_add_u32 v244, 0xfffe0000, v244
    v_mfma_f32_16x16x32_bf16 v[148:151], a[92:95], a[20:23], v[148:151]
    buffer_load_dwordx4 v230, s[52:55], s14 offen offset:0 lds
    v_mfma_f32_16x16x32_bf16 v[148:151], a[88:91], a[16:19], v[148:151]
    ds_read_b128 a[0:3], v244 offset:0
    v_cvt_pk_bf16_f32 v48, v48, v49
    v_mfma_f32_16x16x32_bf16 v[152:155], a[80:83], a[24:27], v[152:155]
    ds_read_b128 a[4:7], v244 offset:8192
    v_add_u32 v238, 0xfffe8000, v238
    v_mfma_f32_16x16x32_bf16 v[152:155], a[84:87], a[28:31], v[152:155]
    s_add_u32 s36, s36, 128
    s_sub_u32 s88, s36, 1152
    s_min_u32 s36, s36, s88
    v_mfma_f32_16x16x32_bf16 v[156:159], a[92:95], a[28:31], v[156:159]
    buffer_load_dwordx4 v231, s[52:55], s14 offen offset:1024 lds
    v_mfma_f32_16x16x32_bf16 v[156:159], a[88:91], a[24:27], v[156:159]
    ds_read_b128 a[64:67], v238 offset:0
    v_add_u32 v239, 0xfffe8000, v239
    v_mfma_f32_16x16x32_bf16 v[192:195], a[80:83], a[32:35], v[192:195]
    ds_read_b128 a[68:71], v239 offset:0
    v_cvt_pk_bf16_f32 v49, v50, v51
    v_mfma_f32_16x16x32_bf16 v[192:195], a[84:87], a[36:39], v[192:195]
    ds_read_b128 a[72:75], v238 offset:2048
    v_cvt_pk_bf16_f32 v50, v52, v53
    v_mfma_f32_16x16x32_bf16 v[196:199], a[92:95], a[36:39], v[196:199]
    ds_read_b128 a[76:79], v239 offset:2048
    v_cvt_pk_bf16_f32 v51, v54, v55
    v_mfma_f32_16x16x32_bf16 v[196:199], a[88:91], a[32:35], v[196:199]
    buffer_load_dwordx4 v232, s[52:55], s14 offen offset:2048 lds
    v_mfma_f32_16x16x32_bf16 a[128:131], a[40:43], a[80:83], a[128:131]
    ds_read_b128 a[8:11], v244 offset:1024
    v_accvgpr_write_b32 a176, v48
    v_mfma_f32_16x16x32_bf16 a[128:131], a[44:47], a[84:87], a[128:131]
    ds_read_b128 a[12:15], v244 offset:9216
    v_accvgpr_write_b32 a177, v49
    v_mfma_f32_16x16x32_bf16 a[132:135], a[44:47], a[92:95], a[132:135]
    buffer_load_dwordx4 v233, s[52:55], s14 offen offset:3072 lds
    v_mfma_f32_16x16x32_bf16 a[132:135], a[40:43], a[88:91], a[132:135]
    ds_read_b128 a[16:19], v244 offset:2048
    v_accvgpr_write_b32 a178, v50
    v_mfma_f32_16x16x32_bf16 a[136:139], a[48:51], a[80:83], a[136:139]
    ds_read_b128 a[20:23], v244 offset:10240
    v_accvgpr_write_b32 a179, v51
    v_mfma_f32_16x16x32_bf16 a[136:139], a[52:55], a[84:87], a[136:139]
    s_add_u32 m0, s16, 147456
    s_add_u32 s14, s24, s37
    ds_read_b128 a[24:27], v244 offset:3072
    v_mfma_f32_16x16x32_bf16 a[140:143], a[52:55], a[92:95], a[140:143]
    buffer_load_dwordx4 v225, s[64:67], s14 offen offset:0 sc1 lds
    v_mfma_f32_16x16x32_bf16 a[140:143], a[48:51], a[88:91], a[140:143]
    ds_read_b128 a[28:31], v244 offset:11264
    v_cvt_pk_bf16_f32 v56, v56, v57
    v_mfma_f32_16x16x32_bf16 a[144:147], a[56:59], a[80:83], a[144:147]
    ds_read_b128 a[32:35], v244 offset:4096
    v_cvt_pk_bf16_f32 v57, v58, v59
    v_mfma_f32_16x16x32_bf16 a[144:147], a[60:63], a[84:87], a[144:147]
    s_add_u32 s37, s37, 16384
    s_sub_u32 s88, s37, 147456
    s_min_u32 s37, s37, s88
    v_mfma_f32_16x16x32_bf16 a[148:151], a[60:63], a[92:95], a[148:151]
    ds_read_b128 a[36:39], v244 offset:12288
    ds_read_b128 a[40:43], v244 offset:5120
    v_mfma_f32_16x16x32_bf16 a[148:151], a[56:59], a[88:91], a[148:151]
    s_waitcnt lgkmcnt(9)
    ds_read_b128 a[44:47], v244 offset:13312
    ds_read_b128 a[48:51], v244 offset:6144
    v_mfma_f32_16x16x32_bf16 v[128:131], a[64:67], a[0:3], v[128:131]
    ds_read_b128 a[52:55], v244 offset:14336
    ds_read_b128 a[56:59], v244 offset:7168
    ds_read_b128 a[60:63], v244 offset:15360
    v_mfma_f32_16x16x32_bf16 v[128:131], a[68:71], a[4:7], v[128:131]
    buffer_load_dwordx4 v225, s[64:67], s14 offen offset:1024 sc1 lds
    v_mfma_f32_16x16x32_bf16 v[132:135], a[76:79], a[4:7], v[132:135]
    v_cvt_pk_bf16_f32 v58, v60, v61
    v_cvt_pk_bf16_f32 v59, v62, v63
    v_mfma_f32_16x16x32_bf16 v[132:135], a[72:75], a[0:3], v[132:135]
    s_waitcnt lgkmcnt(12)
    v_accvgpr_write_b32 a180, v56
    v_accvgpr_write_b32 a181, v57
    v_mfma_f32_16x16x32_bf16 v[136:139], a[64:67], a[8:11], v[136:139]
    buffer_load_dwordx4 v225, s[64:67], s14 offen offset:2048 sc1 lds
    v_mfma_f32_16x16x32_bf16 v[136:139], a[68:71], a[12:15], v[136:139]
    v_accvgpr_write_b32 a182, v58
    v_accvgpr_write_b32 a183, v59
    v_mfma_f32_16x16x32_bf16 v[140:143], a[76:79], a[12:15], v[140:143]
    v_mfma_f32_16x16x32_bf16 v[140:143], a[72:75], a[8:11], v[140:143]
    s_waitcnt lgkmcnt(10)
    buffer_load_dwordx4 v225, s[64:67], s14 offen offset:3072 sc1 lds
    v_mfma_f32_16x16x32_bf16 v[144:147], a[64:67], a[16:19], v[144:147]
    s_waitcnt vmcnt(24)
    s_waitcnt lgkmcnt(0)
    s_barrier
    v_mfma_f32_16x16x32_bf16 v[144:147], a[68:71], a[20:23], v[144:147]
    ds_read_b128 a[0:3], v244 offset:32768
    v_mfma_f32_16x16x32_bf16 v[148:151], a[76:79], a[20:23], v[148:151]
    ds_read_b128 a[4:7], v244 offset:40960
    v_mfma_f32_16x16x32_bf16 v[148:151], a[72:75], a[16:19], v[148:151]
    ds_read_b128 a[80:83], v238 offset:32768
    v_mfma_f32_16x16x32_bf16 v[152:155], a[64:67], a[24:27], v[152:155]
    ds_read_b128 a[84:87], v239 offset:32768
    v_mfma_f32_16x16x32_bf16 v[152:155], a[68:71], a[28:31], v[152:155]
    ds_read_b128 a[88:91], v238 offset:34816
    v_mfma_f32_16x16x32_bf16 v[156:159], a[76:79], a[28:31], v[156:159]
    ds_read_b128 a[92:95], v239 offset:34816
    v_mfma_f32_16x16x32_bf16 v[156:159], a[72:75], a[24:27], v[156:159]
    ds_read_b128 a[8:11], v244 offset:33792
    v_mfma_f32_16x16x32_bf16 v[192:195], a[64:67], a[32:35], v[192:195]
    ds_read_b128 a[12:15], v244 offset:41984
    v_mfma_f32_16x16x32_bf16 v[192:195], a[68:71], a[36:39], v[192:195]
    ds_read_b128 a[16:19], v244 offset:34816
    v_mfma_f32_16x16x32_bf16 v[196:199], a[76:79], a[36:39], v[196:199]
    ds_read_b128 a[20:23], v244 offset:43008
    v_mfma_f32_16x16x32_bf16 v[196:199], a[72:75], a[32:35], v[196:199]
    ds_read_b128 a[24:27], v244 offset:35840
    v_mfma_f32_16x16x32_bf16 a[128:131], a[40:43], a[64:67], a[128:131]
    ds_read_b128 a[28:31], v244 offset:44032
    v_mfma_f32_16x16x32_bf16 a[128:131], a[44:47], a[68:71], a[128:131]
    ds_read_b128 a[32:35], v244 offset:36864
    v_mfma_f32_16x16x32_bf16 a[132:135], a[44:47], a[76:79], a[132:135]
    ds_read_b128 a[36:39], v244 offset:45056
    v_mfma_f32_16x16x32_bf16 a[132:135], a[40:43], a[72:75], a[132:135]
    ds_read_b128 a[40:43], v244 offset:37888
    v_mfma_f32_16x16x32_bf16 a[136:139], a[48:51], a[64:67], a[136:139]
    ds_read_b128 a[44:47], v244 offset:46080
    v_mfma_f32_16x16x32_bf16 a[136:139], a[52:55], a[68:71], a[136:139]
    v_mfma_f32_16x16x32_bf16 a[140:143], a[52:55], a[76:79], a[140:143]
    v_mfma_f32_16x16x32_bf16 a[140:143], a[48:51], a[72:75], a[140:143]
    ds_read_b128 a[48:51], v244 offset:38912
    v_mfma_f32_16x16x32_bf16 a[144:147], a[56:59], a[64:67], a[144:147]
    ds_read_b128 a[52:55], v244 offset:47104
    v_mfma_f32_16x16x32_bf16 a[144:147], a[60:63], a[68:71], a[144:147]
    v_mfma_f32_16x16x32_bf16 a[148:151], a[60:63], a[76:79], a[148:151]
    v_mfma_f32_16x16x32_bf16 a[148:151], a[56:59], a[72:75], a[148:151]
    s_waitcnt lgkmcnt(12)
    ds_read_b128 a[56:59], v244 offset:39936
    ds_read_b128 a[60:63], v244 offset:48128
    v_mfma_f32_16x16x32_bf16 v[128:131], a[80:83], a[0:3], v[128:131]
    v_mfma_f32_16x16x32_bf16 v[128:131], a[84:87], a[4:7], v[128:131]
    v_mfma_f32_16x16x32_bf16 v[132:135], a[92:95], a[4:7], v[132:135]
    v_mfma_f32_16x16x32_bf16 v[132:135], a[88:91], a[0:3], v[132:135]
    s_waitcnt lgkmcnt(12)
    v_mfma_f32_16x16x32_bf16 v[136:139], a[80:83], a[8:11], v[136:139]
    v_mfma_f32_16x16x32_bf16 v[136:139], a[84:87], a[12:15], v[136:139]
    v_mfma_f32_16x16x32_bf16 v[140:143], a[92:95], a[12:15], v[140:143]
    v_mfma_f32_16x16x32_bf16 v[140:143], a[88:91], a[8:11], v[140:143]
    s_waitcnt lgkmcnt(10)
    v_mfma_f32_16x16x32_bf16 v[144:147], a[80:83], a[16:19], v[144:147]
    s_waitcnt vmcnt(16)
    s_waitcnt lgkmcnt(0)
    s_barrier
    v_mfma_f32_16x16x32_bf16 v[144:147], a[84:87], a[20:23], v[144:147]
    s_lshl_b32 s36, s95, 7
    s_add_u32 m0, s16, 32768
    s_add_u32 s14, s21, s36
    v_mfma_f32_16x16x32_bf16 v[148:151], a[92:95], a[20:23], v[148:151]
    buffer_load_dwordx4 v230, s[56:59], s14 offen offset:0 lds
    v_mfma_f32_16x16x32_bf16 v[148:151], a[88:91], a[16:19], v[148:151]
    v_add_u32 v244, 0x10000, v244
    v_mfma_f32_16x16x32_bf16 v[152:155], a[80:83], a[24:27], v[152:155]
    ds_read_b128 a[0:3], v244 offset:0
    v_mfma_f32_16x16x32_bf16 v[152:155], a[84:87], a[28:31], v[152:155]
    buffer_load_dwordx4 v231, s[56:59], s14 offen offset:1024 lds
    v_mfma_f32_16x16x32_bf16 v[156:159], a[92:95], a[28:31], v[156:159]
    ds_read_b128 a[4:7], v244 offset:8192
    v_add_u32 v238, 0x10000, v238
    v_mfma_f32_16x16x32_bf16 v[156:159], a[88:91], a[24:27], v[156:159]
    ds_read_b128 a[64:67], v238 offset:0
    v_add_u32 v239, 0x10000, v239
    v_mfma_f32_16x16x32_bf16 v[192:195], a[80:83], a[32:35], v[192:195]
    ds_read_b128 a[68:71], v239 offset:0
    v_mfma_f32_16x16x32_bf16 v[192:195], a[84:87], a[36:39], v[192:195]
    ds_read_b128 a[72:75], v238 offset:2048
    v_mfma_f32_16x16x32_bf16 v[196:199], a[92:95], a[36:39], v[196:199]
    ds_read_b128 a[76:79], v239 offset:2048
    v_mfma_f32_16x16x32_bf16 v[196:199], a[88:91], a[32:35], v[196:199]
    buffer_load_dwordx4 v232, s[56:59], s14 offen offset:2048 lds
    v_mfma_f32_16x16x32_bf16 a[128:131], a[40:43], a[80:83], a[128:131]
    ds_read_b128 a[8:11], v244 offset:1024
    v_mfma_f32_16x16x32_bf16 a[128:131], a[44:47], a[84:87], a[128:131]
    ds_read_b128 a[12:15], v244 offset:9216
    v_mfma_f32_16x16x32_bf16 a[132:135], a[44:47], a[92:95], a[132:135]
    buffer_load_dwordx4 v233, s[56:59], s14 offen offset:3072 lds
    v_mfma_f32_16x16x32_bf16 a[132:135], a[40:43], a[88:91], a[132:135]
    ds_read_b128 a[16:19], v244 offset:2048
    v_mfma_f32_16x16x32_bf16 a[136:139], a[48:51], a[80:83], a[136:139]
    ds_read_b128 a[20:23], v244 offset:10240
    v_mfma_f32_16x16x32_bf16 a[136:139], a[52:55], a[84:87], a[136:139]
    s_add_u32 m0, s16, 49152
    s_add_u32 s14, s22, s36
    ds_read_b128 a[24:27], v244 offset:3072
    v_mfma_f32_16x16x32_bf16 a[140:143], a[52:55], a[92:95], a[140:143]
    buffer_load_dwordx4 v230, s[56:59], s14 offen offset:0 lds
    v_mfma_f32_16x16x32_bf16 a[140:143], a[48:51], a[88:91], a[140:143]
    ds_read_b128 a[28:31], v244 offset:11264
    v_mfma_f32_16x16x32_bf16 a[144:147], a[56:59], a[80:83], a[144:147]
    ds_read_b128 a[32:35], v244 offset:4096
    v_mfma_f32_16x16x32_bf16 a[144:147], a[60:63], a[84:87], a[144:147]
    s_add_u32 s36, s36, 128
    s_sub_u32 s88, s36, 1152
    s_min_u32 s36, s36, s88
    v_mfma_f32_16x16x32_bf16 a[148:151], a[60:63], a[92:95], a[148:151]
    ds_read_b128 a[36:39], v244 offset:12288
    ds_read_b128 a[40:43], v244 offset:5120
    v_mfma_f32_16x16x32_bf16 a[148:151], a[56:59], a[88:91], a[148:151]
    s_waitcnt lgkmcnt(9)
    ds_read_b128 a[44:47], v244 offset:13312
    ds_read_b128 a[48:51], v244 offset:6144
    v_mfma_f32_16x16x32_bf16 v[128:131], a[64:67], a[0:3], v[128:131]
    ds_read_b128 a[52:55], v244 offset:14336
    ds_read_b128 a[56:59], v244 offset:7168
    ds_read_b128 a[60:63], v244 offset:15360
    v_mfma_f32_16x16x32_bf16 v[128:131], a[68:71], a[4:7], v[128:131]
    buffer_load_dwordx4 v231, s[56:59], s14 offen offset:1024 lds
    v_mfma_f32_16x16x32_bf16 v[132:135], a[76:79], a[4:7], v[132:135]
    v_mfma_f32_16x16x32_bf16 v[132:135], a[72:75], a[0:3], v[132:135]
    s_waitcnt lgkmcnt(12)
    v_mfma_f32_16x16x32_bf16 v[136:139], a[64:67], a[8:11], v[136:139]
    buffer_load_dwordx4 v232, s[56:59], s14 offen offset:2048 lds
    v_mfma_f32_16x16x32_bf16 v[136:139], a[68:71], a[12:15], v[136:139]
    v_mfma_f32_16x16x32_bf16 v[140:143], a[76:79], a[12:15], v[140:143]
    v_mfma_f32_16x16x32_bf16 v[140:143], a[72:75], a[8:11], v[140:143]
    s_waitcnt lgkmcnt(10)
    buffer_load_dwordx4 v233, s[56:59], s14 offen offset:3072 lds
    v_mfma_f32_16x16x32_bf16 v[144:147], a[64:67], a[16:19], v[144:147]
    s_waitcnt vmcnt(16)
    s_waitcnt lgkmcnt(0)
    s_barrier
    v_mfma_f32_16x16x32_bf16 v[144:147], a[68:71], a[20:23], v[144:147]
    s_lshl_b32 s37, s95, 19
    s_add_u32 m0, s17, 65536
    s_add_u32 s14, s19, s37
    v_mfma_f32_16x16x32_bf16 v[148:151], a[76:79], a[20:23], v[148:151]
    buffer_load_dwordx4 v234, s[60:63], s14 offen offset:0 lds
    v_mfma_f32_16x16x32_bf16 v[148:151], a[72:75], a[16:19], v[148:151]
    ds_read_b128 a[0:3], v244 offset:32768
    v_mfma_f32_16x16x32_bf16 v[152:155], a[64:67], a[24:27], v[152:155]
    ds_read_b128 a[4:7], v244 offset:40960
    v_mfma_f32_16x16x32_bf16 v[152:155], a[68:71], a[28:31], v[152:155]
    s_add_u32 s37, s37, 524288
    s_sub_u32 s88, s37, 4718592
    s_min_u32 s37, s37, s88
    v_mfma_f32_16x16x32_bf16 v[156:159], a[76:79], a[28:31], v[156:159]
    buffer_load_dwordx4 v235, s[60:63], s14 offen offset:1024 lds
    v_mfma_f32_16x16x32_bf16 v[156:159], a[72:75], a[24:27], v[156:159]
    ds_read_b128 a[80:83], v238 offset:32768
    v_mfma_f32_16x16x32_bf16 v[192:195], a[64:67], a[32:35], v[192:195]
    ds_read_b128 a[84:87], v239 offset:32768
    v_mfma_f32_16x16x32_bf16 v[192:195], a[68:71], a[36:39], v[192:195]
    ds_read_b128 a[88:91], v238 offset:34816
    v_mfma_f32_16x16x32_bf16 v[196:199], a[76:79], a[36:39], v[196:199]
    ds_read_b128 a[92:95], v239 offset:34816
    v_mfma_f32_16x16x32_bf16 v[196:199], a[72:75], a[32:35], v[196:199]
    buffer_load_dwordx4 v236, s[60:63], s14 offen offset:2048 lds
    v_mfma_f32_16x16x32_bf16 a[128:131], a[40:43], a[64:67], a[128:131]
    ds_read_b128 a[8:11], v244 offset:33792
    v_mfma_f32_16x16x32_bf16 a[128:131], a[44:47], a[68:71], a[128:131]
    ds_read_b128 a[12:15], v244 offset:41984
    v_mfma_f32_16x16x32_bf16 a[132:135], a[44:47], a[76:79], a[132:135]
    buffer_load_dwordx4 v237, s[60:63], s14 offen offset:3072 lds
    v_mfma_f32_16x16x32_bf16 a[132:135], a[40:43], a[72:75], a[132:135]
    ds_read_b128 a[16:19], v244 offset:34816
    v_mfma_f32_16x16x32_bf16 a[136:139], a[48:51], a[64:67], a[136:139]
    ds_read_b128 a[20:23], v244 offset:43008
    v_mfma_f32_16x16x32_bf16 a[136:139], a[52:55], a[68:71], a[136:139]
    s_add_u32 m0, s16, 81920
    s_add_u32 s14, s21, s36
    ds_read_b128 a[24:27], v244 offset:35840
    v_mfma_f32_16x16x32_bf16 a[140:143], a[52:55], a[76:79], a[140:143]
    buffer_load_dwordx4 v230, s[56:59], s14 offen offset:0 lds
    v_mfma_f32_16x16x32_bf16 a[140:143], a[48:51], a[72:75], a[140:143]
    ds_read_b128 a[28:31], v244 offset:44032
    v_mfma_f32_16x16x32_bf16 a[144:147], a[56:59], a[64:67], a[144:147]
    ds_read_b128 a[32:35], v244 offset:36864
    v_mfma_f32_16x16x32_bf16 a[144:147], a[60:63], a[68:71], a[144:147]
    ds_read_b128 a[36:39], v244 offset:45056
    v_mfma_f32_16x16x32_bf16 a[148:151], a[60:63], a[76:79], a[148:151]
    ds_read_b128 a[40:43], v244 offset:37888
    ds_read_b128 a[44:47], v244 offset:46080
    v_mfma_f32_16x16x32_bf16 a[148:151], a[56:59], a[72:75], a[148:151]
    s_waitcnt lgkmcnt(10)
    ds_read_b128 a[48:51], v244 offset:38912
    ds_read_b128 a[52:55], v244 offset:47104
    v_mfma_f32_16x16x32_bf16 v[128:131], a[80:83], a[0:3], v[128:131]
    ds_read_b128 a[56:59], v244 offset:39936
    ds_read_b128 a[60:63], v244 offset:48128
    v_mfma_f32_16x16x32_bf16 v[128:131], a[84:87], a[4:7], v[128:131]
    buffer_load_dwordx4 v231, s[56:59], s14 offen offset:1024 lds
    v_mfma_f32_16x16x32_bf16 v[132:135], a[92:95], a[4:7], v[132:135]
    v_mfma_f32_16x16x32_bf16 v[132:135], a[88:91], a[0:3], v[132:135]
    s_waitcnt lgkmcnt(12)
    v_mfma_f32_16x16x32_bf16 v[136:139], a[80:83], a[8:11], v[136:139]
    buffer_load_dwordx4 v232, s[56:59], s14 offen offset:2048 lds
    v_mfma_f32_16x16x32_bf16 v[136:139], a[84:87], a[12:15], v[136:139]
    v_mfma_f32_16x16x32_bf16 v[140:143], a[92:95], a[12:15], v[140:143]
    v_mfma_f32_16x16x32_bf16 v[140:143], a[88:91], a[8:11], v[140:143]
    s_waitcnt lgkmcnt(10)
    buffer_load_dwordx4 v233, s[56:59], s14 offen offset:3072 lds
    v_mfma_f32_16x16x32_bf16 v[144:147], a[80:83], a[16:19], v[144:147]
    s_waitcnt vmcnt(16)
    s_waitcnt lgkmcnt(0)
    s_barrier
    v_mfma_f32_16x16x32_bf16 v[144:147], a[84:87], a[20:23], v[144:147]
    s_add_u32 m0, s16, 98304
    s_add_u32 s14, s22, s36
    v_add_u32 v244, 0x10000, v244
    v_mfma_f32_16x16x32_bf16 v[148:151], a[92:95], a[20:23], v[148:151]
    buffer_load_dwordx4 v230, s[56:59], s14 offen offset:0 lds
    v_mfma_f32_16x16x32_bf16 v[148:151], a[88:91], a[16:19], v[148:151]
    ds_read_b128 a[0:3], v244 offset:0
    v_mfma_f32_16x16x32_bf16 v[152:155], a[80:83], a[24:27], v[152:155]
    ds_read_b128 a[4:7], v244 offset:8192
    v_add_u32 v238, 0x10000, v238
    v_mfma_f32_16x16x32_bf16 v[152:155], a[84:87], a[28:31], v[152:155]
    s_add_u32 s36, s36, 128
    s_sub_u32 s88, s36, 1152
    s_min_u32 s36, s36, s88
    v_mfma_f32_16x16x32_bf16 v[156:159], a[92:95], a[28:31], v[156:159]
    buffer_load_dwordx4 v231, s[56:59], s14 offen offset:1024 lds
    v_mfma_f32_16x16x32_bf16 v[156:159], a[88:91], a[24:27], v[156:159]
    ds_read_b128 a[64:67], v238 offset:0
    v_add_u32 v239, 0x10000, v239
    v_mfma_f32_16x16x32_bf16 v[192:195], a[80:83], a[32:35], v[192:195]
    ds_read_b128 a[68:71], v239 offset:0
    v_mfma_f32_16x16x32_bf16 v[192:195], a[84:87], a[36:39], v[192:195]
    ds_read_b128 a[72:75], v238 offset:2048
    v_mfma_f32_16x16x32_bf16 v[196:199], a[92:95], a[36:39], v[196:199]
    ds_read_b128 a[76:79], v239 offset:2048
    v_mfma_f32_16x16x32_bf16 v[196:199], a[88:91], a[32:35], v[196:199]
    buffer_load_dwordx4 v232, s[56:59], s14 offen offset:2048 lds
    v_mfma_f32_16x16x32_bf16 a[128:131], a[40:43], a[80:83], a[128:131]
    ds_read_b128 a[8:11], v244 offset:1024
    v_mfma_f32_16x16x32_bf16 a[128:131], a[44:47], a[84:87], a[128:131]
    ds_read_b128 a[12:15], v244 offset:9216
    v_mfma_f32_16x16x32_bf16 a[132:135], a[44:47], a[92:95], a[132:135]
    buffer_load_dwordx4 v233, s[56:59], s14 offen offset:3072 lds
    v_mfma_f32_16x16x32_bf16 a[132:135], a[40:43], a[88:91], a[132:135]
    ds_read_b128 a[16:19], v244 offset:2048
    v_mfma_f32_16x16x32_bf16 a[136:139], a[48:51], a[80:83], a[136:139]
    s_mov_b32 s92, 0x000f000f
    s_mov_b32 s93, 0x000f000f
    s_mov_b32 s13, 0x3fb8aa3b
    v_mfma_f32_16x16x32_bf16 a[136:139], a[52:55], a[84:87], a[136:139]
    s_add_u32 m0, s17, 114688
    s_add_u32 s14, s19, s37
    s_mov_b32 s100, 0xff00ff00
    v_mfma_f32_16x16x32_bf16 a[140:143], a[52:55], a[92:95], a[140:143]
    s_mov_b32 s101, 0xff00ff00
    ds_read_b128 a[20:23], v244 offset:10240
    v_mfma_f32_16x16x32_bf16 a[140:143], a[48:51], a[88:91], a[140:143]
    buffer_load_dwordx4 v234, s[60:63], s14 offen offset:0 lds
    v_mfma_f32_16x16x32_bf16 a[144:147], a[56:59], a[80:83], a[144:147]
    ds_read_b128 a[24:27], v244 offset:3072
    v_mfma_f32_16x16x32_bf16 a[144:147], a[60:63], a[84:87], a[144:147]
    s_add_u32 s37, s37, 524288
    s_sub_u32 s88, s37, 4718592
    s_min_u32 s37, s37, s88
    v_mfma_f32_16x16x32_bf16 a[148:151], a[60:63], a[92:95], a[148:151]
    ds_read_b128 a[28:31], v244 offset:11264
    v_mfma_f32_16x16x32_bf16 a[148:151], a[56:59], a[88:91], a[148:151]
    s_waitcnt lgkmcnt(6)
    buffer_load_dwordx4 v235, s[60:63], s14 offen offset:1024 lds
    v_mfma_f32_16x16x32_bf16 v[128:131], a[64:67], a[0:3], v[128:131]
    ds_read_b128 a[32:35], v244 offset:4096
    v_mfma_f32_16x16x32_bf16 v[128:131], a[68:71], a[4:7], v[128:131]
    ds_read_b128 a[36:39], v244 offset:12288
    v_mfma_f32_16x16x32_bf16 v[132:135], a[76:79], a[4:7], v[132:135]
    buffer_load_dwordx4 v236, s[60:63], s14 offen offset:2048 lds
    v_mfma_f32_16x16x32_bf16 v[132:135], a[72:75], a[0:3], v[132:135]
    s_waitcnt lgkmcnt(6)
    ds_read_b128 a[40:43], v244 offset:5120
    v_mfma_f32_16x16x32_bf16 v[136:139], a[64:67], a[8:11], v[136:139]
    ds_read_b128 a[44:47], v244 offset:13312
    v_mfma_f32_16x16x32_bf16 v[136:139], a[68:71], a[12:15], v[136:139]
    buffer_load_dwordx4 v237, s[60:63], s14 offen offset:3072 lds
    v_mfma_f32_16x16x32_bf16 v[140:143], a[76:79], a[12:15], v[140:143]
    ds_read_b128 a[48:51], v244 offset:6144
    v_mfma_f32_16x16x32_bf16 v[140:143], a[72:75], a[8:11], v[140:143]
    s_waitcnt lgkmcnt(7)
    ds_read_b128 a[52:55], v244 offset:14336
    v_mfma_f32_16x16x32_bf16 v[144:147], a[64:67], a[16:19], v[144:147]
    ds_read_b128 a[56:59], v244 offset:7168
    v_mfma_f32_16x16x32_bf16 v[144:147], a[68:71], a[20:23], v[144:147]
    ds_read_b128 a[60:63], v244 offset:15360
    v_mfma_f32_16x16x32_bf16 v[148:151], a[76:79], a[20:23], v[148:151]
    v_mfma_f32_16x16x32_bf16 v[148:151], a[72:75], a[16:19], v[148:151]
    s_waitcnt lgkmcnt(8)
    v_mul_f32 v64, s13, v128
    v_mul_f32 v65, s13, v129
    v_mfma_f32_16x16x32_bf16 v[152:155], a[64:67], a[24:27], v[152:155]
    v_mul_f32 v66, s13, v130
    v_mul_f32 v67, s13, v131
    v_mfma_f32_16x16x32_bf16 v[152:155], a[68:71], a[28:31], v[152:155]
    v_mul_f32 v68, s13, v132
    v_mul_f32 v69, s13, v133
    v_mfma_f32_16x16x32_bf16 v[156:159], a[76:79], a[28:31], v[156:159]
    v_mul_f32 v70, s13, v134
    v_mul_f32 v71, s13, v135
    v_mfma_f32_16x16x32_bf16 v[156:159], a[72:75], a[24:27], v[156:159]
    s_waitcnt lgkmcnt(6)
    v_exp_f32 v64, v64 clamp
    v_mfma_f32_16x16x32_bf16 v[192:195], a[64:67], a[32:35], v[192:195]
    v_exp_f32 v65, v65 clamp
    v_mfma_f32_16x16x32_bf16 v[192:195], a[68:71], a[36:39], v[192:195]
    v_exp_f32 v66, v66 clamp
    v_mfma_f32_16x16x32_bf16 v[196:199], a[76:79], a[36:39], v[196:199]
    v_exp_f32 v67, v67 clamp
    v_mfma_f32_16x16x32_bf16 v[196:199], a[72:75], a[32:35], v[196:199]
    s_waitcnt lgkmcnt(4)
    v_exp_f32 v68, v68 clamp
    v_mfma_f32_16x16x32_bf16 a[128:131], a[40:43], a[64:67], a[128:131]
    v_exp_f32 v69, v69 clamp
    v_mfma_f32_16x16x32_bf16 a[128:131], a[44:47], a[68:71], a[128:131]
    v_exp_f32 v70, v70 clamp
    v_mfma_f32_16x16x32_bf16 a[132:135], a[44:47], a[76:79], a[132:135]
    v_exp_f32 v71, v71 clamp
    v_mfma_f32_16x16x32_bf16 a[132:135], a[40:43], a[72:75], a[132:135]
    s_waitcnt lgkmcnt(2)
    v_max_f32 v128, 0, v128
    v_max_f32 v129, 0, v129
    v_mfma_f32_16x16x32_bf16 a[136:139], a[48:51], a[64:67], a[136:139]
    v_max_f32 v130, 0, v130
    v_max_f32 v131, 0, v131
    v_mfma_f32_16x16x32_bf16 a[136:139], a[52:55], a[68:71], a[136:139]
    v_max_f32 v132, 0, v132
    v_max_f32 v133, 0, v133
    v_mfma_f32_16x16x32_bf16 a[140:143], a[52:55], a[76:79], a[140:143]
    v_max_f32 v134, 0, v134
    v_max_f32 v135, 0, v135
    v_mfma_f32_16x16x32_bf16 a[140:143], a[48:51], a[72:75], a[140:143]
    s_waitcnt lgkmcnt(0)
    v_add_f32 v128, 0x358637bd, v128
    v_add_f32 v129, 0x358637bd, v129
    v_mfma_f32_16x16x32_bf16 a[144:147], a[56:59], a[64:67], a[144:147]
    v_add_f32 v130, 0x358637bd, v130
    v_add_f32 v131, 0x358637bd, v131
    v_mfma_f32_16x16x32_bf16 a[144:147], a[60:63], a[68:71], a[144:147]
    v_add_f32 v132, 0x358637bd, v132
    v_add_f32 v133, 0x358637bd, v133
    v_mfma_f32_16x16x32_bf16 a[148:151], a[60:63], a[76:79], a[148:151]
    v_add_f32 v134, 0x358637bd, v134
    v_add_f32 v135, 0x358637bd, v135
    v_mfma_f32_16x16x32_bf16 a[148:151], a[56:59], a[72:75], a[148:151]
    v_add_f32 v128, v128, v64
    v_add_f32 v129, v129, v65
    v_add_f32 v130, v130, v66
    v_add_f32 v131, v131, v67
    v_add_f32 v132, v132, v68
    v_add_f32 v133, v133, v69
    v_add_f32 v134, v134, v70
    v_add_f32 v135, v135, v71
    v_cvt_pk_bf16_f32 v128, v128, v129
    v_cvt_pk_bf16_f32 v129, v130, v131
    v_cvt_pk_bf16_f32 v130, v132, v133
    v_cvt_pk_bf16_f32 v131, v134, v135
    v_mul_f32 v64, s13, v136
    v_mul_f32 v65, s13, v137
    v_mul_f32 v66, s13, v138
    v_mul_f32 v67, s13, v139
    v_mul_f32 v68, s13, v140
    v_mul_f32 v69, s13, v141
    v_mul_f32 v70, s13, v142
    v_mul_f32 v71, s13, v143
    v_exp_f32 v64, v64 clamp
    v_exp_f32 v65, v65 clamp
    v_exp_f32 v66, v66 clamp
    v_exp_f32 v67, v67 clamp
    v_exp_f32 v68, v68 clamp
    v_exp_f32 v69, v69 clamp
    v_exp_f32 v70, v70 clamp
    v_exp_f32 v71, v71 clamp
    v_max_f32 v136, 0, v136
    v_max_f32 v137, 0, v137
    v_max_f32 v138, 0, v138
    v_max_f32 v139, 0, v139
    v_max_f32 v140, 0, v140
    v_max_f32 v141, 0, v141
    v_max_f32 v142, 0, v142
    v_max_f32 v143, 0, v143
    v_add_f32 v136, 0x358637bd, v136
    v_add_f32 v137, 0x358637bd, v137
    v_add_f32 v138, 0x358637bd, v138
    v_add_f32 v139, 0x358637bd, v139
    v_add_f32 v140, 0x358637bd, v140
    v_add_f32 v141, 0x358637bd, v141
    v_add_f32 v142, 0x358637bd, v142
    v_add_f32 v143, 0x358637bd, v143
    v_add_f32 v136, v136, v64
    v_add_f32 v137, v137, v65
    v_add_f32 v138, v138, v66
    v_add_f32 v139, v139, v67
    v_add_f32 v140, v140, v68
    v_add_f32 v141, v141, v69
    v_add_f32 v142, v142, v70
    v_add_f32 v143, v143, v71
    v_cvt_pk_bf16_f32 v136, v136, v137
    v_cvt_pk_bf16_f32 v137, v138, v139
    v_cvt_pk_bf16_f32 v138, v140, v141
    v_cvt_pk_bf16_f32 v139, v142, v143
    v_mul_f32 v64, s13, v144
    v_mul_f32 v65, s13, v145
    v_mul_f32 v66, s13, v146
    v_mul_f32 v67, s13, v147
    v_mul_f32 v68, s13, v148
    v_mul_f32 v69, s13, v149
    v_mul_f32 v70, s13, v150
    v_mul_f32 v71, s13, v151
    v_exp_f32 v64, v64 clamp
    v_exp_f32 v65, v65 clamp
    v_exp_f32 v66, v66 clamp
    v_exp_f32 v67, v67 clamp
    v_exp_f32 v68, v68 clamp
    v_exp_f32 v69, v69 clamp
    v_exp_f32 v70, v70 clamp
    v_exp_f32 v71, v71 clamp
    v_max_f32 v72, 0, v144
    v_max_f32 v73, 0, v145
    v_max_f32 v74, 0, v146
    v_max_f32 v75, 0, v147
    v_max_f32 v76, 0, v148
    v_max_f32 v77, 0, v149
    v_max_f32 v78, 0, v150
    v_max_f32 v79, 0, v151
    v_add_f32 v72, 0x358637bd, v72
    v_add_f32 v73, 0x358637bd, v73
    v_add_f32 v74, 0x358637bd, v74
    v_add_f32 v75, 0x358637bd, v75
    v_add_f32 v76, 0x358637bd, v76
    v_add_f32 v77, 0x358637bd, v77
    v_add_f32 v78, 0x358637bd, v78
    v_add_f32 v79, 0x358637bd, v79
    v_add_f32 v72, v72, v64
    v_add_f32 v73, v73, v65
    v_add_f32 v74, v74, v66
    v_add_f32 v75, v75, v67
    v_add_f32 v76, v76, v68
    v_add_f32 v77, v77, v69
    v_add_f32 v78, v78, v70
    v_add_f32 v79, v79, v71
    v_cndmask_b32 v144, v144, v72, s[92:93]
    v_cndmask_b32 v145, v145, v73, s[92:93]
    v_cndmask_b32 v146, v146, v74, s[92:93]
    v_cndmask_b32 v147, v147, v75, s[92:93]
    v_cndmask_b32 v148, v148, v76, s[92:93]
    v_cndmask_b32 v149, v149, v77, s[92:93]
    v_cndmask_b32 v150, v150, v78, s[92:93]
    v_cndmask_b32 v151, v151, v79, s[92:93]
    v_cvt_pk_bf16_f32 v144, v144, v145
    v_cvt_pk_bf16_f32 v145, v146, v147
    v_cvt_pk_bf16_f32 v146, v148, v149
    v_cvt_pk_bf16_f32 v147, v150, v151
    v_cvt_pk_bf16_f32 v152, v152, v153
    v_cvt_pk_bf16_f32 v153, v154, v155
    v_cvt_pk_bf16_f32 v154, v156, v157
    v_cvt_pk_bf16_f32 v155, v158, v159
    v_cndmask_b32 v192, v192, 1.0, s[100:101]
    v_cndmask_b32 v193, v193, 1.0, s[100:101]
    v_cndmask_b32 v194, v194, 1.0, s[100:101]
    v_cndmask_b32 v195, v195, 1.0, s[100:101]
    v_cndmask_b32 v196, v196, 1.0, s[100:101]
    v_cndmask_b32 v197, v197, 1.0, s[100:101]
    v_cndmask_b32 v198, v198, 1.0, s[100:101]
    v_cndmask_b32 v199, v199, 1.0, s[100:101]
    v_cvt_pk_bf16_f32 v192, v192, v193
    v_cvt_pk_bf16_f32 v193, v194, v195
    v_cvt_pk_bf16_f32 v194, v196, v197
    v_cvt_pk_bf16_f32 v195, v198, v199
    s_nop 0
    v_mfma_f32_16x16x32_bf16 v[80:83], v[144:147], v[128:131], 0
    v_mfma_f32_16x16x32_bf16 v[84:87], v[152:155], v[128:131], 0
    v_mfma_f32_16x16x32_bf16 v[88:91], v[192:195], v[128:131], 0
    v_mfma_f32_16x16x32_bf16 v[92:95], v[144:147], v[136:139], 0
    v_mfma_f32_16x16x32_bf16 v[96:99], v[152:155], v[136:139], 0
    v_mfma_f32_16x16x32_bf16 v[100:103], v[192:195], v[136:139], 0
    v_mfma_f32_16x16x32_bf16 v[104:107], v[152:155], v[144:147], 0
    v_mfma_f32_16x16x32_bf16 v[108:111], v[192:195], v[144:147], 0
    s_lshr_b32 s8, s3, 1
    s_mul_i32 s8, s8, 0
    s_add_u32 s8, s8, s16
    s_add_u32 s8, s8, 0
    v_add_u32 v248, s8, v225
    v_add_u32 v250, 0, v224
    v_add_u32 v249, s98, v250
    v_add_u32 v250, s99, v250
    v_lshrrev_b32 v251, 2, v224
    v_subrev_u32 v251, 128, v251
    v_cmp_gt_u32 vcc, 64, v251
    v_bfrev_b32 v252, 1
    s_nop 0
    v_cndmask_b32 v251, v252, v251, vcc
    ds_write_b128 v248, v[80:83] offset:0
    ds_write_b128 v248, v[84:87] offset:1024
    ds_write_b128 v248, v[88:91] offset:2048
    ds_write_b128 v248, v[92:95] offset:3072
    ds_write_b128 v248, v[96:99] offset:4096
    ds_write_b128 v248, v[100:103] offset:5120
    ds_write_b128 v248, v[104:107] offset:6144
    ds_write_b128 v248, v[108:111] offset:7168
    s_waitcnt vmcnt(12)
    s_waitcnt lgkmcnt(0)
    s_barrier
    ds_read_b128 v[128:131], v249 offset:0
    ds_read_b128 v[132:135], v249 offset:1024
    ds_read_b32 v120, v250 offset:0
    ds_read_b128 v[136:139], v249 offset:8192
    ds_read_b128 v[140:143], v249 offset:9216
    ds_read_b32 v121, v250 offset:8192
    ds_read_b128 v[144:147], v249 offset:16384
    ds_read_b128 v[148:151], v249 offset:17408
    ds_read_b32 v122, v250 offset:16384
    ds_read_b128 v[152:155], v249 offset:24576
    ds_read_b128 v[156:159], v249 offset:25600
    ds_read_b32 v123, v250 offset:24576
    v_add_u32 v240, 0x10000, v240
    ds_read_b64_tr_b16 v[160:161], v240 offset:0
    ds_read_b64_tr_b16 v[162:163], v240 offset:512
    ds_read_b64_tr_b16 v[164:165], v240 offset:4096
    ds_read_b64_tr_b16 v[166:167], v240 offset:4608
    v_add_u32 v238, 0xfffe8000, v238
    ds_read_b128 a[64:67], v238 offset:0
    v_add_u32 v239, 0xfffe8000, v239
    ds_read_b128 a[68:71], v239 offset:0
    ds_read_b128 a[72:75], v238 offset:2048
    ds_read_b128 a[76:79], v239 offset:2048
    ds_read_b128 a[80:83], v238 offset:16384
    ds_read_b128 a[84:87], v239 offset:16384
    ds_read_b128 a[88:91], v238 offset:18432
    ds_read_b128 a[92:95], v239 offset:18432
    v_add_u32 v241, 0x10000, v241
    ds_read_b64_tr_b16 v[168:169], v241 offset:0
    ds_read_b64_tr_b16 v[170:171], v241 offset:512
    ds_read_b64_tr_b16 v[172:173], v241 offset:4096
    ds_read_b64_tr_b16 v[174:175], v241 offset:4608
    s_waitcnt lgkmcnt(15)
    v_add_f32 v128, v128, v136
    v_add_f32 v129, v129, v137
    v_add_f32 v130, v130, v138
    v_add_f32 v131, v131, v139
    v_add_f32 v132, v132, v140
    v_add_f32 v133, v133, v141
    v_add_f32 v134, v134, v142
    v_add_f32 v135, v135, v143
    v_add_f32 v120, v120, v121
    v_add_f32 v128, v128, v144
    v_add_f32 v129, v129, v145
    v_add_f32 v130, v130, v146
    v_add_f32 v131, v131, v147
    v_add_f32 v132, v132, v148
    v_add_f32 v133, v133, v149
    v_add_f32 v134, v134, v150
    v_add_f32 v135, v135, v151
    v_add_f32 v120, v120, v122
    v_add_f32 v128, v128, v152
    v_add_f32 v129, v129, v153
    v_add_f32 v130, v130, v154
    v_add_f32 v131, v131, v155
    v_add_f32 v132, v132, v156
    v_add_f32 v133, v133, v157
    v_add_f32 v134, v134, v158
    v_add_f32 v135, v135, v159
    v_add_f32 v120, v120, v123
    v_cvt_pk_bf16_f32 v128, v128, v129
    v_cvt_pk_bf16_f32 v129, v130, v131
    v_cvt_pk_bf16_f32 v130, v132, v133
    v_cvt_pk_bf16_f32 v131, v134, v135
    buffer_store_dwordx4 v[128:131], v224, s[64:67], s96 offen sc1
    buffer_store_dword v120, v251, s[64:67], s97 offen sc1
    s_waitcnt lgkmcnt(4)
    v_mfma_f32_16x16x32_bf16 v[0:3], v[160:163], a[64:67], 0
    s_add_u32 m0, s16, 131072
    s_add_u32 s14, s21, s36
    v_add_u32 v242, 0x10000, v242
    v_mfma_f32_16x16x32_bf16 v[0:3], v[164:167], a[68:71], v[0:3]
    ds_read_b64_tr_b16 v[176:177], v242 offset:0
    ds_read_b64_tr_b16 v[178:179], v242 offset:512
    v_mfma_f32_16x16x32_bf16 v[32:35], v[164:167], a[76:79], 0
    ds_read_b64_tr_b16 v[180:181], v242 offset:4096
    ds_read_b64_tr_b16 v[182:183], v242 offset:4608
    v_add_u32 v243, 0x10000, v243
    ds_read_b64_tr_b16 v[184:185], v243 offset:0
    ds_read_b64_tr_b16 v[186:187], v243 offset:512
    ds_read_b64_tr_b16 v[188:189], v243 offset:4096
    ds_read_b64_tr_b16 v[190:191], v243 offset:4608
    ds_read_b64_tr_b16 v[192:193], v240 offset:8192
    ds_read_b64_tr_b16 v[194:195], v240 offset:8704
    ds_read_b64_tr_b16 v[196:197], v240 offset:12288
    ds_read_b64_tr_b16 v[198:199], v240 offset:12800
    ds_read_b64_tr_b16 v[200:201], v241 offset:8192
    ds_read_b64_tr_b16 v[202:203], v241 offset:8704
    ds_read_b64_tr_b16 v[204:205], v241 offset:12288
    ds_read_b64_tr_b16 v[206:207], v241 offset:12800
    ds_read_b64_tr_b16 v[208:209], v242 offset:8192
    ds_read_b64_tr_b16 v[210:211], v242 offset:8704
    ds_read_b64_tr_b16 v[212:213], v242 offset:12288
    ds_read_b64_tr_b16 v[214:215], v242 offset:12800
    ds_read_b64_tr_b16 v[216:217], v243 offset:8192
    ds_read_b64_tr_b16 v[218:219], v243 offset:8704
    ds_read_b64_tr_b16 v[220:221], v243 offset:12288
    ds_read_b64_tr_b16 v[222:223], v243 offset:12800
    v_mfma_f32_16x16x32_bf16 v[32:35], v[160:163], a[72:75], v[32:35]
    buffer_load_dwordx4 v230, s[56:59], s14 offen offset:0 lds
    v_mfma_f32_16x16x32_bf16 v[64:67], v[160:163], a[80:83], 0
    v_mfma_f32_16x16x32_bf16 v[64:67], v[164:167], a[84:87], v[64:67]
    v_mfma_f32_16x16x32_bf16 v[96:99], v[164:167], a[92:95], 0
    buffer_load_dwordx4 v231, s[56:59], s14 offen offset:1024 lds
    v_mfma_f32_16x16x32_bf16 v[96:99], v[160:163], a[88:91], v[96:99]
    s_waitcnt lgkmcnt(15)
    v_mfma_f32_16x16x32_bf16 v[100:103], v[168:171], a[88:91], 0
    v_mfma_f32_16x16x32_bf16 v[100:103], v[172:175], a[92:95], v[100:103]
    buffer_load_dwordx4 v232, s[56:59], s14 offen offset:2048 lds
    v_mfma_f32_16x16x32_bf16 v[68:71], v[172:175], a[84:87], 0
    s_waitcnt vmcnt(5)
    s_waitcnt lgkmcnt(0)
    s_barrier
    v_mfma_f32_16x16x32_bf16 v[68:71], v[168:171], a[80:83], v[68:71]
    ds_read_b64_tr_b16 v[160:161], v240 offset:49152
    v_mfma_f32_16x16x32_bf16 v[36:39], v[168:171], a[72:75], 0
    buffer_load_dwordx4 v233, s[56:59], s14 offen offset:3072 lds
    v_mfma_f32_16x16x32_bf16 v[36:39], v[172:175], a[76:79], v[36:39]
    ds_read_b64_tr_b16 v[162:163], v240 offset:49664
    v_mfma_f32_16x16x32_bf16 v[4:7], v[172:175], a[68:71], 0
    ds_read_b64_tr_b16 v[164:165], v240 offset:53248
    v_mfma_f32_16x16x32_bf16 v[4:7], v[168:171], a[64:67], v[4:7]
    ds_read_b64_tr_b16 v[166:167], v240 offset:53760
    v_mfma_f32_16x16x32_bf16 v[8:11], v[176:179], a[64:67], 0
    s_add_u32 m0, s16, 147456
    s_add_u32 s14, s22, s36
    ds_read_b128 a[96:99], v238 offset:49152
    v_mfma_f32_16x16x32_bf16 v[8:11], v[180:183], a[68:71], v[8:11]
    buffer_load_dwordx4 v230, s[56:59], s14 offen offset:0 lds
    v_mfma_f32_16x16x32_bf16 v[40:43], v[180:183], a[76:79], 0
    ds_read_b128 a[100:103], v239 offset:49152
    v_mfma_f32_16x16x32_bf16 v[40:43], v[176:179], a[72:75], v[40:43]
    ds_read_b128 a[104:107], v238 offset:51200
    v_mfma_f32_16x16x32_bf16 v[72:75], v[176:179], a[80:83], 0
    s_add_u32 s36, s36, 128
    s_sub_u32 s88, s36, 1152
    s_min_u32 s36, s36, s88
    v_mfma_f32_16x16x32_bf16 v[72:75], v[180:183], a[84:87], v[72:75]
    buffer_load_dwordx4 v231, s[56:59], s14 offen offset:1024 lds
    v_mfma_f32_16x16x32_bf16 v[104:107], v[180:183], a[92:95], 0
    ds_read_b128 a[108:111], v239 offset:51200
    v_add_u32 v238, 0x10000, v238
    v_mfma_f32_16x16x32_bf16 v[104:107], v[176:179], a[88:91], v[104:107]
    ds_read_b128 a[112:115], v238 offset:0
    v_add_u32 v239, 0x10000, v239
    v_mfma_f32_16x16x32_bf16 v[108:111], v[184:187], a[88:91], 0
    buffer_load_dwordx4 v232, s[56:59], s14 offen offset:2048 lds
    v_mfma_f32_16x16x32_bf16 v[108:111], v[188:191], a[92:95], v[108:111]
    ds_read_b128 a[116:119], v239 offset:0
    v_mfma_f32_16x16x32_bf16 v[76:79], v[188:191], a[84:87], 0
    ds_read_b128 a[120:123], v238 offset:2048
    v_mfma_f32_16x16x32_bf16 v[76:79], v[184:187], a[80:83], v[76:79]
    ds_read_b128 a[124:127], v239 offset:2048
    v_mfma_f32_16x16x32_bf16 v[44:47], v[184:187], a[72:75], 0
    buffer_load_dwordx4 v233, s[56:59], s14 offen offset:3072 lds
    v_mfma_f32_16x16x32_bf16 v[44:47], v[188:191], a[76:79], v[44:47]
    ds_read_b64_tr_b16 v[168:169], v241 offset:49152
    v_mfma_f32_16x16x32_bf16 v[12:15], v[188:191], a[68:71], 0
    ds_read_b64_tr_b16 v[170:171], v241 offset:49664
    v_mfma_f32_16x16x32_bf16 v[12:15], v[184:187], a[64:67], v[12:15]
    ds_read_b64_tr_b16 v[172:173], v241 offset:53248
    v_mfma_f32_16x16x32_bf16 v[16:19], v[192:195], a[64:67], 0
    s_add_u32 m0, s17, 0
    s_add_u32 s14, s19, s37
    ds_read_b64_tr_b16 v[174:175], v241 offset:53760
    v_mfma_f32_16x16x32_bf16 v[16:19], v[196:199], a[68:71], v[16:19]
    buffer_load_dwordx4 v234, s[60:63], s14 offen offset:0 lds
    v_mfma_f32_16x16x32_bf16 v[48:51], v[196:199], a[76:79], 0
    ds_read_b64_tr_b16 v[176:177], v242 offset:49152
    v_mfma_f32_16x16x32_bf16 v[48:51], v[192:195], a[72:75], v[48:51]
    ds_read_b64_tr_b16 v[178:179], v242 offset:49664
    v_mfma_f32_16x16x32_bf16 v[80:83], v[192:195], a[80:83], 0
    s_add_u32 s37, s37, 524288
    s_sub_u32 s88, s37, 4718592
    s_min_u32 s37, s37, s88
    v_mfma_f32_16x16x32_bf16 v[80:83], v[196:199], a[84:87], v[80:83]
    buffer_load_dwordx4 v235, s[60:63], s14 offen offset:1024 lds
    v_mfma_f32_16x16x32_bf16 v[112:115], v[196:199], a[92:95], 0
    ds_read_b64_tr_b16 v[180:181], v242 offset:53248
    v_mfma_f32_16x16x32_bf16 v[112:115], v[192:195], a[88:91], v[112:115]
    ds_read_b64_tr_b16 v[182:183], v242 offset:53760
    v_mfma_f32_16x16x32_bf16 v[116:119], v[200:203], a[88:91], 0
    buffer_load_dwordx4 v236, s[60:63], s14 offen offset:2048 lds
    v_mfma_f32_16x16x32_bf16 v[116:119], v[204:207], a[92:95], v[116:119]
    ds_read_b64_tr_b16 v[184:185], v243 offset:49152
    v_mfma_f32_16x16x32_bf16 v[84:87], v[204:207], a[84:87], 0
    ds_read_b64_tr_b16 v[186:187], v243 offset:49664
    v_mfma_f32_16x16x32_bf16 v[84:87], v[200:203], a[80:83], v[84:87]
    ds_read_b64_tr_b16 v[188:189], v243 offset:53248
    v_mfma_f32_16x16x32_bf16 v[52:55], v[200:203], a[72:75], 0
    buffer_load_dwordx4 v237, s[60:63], s14 offen offset:3072 lds
    v_mfma_f32_16x16x32_bf16 v[52:55], v[204:207], a[76:79], v[52:55]
    ds_read_b64_tr_b16 v[190:191], v243 offset:53760
    v_mfma_f32_16x16x32_bf16 v[20:23], v[204:207], a[68:71], 0
    ds_read_b64_tr_b16 v[192:193], v240 offset:57344
    v_mfma_f32_16x16x32_bf16 v[20:23], v[200:203], a[64:67], v[20:23]
    ds_read_b64_tr_b16 v[194:195], v240 offset:57856
    v_mfma_f32_16x16x32_bf16 v[24:27], v[208:211], a[64:67], 0
    s_add_u32 m0, s16, 16384
    s_add_u32 s14, s21, s36
    ds_read_b64_tr_b16 v[196:197], v240 offset:61440
    v_mfma_f32_16x16x32_bf16 v[24:27], v[212:215], a[68:71], v[24:27]
    buffer_load_dwordx4 v230, s[56:59], s14 offen offset:0 lds
    v_mfma_f32_16x16x32_bf16 v[56:59], v[212:215], a[76:79], 0
    ds_read_b64_tr_b16 v[198:199], v240 offset:61952
    v_mfma_f32_16x16x32_bf16 v[56:59], v[208:211], a[72:75], v[56:59]
    ds_read_b64_tr_b16 v[200:201], v241 offset:57344
    v_mfma_f32_16x16x32_bf16 v[88:91], v[208:211], a[80:83], 0
    buffer_load_dwordx4 v231, s[56:59], s14 offen offset:1024 lds
    v_mfma_f32_16x16x32_bf16 v[88:91], v[212:215], a[84:87], v[88:91]
    ds_read_b64_tr_b16 v[202:203], v241 offset:57856
    v_mfma_f32_16x16x32_bf16 v[120:123], v[212:215], a[92:95], 0
    ds_read_b64_tr_b16 v[204:205], v241 offset:61440
    v_mfma_f32_16x16x32_bf16 v[120:123], v[208:211], a[88:91], v[120:123]
    ds_read_b64_tr_b16 v[206:207], v241 offset:61952
    v_mfma_f32_16x16x32_bf16 v[124:127], v[216:219], a[88:91], 0
    buffer_load_dwordx4 v232, s[56:59], s14 offen offset:2048 lds
    v_mfma_f32_16x16x32_bf16 v[124:127], v[220:223], a[92:95], v[124:127]
    ds_read_b64_tr_b16 v[208:209], v242 offset:57344
    v_mfma_f32_16x16x32_bf16 v[92:95], v[220:223], a[84:87], 0
    ds_read_b64_tr_b16 v[210:211], v242 offset:57856
    v_mfma_f32_16x16x32_bf16 v[92:95], v[216:219], a[80:83], v[92:95]
    ds_read_b64_tr_b16 v[212:213], v242 offset:61440
    v_mfma_f32_16x16x32_bf16 v[60:63], v[216:219], a[72:75], 0
    ds_read_b64_tr_b16 v[214:215], v242 offset:61952
    v_mfma_f32_16x16x32_bf16 v[60:63], v[220:223], a[76:79], v[60:63]
    buffer_load_dwordx4 v233, s[56:59], s14 offen offset:3072 lds
    v_mfma_f32_16x16x32_bf16 v[28:31], v[220:223], a[68:71], 0
    v_mfma_f32_16x16x32_bf16 v[28:31], v[216:219], a[64:67], v[28:31]
    s_waitcnt lgkmcnt(15)
    ds_read_b64_tr_b16 v[216:217], v243 offset:57344
    v_mfma_f32_16x16x32_bf16 v[0:3], v[160:163], a[96:99], v[0:3]
    s_add_u32 m0, s16, 32768
    s_add_u32 s14, s22, s36
    ds_read_b64_tr_b16 v[218:219], v243 offset:57856
    v_mfma_f32_16x16x32_bf16 v[0:3], v[164:167], a[100:103], v[0:3]
    ds_read_b64_tr_b16 v[220:221], v243 offset:61440
    ds_read_b64_tr_b16 v[222:223], v243 offset:61952
    v_mfma_f32_16x16x32_bf16 v[32:35], v[164:167], a[108:111], v[32:35]
    buffer_load_dwordx4 v230, s[56:59], s14 offen offset:0 lds
    v_mfma_f32_16x16x32_bf16 v[32:35], v[160:163], a[104:107], v[32:35]
    v_mfma_f32_16x16x32_bf16 v[64:67], v[160:163], a[112:115], v[64:67]
    s_add_u32 s36, s36, 128
    s_sub_u32 s88, s36, 1152
    s_min_u32 s36, s36, s88
    v_mfma_f32_16x16x32_bf16 v[64:67], v[164:167], a[116:119], v[64:67]
    buffer_load_dwordx4 v231, s[56:59], s14 offen offset:1024 lds
    v_mfma_f32_16x16x32_bf16 v[96:99], v[164:167], a[124:127], v[96:99]
    s_sub_u32 s25, s25, s39
    s_sub_u32 s25, s25, s39
    s_add_u32 s15, s25, 28672
    v_mfma_f32_16x16x32_bf16 v[96:99], v[160:163], a[120:123], v[96:99]
    v_mfma_f32_16x16x32_bf16 v[100:103], v[168:171], a[120:123], v[100:103]
    buffer_load_dwordx4 v232, s[56:59], s14 offen offset:2048 lds
    v_mfma_f32_16x16x32_bf16 v[100:103], v[172:175], a[124:127], v[100:103]
    v_mfma_f32_16x16x32_bf16 v[68:71], v[172:175], a[116:119], v[68:71]
    s_waitcnt vmcnt(7)
    s_waitcnt lgkmcnt(0)
    s_barrier
    v_mfma_f32_16x16x32_bf16 v[68:71], v[168:171], a[112:115], v[68:71]
    buffer_store_dwordx4 a[152:155], v224, s[64:67], s15 offen offset:0 sc1
    v_mfma_f32_16x16x32_bf16 v[36:39], v[168:171], a[104:107], v[36:39]
    v_add_u32 v240, 0xffff0000, v240
    v_mfma_f32_16x16x32_bf16 v[36:39], v[172:175], a[108:111], v[36:39]
    ds_read_b64_tr_b16 v[160:161], v240 offset:0
    v_mfma_f32_16x16x32_bf16 v[4:7], v[172:175], a[100:103], v[4:7]
    buffer_load_dwordx4 v233, s[56:59], s14 offen offset:3072 lds
    v_mfma_f32_16x16x32_bf16 v[4:7], v[168:171], a[96:99], v[4:7]
    ds_read_b64_tr_b16 v[162:163], v240 offset:512
    v_mfma_f32_16x16x32_bf16 v[8:11], v[176:179], a[96:99], v[8:11]
    s_add_u32 m0, s17, 49152
    s_add_u32 s14, s19, s37
    ds_read_b64_tr_b16 v[164:165], v240 offset:4096
    v_mfma_f32_16x16x32_bf16 v[8:11], v[180:183], a[100:103], v[8:11]
    buffer_load_dwordx4 v234, s[60:63], s14 offen offset:0 lds
    v_mfma_f32_16x16x32_bf16 v[40:43], v[180:183], a[108:111], v[40:43]
    ds_read_b64_tr_b16 v[166:167], v240 offset:4608
    v_mfma_f32_16x16x32_bf16 v[40:43], v[176:179], a[104:107], v[40:43]
    ds_read_b128 a[64:67], v238 offset:32768
    v_mfma_f32_16x16x32_bf16 v[72:75], v[176:179], a[112:115], v[72:75]
    s_add_u32 s37, s37, 524288
    s_sub_u32 s88, s37, 4718592
    s_min_u32 s37, s37, s88
    v_mfma_f32_16x16x32_bf16 v[72:75], v[180:183], a[116:119], v[72:75]
    buffer_load_dwordx4 v235, s[60:63], s14 offen offset:1024 lds
    v_mfma_f32_16x16x32_bf16 v[104:107], v[180:183], a[124:127], v[104:107]
    s_add_u32 s15, s25, 28672
    ds_read_b128 a[68:71], v239 offset:32768
    v_mfma_f32_16x16x32_bf16 v[104:107], v[176:179], a[120:123], v[104:107]
    ds_read_b128 a[72:75], v238 offset:34816
    v_mfma_f32_16x16x32_bf16 v[108:111], v[184:187], a[120:123], v[108:111]
    buffer_load_dwordx4 v236, s[60:63], s14 offen offset:2048 lds
    v_mfma_f32_16x16x32_bf16 v[108:111], v[188:191], a[124:127], v[108:111]
    ds_read_b128 a[76:79], v239 offset:34816
    v_mfma_f32_16x16x32_bf16 v[76:79], v[188:191], a[116:119], v[76:79]
    ds_read_b128 a[80:83], v238 offset:49152
    v_mfma_f32_16x16x32_bf16 v[76:79], v[184:187], a[112:115], v[76:79]
    buffer_store_dwordx4 a[156:159], v224, s[64:67], s15 offen offset:1024 sc1
    v_mfma_f32_16x16x32_bf16 v[44:47], v[184:187], a[104:107], v[44:47]
    ds_read_b128 a[84:87], v239 offset:49152
    v_mfma_f32_16x16x32_bf16 v[44:47], v[188:191], a[108:111], v[44:47]
    ds_read_b128 a[88:91], v238 offset:51200
    v_mfma_f32_16x16x32_bf16 v[12:15], v[188:191], a[100:103], v[12:15]
    buffer_load_dwordx4 v237, s[60:63], s14 offen offset:3072 lds
    v_mfma_f32_16x16x32_bf16 v[12:15], v[184:187], a[96:99], v[12:15]
    ds_read_b128 a[92:95], v239 offset:51200
    v_add_u32 v241, 0xffff0000, v241
    v_mfma_f32_16x16x32_bf16 v[16:19], v[192:195], a[96:99], v[16:19]
    s_add_u32 m0, s16, 65536
    s_add_u32 s14, s21, s36
    ds_read_b64_tr_b16 v[168:169], v241 offset:0
    v_mfma_f32_16x16x32_bf16 v[16:19], v[196:199], a[100:103], v[16:19]
    buffer_load_dwordx4 v230, s[56:59], s14 offen offset:0 lds
    v_mfma_f32_16x16x32_bf16 v[48:51], v[196:199], a[108:111], v[48:51]
    ds_read_b64_tr_b16 v[170:171], v241 offset:512
    v_mfma_f32_16x16x32_bf16 v[48:51], v[192:195], a[104:107], v[48:51]
    ds_read_b64_tr_b16 v[172:173], v241 offset:4096
    v_mfma_f32_16x16x32_bf16 v[80:83], v[192:195], a[112:115], v[80:83]
    buffer_load_dwordx4 v231, s[56:59], s14 offen offset:1024 lds
    v_mfma_f32_16x16x32_bf16 v[80:83], v[196:199], a[116:119], v[80:83]
    ds_read_b64_tr_b16 v[174:175], v241 offset:4608
    v_add_u32 v242, 0xffff0000, v242
    v_mfma_f32_16x16x32_bf16 v[112:115], v[196:199], a[124:127], v[112:115]
    s_add_u32 s15, s25, 28672
    ds_read_b64_tr_b16 v[176:177], v242 offset:0
    v_mfma_f32_16x16x32_bf16 v[112:115], v[192:195], a[120:123], v[112:115]
    buffer_store_dwordx4 a[160:163], v224, s[64:67], s15 offen offset:2048 sc1
    v_mfma_f32_16x16x32_bf16 v[116:119], v[200:203], a[120:123], v[116:119]
    ds_read_b64_tr_b16 v[178:179], v242 offset:512
    v_mfma_f32_16x16x32_bf16 v[116:119], v[204:207], a[124:127], v[116:119]
    ds_read_b64_tr_b16 v[180:181], v242 offset:4096
    v_mfma_f32_16x16x32_bf16 v[84:87], v[204:207], a[116:119], v[84:87]
    buffer_load_dwordx4 v232, s[56:59], s14 offen offset:2048 lds
    v_mfma_f32_16x16x32_bf16 v[84:87], v[200:203], a[112:115], v[84:87]
    ds_read_b64_tr_b16 v[182:183], v242 offset:4608
    v_add_u32 v243, 0xffff0000, v243
    v_mfma_f32_16x16x32_bf16 v[52:55], v[200:203], a[104:107], v[52:55]
    ds_read_b64_tr_b16 v[184:185], v243 offset:0
    v_mfma_f32_16x16x32_bf16 v[52:55], v[204:207], a[108:111], v[52:55]
    buffer_load_dwordx4 v233, s[56:59], s14 offen offset:3072 lds
    v_mfma_f32_16x16x32_bf16 v[20:23], v[204:207], a[100:103], v[20:23]
    ds_read_b64_tr_b16 v[186:187], v243 offset:512
    v_mfma_f32_16x16x32_bf16 v[20:23], v[200:203], a[96:99], v[20:23]
    ds_read_b64_tr_b16 v[188:189], v243 offset:4096
    v_mfma_f32_16x16x32_bf16 v[24:27], v[208:211], a[96:99], v[24:27]
    buffer_store_dword v246, v245, s[64:67], s27 offen sc1
    v_mfma_f32_16x16x32_bf16 v[24:27], v[212:215], a[100:103], v[24:27]
    ds_read_b64_tr_b16 v[190:191], v243 offset:4608
    v_mfma_f32_16x16x32_bf16 v[56:59], v[212:215], a[108:111], v[56:59]
    ds_read_b64_tr_b16 v[192:193], v240 offset:8192
    v_mfma_f32_16x16x32_bf16 v[56:59], v[208:211], a[104:107], v[56:59]
    ds_read_b64_tr_b16 v[194:195], v240 offset:8704
    v_mfma_f32_16x16x32_bf16 v[88:91], v[208:211], a[112:115], v[88:91]
    ds_read_b64_tr_b16 v[196:197], v240 offset:12288
    v_mfma_f32_16x16x32_bf16 v[88:91], v[212:215], a[116:119], v[88:91]
    s_add_u32 m0, s16, 81920
    s_add_u32 s14, s22, s36
    ds_read_b64_tr_b16 v[198:199], v240 offset:12800
    v_mfma_f32_16x16x32_bf16 v[120:123], v[212:215], a[124:127], v[120:123]
    s_add_u32 s15, s25, 28672
    buffer_load_dwordx4 v230, s[56:59], s14 offen offset:0 lds
    v_mfma_f32_16x16x32_bf16 v[120:123], v[208:211], a[120:123], v[120:123]
    ds_read_b64_tr_b16 v[200:201], v241 offset:8192
    v_mfma_f32_16x16x32_bf16 v[124:127], v[216:219], a[120:123], v[124:127]
    ds_read_b64_tr_b16 v[202:203], v241 offset:8704
    v_mfma_f32_16x16x32_bf16 v[124:127], v[220:223], a[124:127], v[124:127]
    ds_read_b64_tr_b16 v[204:205], v241 offset:12288
    v_mfma_f32_16x16x32_bf16 v[92:95], v[220:223], a[116:119], v[92:95]
    s_add_u32 s36, s36, 128
    s_sub_u32 s88, s36, 1152
    s_min_u32 s36, s36, s88
    v_mfma_f32_16x16x32_bf16 v[92:95], v[216:219], a[112:115], v[92:95]
    buffer_load_dwordx4 v231, s[56:59], s14 offen offset:1024 lds
    v_mfma_f32_16x16x32_bf16 v[60:63], v[216:219], a[104:107], v[60:63]
    ds_read_b64_tr_b16 v[206:207], v241 offset:12800
    v_mfma_f32_16x16x32_bf16 v[60:63], v[220:223], a[108:111], v[60:63]
    ds_read_b64_tr_b16 v[208:209], v242 offset:8192
    v_mfma_f32_16x16x32_bf16 v[28:31], v[220:223], a[100:103], v[28:31]
    ds_read_b64_tr_b16 v[210:211], v242 offset:8704
    v_mfma_f32_16x16x32_bf16 v[28:31], v[216:219], a[96:99], v[28:31]
    s_waitcnt lgkmcnt(15)
    ds_read_b64_tr_b16 v[212:213], v242 offset:12288
    v_mfma_f32_16x16x32_bf16 v[0:3], v[160:163], a[64:67], v[0:3]
    ds_read_b64_tr_b16 v[214:215], v242 offset:12800
    ds_read_b64_tr_b16 v[216:217], v243 offset:8192
    v_mfma_f32_16x16x32_bf16 v[0:3], v[164:167], a[68:71], v[0:3]
    ds_read_b64_tr_b16 v[218:219], v243 offset:8704
    ds_read_b64_tr_b16 v[220:221], v243 offset:12288
    v_mfma_f32_16x16x32_bf16 v[32:35], v[164:167], a[76:79], v[32:35]
    ds_read_b64_tr_b16 v[222:223], v243 offset:12800
    buffer_store_dwordx4 a[164:167], v224, s[64:67], s15 offen offset:3072 sc1
    v_mfma_f32_16x16x32_bf16 v[32:35], v[160:163], a[72:75], v[32:35]
    v_mfma_f32_16x16x32_bf16 v[64:67], v[160:163], a[80:83], v[64:67]
    v_mfma_f32_16x16x32_bf16 v[64:67], v[164:167], a[84:87], v[64:67]
    buffer_load_dwordx4 v232, s[56:59], s14 offen offset:2048 lds
    v_mfma_f32_16x16x32_bf16 v[96:99], v[164:167], a[92:95], v[96:99]
    s_add_u32 s15, s25, 45056
    v_mfma_f32_16x16x32_bf16 v[96:99], v[160:163], a[88:91], v[96:99]
    v_mfma_f32_16x16x32_bf16 v[100:103], v[168:171], a[88:91], v[100:103]
    buffer_load_dwordx4 v233, s[56:59], s14 offen offset:3072 lds
    v_mfma_f32_16x16x32_bf16 v[100:103], v[172:175], a[92:95], v[100:103]
    s_add_u32 m0, s17, 98304
    s_add_u32 s14, s19, s37
    v_mfma_f32_16x16x32_bf16 v[68:71], v[172:175], a[84:87], v[68:71]
    s_waitcnt vmcnt(11)
    s_waitcnt lgkmcnt(0)
    s_barrier
    v_mfma_f32_16x16x32_bf16 v[68:71], v[168:171], a[80:83], v[68:71]
    buffer_load_dwordx4 v234, s[60:63], s14 offen offset:0 lds
    v_mfma_f32_16x16x32_bf16 v[36:39], v[168:171], a[72:75], v[36:39]
    ds_read_b64_tr_b16 v[160:161], v240 offset:49152
    v_mfma_f32_16x16x32_bf16 v[36:39], v[172:175], a[76:79], v[36:39]
    ds_read_b64_tr_b16 v[162:163], v240 offset:49664
    v_mfma_f32_16x16x32_bf16 v[4:7], v[172:175], a[68:71], v[4:7]
    s_add_u32 s37, s37, 524288
    s_sub_u32 s88, s37, 4718592
    s_min_u32 s37, s37, s88
    v_mfma_f32_16x16x32_bf16 v[4:7], v[168:171], a[64:67], v[4:7]
    buffer_store_dwordx4 a[168:171], v224, s[64:67], s15 offen offset:0 sc1
    v_mfma_f32_16x16x32_bf16 v[8:11], v[176:179], a[64:67], v[8:11]
    ds_read_b64_tr_b16 v[164:165], v240 offset:53248
    v_mfma_f32_16x16x32_bf16 v[8:11], v[180:183], a[68:71], v[8:11]
    ds_read_b64_tr_b16 v[166:167], v240 offset:53760
    v_add_u32 v238, 0xfffec000, v238
    v_mfma_f32_16x16x32_bf16 v[40:43], v[180:183], a[76:79], v[40:43]
    buffer_load_dwordx4 v235, s[60:63], s14 offen offset:1024 lds
    v_mfma_f32_16x16x32_bf16 v[40:43], v[176:179], a[72:75], v[40:43]
    ds_read_b128 a[96:99], v238 offset:0
    v_add_u32 v239, 0xfffec000, v239
    v_mfma_f32_16x16x32_bf16 v[72:75], v[176:179], a[80:83], v[72:75]
    ds_read_b128 a[100:103], v239 offset:0
    v_mfma_f32_16x16x32_bf16 v[72:75], v[180:183], a[84:87], v[72:75]
    buffer_load_dwordx4 v236, s[60:63], s14 offen offset:2048 lds
    v_mfma_f32_16x16x32_bf16 v[104:107], v[180:183], a[92:95], v[104:107]
    s_add_u32 s15, s25, 45056
    ds_read_b128 a[104:107], v238 offset:2048
    v_mfma_f32_16x16x32_bf16 v[104:107], v[176:179], a[88:91], v[104:107]
    ds_read_b128 a[108:111], v239 offset:2048
    v_mfma_f32_16x16x32_bf16 v[108:111], v[184:187], a[88:91], v[108:111]
    buffer_load_dwordx4 v237, s[60:63], s14 offen offset:3072 lds
    v_mfma_f32_16x16x32_bf16 v[108:111], v[188:191], a[92:95], v[108:111]
    ds_read_b128 a[112:115], v238 offset:16384
    v_mfma_f32_16x16x32_bf16 v[76:79], v[188:191], a[84:87], v[76:79]
    ds_read_b128 a[116:119], v239 offset:16384
    v_mfma_f32_16x16x32_bf16 v[76:79], v[184:187], a[80:83], v[76:79]
    buffer_store_dwordx4 a[172:175], v224, s[64:67], s15 offen offset:1024 sc1
    v_mfma_f32_16x16x32_bf16 v[44:47], v[184:187], a[72:75], v[44:47]
    ds_read_b128 a[120:123], v238 offset:18432
    v_mfma_f32_16x16x32_bf16 v[44:47], v[188:191], a[76:79], v[44:47]
    s_add_u32 m0, s16, 114688
    s_add_u32 s14, s21, s36
    ds_read_b128 a[124:127], v239 offset:18432
    v_mfma_f32_16x16x32_bf16 v[12:15], v[188:191], a[68:71], v[12:15]
    buffer_load_dwordx4 v230, s[56:59], s14 offen offset:0 lds
    v_mfma_f32_16x16x32_bf16 v[12:15], v[184:187], a[64:67], v[12:15]
    ds_read_b64_tr_b16 v[168:169], v241 offset:49152
    v_mfma_f32_16x16x32_bf16 v[16:19], v[192:195], a[64:67], v[16:19]
    ds_read_b64_tr_b16 v[170:171], v241 offset:49664
    v_mfma_f32_16x16x32_bf16 v[16:19], v[196:199], a[68:71], v[16:19]
    ds_read_b64_tr_b16 v[172:173], v241 offset:53248
    v_mfma_f32_16x16x32_bf16 v[48:51], v[196:199], a[76:79], v[48:51]
    buffer_load_dwordx4 v231, s[56:59], s14 offen offset:1024 lds
    v_mfma_f32_16x16x32_bf16 v[48:51], v[192:195], a[72:75], v[48:51]
    ds_read_b64_tr_b16 v[174:175], v241 offset:53760
    v_mfma_f32_16x16x32_bf16 v[80:83], v[192:195], a[80:83], v[80:83]
    ds_read_b64_tr_b16 v[176:177], v242 offset:49152
    v_mfma_f32_16x16x32_bf16 v[80:83], v[196:199], a[84:87], v[80:83]
    ds_read_b64_tr_b16 v[178:179], v242 offset:49664
    v_mfma_f32_16x16x32_bf16 v[112:115], v[196:199], a[92:95], v[112:115]
    s_add_u32 s15, s25, 45056
    buffer_store_dwordx4 a[176:179], v224, s[64:67], s15 offen offset:2048 sc1
    v_mfma_f32_16x16x32_bf16 v[112:115], v[192:195], a[88:91], v[112:115]
    ds_read_b64_tr_b16 v[180:181], v242 offset:53248
    v_mfma_f32_16x16x32_bf16 v[116:119], v[200:203], a[88:91], v[116:119]
    ds_read_b64_tr_b16 v[182:183], v242 offset:53760
    v_mfma_f32_16x16x32_bf16 v[116:119], v[204:207], a[92:95], v[116:119]
    buffer_load_dwordx4 v232, s[56:59], s14 offen offset:2048 lds
    v_mfma_f32_16x16x32_bf16 v[84:87], v[204:207], a[84:87], v[84:87]
    ds_read_b64_tr_b16 v[184:185], v243 offset:49152
    v_mfma_f32_16x16x32_bf16 v[84:87], v[200:203], a[80:83], v[84:87]
    ds_read_b64_tr_b16 v[186:187], v243 offset:49664
    v_mfma_f32_16x16x32_bf16 v[52:55], v[200:203], a[72:75], v[52:55]
    buffer_load_dwordx4 v233, s[56:59], s14 offen offset:3072 lds
    v_mfma_f32_16x16x32_bf16 v[52:55], v[204:207], a[76:79], v[52:55]
    ds_read_b64_tr_b16 v[188:189], v243 offset:53248
    v_mfma_f32_16x16x32_bf16 v[20:23], v[204:207], a[68:71], v[20:23]
    ds_read_b64_tr_b16 v[190:191], v243 offset:53760
    v_mfma_f32_16x16x32_bf16 v[20:23], v[200:203], a[64:67], v[20:23]
    ds_read_b64_tr_b16 v[192:193], v240 offset:57344
    v_mfma_f32_16x16x32_bf16 v[24:27], v[208:211], a[64:67], v[24:27]
    ds_read_b64_tr_b16 v[194:195], v240 offset:57856
    v_mfma_f32_16x16x32_bf16 v[24:27], v[212:215], a[68:71], v[24:27]
    s_add_u32 m0, s16, 131072
    s_add_u32 s14, s22, s36
    ds_read_b64_tr_b16 v[196:197], v240 offset:61440
    v_mfma_f32_16x16x32_bf16 v[56:59], v[212:215], a[76:79], v[56:59]
    buffer_load_dwordx4 v230, s[56:59], s14 offen offset:0 lds
    v_mfma_f32_16x16x32_bf16 v[56:59], v[208:211], a[72:75], v[56:59]
    ds_read_b64_tr_b16 v[198:199], v240 offset:61952
    v_mfma_f32_16x16x32_bf16 v[88:91], v[208:211], a[80:83], v[88:91]
    ds_read_b64_tr_b16 v[200:201], v241 offset:57344
    v_mfma_f32_16x16x32_bf16 v[88:91], v[212:215], a[84:87], v[88:91]
    ds_read_b64_tr_b16 v[202:203], v241 offset:57856
    v_mfma_f32_16x16x32_bf16 v[120:123], v[212:215], a[92:95], v[120:123]
    s_add_u32 s36, s36, 128
    s_sub_u32 s88, s36, 1152
    s_min_u32 s36, s36, s88
    v_mfma_f32_16x16x32_bf16 v[120:123], v[208:211], a[88:91], v[120:123]
    s_add_u32 s15, s25, 45056
    ds_read_b64_tr_b16 v[204:205], v241 offset:61440
    v_mfma_f32_16x16x32_bf16 v[124:127], v[216:219], a[88:91], v[124:127]
    buffer_load_dwordx4 v231, s[56:59], s14 offen offset:1024 lds
    v_mfma_f32_16x16x32_bf16 v[124:127], v[220:223], a[92:95], v[124:127]
    ds_read_b64_tr_b16 v[206:207], v241 offset:61952
    v_mfma_f32_16x16x32_bf16 v[92:95], v[220:223], a[84:87], v[92:95]
    ds_read_b64_tr_b16 v[208:209], v242 offset:57344
    v_mfma_f32_16x16x32_bf16 v[92:95], v[216:219], a[80:83], v[92:95]
    buffer_load_dwordx4 v232, s[56:59], s14 offen offset:2048 lds
    v_mfma_f32_16x16x32_bf16 v[60:63], v[216:219], a[72:75], v[60:63]
    ds_read_b64_tr_b16 v[210:211], v242 offset:57856
    v_mfma_f32_16x16x32_bf16 v[60:63], v[220:223], a[76:79], v[60:63]
    ds_read_b64_tr_b16 v[212:213], v242 offset:61440
    v_mfma_f32_16x16x32_bf16 v[28:31], v[220:223], a[68:71], v[28:31]
    ds_read_b64_tr_b16 v[214:215], v242 offset:61952
    v_mfma_f32_16x16x32_bf16 v[28:31], v[216:219], a[64:67], v[28:31]
    s_waitcnt lgkmcnt(15)
    ds_read_b64_tr_b16 v[216:217], v243 offset:57344
    v_mfma_f32_16x16x32_bf16 v[0:3], v[160:163], a[96:99], v[0:3]
    ds_read_b64_tr_b16 v[218:219], v243 offset:57856
    ds_read_b64_tr_b16 v[220:221], v243 offset:61440
    v_mfma_f32_16x16x32_bf16 v[0:3], v[164:167], a[100:103], v[0:3]
    ds_read_b64_tr_b16 v[222:223], v243 offset:61952
    v_mfma_f32_16x16x32_bf16 v[32:35], v[164:167], a[108:111], v[32:35]
    buffer_store_dwordx4 a[180:183], v224, s[64:67], s15 offen offset:3072 sc1
    v_mfma_f32_16x16x32_bf16 v[32:35], v[160:163], a[104:107], v[32:35]
    v_mfma_f32_16x16x32_bf16 v[64:67], v[160:163], a[112:115], v[64:67]
    v_mfma_f32_16x16x32_bf16 v[64:67], v[164:167], a[116:119], v[64:67]
    buffer_load_dwordx4 v233, s[56:59], s14 offen offset:3072 lds
    s_add_u32 m0, s17, 147456
    v_mfma_f32_16x16x32_bf16 v[96:99], v[164:167], a[124:127], v[96:99]
    s_add_u32 s14, s19, s37
    v_mfma_f32_16x16x32_bf16 v[96:99], v[160:163], a[120:123], v[96:99]
    v_mfma_f32_16x16x32_bf16 v[100:103], v[168:171], a[120:123], v[100:103]
    buffer_load_dwordx4 v234, s[60:63], s14 offen offset:0 lds
    v_mfma_f32_16x16x32_bf16 v[100:103], v[172:175], a[124:127], v[100:103]
    v_mfma_f32_16x16x32_bf16 v[68:71], v[172:175], a[116:119], v[68:71]
    s_waitcnt vmcnt(12)
    s_waitcnt lgkmcnt(0)
    s_barrier
    v_mfma_f32_16x16x32_bf16 v[68:71], v[168:171], a[112:115], v[68:71]
    s_add_u32 s37, s37, 524288
    s_sub_u32 s88, s37, 4718592
    s_min_u32 s37, s37, s88
    v_mfma_f32_16x16x32_bf16 v[36:39], v[168:171], a[104:107], v[36:39]
    buffer_load_dwordx4 v235, s[60:63], s14 offen offset:1024 lds
    v_mfma_f32_16x16x32_bf16 v[36:39], v[172:175], a[108:111], v[36:39]
    v_add_u32 v240, 0x18000, v240
    v_mfma_f32_16x16x32_bf16 v[4:7], v[172:175], a[100:103], v[4:7]
    ds_read_b64_tr_b16 v[160:161], v240 offset:0
    v_mfma_f32_16x16x32_bf16 v[4:7], v[168:171], a[96:99], v[4:7]
    buffer_load_dwordx4 v236, s[60:63], s14 offen offset:2048 lds
    v_mfma_f32_16x16x32_bf16 v[8:11], v[176:179], a[96:99], v[8:11]
    ds_read_b64_tr_b16 v[162:163], v240 offset:512
    v_mfma_f32_16x16x32_bf16 v[8:11], v[180:183], a[100:103], v[8:11]
    ds_read_b64_tr_b16 v[164:165], v240 offset:4096
    v_mfma_f32_16x16x32_bf16 v[40:43], v[180:183], a[108:111], v[40:43]
    ds_read_b64_tr_b16 v[166:167], v240 offset:4608
    v_mfma_f32_16x16x32_bf16 v[40:43], v[176:179], a[104:107], v[40:43]
    ds_read_b128 a[64:67], v238 offset:49152
    v_mfma_f32_16x16x32_bf16 v[72:75], v[176:179], a[112:115], v[72:75]
    buffer_load_dwordx4 v237, s[60:63], s14 offen offset:3072 lds
    v_mfma_f32_16x16x32_bf16 v[72:75], v[180:183], a[116:119], v[72:75]
    ds_read_b128 a[68:71], v239 offset:49152
    v_mfma_f32_16x16x32_bf16 v[104:107], v[180:183], a[124:127], v[104:107]
    ds_read_b128 a[72:75], v238 offset:51200
    v_mfma_f32_16x16x32_bf16 v[104:107], v[176:179], a[120:123], v[104:107]
    ds_read_b128 a[76:79], v239 offset:51200
    v_add_u32 v238, 0x10000, v238
    v_mfma_f32_16x16x32_bf16 v[108:111], v[184:187], a[120:123], v[108:111]
    ds_read_b128 a[80:83], v238 offset:0
    v_add_u32 v239, 0x10000, v239
    v_mfma_f32_16x16x32_bf16 v[108:111], v[188:191], a[124:127], v[108:111]
    s_add_u32 m0, s16, 0
    s_add_u32 s14, s21, s36
    ds_read_b128 a[84:87], v239 offset:0
    v_mfma_f32_16x16x32_bf16 v[76:79], v[188:191], a[116:119], v[76:79]
    buffer_load_dwordx4 v230, s[56:59], s14 offen offset:0 lds
    v_mfma_f32_16x16x32_bf16 v[76:79], v[184:187], a[112:115], v[76:79]
    ds_read_b128 a[88:91], v238 offset:2048
    v_mfma_f32_16x16x32_bf16 v[44:47], v[184:187], a[104:107], v[44:47]
    ds_read_b128 a[92:95], v239 offset:2048
    v_add_u32 v241, 0x18000, v241
    v_mfma_f32_16x16x32_bf16 v[44:47], v[188:191], a[108:111], v[44:47]
    ds_read_b64_tr_b16 v[168:169], v241 offset:0
    v_mfma_f32_16x16x32_bf16 v[12:15], v[188:191], a[100:103], v[12:15]
    buffer_load_dwordx4 v231, s[56:59], s14 offen offset:1024 lds
    v_mfma_f32_16x16x32_bf16 v[12:15], v[184:187], a[96:99], v[12:15]
    ds_read_b64_tr_b16 v[170:171], v241 offset:512
    v_mfma_f32_16x16x32_bf16 v[16:19], v[192:195], a[96:99], v[16:19]
    ds_read_b64_tr_b16 v[172:173], v241 offset:4096
    v_mfma_f32_16x16x32_bf16 v[16:19], v[196:199], a[100:103], v[16:19]
    ds_read_b64_tr_b16 v[174:175], v241 offset:4608
    v_add_u32 v242, 0x18000, v242
    v_mfma_f32_16x16x32_bf16 v[48:51], v[196:199], a[108:111], v[48:51]
    ds_read_b64_tr_b16 v[176:177], v242 offset:0
    v_mfma_f32_16x16x32_bf16 v[48:51], v[192:195], a[104:107], v[48:51]
    buffer_load_dwordx4 v232, s[56:59], s14 offen offset:2048 lds
    v_mfma_f32_16x16x32_bf16 v[80:83], v[192:195], a[112:115], v[80:83]
    ds_read_b64_tr_b16 v[178:179], v242 offset:512
    v_mfma_f32_16x16x32_bf16 v[80:83], v[196:199], a[116:119], v[80:83]
    ds_read_b64_tr_b16 v[180:181], v242 offset:4096
    v_mfma_f32_16x16x32_bf16 v[112:115], v[196:199], a[124:127], v[112:115]
    ds_read_b64_tr_b16 v[182:183], v242 offset:4608
    v_add_u32 v243, 0x18000, v243
    v_mfma_f32_16x16x32_bf16 v[112:115], v[192:195], a[120:123], v[112:115]
    ds_read_b64_tr_b16 v[184:185], v243 offset:0
    v_mfma_f32_16x16x32_bf16 v[116:119], v[200:203], a[120:123], v[116:119]
    buffer_load_dwordx4 v233, s[56:59], s14 offen offset:3072 lds
    v_mfma_f32_16x16x32_bf16 v[116:119], v[204:207], a[124:127], v[116:119]
    ds_read_b64_tr_b16 v[186:187], v243 offset:512
    v_mfma_f32_16x16x32_bf16 v[84:87], v[204:207], a[116:119], v[84:87]
    ds_read_b64_tr_b16 v[188:189], v243 offset:4096
    v_mfma_f32_16x16x32_bf16 v[84:87], v[200:203], a[112:115], v[84:87]
    ds_read_b64_tr_b16 v[190:191], v243 offset:4608
    v_mfma_f32_16x16x32_bf16 v[52:55], v[200:203], a[104:107], v[52:55]
    ds_read_b64_tr_b16 v[192:193], v240 offset:8192
    v_mfma_f32_16x16x32_bf16 v[52:55], v[204:207], a[108:111], v[52:55]
    ds_read_b64_tr_b16 v[194:195], v240 offset:8704
    v_bfe_u32 v248, v224, 4, 4
    v_mfma_f32_16x16x32_bf16 v[20:23], v[204:207], a[100:103], v[20:23]
    ds_read_b64_tr_b16 v[196:197], v240 offset:12288
    v_lshlrev_b32 v248, 2, v248
    v_mfma_f32_16x16x32_bf16 v[20:23], v[200:203], a[96:99], v[20:23]
    s_and_b32 s8, s27, 0xffffff80
    ds_read_b64_tr_b16 v[198:199], v240 offset:12800
    v_mfma_f32_16x16x32_bf16 v[24:27], v[208:211], a[96:99], v[24:27]
    buffer_load_dword v247, v248, s[64:67], s8 offen sc1
    v_mfma_f32_16x16x32_bf16 v[24:27], v[212:215], a[100:103], v[24:27]
    ds_read_b64_tr_b16 v[200:201], v241 offset:8192
    v_mfma_f32_16x16x32_bf16 v[56:59], v[212:215], a[108:111], v[56:59]
    s_add_u32 m0, s16, 16384
    s_add_u32 s14, s22, s36
    ds_read_b64_tr_b16 v[202:203], v241 offset:8704
    v_mfma_f32_16x16x32_bf16 v[56:59], v[208:211], a[104:107], v[56:59]
    buffer_load_dwordx4 v230, s[56:59], s14 offen offset:0 lds
    v_mfma_f32_16x16x32_bf16 v[88:91], v[208:211], a[112:115], v[88:91]
    ds_read_b64_tr_b16 v[204:205], v241 offset:12288
    v_mfma_f32_16x16x32_bf16 v[88:91], v[212:215], a[116:119], v[88:91]
    ds_read_b64_tr_b16 v[206:207], v241 offset:12800
    v_mfma_f32_16x16x32_bf16 v[120:123], v[212:215], a[124:127], v[120:123]
    v_mfma_f32_16x16x32_bf16 v[120:123], v[208:211], a[120:123], v[120:123]
    s_add_u32 s36, s36, 128
    s_sub_u32 s88, s36, 1152
    v_mfma_f32_16x16x32_bf16 v[124:127], v[216:219], a[120:123], v[124:127]
    s_min_u32 s36, s36, s88
    buffer_load_dwordx4 v231, s[56:59], s14 offen offset:1024 lds
    v_mfma_f32_16x16x32_bf16 v[124:127], v[220:223], a[124:127], v[124:127]
    ds_read_b64_tr_b16 v[208:209], v242 offset:8192
    v_mfma_f32_16x16x32_bf16 v[92:95], v[220:223], a[116:119], v[92:95]
    ds_read_b64_tr_b16 v[210:211], v242 offset:8704
    v_mfma_f32_16x16x32_bf16 v[92:95], v[216:219], a[112:115], v[92:95]
    ds_read_b64_tr_b16 v[212:213], v242 offset:12288
    v_mfma_f32_16x16x32_bf16 v[60:63], v[216:219], a[104:107], v[60:63]
    ds_read_b64_tr_b16 v[214:215], v242 offset:12800
    v_mfma_f32_16x16x32_bf16 v[60:63], v[220:223], a[108:111], v[60:63]
    buffer_load_dwordx4 v232, s[56:59], s14 offen offset:2048 lds
    v_mfma_f32_16x16x32_bf16 v[28:31], v[220:223], a[100:103], v[28:31]
    v_mfma_f32_16x16x32_bf16 v[28:31], v[216:219], a[96:99], v[28:31]
    s_waitcnt lgkmcnt(15)
    ds_read_b64_tr_b16 v[216:217], v243 offset:8192
    v_mfma_f32_16x16x32_bf16 v[0:3], v[160:163], a[64:67], v[0:3]
    ds_read_b64_tr_b16 v[218:219], v243 offset:8704
    ds_read_b64_tr_b16 v[220:221], v243 offset:12288
    v_mfma_f32_16x16x32_bf16 v[0:3], v[164:167], a[68:71], v[0:3]
    ds_read_b64_tr_b16 v[222:223], v243 offset:12800
    v_mfma_f32_16x16x32_bf16 v[32:35], v[164:167], a[76:79], v[32:35]
    buffer_load_dwordx4 v233, s[56:59], s14 offen offset:3072 lds
    v_mfma_f32_16x16x32_bf16 v[32:35], v[160:163], a[72:75], v[32:35]
    v_mfma_f32_16x16x32_bf16 v[64:67], v[160:163], a[80:83], v[64:67]
    v_mfma_f32_16x16x32_bf16 v[64:67], v[164:167], a[84:87], v[64:67]
    v_mfma_f32_16x16x32_bf16 v[96:99], v[164:167], a[92:95], v[96:99]
    s_add_u32 m0, s17, 32768
    s_add_u32 s14, s19, s37
    v_mfma_f32_16x16x32_bf16 v[96:99], v[160:163], a[88:91], v[96:99]
    buffer_load_dwordx4 v234, s[60:63], s14 offen offset:0 lds
    v_mfma_f32_16x16x32_bf16 v[100:103], v[168:171], a[88:91], v[100:103]
    v_mfma_f32_16x16x32_bf16 v[100:103], v[172:175], a[92:95], v[100:103]
    v_mfma_f32_16x16x32_bf16 v[68:71], v[172:175], a[84:87], v[68:71]
    s_waitcnt vmcnt(10)
    s_waitcnt lgkmcnt(0)
    s_barrier
    v_mfma_f32_16x16x32_bf16 v[68:71], v[168:171], a[80:83], v[68:71]
    s_add_u32 s37, s37, 524288
    s_sub_u32 s88, s37, 4718592
    s_min_u32 s37, s37, s88
    v_mfma_f32_16x16x32_bf16 v[36:39], v[168:171], a[72:75], v[36:39]
    buffer_load_dwordx4 v235, s[60:63], s14 offen offset:1024 lds
    v_mfma_f32_16x16x32_bf16 v[36:39], v[172:175], a[76:79], v[36:39]
    ds_read_b64_tr_b16 v[160:161], v240 offset:49152
    v_mfma_f32_16x16x32_bf16 v[4:7], v[172:175], a[68:71], v[4:7]
    ds_read_b64_tr_b16 v[162:163], v240 offset:49664
    v_mfma_f32_16x16x32_bf16 v[4:7], v[168:171], a[64:67], v[4:7]
    ds_read_b64_tr_b16 v[164:165], v240 offset:53248
    v_mfma_f32_16x16x32_bf16 v[8:11], v[176:179], a[64:67], v[8:11]
    buffer_load_dwordx4 v236, s[60:63], s14 offen offset:2048 lds
    v_mfma_f32_16x16x32_bf16 v[8:11], v[180:183], a[68:71], v[8:11]
    ds_read_b64_tr_b16 v[166:167], v240 offset:53760
    v_mfma_f32_16x16x32_bf16 v[40:43], v[180:183], a[76:79], v[40:43]
    ds_read_b128 a[96:99], v238 offset:32768
    v_mfma_f32_16x16x32_bf16 v[40:43], v[176:179], a[72:75], v[40:43]
    ds_read_b128 a[100:103], v239 offset:32768
    v_mfma_f32_16x16x32_bf16 v[72:75], v[176:179], a[80:83], v[72:75]
    ds_read_b128 a[104:107], v238 offset:34816
    v_mfma_f32_16x16x32_bf16 v[72:75], v[180:183], a[84:87], v[72:75]
    buffer_load_dwordx4 v237, s[60:63], s14 offen offset:3072 lds
    v_mfma_f32_16x16x32_bf16 v[104:107], v[180:183], a[92:95], v[104:107]
    ds_read_b128 a[108:111], v239 offset:34816
    v_mfma_f32_16x16x32_bf16 v[104:107], v[176:179], a[88:91], v[104:107]
    ds_read_b128 a[112:115], v238 offset:49152
    v_mfma_f32_16x16x32_bf16 v[108:111], v[184:187], a[88:91], v[108:111]
    ds_read_b128 a[116:119], v239 offset:49152
    v_mfma_f32_16x16x32_bf16 v[108:111], v[188:191], a[92:95], v[108:111]
    ds_read_b128 a[120:123], v238 offset:51200
    v_mfma_f32_16x16x32_bf16 v[76:79], v[188:191], a[84:87], v[76:79]
    s_add_u32 m0, s16, 49152
    s_add_u32 s14, s21, s36
    ds_read_b128 a[124:127], v239 offset:51200
    v_mfma_f32_16x16x32_bf16 v[76:79], v[184:187], a[80:83], v[76:79]
    buffer_load_dwordx4 v230, s[56:59], s14 offen offset:0 lds
    v_mfma_f32_16x16x32_bf16 v[44:47], v[184:187], a[72:75], v[44:47]
    ds_read_b64_tr_b16 v[168:169], v241 offset:49152
    v_mfma_f32_16x16x32_bf16 v[44:47], v[188:191], a[76:79], v[44:47]
    ds_read_b64_tr_b16 v[170:171], v241 offset:49664
    v_mfma_f32_16x16x32_bf16 v[12:15], v[188:191], a[68:71], v[12:15]
    ds_read_b64_tr_b16 v[172:173], v241 offset:53248
    v_mfma_f32_16x16x32_bf16 v[12:15], v[184:187], a[64:67], v[12:15]
    buffer_load_dwordx4 v231, s[56:59], s14 offen offset:1024 lds
    v_mfma_f32_16x16x32_bf16 v[16:19], v[192:195], a[64:67], v[16:19]
    ds_read_b64_tr_b16 v[174:175], v241 offset:53760
    v_mfma_f32_16x16x32_bf16 v[16:19], v[196:199], a[68:71], v[16:19]
    ds_read_b64_tr_b16 v[176:177], v242 offset:49152
    v_mfma_f32_16x16x32_bf16 v[48:51], v[196:199], a[76:79], v[48:51]
    ds_read_b64_tr_b16 v[178:179], v242 offset:49664
    v_mfma_f32_16x16x32_bf16 v[48:51], v[192:195], a[72:75], v[48:51]
    ds_read_b64_tr_b16 v[180:181], v242 offset:53248
    v_mfma_f32_16x16x32_bf16 v[80:83], v[192:195], a[80:83], v[80:83]
    buffer_load_dwordx4 v232, s[56:59], s14 offen offset:2048 lds
    v_mfma_f32_16x16x32_bf16 v[80:83], v[196:199], a[84:87], v[80:83]
    ds_read_b64_tr_b16 v[182:183], v242 offset:53760
    v_mfma_f32_16x16x32_bf16 v[112:115], v[196:199], a[92:95], v[112:115]
    ds_read_b64_tr_b16 v[184:185], v243 offset:49152
    v_mfma_f32_16x16x32_bf16 v[112:115], v[192:195], a[88:91], v[112:115]
    ds_read_b64_tr_b16 v[186:187], v243 offset:49664
    v_mfma_f32_16x16x32_bf16 v[116:119], v[200:203], a[88:91], v[116:119]
    ds_read_b64_tr_b16 v[188:189], v243 offset:53248
    v_mfma_f32_16x16x32_bf16 v[116:119], v[204:207], a[92:95], v[116:119]
    buffer_load_dwordx4 v233, s[56:59], s14 offen offset:3072 lds
    v_mfma_f32_16x16x32_bf16 v[84:87], v[204:207], a[84:87], v[84:87]
    ds_read_b64_tr_b16 v[190:191], v243 offset:53760
    v_mfma_f32_16x16x32_bf16 v[84:87], v[200:203], a[80:83], v[84:87]
    ds_read_b64_tr_b16 v[192:193], v240 offset:57344
    v_mfma_f32_16x16x32_bf16 v[52:55], v[200:203], a[72:75], v[52:55]
    ds_read_b64_tr_b16 v[194:195], v240 offset:57856
    v_mfma_f32_16x16x32_bf16 v[52:55], v[204:207], a[76:79], v[52:55]
    ds_read_b64_tr_b16 v[196:197], v240 offset:61440
    v_mfma_f32_16x16x32_bf16 v[20:23], v[204:207], a[68:71], v[20:23]
    buffer_store_dword v246, v245, s[64:67], s26 offen sc1
    v_mfma_f32_16x16x32_bf16 v[20:23], v[200:203], a[64:67], v[20:23]
    ds_read_b64_tr_b16 v[198:199], v240 offset:61952
    v_mfma_f32_16x16x32_bf16 v[24:27], v[208:211], a[64:67], v[24:27]
    ds_read_b64_tr_b16 v[200:201], v241 offset:57344
    v_mfma_f32_16x16x32_bf16 v[24:27], v[212:215], a[68:71], v[24:27]
    ds_read_b64_tr_b16 v[202:203], v241 offset:57856
    v_mfma_f32_16x16x32_bf16 v[56:59], v[212:215], a[76:79], v[56:59]
    ds_read_b64_tr_b16 v[204:205], v241 offset:61440
    v_mfma_f32_16x16x32_bf16 v[56:59], v[208:211], a[72:75], v[56:59]
    s_add_u32 m0, s16, 65536
    s_add_u32 s14, s22, s36
    ds_read_b64_tr_b16 v[206:207], v241 offset:61952
    v_mfma_f32_16x16x32_bf16 v[88:91], v[208:211], a[80:83], v[88:91]
    buffer_load_dwordx4 v230, s[56:59], s14 offen offset:0 lds
    v_mfma_f32_16x16x32_bf16 v[88:91], v[212:215], a[84:87], v[88:91]
    v_mfma_f32_16x16x32_bf16 v[120:123], v[212:215], a[92:95], v[120:123]
    v_mfma_f32_16x16x32_bf16 v[120:123], v[208:211], a[88:91], v[120:123]
    ds_read_b64_tr_b16 v[208:209], v242 offset:57344
    v_mfma_f32_16x16x32_bf16 v[124:127], v[216:219], a[88:91], v[124:127]
    s_add_u32 s36, s36, 128
    s_sub_u32 s88, s36, 1152
    s_min_u32 s36, s36, s88
    v_mfma_f32_16x16x32_bf16 v[124:127], v[220:223], a[92:95], v[124:127]
    buffer_load_dwordx4 v231, s[56:59], s14 offen offset:1024 lds
    v_mfma_f32_16x16x32_bf16 v[92:95], v[220:223], a[84:87], v[92:95]
    ds_read_b64_tr_b16 v[210:211], v242 offset:57856
    v_mfma_f32_16x16x32_bf16 v[92:95], v[216:219], a[80:83], v[92:95]
    ds_read_b64_tr_b16 v[212:213], v242 offset:61440
    v_mfma_f32_16x16x32_bf16 v[60:63], v[216:219], a[72:75], v[60:63]
    ds_read_b64_tr_b16 v[214:215], v242 offset:61952
    v_mfma_f32_16x16x32_bf16 v[60:63], v[220:223], a[76:79], v[60:63]
    buffer_load_dwordx4 v232, s[56:59], s14 offen offset:2048 lds
    v_mfma_f32_16x16x32_bf16 v[28:31], v[220:223], a[68:71], v[28:31]
    v_mfma_f32_16x16x32_bf16 v[28:31], v[216:219], a[64:67], v[28:31]
    s_waitcnt lgkmcnt(15)
    ds_read_b64_tr_b16 v[216:217], v243 offset:57344
    v_mfma_f32_16x16x32_bf16 v[0:3], v[160:163], a[96:99], v[0:3]
    ds_read_b64_tr_b16 v[218:219], v243 offset:57856
    ds_read_b64_tr_b16 v[220:221], v243 offset:61440
    v_mfma_f32_16x16x32_bf16 v[0:3], v[164:167], a[100:103], v[0:3]
    ds_read_b64_tr_b16 v[222:223], v243 offset:61952
    v_mfma_f32_16x16x32_bf16 v[32:35], v[164:167], a[108:111], v[32:35]
    buffer_load_dwordx4 v233, s[56:59], s14 offen offset:3072 lds
    v_mfma_f32_16x16x32_bf16 v[32:35], v[160:163], a[104:107], v[32:35]
    v_mfma_f32_16x16x32_bf16 v[64:67], v[160:163], a[112:115], v[64:67]
    v_mfma_f32_16x16x32_bf16 v[64:67], v[164:167], a[116:119], v[64:67]
    v_mfma_f32_16x16x32_bf16 v[96:99], v[164:167], a[124:127], v[96:99]
    v_mfma_f32_16x16x32_bf16 v[96:99], v[160:163], a[120:123], v[96:99]
    s_add_u32 m0, s17, 81920
    s_add_u32 s14, s19, s37
    v_mfma_f32_16x16x32_bf16 v[100:103], v[168:171], a[120:123], v[100:103]
    buffer_load_dwordx4 v234, s[60:63], s14 offen offset:0 lds
    v_mfma_f32_16x16x32_bf16 v[100:103], v[172:175], a[124:127], v[100:103]
    v_mfma_f32_16x16x32_bf16 v[68:71], v[172:175], a[116:119], v[68:71]
    s_waitcnt vmcnt(10)
    s_waitcnt lgkmcnt(0)
    s_barrier
    v_mfma_f32_16x16x32_bf16 v[68:71], v[168:171], a[112:115], v[68:71]
    v_add_u32 v240, 0xffff0000, v240
    v_mfma_f32_16x16x32_bf16 v[36:39], v[168:171], a[104:107], v[36:39]
    s_add_u32 s37, s37, 524288
    s_sub_u32 s88, s37, 4718592
    s_min_u32 s37, s37, s88
    v_mfma_f32_16x16x32_bf16 v[36:39], v[172:175], a[108:111], v[36:39]
    buffer_load_dwordx4 v235, s[60:63], s14 offen offset:1024 lds
    v_mfma_f32_16x16x32_bf16 v[4:7], v[172:175], a[100:103], v[4:7]
    ds_read_b64_tr_b16 v[160:161], v240 offset:0
    v_mfma_f32_16x16x32_bf16 v[4:7], v[168:171], a[96:99], v[4:7]
    ds_read_b64_tr_b16 v[162:163], v240 offset:512
    v_mfma_f32_16x16x32_bf16 v[8:11], v[176:179], a[96:99], v[8:11]
    ds_read_b64_tr_b16 v[164:165], v240 offset:4096
    v_mfma_f32_16x16x32_bf16 v[8:11], v[180:183], a[100:103], v[8:11]
    buffer_load_dwordx4 v236, s[60:63], s14 offen offset:2048 lds
    v_mfma_f32_16x16x32_bf16 v[40:43], v[180:183], a[108:111], v[40:43]
    ds_read_b64_tr_b16 v[166:167], v240 offset:4608
    v_add_u32 v238, 0xfffec000, v238
    v_mfma_f32_16x16x32_bf16 v[40:43], v[176:179], a[104:107], v[40:43]
    ds_read_b128 a[64:67], v238 offset:0
    v_add_u32 v239, 0xfffec000, v239
    v_mfma_f32_16x16x32_bf16 v[72:75], v[176:179], a[112:115], v[72:75]
    ds_read_b128 a[68:71], v239 offset:0
    v_mfma_f32_16x16x32_bf16 v[72:75], v[180:183], a[116:119], v[72:75]
    ds_read_b128 a[72:75], v238 offset:2048
    v_mfma_f32_16x16x32_bf16 v[104:107], v[180:183], a[124:127], v[104:107]
    buffer_load_dwordx4 v237, s[60:63], s14 offen offset:3072 lds
    v_mfma_f32_16x16x32_bf16 v[104:107], v[176:179], a[120:123], v[104:107]
    ds_read_b128 a[76:79], v239 offset:2048
    v_mfma_f32_16x16x32_bf16 v[108:111], v[184:187], a[120:123], v[108:111]
    ds_read_b128 a[80:83], v238 offset:16384
    v_mfma_f32_16x16x32_bf16 v[108:111], v[188:191], a[124:127], v[108:111]
    ds_read_b128 a[84:87], v239 offset:16384
    v_mfma_f32_16x16x32_bf16 v[76:79], v[188:191], a[116:119], v[76:79]
    ds_read_b128 a[88:91], v238 offset:18432
    v_mfma_f32_16x16x32_bf16 v[76:79], v[184:187], a[112:115], v[76:79]
    s_add_u32 m0, s16, 98304
    s_add_u32 s14, s21, s36
    ds_read_b128 a[92:95], v239 offset:18432
    v_mfma_f32_16x16x32_bf16 v[44:47], v[184:187], a[104:107], v[44:47]
    buffer_load_dwordx4 v230, s[56:59], s14 offen offset:0 lds
    v_mfma_f32_16x16x32_bf16 v[44:47], v[188:191], a[108:111], v[44:47]
    v_add_u32 v241, 0xffff0000, v241
    v_mfma_f32_16x16x32_bf16 v[12:15], v[188:191], a[100:103], v[12:15]
    ds_read_b64_tr_b16 v[168:169], v241 offset:0
    v_mfma_f32_16x16x32_bf16 v[12:15], v[184:187], a[96:99], v[12:15]
    ds_read_b64_tr_b16 v[170:171], v241 offset:512
    v_mfma_f32_16x16x32_bf16 v[16:19], v[192:195], a[96:99], v[16:19]
    buffer_load_dwordx4 v231, s[56:59], s14 offen offset:1024 lds
    v_mfma_f32_16x16x32_bf16 v[16:19], v[196:199], a[100:103], v[16:19]
    ds_read_b64_tr_b16 v[172:173], v241 offset:4096
    v_mfma_f32_16x16x32_bf16 v[48:51], v[196:199], a[108:111], v[48:51]
    ds_read_b64_tr_b16 v[174:175], v241 offset:4608
    v_add_u32 v242, 0xffff0000, v242
    v_mfma_f32_16x16x32_bf16 v[48:51], v[192:195], a[104:107], v[48:51]
    ds_read_b64_tr_b16 v[176:177], v242 offset:0
    v_mfma_f32_16x16x32_bf16 v[80:83], v[192:195], a[112:115], v[80:83]
    ds_read_b64_tr_b16 v[178:179], v242 offset:512
    v_mfma_f32_16x16x32_bf16 v[80:83], v[196:199], a[116:119], v[80:83]
    buffer_load_dwordx4 v232, s[56:59], s14 offen offset:2048 lds
    v_mfma_f32_16x16x32_bf16 v[112:115], v[196:199], a[124:127], v[112:115]
    ds_read_b64_tr_b16 v[180:181], v242 offset:4096
    v_mfma_f32_16x16x32_bf16 v[112:115], v[192:195], a[120:123], v[112:115]
    ds_read_b64_tr_b16 v[182:183], v242 offset:4608
    v_add_u32 v243, 0xffff0000, v243
    v_mfma_f32_16x16x32_bf16 v[116:119], v[200:203], a[120:123], v[116:119]
    ds_read_b64_tr_b16 v[184:185], v243 offset:0
    v_mfma_f32_16x16x32_bf16 v[116:119], v[204:207], a[124:127], v[116:119]
    ds_read_b64_tr_b16 v[186:187], v243 offset:512
    v_mfma_f32_16x16x32_bf16 v[84:87], v[204:207], a[116:119], v[84:87]
    buffer_load_dwordx4 v233, s[56:59], s14 offen offset:3072 lds
    v_mfma_f32_16x16x32_bf16 v[84:87], v[200:203], a[112:115], v[84:87]
    ds_read_b64_tr_b16 v[188:189], v243 offset:4096
    v_mfma_f32_16x16x32_bf16 v[52:55], v[200:203], a[104:107], v[52:55]
    ds_read_b64_tr_b16 v[190:191], v243 offset:4608
    v_mfma_f32_16x16x32_bf16 v[52:55], v[204:207], a[108:111], v[52:55]
    ds_read_b64_tr_b16 v[192:193], v240 offset:8192
    v_mfma_f32_16x16x32_bf16 v[20:23], v[204:207], a[100:103], v[20:23]
    ds_read_b64_tr_b16 v[194:195], v240 offset:8704
    v_mfma_f32_16x16x32_bf16 v[20:23], v[200:203], a[96:99], v[20:23]
    s_add_u32 m0, s16, 114688
    s_add_u32 s14, s22, s36
    v_mfma_f32_16x16x32_bf16 v[24:27], v[208:211], a[96:99], v[24:27]
    buffer_load_dwordx4 v230, s[56:59], s14 offen offset:0 lds
    v_mfma_f32_16x16x32_bf16 v[24:27], v[212:215], a[100:103], v[24:27]
    ds_read_b64_tr_b16 v[196:197], v240 offset:12288
    v_mfma_f32_16x16x32_bf16 v[56:59], v[212:215], a[108:111], v[56:59]
    ds_read_b64_tr_b16 v[198:199], v240 offset:12800
    v_mfma_f32_16x16x32_bf16 v[56:59], v[208:211], a[104:107], v[56:59]
    s_add_u32 s36, s36, 128
    s_sub_u32 s88, s36, 1152
    s_min_u32 s36, s36, s88
    v_mfma_f32_16x16x32_bf16 v[88:91], v[208:211], a[112:115], v[88:91]
    buffer_load_dwordx4 v231, s[56:59], s14 offen offset:1024 lds
    v_mfma_f32_16x16x32_bf16 v[88:91], v[212:215], a[116:119], v[88:91]
    ds_read_b64_tr_b16 v[200:201], v241 offset:8192
    v_mfma_f32_16x16x32_bf16 v[120:123], v[212:215], a[124:127], v[120:123]
    ds_read_b64_tr_b16 v[202:203], v241 offset:8704
    v_mfma_f32_16x16x32_bf16 v[120:123], v[208:211], a[120:123], v[120:123]
    buffer_load_dwordx4 v232, s[56:59], s14 offen offset:2048 lds
    v_mfma_f32_16x16x32_bf16 v[124:127], v[216:219], a[120:123], v[124:127]
    ds_read_b64_tr_b16 v[204:205], v241 offset:12288
    v_mfma_f32_16x16x32_bf16 v[124:127], v[220:223], a[124:127], v[124:127]
    ds_read_b64_tr_b16 v[206:207], v241 offset:12800
    v_mfma_f32_16x16x32_bf16 v[92:95], v[220:223], a[116:119], v[92:95]
    ds_read_b64_tr_b16 v[208:209], v242 offset:8192
    v_mfma_f32_16x16x32_bf16 v[92:95], v[216:219], a[112:115], v[92:95]
    buffer_load_dwordx4 v233, s[56:59], s14 offen offset:3072 lds
    v_mfma_f32_16x16x32_bf16 v[60:63], v[216:219], a[104:107], v[60:63]
    ds_read_b64_tr_b16 v[210:211], v242 offset:8704
    v_mfma_f32_16x16x32_bf16 v[60:63], v[220:223], a[108:111], v[60:63]
    ds_read_b64_tr_b16 v[212:213], v242 offset:12288
    v_mfma_f32_16x16x32_bf16 v[28:31], v[220:223], a[100:103], v[28:31]
    ds_read_b64_tr_b16 v[214:215], v242 offset:12800
    v_mfma_f32_16x16x32_bf16 v[28:31], v[216:219], a[96:99], v[28:31]
    s_waitcnt lgkmcnt(15)
    s_add_u32 m0, s17, 131072
    s_add_u32 s14, s19, s37
    v_mfma_f32_16x16x32_bf16 v[0:3], v[160:163], a[64:67], v[0:3]
    ds_read_b64_tr_b16 v[216:217], v243 offset:8192
    ds_read_b64_tr_b16 v[218:219], v243 offset:8704
    v_mfma_f32_16x16x32_bf16 v[0:3], v[164:167], a[68:71], v[0:3]
    ds_read_b64_tr_b16 v[220:221], v243 offset:12288
    ds_read_b64_tr_b16 v[222:223], v243 offset:12800
    v_mfma_f32_16x16x32_bf16 v[32:35], v[164:167], a[76:79], v[32:35]
    buffer_load_dwordx4 v234, s[60:63], s14 offen offset:0 lds
    v_mfma_f32_16x16x32_bf16 v[32:35], v[160:163], a[72:75], v[32:35]
    s_add_u32 s37, s37, 524288
    s_sub_u32 s88, s37, 4718592
    s_min_u32 s37, s37, s88
    v_mfma_f32_16x16x32_bf16 v[64:67], v[160:163], a[80:83], v[64:67]
    v_mfma_f32_16x16x32_bf16 v[64:67], v[164:167], a[84:87], v[64:67]
    buffer_load_dwordx4 v235, s[60:63], s14 offen offset:1024 lds
    v_mfma_f32_16x16x32_bf16 v[96:99], v[164:167], a[92:95], v[96:99]
    v_mfma_f32_16x16x32_bf16 v[96:99], v[160:163], a[88:91], v[96:99]
    v_mfma_f32_16x16x32_bf16 v[100:103], v[168:171], a[88:91], v[100:103]
    buffer_load_dwordx4 v236, s[60:63], s14 offen offset:2048 lds
    v_mfma_f32_16x16x32_bf16 v[100:103], v[172:175], a[92:95], v[100:103]
    v_mfma_f32_16x16x32_bf16 v[68:71], v[172:175], a[84:87], v[68:71]
    s_waitcnt vmcnt(11)
    s_waitcnt lgkmcnt(0)
    s_barrier
    v_mfma_f32_16x16x32_bf16 v[68:71], v[168:171], a[80:83], v[68:71]
    buffer_load_dwordx4 v237, s[60:63], s14 offen offset:3072 lds
    v_mfma_f32_16x16x32_bf16 v[36:39], v[168:171], a[72:75], v[36:39]
    ds_read_b64_tr_b16 v[160:161], v240 offset:49152
    v_mfma_f32_16x16x32_bf16 v[36:39], v[172:175], a[76:79], v[36:39]
    ds_read_b64_tr_b16 v[162:163], v240 offset:49664
    v_mfma_f32_16x16x32_bf16 v[4:7], v[172:175], a[68:71], v[4:7]
    ds_read_b64_tr_b16 v[164:165], v240 offset:53248
    v_mfma_f32_16x16x32_bf16 v[4:7], v[168:171], a[64:67], v[4:7]
    ds_read_b64_tr_b16 v[166:167], v240 offset:53760
    v_mfma_f32_16x16x32_bf16 v[8:11], v[176:179], a[64:67], v[8:11]
    ds_read_b128 a[96:99], v238 offset:49152
    v_cmp_ne_u32 vcc, 1, v247
    v_mfma_f32_16x16x32_bf16 v[8:11], v[180:183], a[68:71], v[8:11]
    s_nop 0
    s_cbranch_vccnz L_SPIN_B
L_BACK_B:
    s_and_b32 s8, s6, 3
    v_mfma_f32_16x16x32_bf16 v[40:43], v[180:183], a[76:79], v[40:43]
    s_lshl_b32 s9, s7, 2
    s_add_u32 s9, s9, s8
    s_lshl_b32 s9, s9, 14
    v_mfma_f32_16x16x32_bf16 v[40:43], v[176:179], a[72:75], v[40:43]
    s_add_u32 s9, s9, 54788096
    buffer_load_dwordx4 a[152:155], v224, s[64:67], s9 offen offset:0 sc1
    v_mfma_f32_16x16x32_bf16 v[72:75], v[176:179], a[80:83], v[72:75]
    ds_read_b128 a[100:103], v239 offset:49152
    v_mfma_f32_16x16x32_bf16 v[72:75], v[180:183], a[84:87], v[72:75]
    ds_read_b128 a[104:107], v238 offset:51200
    v_mfma_f32_16x16x32_bf16 v[104:107], v[180:183], a[92:95], v[104:107]
    buffer_load_dwordx4 a[156:159], v224, s[64:67], s9 offen offset:1024 sc1
    v_mfma_f32_16x16x32_bf16 v[104:107], v[176:179], a[88:91], v[104:107]
    ds_read_b128 a[108:111], v239 offset:51200
    v_add_u32 v238, 0x10000, v238
    v_mfma_f32_16x16x32_bf16 v[108:111], v[184:187], a[88:91], v[108:111]
    ds_read_b128 a[112:115], v238 offset:0
    v_add_u32 v239, 0x10000, v239
    v_mfma_f32_16x16x32_bf16 v[108:111], v[188:191], a[92:95], v[108:111]
    buffer_load_dwordx4 a[160:163], v224, s[64:67], s9 offen offset:2048 sc1
    v_mfma_f32_16x16x32_bf16 v[76:79], v[188:191], a[84:87], v[76:79]
    ds_read_b128 a[116:119], v239 offset:0
    v_mfma_f32_16x16x32_bf16 v[76:79], v[184:187], a[80:83], v[76:79]
    ds_read_b128 a[120:123], v238 offset:2048
    v_mfma_f32_16x16x32_bf16 v[44:47], v[184:187], a[72:75], v[44:47]
    buffer_load_dwordx4 a[164:167], v224, s[64:67], s9 offen offset:3072 sc1
    v_mfma_f32_16x16x32_bf16 v[44:47], v[188:191], a[76:79], v[44:47]
    ds_read_b128 a[124:127], v239 offset:2048
    v_mfma_f32_16x16x32_bf16 v[12:15], v[188:191], a[68:71], v[12:15]
    ds_read_b64_tr_b16 v[168:169], v241 offset:49152
    v_mfma_f32_16x16x32_bf16 v[12:15], v[184:187], a[64:67], v[12:15]
    s_add_u32 s9, s9, 4096
    ds_read_b64_tr_b16 v[170:171], v241 offset:49664
    v_mfma_f32_16x16x32_bf16 v[16:19], v[192:195], a[64:67], v[16:19]
    buffer_load_dwordx4 a[168:171], v224, s[64:67], s9 offen offset:0 sc1
    v_mfma_f32_16x16x32_bf16 v[16:19], v[196:199], a[68:71], v[16:19]
    ds_read_b64_tr_b16 v[172:173], v241 offset:53248
    v_mfma_f32_16x16x32_bf16 v[48:51], v[196:199], a[76:79], v[48:51]
    ds_read_b64_tr_b16 v[174:175], v241 offset:53760
    v_mfma_f32_16x16x32_bf16 v[48:51], v[192:195], a[72:75], v[48:51]
    buffer_load_dwordx4 a[172:175], v224, s[64:67], s9 offen offset:1024 sc1
    v_mfma_f32_16x16x32_bf16 v[80:83], v[192:195], a[80:83], v[80:83]
    ds_read_b64_tr_b16 v[176:177], v242 offset:49152
    v_mfma_f32_16x16x32_bf16 v[80:83], v[196:199], a[84:87], v[80:83]
    ds_read_b64_tr_b16 v[178:179], v242 offset:49664
    v_mfma_f32_16x16x32_bf16 v[112:115], v[196:199], a[92:95], v[112:115]
    ds_read_b64_tr_b16 v[180:181], v242 offset:53248
    v_mfma_f32_16x16x32_bf16 v[112:115], v[192:195], a[88:91], v[112:115]
    buffer_load_dwordx4 a[176:179], v224, s[64:67], s9 offen offset:2048 sc1
    v_mfma_f32_16x16x32_bf16 v[116:119], v[200:203], a[88:91], v[116:119]
    ds_read_b64_tr_b16 v[182:183], v242 offset:53760
    v_mfma_f32_16x16x32_bf16 v[116:119], v[204:207], a[92:95], v[116:119]
    ds_read_b64_tr_b16 v[184:185], v243 offset:49152
    v_mfma_f32_16x16x32_bf16 v[84:87], v[204:207], a[84:87], v[84:87]
    ds_read_b64_tr_b16 v[186:187], v243 offset:49664
    v_mfma_f32_16x16x32_bf16 v[84:87], v[200:203], a[80:83], v[84:87]
    buffer_load_dwordx4 a[180:183], v224, s[64:67], s9 offen offset:3072 sc1
    v_mfma_f32_16x16x32_bf16 v[52:55], v[200:203], a[72:75], v[52:55]
    ds_read_b64_tr_b16 v[188:189], v243 offset:53248
    v_mfma_f32_16x16x32_bf16 v[52:55], v[204:207], a[76:79], v[52:55]
    ds_read_b64_tr_b16 v[190:191], v243 offset:53760
    v_mfma_f32_16x16x32_bf16 v[20:23], v[204:207], a[68:71], v[20:23]
    ds_read_b64_tr_b16 v[192:193], v240 offset:57344
    v_mfma_f32_16x16x32_bf16 v[20:23], v[200:203], a[64:67], v[20:23]
    s_add_u32 s9, s9, 4096
    ds_read_b64_tr_b16 v[194:195], v240 offset:57856
    v_mfma_f32_16x16x32_bf16 v[24:27], v[208:211], a[64:67], v[24:27]
    ds_read_b64_tr_b16 v[196:197], v240 offset:61440
    v_and_b32 v248, 28, v248
    v_mfma_f32_16x16x32_bf16 v[24:27], v[212:215], a[68:71], v[24:27]
    s_lshl_b32 s13, s4, 7
    s_add_u32 s13, s13, 59047936
    ds_read_b64_tr_b16 v[198:199], v240 offset:61952
    v_mfma_f32_16x16x32_bf16 v[56:59], v[212:215], a[76:79], v[56:59]
    buffer_load_dword v247, v248, s[64:67], s13 offen sc1
    v_mfma_f32_16x16x32_bf16 v[56:59], v[208:211], a[72:75], v[56:59]
    ds_read_b64_tr_b16 v[200:201], v241 offset:57344
    v_mfma_f32_16x16x32_bf16 v[88:91], v[208:211], a[80:83], v[88:91]
    ds_read_b64_tr_b16 v[202:203], v241 offset:57856
    v_mfma_f32_16x16x32_bf16 v[88:91], v[212:215], a[84:87], v[88:91]
    buffer_load_dwordx4 a[184:187], v224, s[64:67], s9 offen offset:0 sc1
    v_mfma_f32_16x16x32_bf16 v[120:123], v[212:215], a[92:95], v[120:123]
    ds_read_b64_tr_b16 v[204:205], v241 offset:61440
    v_mfma_f32_16x16x32_bf16 v[120:123], v[208:211], a[88:91], v[120:123]
    ds_read_b64_tr_b16 v[206:207], v241 offset:61952
    v_mfma_f32_16x16x32_bf16 v[124:127], v[216:219], a[88:91], v[124:127]
    buffer_load_dwordx4 a[188:191], v224, s[64:67], s9 offen offset:1024 sc1
    v_mfma_f32_16x16x32_bf16 v[124:127], v[220:223], a[92:95], v[124:127]
    ds_read_b64_tr_b16 v[208:209], v242 offset:57344
    v_mfma_f32_16x16x32_bf16 v[92:95], v[220:223], a[84:87], v[92:95]
    ds_read_b64_tr_b16 v[210:211], v242 offset:57856
    v_mfma_f32_16x16x32_bf16 v[92:95], v[216:219], a[80:83], v[92:95]
    buffer_load_dwordx4 a[192:195], v224, s[64:67], s9 offen offset:2048 sc1
    v_mfma_f32_16x16x32_bf16 v[60:63], v[216:219], a[72:75], v[60:63]
    ds_read_b64_tr_b16 v[212:213], v242 offset:61440
    v_mfma_f32_16x16x32_bf16 v[60:63], v[220:223], a[76:79], v[60:63]
    ds_read_b64_tr_b16 v[214:215], v242 offset:61952
    v_mfma_f32_16x16x32_bf16 v[28:31], v[220:223], a[68:71], v[28:31]
    v_mfma_f32_16x16x32_bf16 v[28:31], v[216:219], a[64:67], v[28:31]
    s_waitcnt lgkmcnt(15)
    ds_read_b64_tr_b16 v[216:217], v243 offset:57344
    v_mfma_f32_16x16x32_bf16 v[0:3], v[160:163], a[96:99], v[0:3]
    ds_read_b64_tr_b16 v[218:219], v243 offset:57856
    ds_read_b64_tr_b16 v[220:221], v243 offset:61440
    v_mfma_f32_16x16x32_bf16 v[0:3], v[164:167], a[100:103], v[0:3]
    ds_read_b64_tr_b16 v[222:223], v243 offset:61952
    v_mfma_f32_16x16x32_bf16 v[32:35], v[164:167], a[108:111], v[32:35]
    buffer_load_dwordx4 a[196:199], v224, s[64:67], s9 offen offset:3072 sc1
    v_mfma_f32_16x16x32_bf16 v[32:35], v[160:163], a[104:107], v[32:35]
    s_add_u32 s9, s9, 4096
    v_mfma_f32_16x16x32_bf16 v[64:67], v[160:163], a[112:115], v[64:67]
    v_mfma_f32_16x16x32_bf16 v[64:67], v[164:167], a[116:119], v[64:67]
    buffer_load_dwordx4 a[200:203], v224, s[64:67], s9 offen offset:0 sc1
    v_mfma_f32_16x16x32_bf16 v[96:99], v[164:167], a[124:127], v[96:99]
    v_mfma_f32_16x16x32_bf16 v[96:99], v[160:163], a[120:123], v[96:99]
    v_mfma_f32_16x16x32_bf16 v[100:103], v[168:171], a[120:123], v[100:103]
    buffer_load_dwordx4 a[204:207], v224, s[64:67], s9 offen offset:1024 sc1
    v_mfma_f32_16x16x32_bf16 v[100:103], v[172:175], a[124:127], v[100:103]
    v_mfma_f32_16x16x32_bf16 v[68:71], v[172:175], a[116:119], v[68:71]
    s_waitcnt vmcnt(15)
    s_waitcnt lgkmcnt(0)
    s_barrier
    v_mfma_f32_16x16x32_bf16 v[68:71], v[168:171], a[112:115], v[68:71]
    buffer_load_dwordx4 a[208:211], v224, s[64:67], s9 offen offset:2048 sc1
    v_mfma_f32_16x16x32_bf16 v[36:39], v[168:171], a[104:107], v[36:39]
    v_add_u32 v240, 0x18000, v240
    v_mfma_f32_16x16x32_bf16 v[36:39], v[172:175], a[108:111], v[36:39]
    ds_read_b64_tr_b16 v[160:161], v240 offset:0
    v_mfma_f32_16x16x32_bf16 v[4:7], v[172:175], a[100:103], v[4:7]
    ds_read_b64_tr_b16 v[162:163], v240 offset:512
    v_mfma_f32_16x16x32_bf16 v[4:7], v[168:171], a[96:99], v[4:7]
    buffer_load_dwordx4 a[212:215], v224, s[64:67], s9 offen offset:3072 sc1
    v_mfma_f32_16x16x32_bf16 v[8:11], v[176:179], a[96:99], v[8:11]
    ds_read_b64_tr_b16 v[164:165], v240 offset:4096
    v_mfma_f32_16x16x32_bf16 v[8:11], v[180:183], a[100:103], v[8:11]
    ds_read_b64_tr_b16 v[166:167], v240 offset:4608
    v_mfma_f32_16x16x32_bf16 v[40:43], v[180:183], a[108:111], v[40:43]
    ds_read_b128 a[64:67], v238 offset:32768
    v_mfma_f32_16x16x32_bf16 v[40:43], v[176:179], a[104:107], v[40:43]
    ds_read_b128 a[68:71], v239 offset:32768
    v_bfe_u32 v249, v224, 4, 4
    v_mfma_f32_16x16x32_bf16 v[72:75], v[176:179], a[112:115], v[72:75]
    ds_read_b128 a[72:75], v238 offset:34816
    v_lshrrev_b32 v250, 8, v224
    v_mfma_f32_16x16x32_bf16 v[72:75], v[180:183], a[116:119], v[72:75]
    ds_read_b128 a[76:79], v239 offset:34816
    v_lshlrev_b32 v250, 4, v250
    v_mfma_f32_16x16x32_bf16 v[104:107], v[180:183], a[124:127], v[104:107]
    ds_read_b128 a[80:83], v238 offset:49152
    v_lshl_add_u32 v249, v249, 8, v250
    v_mfma_f32_16x16x32_bf16 v[104:107], v[176:179], a[120:123], v[104:107]
    s_lshl_b32 s9, s7, 12
    s_add_u32 s9, s9, 55836672
    v_mfma_f32_16x16x32_bf16 v[108:111], v[184:187], a[120:123], v[108:111]
    buffer_load_dwordx4 a[216:219], v249, s[64:67], s9 offen offset:0 sc1
    v_mfma_f32_16x16x32_bf16 v[108:111], v[188:191], a[124:127], v[108:111]
    ds_read_b128 a[84:87], v239 offset:49152
    v_mfma_f32_16x16x32_bf16 v[76:79], v[188:191], a[116:119], v[76:79]
    ds_read_b128 a[88:91], v238 offset:51200
    v_mfma_f32_16x16x32_bf16 v[76:79], v[184:187], a[112:115], v[76:79]
    buffer_load_dwordx4 a[220:223], v249, s[64:67], s9 offen offset:64 sc1
    v_mfma_f32_16x16x32_bf16 v[44:47], v[184:187], a[104:107], v[44:47]
    ds_read_b128 a[92:95], v239 offset:51200
    v_add_u32 v241, 0x18000, v241
    v_mfma_f32_16x16x32_bf16 v[44:47], v[188:191], a[108:111], v[44:47]
    ds_read_b64_tr_b16 v[168:169], v241 offset:0
    v_mfma_f32_16x16x32_bf16 v[12:15], v[188:191], a[100:103], v[12:15]
    buffer_load_dwordx4 a[224:227], v249, s[64:67], s9 offen offset:128 sc1
    v_mfma_f32_16x16x32_bf16 v[12:15], v[184:187], a[96:99], v[12:15]
    s_lshr_b32 s10, s8, 1
    ds_read_b64_tr_b16 v[170:171], v241 offset:512
    v_mfma_f32_16x16x32_bf16 v[16:19], v[192:195], a[96:99], v[16:19]
    ds_read_b64_tr_b16 v[172:173], v241 offset:4096
    v_lshrrev_b32 v250, 5, v224
    v_mfma_f32_16x16x32_bf16 v[16:19], v[196:199], a[100:103], v[16:19]
    ds_read_b64_tr_b16 v[174:175], v241 offset:4608
    v_subrev_u32 v250, 4, v250
    v_mfma_f32_16x16x32_bf16 v[48:51], v[196:199], a[108:111], v[48:51]
    s_lshl_b32 s11, s10, 1
    v_subrev_u32 v251, s11, v250
    v_cmp_gt_u32 vcc, 18, v251
    v_mfma_f32_16x16x32_bf16 v[48:51], v[192:195], a[104:107], v[48:51]
    v_mul_u32_u24 v250, 1152, v250
    v_and_b32 v251, 16, v224
    v_mfma_f32_16x16x32_bf16 v[80:83], v[192:195], a[112:115], v[80:83]
    v_add_u32 v250, v250, v251
    v_bfrev_b32 v251, 1
    v_mfma_f32_16x16x32_bf16 v[80:83], v[196:199], a[116:119], v[80:83]
    v_cndmask_b32 v250, v251, v250, vcc
    s_mul_i32 s9, s7, 36
    s_lshl_b32 s10, s10, 4
    s_add_u32 s9, s9, s10
    s_mul_i32 s9, s9, 1152
    s_lshr_b32 s10, s6, 2
    s_mul_i32 s10, s10, 288
    s_add_u32 s9, s9, s10
    s_lshl_b32 s10, s3, 5
    s_add_u32 m0, s16, 147456
    s_add_u32 s11, s9, s10
    buffer_load_dwordx4 v250, s[72:75], s11 offen lds
    v_mfma_f32_16x16x32_bf16 v[112:115], v[196:199], a[124:127], v[112:115]
    s_add_u32 s10, s10, 128
    s_add_u32 m0, s16, 148480
    s_add_u32 s11, s9, s10
    v_mfma_f32_16x16x32_bf16 v[112:115], v[192:195], a[120:123], v[112:115]
    v_add_u32 v242, 0x18000, v242
    v_mfma_f32_16x16x32_bf16 v[116:119], v[200:203], a[120:123], v[116:119]
    buffer_load_dwordx4 v250, s[72:75], s11 offen lds
    s_add_u32 m0, s16, 149504
    v_mfma_f32_16x16x32_bf16 v[116:119], v[204:207], a[124:127], v[116:119]
    s_add_u32 s11, s9, 256
    ds_read_b64_tr_b16 v[176:177], v242 offset:0
    v_mfma_f32_16x16x32_bf16 v[84:87], v[204:207], a[116:119], v[84:87]
    ds_read_b64_tr_b16 v[178:179], v242 offset:512
    v_mfma_f32_16x16x32_bf16 v[84:87], v[200:203], a[112:115], v[84:87]
    buffer_load_dwordx4 v250, s[72:75], s11 offen lds
    s_mov_b32 s39, 0
    v_mfma_f32_16x16x32_bf16 v[52:55], v[200:203], a[104:107], v[52:55]
    s_mul_i32 s8, s4, 1064960
    s_add_u32 s8, s8, 0
    s_add_u32 s68, s64, s8
    v_mfma_f32_16x16x32_bf16 v[52:55], v[204:207], a[108:111], v[52:55]
    s_addc_u32 s69, s65, 0
    s_mul_i32 s8, s5, 65536
    s_sub_u32 s70, 1064960, s8
    v_mfma_f32_16x16x32_bf16 v[20:23], v[204:207], a[100:103], v[20:23]
    s_lshl_b32 s8, s4, 12
    s_add_u32 s8, s8, 34603008
    s_lshr_b32 s9, s4, 3
    v_mfma_f32_16x16x32_bf16 v[20:23], v[200:203], a[96:99], v[20:23]
    s_mul_i32 s9, s9, 1024
    s_add_u32 s8, s8, s9
    v_mfma_f32_16x16x32_bf16 v[24:27], v[208:211], a[96:99], v[24:27]
    s_mul_i32 s94, s32, 272384
    s_add_u32 s94, s94, s8
    s_mul_i32 s95, s33, 272384
    v_mfma_f32_16x16x32_bf16 v[24:27], v[212:215], a[100:103], v[24:27]
    s_add_u32 s95, s95, s8
    s_waitcnt vmcnt(14)
    v_cmp_ne_u32 vcc, 1, v247
    s_nop 0
    s_cbranch_vccnz L_SPIN_K
L_BACK_K:
    s_add_u32 m0, s16, 0
    s_mov_b32 s35, 0
    buffer_load_dwordx4 v225, s[68:71], s35 offen offset:0 lds
    v_mfma_f32_16x16x32_bf16 v[56:59], v[212:215], a[108:111], v[56:59]
    ds_read_b64_tr_b16 v[180:181], v242 offset:4096
    v_mfma_f32_16x16x32_bf16 v[56:59], v[208:211], a[104:107], v[56:59]
    ds_read_b64_tr_b16 v[182:183], v242 offset:4608
    v_add_u32 v243, 0x18000, v243
    v_mfma_f32_16x16x32_bf16 v[88:91], v[208:211], a[112:115], v[88:91]
    buffer_load_dwordx4 v225, s[68:71], s35 offen offset:1024 lds
    v_mfma_f32_16x16x32_bf16 v[88:91], v[212:215], a[116:119], v[88:91]
    ds_read_b64_tr_b16 v[184:185], v243 offset:0
    v_mfma_f32_16x16x32_bf16 v[120:123], v[212:215], a[124:127], v[120:123]
    ds_read_b64_tr_b16 v[186:187], v243 offset:512
    v_mfma_f32_16x16x32_bf16 v[120:123], v[208:211], a[120:123], v[120:123]
    buffer_load_dwordx4 v225, s[68:71], s35 offen offset:2048 lds
    v_mfma_f32_16x16x32_bf16 v[124:127], v[216:219], a[120:123], v[124:127]
    ds_read_b64_tr_b16 v[188:189], v243 offset:4096
    v_mfma_f32_16x16x32_bf16 v[124:127], v[220:223], a[124:127], v[124:127]
    ds_read_b64_tr_b16 v[190:191], v243 offset:4608
    v_mfma_f32_16x16x32_bf16 v[92:95], v[220:223], a[116:119], v[92:95]
    buffer_load_dwordx4 v225, s[68:71], s35 offen offset:3072 lds
    v_mfma_f32_16x16x32_bf16 v[92:95], v[216:219], a[112:115], v[92:95]
    s_add_u32 m0, s16, 16384
    s_mov_b32 s35, 16384
    ds_read_b64_tr_b16 v[192:193], v240 offset:8192
    v_mfma_f32_16x16x32_bf16 v[60:63], v[216:219], a[104:107], v[60:63]
    ds_read_b64_tr_b16 v[194:195], v240 offset:8704
    v_mfma_f32_16x16x32_bf16 v[60:63], v[220:223], a[108:111], v[60:63]
    buffer_load_dwordx4 v225, s[68:71], s35 offen offset:0 lds
    v_mfma_f32_16x16x32_bf16 v[28:31], v[220:223], a[100:103], v[28:31]
    ds_read_b64_tr_b16 v[196:197], v240 offset:12288
    v_mfma_f32_16x16x32_bf16 v[28:31], v[216:219], a[96:99], v[28:31]
    s_waitcnt lgkmcnt(15)
    ds_read_b64_tr_b16 v[198:199], v240 offset:12800
    v_mfma_f32_16x16x32_bf16 v[0:3], v[160:163], a[64:67], v[0:3]
    buffer_load_dwordx4 v225, s[68:71], s35 offen offset:1024 lds
    v_mfma_f32_16x16x32_bf16 v[0:3], v[164:167], a[68:71], v[0:3]
    ds_read_b64_tr_b16 v[200:201], v241 offset:8192
    v_mfma_f32_16x16x32_bf16 v[32:35], v[164:167], a[76:79], v[32:35]
    ds_read_b64_tr_b16 v[202:203], v241 offset:8704
    v_mfma_f32_16x16x32_bf16 v[32:35], v[160:163], a[72:75], v[32:35]
    buffer_load_dwordx4 v225, s[68:71], s35 offen offset:2048 lds
    v_mfma_f32_16x16x32_bf16 v[64:67], v[160:163], a[80:83], v[64:67]
    ds_read_b64_tr_b16 v[204:205], v241 offset:12288
    v_mfma_f32_16x16x32_bf16 v[64:67], v[164:167], a[84:87], v[64:67]
    ds_read_b64_tr_b16 v[206:207], v241 offset:12800
    v_mfma_f32_16x16x32_bf16 v[96:99], v[164:167], a[92:95], v[96:99]
    ds_read_b64_tr_b16 v[208:209], v242 offset:8192
    v_mfma_f32_16x16x32_bf16 v[96:99], v[160:163], a[88:91], v[96:99]
    s_waitcnt lgkmcnt(15)
    buffer_load_dwordx4 v225, s[68:71], s35 offen offset:3072 lds
    v_mfma_f32_16x16x32_bf16 v[100:103], v[168:171], a[88:91], v[100:103]
    ds_read_b64_tr_b16 v[210:211], v242 offset:8704
    v_mfma_f32_16x16x32_bf16 v[100:103], v[172:175], a[92:95], v[100:103]
    ds_read_b64_tr_b16 v[212:213], v242 offset:12288
    v_mfma_f32_16x16x32_bf16 v[68:71], v[172:175], a[84:87], v[68:71]
    ds_read_b64_tr_b16 v[214:215], v242 offset:12800
    v_mfma_f32_16x16x32_bf16 v[68:71], v[168:171], a[80:83], v[68:71]
    s_add_u32 m0, s16, 32768
    s_mov_b32 s35, 32768
    ds_read_b64_tr_b16 v[216:217], v243 offset:8192
    v_mfma_f32_16x16x32_bf16 v[36:39], v[168:171], a[72:75], v[36:39]
    buffer_load_dwordx4 v225, s[68:71], s35 offen offset:0 lds
    v_mfma_f32_16x16x32_bf16 v[36:39], v[172:175], a[76:79], v[36:39]
    ds_read_b64_tr_b16 v[218:219], v243 offset:8704
    v_mfma_f32_16x16x32_bf16 v[4:7], v[172:175], a[68:71], v[4:7]
    ds_read_b64_tr_b16 v[220:221], v243 offset:12288
    v_mfma_f32_16x16x32_bf16 v[4:7], v[168:171], a[64:67], v[4:7]
    s_waitcnt lgkmcnt(15)
    buffer_load_dwordx4 v225, s[68:71], s35 offen offset:1024 lds
    v_mfma_f32_16x16x32_bf16 v[8:11], v[176:179], a[64:67], v[8:11]
    ds_read_b64_tr_b16 v[222:223], v243 offset:12800
    v_mfma_f32_16x16x32_bf16 v[8:11], v[180:183], a[68:71], v[8:11]
    v_mfma_f32_16x16x32_bf16 v[40:43], v[180:183], a[76:79], v[40:43]
    v_mfma_f32_16x16x32_bf16 v[40:43], v[176:179], a[72:75], v[40:43]
    buffer_load_dwordx4 v225, s[68:71], s35 offen offset:2048 lds
    v_mfma_f32_16x16x32_bf16 v[72:75], v[176:179], a[80:83], v[72:75]
    v_mfma_f32_16x16x32_bf16 v[72:75], v[180:183], a[84:87], v[72:75]
    v_mfma_f32_16x16x32_bf16 v[104:107], v[180:183], a[92:95], v[104:107]
    v_mfma_f32_16x16x32_bf16 v[104:107], v[176:179], a[88:91], v[104:107]
    buffer_load_dwordx4 v225, s[68:71], s35 offen offset:3072 lds
    v_mfma_f32_16x16x32_bf16 v[108:111], v[184:187], a[88:91], v[108:111]
    v_cvt_pk_bf16_f32 v0, v0, v1
    v_cvt_pk_bf16_f32 v1, v2, v3
    v_mfma_f32_16x16x32_bf16 v[108:111], v[188:191], a[92:95], v[108:111]
    v_cvt_pk_bf16_f32 v2, v4, v5
    v_cvt_pk_bf16_f32 v3, v6, v7
    v_mfma_f32_16x16x32_bf16 v[76:79], v[188:191], a[84:87], v[76:79]
    v_accvgpr_write_b32 a0, v0
    v_accvgpr_write_b32 a1, v1
    v_mfma_f32_16x16x32_bf16 v[76:79], v[184:187], a[80:83], v[76:79]
    s_add_u32 m0, s16, 49152
    s_mov_b32 s35, 49152
    v_accvgpr_write_b32 a2, v2
    v_mfma_f32_16x16x32_bf16 v[44:47], v[184:187], a[72:75], v[44:47]
    buffer_load_dwordx4 v225, s[68:71], s35 offen offset:0 lds
    v_mfma_f32_16x16x32_bf16 v[44:47], v[188:191], a[76:79], v[44:47]
    v_accvgpr_write_b32 a3, v3
    v_cvt_pk_bf16_f32 v32, v32, v33
    v_mfma_f32_16x16x32_bf16 v[12:15], v[188:191], a[68:71], v[12:15]
    v_cvt_pk_bf16_f32 v33, v34, v35
    v_cvt_pk_bf16_f32 v34, v36, v37
    v_mfma_f32_16x16x32_bf16 v[12:15], v[184:187], a[64:67], v[12:15]
    s_waitcnt lgkmcnt(12)
    buffer_load_dwordx4 v225, s[68:71], s35 offen offset:1024 lds
    v_mfma_f32_16x16x32_bf16 v[16:19], v[192:195], a[64:67], v[16:19]
    v_cvt_pk_bf16_f32 v35, v38, v39
    v_accvgpr_write_b32 a16, v32
    v_mfma_f32_16x16x32_bf16 v[16:19], v[196:199], a[68:71], v[16:19]
    v_accvgpr_write_b32 a17, v33
    v_accvgpr_write_b32 a18, v34
    v_mfma_f32_16x16x32_bf16 v[48:51], v[196:199], a[76:79], v[48:51]
    v_accvgpr_write_b32 a19, v35
    v_cvt_pk_bf16_f32 v64, v64, v65
    v_mfma_f32_16x16x32_bf16 v[48:51], v[192:195], a[72:75], v[48:51]
    buffer_load_dwordx4 v225, s[68:71], s35 offen offset:2048 lds
    v_mfma_f32_16x16x32_bf16 v[80:83], v[192:195], a[80:83], v[80:83]
    v_cvt_pk_bf16_f32 v65, v66, v67
    v_cvt_pk_bf16_f32 v66, v68, v69
    v_mfma_f32_16x16x32_bf16 v[80:83], v[196:199], a[84:87], v[80:83]
    v_cvt_pk_bf16_f32 v67, v70, v71
    v_accvgpr_write_b32 a32, v64
    v_mfma_f32_16x16x32_bf16 v[112:115], v[196:199], a[92:95], v[112:115]
    v_accvgpr_write_b32 a33, v65
    v_accvgpr_write_b32 a34, v66
    v_mfma_f32_16x16x32_bf16 v[112:115], v[192:195], a[88:91], v[112:115]
    s_waitcnt lgkmcnt(8)
    buffer_load_dwordx4 v225, s[68:71], s35 offen offset:3072 lds
    v_mfma_f32_16x16x32_bf16 v[116:119], v[200:203], a[88:91], v[116:119]
    v_accvgpr_write_b32 a35, v67
    v_cvt_pk_bf16_f32 v96, v96, v97
    v_mfma_f32_16x16x32_bf16 v[116:119], v[204:207], a[92:95], v[116:119]
    v_cvt_pk_bf16_f32 v97, v98, v99
    v_cvt_pk_bf16_f32 v98, v100, v101
    v_mfma_f32_16x16x32_bf16 v[84:87], v[204:207], a[84:87], v[84:87]
    v_cvt_pk_bf16_f32 v99, v102, v103
    v_accvgpr_write_b32 a48, v96
    v_mfma_f32_16x16x32_bf16 v[84:87], v[200:203], a[80:83], v[84:87]
    s_add_u32 m0, s16, 65536
    s_mov_b32 s35, 65536
    v_accvgpr_write_b32 a49, v97
    v_mfma_f32_16x16x32_bf16 v[52:55], v[200:203], a[72:75], v[52:55]
    buffer_load_dwordx4 v225, s[68:71], s35 offen offset:0 lds
    v_mfma_f32_16x16x32_bf16 v[52:55], v[204:207], a[76:79], v[52:55]
    v_accvgpr_write_b32 a50, v98
    v_accvgpr_write_b32 a51, v99
    v_mfma_f32_16x16x32_bf16 v[20:23], v[204:207], a[68:71], v[20:23]
    v_cvt_pk_bf16_f32 v8, v8, v9
    v_cvt_pk_bf16_f32 v9, v10, v11
    v_mfma_f32_16x16x32_bf16 v[20:23], v[200:203], a[64:67], v[20:23]
    s_waitcnt lgkmcnt(4)
    buffer_load_dwordx4 v225, s[68:71], s35 offen offset:1024 lds
    v_mfma_f32_16x16x32_bf16 v[24:27], v[208:211], a[64:67], v[24:27]
    v_cvt_pk_bf16_f32 v10, v12, v13
    v_cvt_pk_bf16_f32 v11, v14, v15
    v_mfma_f32_16x16x32_bf16 v[24:27], v[212:215], a[68:71], v[24:27]
    v_accvgpr_write_b32 a4, v8
    v_accvgpr_write_b32 a5, v9
    v_mfma_f32_16x16x32_bf16 v[56:59], v[212:215], a[76:79], v[56:59]
    v_accvgpr_write_b32 a6, v10
    v_accvgpr_write_b32 a7, v11
    v_mfma_f32_16x16x32_bf16 v[56:59], v[208:211], a[72:75], v[56:59]
    buffer_load_dwordx4 v225, s[68:71], s35 offen offset:2048 lds
    v_mfma_f32_16x16x32_bf16 v[88:91], v[208:211], a[80:83], v[88:91]
    v_cvt_pk_bf16_f32 v40, v40, v41
    v_cvt_pk_bf16_f32 v41, v42, v43
    v_mfma_f32_16x16x32_bf16 v[88:91], v[212:215], a[84:87], v[88:91]
    v_cvt_pk_bf16_f32 v42, v44, v45
    v_cvt_pk_bf16_f32 v43, v46, v47
    v_mfma_f32_16x16x32_bf16 v[120:123], v[212:215], a[92:95], v[120:123]
    v_accvgpr_write_b32 a20, v40
    v_accvgpr_write_b32 a21, v41
    v_mfma_f32_16x16x32_bf16 v[120:123], v[208:211], a[88:91], v[120:123]
    s_waitcnt lgkmcnt(0)
    buffer_load_dwordx4 v225, s[68:71], s35 offen offset:3072 lds
    v_mfma_f32_16x16x32_bf16 v[124:127], v[216:219], a[88:91], v[124:127]
    v_accvgpr_write_b32 a22, v42
    v_accvgpr_write_b32 a23, v43
    v_mfma_f32_16x16x32_bf16 v[124:127], v[220:223], a[92:95], v[124:127]
    v_cvt_pk_bf16_f32 v72, v72, v73
    v_cvt_pk_bf16_f32 v73, v74, v75
    v_mfma_f32_16x16x32_bf16 v[92:95], v[220:223], a[84:87], v[92:95]
    v_cvt_pk_bf16_f32 v74, v76, v77
    v_cvt_pk_bf16_f32 v75, v78, v79
    v_mfma_f32_16x16x32_bf16 v[92:95], v[216:219], a[80:83], v[92:95]
    s_add_u32 m0, s16, 81920
    s_mov_b32 s35, 81920
    v_accvgpr_write_b32 a36, v72
    v_mfma_f32_16x16x32_bf16 v[60:63], v[216:219], a[72:75], v[60:63]
    buffer_load_dwordx4 v225, s[68:71], s35 offen offset:0 lds
    v_mfma_f32_16x16x32_bf16 v[60:63], v[220:223], a[76:79], v[60:63]
    v_accvgpr_write_b32 a37, v73
    v_accvgpr_write_b32 a38, v74
    v_mfma_f32_16x16x32_bf16 v[28:31], v[220:223], a[68:71], v[28:31]
    v_accvgpr_write_b32 a39, v75
    v_cvt_pk_bf16_f32 v104, v104, v105
    v_mfma_f32_16x16x32_bf16 v[28:31], v[216:219], a[64:67], v[28:31]
    buffer_load_dwordx4 v225, s[68:71], s35 offen offset:1024 lds
    buffer_load_dwordx4 v225, s[68:71], s35 offen offset:2048 lds
    buffer_load_dwordx4 v225, s[68:71], s35 offen offset:3072 lds
    v_cvt_pk_bf16_f32 v105, v106, v107
    v_cvt_pk_bf16_f32 v106, v108, v109
    v_cvt_pk_bf16_f32 v107, v110, v111
    v_accvgpr_write_b32 a52, v104
    v_accvgpr_write_b32 a53, v105
    v_accvgpr_write_b32 a54, v106
    v_accvgpr_write_b32 a55, v107
    v_cvt_pk_bf16_f32 v16, v16, v17
    v_cvt_pk_bf16_f32 v17, v18, v19
    v_cvt_pk_bf16_f32 v18, v20, v21
    v_cvt_pk_bf16_f32 v19, v22, v23
    v_accvgpr_write_b32 a8, v16
    v_accvgpr_write_b32 a9, v17
    v_accvgpr_write_b32 a10, v18
    v_accvgpr_write_b32 a11, v19
    v_cvt_pk_bf16_f32 v48, v48, v49
    v_cvt_pk_bf16_f32 v49, v50, v51
    v_cvt_pk_bf16_f32 v50, v52, v53
    v_cvt_pk_bf16_f32 v51, v54, v55
    v_accvgpr_write_b32 a24, v48
    v_accvgpr_write_b32 a25, v49
    v_accvgpr_write_b32 a26, v50
    v_accvgpr_write_b32 a27, v51
    v_cvt_pk_bf16_f32 v80, v80, v81
    v_cvt_pk_bf16_f32 v81, v82, v83
    v_cvt_pk_bf16_f32 v82, v84, v85
    v_cvt_pk_bf16_f32 v83, v86, v87
    v_accvgpr_write_b32 a40, v80
    v_accvgpr_write_b32 a41, v81
    v_accvgpr_write_b32 a42, v82
    v_accvgpr_write_b32 a43, v83
    v_cvt_pk_bf16_f32 v112, v112, v113
    v_cvt_pk_bf16_f32 v113, v114, v115
    v_cvt_pk_bf16_f32 v114, v116, v117
    v_cvt_pk_bf16_f32 v115, v118, v119
    v_accvgpr_write_b32 a56, v112
    v_accvgpr_write_b32 a57, v113
    v_accvgpr_write_b32 a58, v114
    v_accvgpr_write_b32 a59, v115
    v_cvt_pk_bf16_f32 v24, v24, v25
    v_cvt_pk_bf16_f32 v25, v26, v27
    v_cvt_pk_bf16_f32 v26, v28, v29
    v_cvt_pk_bf16_f32 v27, v30, v31
    v_accvgpr_write_b32 a12, v24
    v_accvgpr_write_b32 a13, v25
    v_accvgpr_write_b32 a14, v26
    v_accvgpr_write_b32 a15, v27
    v_cvt_pk_bf16_f32 v56, v56, v57
    v_cvt_pk_bf16_f32 v57, v58, v59
    v_cvt_pk_bf16_f32 v58, v60, v61
    v_cvt_pk_bf16_f32 v59, v62, v63
    v_accvgpr_write_b32 a28, v56
    v_accvgpr_write_b32 a29, v57
    v_accvgpr_write_b32 a30, v58
    v_accvgpr_write_b32 a31, v59
    v_cvt_pk_bf16_f32 v88, v88, v89
    v_cvt_pk_bf16_f32 v89, v90, v91
    v_cvt_pk_bf16_f32 v90, v92, v93
    v_cvt_pk_bf16_f32 v91, v94, v95
    v_accvgpr_write_b32 a44, v88
    v_accvgpr_write_b32 a45, v89
    v_accvgpr_write_b32 a46, v90
    v_accvgpr_write_b32 a47, v91
    v_cvt_pk_bf16_f32 v120, v120, v121
    v_cvt_pk_bf16_f32 v121, v122, v123
    v_cvt_pk_bf16_f32 v122, v124, v125
    v_cvt_pk_bf16_f32 v123, v126, v127
    v_accvgpr_write_b32 a60, v120
    v_accvgpr_write_b32 a61, v121
    v_accvgpr_write_b32 a62, v122
    v_accvgpr_write_b32 a63, v123
    s_waitcnt vmcnt(24)
    v_lshrrev_b32 v251, 1, v224
    s_add_u32 s8, s16, 147456
    v_add_u32 v251, s8, v251
    ds_read_b64_tr_b16 a[232:233], v251 offset:0
    ds_read_b64_tr_b16 a[234:235], v251 offset:512
    ds_read_b64_tr_b16 a[236:237], v251 offset:1024
    ds_read_b64_tr_b16 a[238:239], v251 offset:1536
    ds_read_b64_tr_b16 a[240:241], v251 offset:2048
    ds_read_b64_tr_b16 a[242:243], v251 offset:2560
L_ATT:
    s_waitcnt vmcnt(16)
    s_waitcnt lgkmcnt(0)
    s_barrier
    v_mov_b32 v244, v224
    ds_read_b128 a[64:67], v244 offset:0
    ds_read_b128 a[68:71], v244 offset:1024
    ds_read_b128 a[72:75], v244 offset:2048
    ds_read_b128 a[76:79], v244 offset:3072
    ds_read_b128 a[80:83], v244 offset:4096
    ds_read_b128 a[84:87], v244 offset:5120
    ds_read_b128 a[88:91], v244 offset:6144
    ds_read_b128 a[92:95], v244 offset:7168
    s_mov_b32 s36, 16384
    v_add_u32 v244, 16384, v224
    s_cmp_lg_u32 s39, 0
    s_cselect_b64 s[92:93], -1, 0
    v_bfe_u32 v248, v224, 4, 4
    v_lshrrev_b32 v249, 8, v224
    v_lshlrev_b32 v249, 2, v249
    v_sub_u32 v248, v248, v249
    v_mov_b32 v249, 0xff800000
    v_cmp_gt_i32 vcc, 0, v248
    v_mov_b32 v212, 0
    s_nop 0
    v_cndmask_b32 v208, 0, v249, vcc
    v_cmp_gt_i32 vcc, 1, v248
    v_mov_b32 v214, 0
    s_nop 0
    v_cndmask_b32 v209, 0, v249, vcc
    v_cmp_gt_i32 vcc, 2, v248
    v_mov_b32 v216, 0
    s_nop 0
    v_cndmask_b32 v210, 0, v249, vcc
    v_cmp_gt_i32 vcc, 3, v248
    v_mov_b32 v218, 0
    s_nop 0
    v_cndmask_b32 v211, 0, v249, vcc
    v_and_b32 v248, 0xf0, v224
    v_cmp_eq_u32 vcc, 0, v248
    v_mov_b32 v249, 0x3f803f80
    v_mov_b64 v[230:231], 0
    v_mov_b64 v[232:233], 0
    v_mov_b64 v[234:235], 0
    v_mov_b64 v[236:237], 0
    v_cndmask_b32 v248, 0, v249, vcc
    v_accvgpr_write_b32 a228, v248
    v_accvgpr_write_b32 a229, v248
    v_accvgpr_write_b32 a230, v248
    v_accvgpr_write_b32 a231, v248
    v_mov_b64 v[0:1], 0
    v_mov_b64 v[2:3], 0
    v_mov_b64 v[4:5], 0
    v_mov_b64 v[6:7], 0
    v_mov_b64 v[8:9], 0
    v_mov_b64 v[10:11], 0
    v_mov_b64 v[12:13], 0
    v_mov_b64 v[14:15], 0
    v_mov_b64 v[16:17], 0
    v_mov_b64 v[18:19], 0
    v_mov_b64 v[20:21], 0
    v_mov_b64 v[22:23], 0
    v_mov_b64 v[24:25], 0
    v_mov_b64 v[26:27], 0
    v_mov_b64 v[28:29], 0
    v_mov_b64 v[30:31], 0
    v_mov_b64 v[32:33], 0
    v_mov_b64 v[34:35], 0
    v_mov_b64 v[36:37], 0
    v_mov_b64 v[38:39], 0
    v_mov_b64 v[40:41], 0
    v_mov_b64 v[42:43], 0
    v_mov_b64 v[44:45], 0
    v_mov_b64 v[46:47], 0
    v_mov_b64 v[48:49], 0
    v_mov_b64 v[50:51], 0
    v_mov_b64 v[52:53], 0
    v_mov_b64 v[54:55], 0
    v_mov_b64 v[56:57], 0
    v_mov_b64 v[58:59], 0
    v_mov_b64 v[60:61], 0
    v_mov_b64 v[62:63], 0
    s_waitcnt lgkmcnt(0)
    v_mfma_f32_16x16x32_bf16 v[128:131], a[64:67], a[0:3], 0
    s_add_u32 m0, s16, 98304
    s_mov_b32 s35, 98304
    v_mov_b64 v[64:65], 0
    v_mfma_f32_16x16x32_bf16 v[128:131], a[68:71], a[4:7], v[128:131]
    buffer_load_dwordx4 v225, s[68:71], s35 offen offset:0 lds
    v_mfma_f32_16x16x32_bf16 v[128:131], a[72:75], a[8:11], v[128:131]
    v_mov_b64 v[66:67], 0
    v_mov_b64 v[68:69], 0
    v_mfma_f32_16x16x32_bf16 v[128:131], a[76:79], a[12:15], v[128:131]
    buffer_load_dwordx4 v225, s[68:71], s35 offen offset:1024 lds
    v_mfma_f32_16x16x32_bf16 v[136:139], a[76:79], a[28:31], 0
    v_mov_b64 v[70:71], 0
    v_mov_b64 v[72:73], 0
    v_mfma_f32_16x16x32_bf16 v[136:139], a[72:75], a[24:27], v[136:139]
    v_mov_b64 v[74:75], 0
    v_mov_b64 v[76:77], 0
    v_mfma_f32_16x16x32_bf16 v[136:139], a[68:71], a[20:23], v[136:139]
    buffer_load_dwordx4 v225, s[68:71], s35 offen offset:2048 lds
    v_mfma_f32_16x16x32_bf16 v[136:139], a[64:67], a[16:19], v[136:139]
    v_mov_b64 v[78:79], 0
    v_mov_b64 v[80:81], 0
    v_mfma_f32_16x16x32_bf16 v[140:143], a[80:83], a[16:19], 0
    v_mov_b64 v[82:83], 0
    v_mov_b64 v[84:85], 0
    v_mfma_f32_16x16x32_bf16 v[140:143], a[84:87], a[20:23], v[140:143]
    buffer_load_dwordx4 v225, s[68:71], s35 offen offset:3072 lds
    v_mfma_f32_16x16x32_bf16 v[140:143], a[88:91], a[24:27], v[140:143]
    v_mov_b64 v[86:87], 0
    v_mov_b64 v[88:89], 0
    v_mfma_f32_16x16x32_bf16 v[140:143], a[92:95], a[28:31], v[140:143]
    v_mov_b64 v[90:91], 0
    v_mov_b64 v[92:93], 0
    v_mfma_f32_16x16x32_bf16 v[132:135], a[92:95], a[12:15], 0
    s_add_u32 m0, s16, 114688
    s_mov_b32 s35, 114688
    v_mov_b64 v[94:95], 0
    v_mfma_f32_16x16x32_bf16 v[132:135], a[88:91], a[8:11], v[132:135]
    buffer_load_dwordx4 v225, s[68:71], s35 offen offset:0 lds
    v_mfma_f32_16x16x32_bf16 v[132:135], a[84:87], a[4:7], v[132:135]
    v_mov_b64 v[96:97], 0
    v_mov_b64 v[98:99], 0
    v_mfma_f32_16x16x32_bf16 v[132:135], a[80:83], a[0:3], v[132:135]
    buffer_load_dwordx4 v225, s[68:71], s35 offen offset:1024 lds
    v_mov_b64 v[100:101], 0
    v_mov_b64 v[102:103], 0
    v_mov_b64 v[104:105], 0
    v_mov_b64 v[106:107], 0
    v_mov_b64 v[108:109], 0
    v_mov_b64 v[110:111], 0
    v_mov_b64 v[112:113], 0
    v_mov_b64 v[114:115], 0
    v_mov_b64 v[116:117], 0
    v_mov_b64 v[118:119], 0
    v_mov_b64 v[120:121], 0
    v_mov_b64 v[122:123], 0
    v_mov_b64 v[124:125], 0
    v_mov_b64 v[126:127], 0
    v_mfma_f32_16x16x32_bf16 v[144:147], a[64:67], a[32:35], 0
    v_mfma_f32_16x16x32_bf16 v[144:147], a[68:71], a[36:39], v[144:147]
    v_mfma_f32_16x16x32_bf16 v[144:147], a[72:75], a[40:43], v[144:147]
    buffer_load_dwordx4 v225, s[68:71], s35 offen offset:2048 lds
    v_mfma_f32_16x16x32_bf16 v[144:147], a[76:79], a[44:47], v[144:147]
    v_max3_f32 v248, v128, v129, v130
    v_max3_f32 v248, v248, v131, v132
    v_mfma_f32_16x16x32_bf16 v[152:155], a[76:79], a[60:63], 0
    ds_read_b128 a[76:79], v244 offset:3072
    v_max3_f32 v248, v248, v133, v134
    v_mfma_f32_16x16x32_bf16 v[152:155], a[72:75], a[56:59], v[152:155]
    buffer_load_dwordx4 v225, s[68:71], s35 offen offset:3072 lds
    v_mfma_f32_16x16x32_bf16 v[152:155], a[68:71], a[52:55], v[152:155]
    ds_read_b128 a[72:75], v244 offset:2048
    ds_read_b128 a[68:71], v244 offset:1024
    v_mfma_f32_16x16x32_bf16 v[152:155], a[64:67], a[48:51], v[152:155]
    ds_read_b128 a[64:67], v244 offset:0
    v_max_f32 v248, v248, v135
    v_mfma_f32_16x16x32_bf16 v[156:159], a[80:83], a[48:51], 0
    s_add_u32 m0, s16, 131072
    s_mov_b32 s35, 131072
    v_max3_f32 v249, v136, v137, v138
    v_mfma_f32_16x16x32_bf16 v[156:159], a[84:87], a[52:55], v[156:159]
    buffer_load_dwordx4 v225, s[68:71], s35 offen offset:0 lds
    v_mfma_f32_16x16x32_bf16 v[156:159], a[88:91], a[56:59], v[156:159]
    v_max3_f32 v249, v249, v139, v140
    v_max3_f32 v249, v249, v141, v142
    v_mfma_f32_16x16x32_bf16 v[156:159], a[92:95], a[60:63], v[156:159]
    buffer_load_dwordx4 v225, s[68:71], s35 offen offset:1024 lds
    v_mfma_f32_16x16x32_bf16 v[148:151], a[92:95], a[44:47], 0
    ds_read_b128 a[92:95], v244 offset:7168
    v_max_f32 v249, v249, v143
    v_mfma_f32_16x16x32_bf16 v[148:151], a[88:91], a[40:43], v[148:151]
    ds_read_b128 a[88:91], v244 offset:6144
    v_mov_b32 v250, v248
    v_mfma_f32_16x16x32_bf16 v[148:151], a[84:87], a[36:39], v[148:151]
    buffer_load_dwordx4 v225, s[68:71], s35 offen offset:2048 lds
    v_mfma_f32_16x16x32_bf16 v[148:151], a[80:83], a[32:35], v[148:151]
    ds_read_b128 a[84:87], v244 offset:5120
    ds_read_b128 a[80:83], v244 offset:4096
    buffer_load_dwordx4 v225, s[68:71], s35 offen offset:3072 lds
    v_mov_b32 v251, v249
    s_nop 0
    v_permlane16_swap_b32 v250, v248
    v_permlane16_swap_b32 v251, v249
    v_max_f32 v248, v248, v250
    v_max_f32 v249, v249, v251
    v_mov_b32 v250, v248
    v_mov_b32 v251, v249
    s_nop 0
    v_permlane32_swap_b32 v250, v248
    v_permlane32_swap_b32 v251, v249
    v_max_f32 v248, v248, v250
    v_max_f32 v249, v249, v251
    v_cndmask_b32 v248, v248, v220, s[92:93]
    v_cndmask_b32 v249, v249, v221, s[92:93]
    v_sub_f32 v176, 0, v248
    v_sub_f32 v177, 0, v248
    v_mov_b64 v[178:179], v[176:177]
    v_mov_b64 v[180:181], v[176:177]
    v_mov_b64 v[182:183], v[176:177]
    v_sub_f32 v184, 0, v249
    v_sub_f32 v185, 0, v249
    v_mov_b64 v[186:187], v[184:185]
    v_mov_b64 v[188:189], v[184:185]
    v_mov_b64 v[190:191], v[184:185]
    s_cmp_eq_u32 s32, 0
    s_cbranch_scc1 L_MASK_P0
L_MRET_P0:
    v_pk_add_f32 v[128:129], v[128:129], v[176:177]
    v_pk_add_f32 v[130:131], v[130:131], v[178:179]
    v_pk_add_f32 v[132:133], v[132:133], v[180:181]
    v_pk_add_f32 v[134:135], v[134:135], v[182:183]
    v_pk_add_f32 v[136:137], v[136:137], v[184:185]
    v_pk_add_f32 v[138:139], v[138:139], v[186:187]
    v_pk_add_f32 v[140:141], v[140:141], v[188:189]
    v_pk_add_f32 v[142:143], v[142:143], v[190:191]
    v_max3_f32 v248, v144, v145, v146
    v_max3_f32 v248, v248, v147, v148
    v_max3_f32 v248, v248, v149, v150
    v_max_f32 v248, v248, v151
    v_max3_f32 v249, v152, v153, v154
    v_max3_f32 v249, v249, v155, v156
    v_max3_f32 v249, v249, v157, v158
    v_max_f32 v249, v249, v159
    v_mov_b32 v250, v248
    v_mov_b32 v251, v249
    s_nop 0
    v_permlane16_swap_b32 v250, v248
    v_permlane16_swap_b32 v251, v249
    v_max_f32 v248, v248, v250
    v_max_f32 v249, v249, v251
    v_mov_b32 v250, v248
    v_mov_b32 v251, v249
    s_nop 0
    v_permlane32_swap_b32 v250, v248
    v_permlane32_swap_b32 v251, v249
    v_max_f32 v248, v248, v250
    v_max_f32 v249, v249, v251
    v_cndmask_b32 v248, v248, v222, s[92:93]
    v_cndmask_b32 v249, v249, v223, s[92:93]
    v_sub_f32 v192, 0, v248
    v_sub_f32 v193, 0, v248
    v_mov_b64 v[194:195], v[192:193]
    v_mov_b64 v[196:197], v[192:193]
    v_mov_b64 v[198:199], v[192:193]
    v_sub_f32 v200, 0, v249
    v_sub_f32 v201, 0, v249
    v_mov_b64 v[202:203], v[200:201]
    v_mov_b64 v[204:205], v[200:201]
    v_mov_b64 v[206:207], v[200:201]
    v_exp_f32 v128, v128
    v_exp_f32 v129, v129
    v_exp_f32 v130, v130
    v_add_f32 v212, v212, v128
    v_exp_f32 v131, v131
    v_add_f32 v212, v212, v129
    v_cvt_pk_bf16_f32 v160, v128, v129
    v_exp_f32 v132, v132
    v_add_f32 v212, v212, v130
    v_exp_f32 v133, v133
    v_add_f32 v212, v212, v131
    v_cvt_pk_bf16_f32 v161, v130, v131
    v_exp_f32 v134, v134
    v_add_f32 v212, v212, v132
    v_exp_f32 v135, v135
    v_add_f32 v212, v212, v133
    v_cvt_pk_bf16_f32 v162, v132, v133
    v_exp_f32 v136, v136
    v_add_f32 v212, v212, v134
    v_exp_f32 v137, v137
    v_add_f32 v212, v212, v135
    v_cvt_pk_bf16_f32 v163, v134, v135
    v_exp_f32 v138, v138
    v_add_f32 v214, v214, v136
    v_exp_f32 v139, v139
    v_add_f32 v214, v214, v137
    v_cvt_pk_bf16_f32 v164, v136, v137
    v_exp_f32 v140, v140
    v_add_f32 v214, v214, v138
    v_exp_f32 v141, v141
    v_add_f32 v214, v214, v139
    v_cvt_pk_bf16_f32 v165, v138, v139
    v_exp_f32 v142, v142
    v_add_f32 v214, v214, v140
    v_exp_f32 v143, v143
    v_add_f32 v214, v214, v141
    v_cvt_pk_bf16_f32 v166, v140, v141
    v_pk_add_f32 v[144:145], v[144:145], v[192:193]
    v_pk_add_f32 v[146:147], v[146:147], v[194:195]
    v_pk_add_f32 v[148:149], v[148:149], v[196:197]
    v_pk_add_f32 v[150:151], v[150:151], v[198:199]
    v_pk_add_f32 v[152:153], v[152:153], v[200:201]
    v_pk_add_f32 v[154:155], v[154:155], v[202:203]
    v_pk_add_f32 v[156:157], v[156:157], v[204:205]
    v_pk_add_f32 v[158:159], v[158:159], v[206:207]
    v_add_f32 v214, v214, v142
    v_add_f32 v214, v214, v143
    v_cvt_pk_bf16_f32 v167, v142, v143
    s_cmp_eq_u32 s32, 1
    s_cbranch_scc1 L_MASK_P1
L_MRET_P1:
    s_mov_b32 s38, s32
    s_cmp_eq_u32 s32, 0
    s_cbranch_scc1 L_T1
.p2align 3
L_C:
    s_waitcnt lgkmcnt(0)
    v_mfma_f32_16x16x32_bf16 v[128:131], a[64:67], a[0:3], v[176:179]
    v_exp_f32 v144, v144
    v_mfma_f32_16x16x32_bf16 v[128:131], a[68:71], a[4:7], v[128:131]
    s_waitcnt vmcnt(12)
    s_barrier
    ds_read_b128 a[96:99], v244 offset:8192
    v_add_f32 v216, v216, v144
    v_mfma_f32_16x16x32_bf16 v[128:131], a[72:75], a[8:11], v[128:131]
    s_add_u32 s10, m0, 16384
    v_exp_f32 v145, v145
    v_mfma_f32_16x16x32_bf16 v[128:131], a[76:79], a[12:15], v[128:131]
    s_sub_u32 m0, m0, 147456
    ds_read_b128 a[100:103], v244 offset:9216
    v_add_f32 v216, v216, v145
    v_cvt_pk_bf16_f32 v168, v144, v145
    v_mfma_f32_16x16x32_bf16 v[136:139], a[76:79], a[28:31], v[184:187]
    s_min_u32 m0, m0, s10
    v_exp_f32 v146, v146
    v_mfma_f32_16x16x32_bf16 v[136:139], a[72:75], a[24:27], v[136:139]
    s_add_u32 s35, s35, 16384
    ds_read_b128 a[104:107], v244 offset:10240
    v_add_f32 v216, v216, v146
    v_mfma_f32_16x16x32_bf16 v[136:139], a[68:71], a[20:23], v[136:139]
    v_exp_f32 v147, v147
    v_mfma_f32_16x16x32_bf16 v[136:139], a[64:67], a[16:19], v[136:139]
    ds_read_b128 a[108:111], v244 offset:11264
    buffer_load_dwordx4 v225, s[68:71], s35 offen offset:0 lds
    v_add_f32 v216, v216, v147
    v_mfma_f32_16x16x32_bf16 v[140:143], a[80:83], a[16:19], v[188:191]
    v_exp_f32 v148, v148
    v_mfma_f32_16x16x32_bf16 v[140:143], a[84:87], a[20:23], v[140:143]
    ds_read_b128 a[112:115], v244 offset:12288
    v_add_f32 v216, v216, v148
    v_cvt_pk_bf16_f32 v169, v146, v147
    v_mfma_f32_16x16x32_bf16 v[140:143], a[88:91], a[24:27], v[140:143]
    v_exp_f32 v149, v149
    v_mfma_f32_16x16x32_bf16 v[140:143], a[92:95], a[28:31], v[140:143]
    ds_read_b128 a[116:119], v244 offset:13312
    v_add_f32 v216, v216, v149
    v_cvt_pk_bf16_f32 v170, v148, v149
    v_mfma_f32_16x16x32_bf16 v[132:135], a[92:95], a[12:15], v[180:183]
    v_exp_f32 v150, v150
    v_mfma_f32_16x16x32_bf16 v[132:135], a[88:91], a[8:11], v[132:135]
    ds_read_b128 a[120:123], v244 offset:14336
    buffer_load_dwordx4 v225, s[68:71], s35 offen offset:1024 lds
    v_add_f32 v216, v216, v150
    v_mfma_f32_16x16x32_bf16 v[132:135], a[84:87], a[4:7], v[132:135]
    v_exp_f32 v151, v151
    v_mfma_f32_16x16x32_bf16 v[132:135], a[80:83], a[0:3], v[132:135]
    s_waitcnt lgkmcnt(3)
    ds_read_b128 a[124:127], v244 offset:15360
    v_add_f32 v216, v216, v151
    v_cvt_pk_bf16_f32 v171, v150, v151
    v_mfma_f32_16x16x32_bf16 v[0:3], a[96:99], v[160:163], v[0:3]
    s_add_u32 s11, s36, 16384
    v_exp_f32 v152, v152
    v_mfma_f32_16x16x32_bf16 v[32:35], a[96:99], v[164:167], v[32:35]
    s_sub_u32 s36, s11, 163840
    v_add_f32 v218, v218, v152
    v_mfma_f32_16x16x32_bf16 v[36:39], a[100:103], v[164:167], v[36:39]
    s_min_u32 s36, s36, s11
    v_exp_f32 v153, v153
    v_mfma_f32_16x16x32_bf16 v[4:7], a[100:103], v[160:163], v[4:7]
    buffer_load_dwordx4 v225, s[68:71], s35 offen offset:2048 lds
    v_add_f32 v218, v218, v153
    v_add_u32 v244, s36, v224
    v_mfma_f32_16x16x32_bf16 v[8:11], a[104:107], v[160:163], v[8:11]
    v_exp_f32 v154, v154
    v_mfma_f32_16x16x32_bf16 v[40:43], a[104:107], v[164:167], v[40:43]
    v_add_f32 v218, v218, v154
    v_cvt_pk_bf16_f32 v172, v152, v153
    v_mfma_f32_16x16x32_bf16 v[44:47], a[108:111], v[164:167], v[44:47]
    v_exp_f32 v155, v155
    v_mfma_f32_16x16x32_bf16 v[12:15], a[108:111], v[160:163], v[12:15]
    s_waitcnt lgkmcnt(0)
    v_add_f32 v218, v218, v155
    v_cvt_pk_bf16_f32 v173, v154, v155
    v_mfma_f32_16x16x32_bf16 v[16:19], a[112:115], v[160:163], v[16:19]
    v_exp_f32 v156, v156
    v_mfma_f32_16x16x32_bf16 v[48:51], a[112:115], v[164:167], v[48:51]
    buffer_load_dwordx4 v225, s[68:71], s35 offen offset:3072 lds
    v_add_f32 v218, v218, v156
    v_mfma_f32_16x16x32_bf16 v[52:55], a[116:119], v[164:167], v[52:55]
    v_exp_f32 v157, v157
    v_mfma_f32_16x16x32_bf16 v[20:23], a[116:119], v[160:163], v[20:23]
    v_add_f32 v218, v218, v157
    v_cvt_pk_bf16_f32 v174, v156, v157
    v_mfma_f32_16x16x32_bf16 v[24:27], a[120:123], v[160:163], v[24:27]
    v_exp_f32 v158, v158
    v_mfma_f32_16x16x32_bf16 v[56:59], a[120:123], v[164:167], v[56:59]
    v_add_f32 v218, v218, v158
    v_mfma_f32_16x16x32_bf16 v[60:63], a[124:127], v[164:167], v[60:63]
    v_exp_f32 v159, v159
    v_mfma_f32_16x16x32_bf16 v[28:31], a[124:127], v[160:163], v[28:31]
    v_add_f32 v218, v218, v159
    v_cvt_pk_bf16_f32 v175, v158, v159
    v_mfma_f32_16x16x32_bf16 v[144:147], a[64:67], a[32:35], v[192:195]
    v_exp_f32 v128, v128
    v_mfma_f32_16x16x32_bf16 v[144:147], a[68:71], a[36:39], v[144:147]
    v_add_f32 v212, v212, v128
    v_mfma_f32_16x16x32_bf16 v[144:147], a[72:75], a[40:43], v[144:147]
    v_exp_f32 v129, v129
    v_mfma_f32_16x16x32_bf16 v[144:147], a[76:79], a[44:47], v[144:147]
    v_add_f32 v212, v212, v129
    v_cvt_pk_bf16_f32 v160, v128, v129
    v_mfma_f32_16x16x32_bf16 v[152:155], a[76:79], a[60:63], v[200:203]
    v_exp_f32 v130, v130
    v_mfma_f32_16x16x32_bf16 v[152:155], a[72:75], a[56:59], v[152:155]
    ds_read_b128 a[76:79], v244 offset:3072
    v_add_f32 v212, v212, v130
    v_mfma_f32_16x16x32_bf16 v[152:155], a[68:71], a[52:55], v[152:155]
    v_exp_f32 v131, v131
    v_mfma_f32_16x16x32_bf16 v[152:155], a[64:67], a[48:51], v[152:155]
    ds_read_b128 a[72:75], v244 offset:2048
    v_add_f32 v212, v212, v131
    v_mfma_f32_16x16x32_bf16 v[156:159], a[80:83], a[48:51], v[204:207]
    v_exp_f32 v132, v132
    v_mfma_f32_16x16x32_bf16 v[156:159], a[84:87], a[52:55], v[156:159]
    ds_read_b128 a[68:71], v244 offset:1024
    v_add_f32 v212, v212, v132
    v_mfma_f32_16x16x32_bf16 v[156:159], a[88:91], a[56:59], v[156:159]
    v_exp_f32 v133, v133
    v_mfma_f32_16x16x32_bf16 v[156:159], a[92:95], a[60:63], v[156:159]
    ds_read_b128 a[64:67], v244 offset:0
    v_add_f32 v212, v212, v133
    v_mfma_f32_16x16x32_bf16 v[148:151], a[92:95], a[44:47], v[196:199]
    v_exp_f32 v134, v134
    v_mfma_f32_16x16x32_bf16 v[148:151], a[88:91], a[40:43], v[148:151]
    v_add_f32 v212, v212, v134
    v_cvt_pk_bf16_f32 v161, v130, v131
    v_mfma_f32_16x16x32_bf16 v[148:151], a[84:87], a[36:39], v[148:151]
    v_exp_f32 v135, v135
    v_mfma_f32_16x16x32_bf16 v[148:151], a[80:83], a[32:35], v[148:151]
    ds_read_b128 a[92:95], v244 offset:7168
    v_add_f32 v212, v212, v135
    v_mfma_f32_16x16x32_bf16 v[64:67], a[96:99], v[168:171], v[64:67]
    v_exp_f32 v136, v136
    v_mfma_f32_16x16x32_bf16 v[96:99], a[96:99], v[172:175], v[96:99]
    v_add_f32 v214, v214, v136
    v_cvt_pk_bf16_f32 v162, v132, v133
    v_mfma_f32_16x16x32_bf16 v[100:103], a[100:103], v[172:175], v[100:103]
    v_exp_f32 v137, v137
    v_mfma_f32_16x16x32_bf16 v[68:71], a[100:103], v[168:171], v[68:71]
    ds_read_b128 a[88:91], v244 offset:6144
    v_add_f32 v214, v214, v137
    v_mfma_f32_16x16x32_bf16 v[72:75], a[104:107], v[168:171], v[72:75]
    v_exp_f32 v138, v138
    v_mfma_f32_16x16x32_bf16 v[104:107], a[104:107], v[172:175], v[104:107]
    ds_read_b128 a[84:87], v244 offset:5120
    v_add_f32 v214, v214, v138
    v_cvt_pk_bf16_f32 v163, v134, v135
    v_mfma_f32_16x16x32_bf16 v[108:111], a[108:111], v[172:175], v[108:111]
    v_exp_f32 v139, v139
    v_mfma_f32_16x16x32_bf16 v[76:79], a[108:111], v[168:171], v[76:79]
    ds_read_b128 a[80:83], v244 offset:4096
    v_add_f32 v214, v214, v139
    v_mfma_f32_16x16x32_bf16 v[80:83], a[112:115], v[168:171], v[80:83]
    v_exp_f32 v140, v140
    v_mfma_f32_16x16x32_bf16 v[112:115], a[112:115], v[172:175], v[112:115]
    v_add_f32 v214, v214, v140
    v_cvt_pk_bf16_f32 v164, v136, v137
    v_mfma_f32_16x16x32_bf16 v[116:119], a[116:119], v[172:175], v[116:119]
    s_sub_u32 s38, s38, 1
    v_exp_f32 v141, v141
    v_mfma_f32_16x16x32_bf16 v[84:87], a[116:119], v[168:171], v[84:87]
    s_cmp_eq_u32 s38, 1
    s_cbranch_scc1 L_MASK_C
L_MRET_C:
    v_add_f32 v214, v214, v141
    v_mfma_f32_16x16x32_bf16 v[88:91], a[120:123], v[168:171], v[88:91]
    v_exp_f32 v142, v142
    v_mfma_f32_16x16x32_bf16 v[120:123], a[120:123], v[172:175], v[120:123]
    v_add_f32 v214, v214, v142
    v_cvt_pk_bf16_f32 v165, v138, v139
    v_mfma_f32_16x16x32_bf16 v[124:127], a[124:127], v[172:175], v[124:127]
    v_exp_f32 v143, v143
    v_mfma_f32_16x16x32_bf16 v[92:95], a[124:127], v[168:171], v[92:95]
    v_add_f32 v214, v214, v143
    v_cvt_pk_bf16_f32 v166, v140, v141
    v_cvt_pk_bf16_f32 v167, v142, v143
    s_cmp_lg_u32 s38, 0
    s_cbranch_scc1 L_C
L_T1:
    s_cmp_eq_u32 s32, 31
    s_cbranch_scc1 L_MASK_T
L_MRET_T:
    s_add_u32 s11, s36, 16384
    s_sub_u32 s37, s11, 163840
    s_min_u32 s37, s37, s11
    v_add_u32 v238, s37, v224
    s_waitcnt lgkmcnt(0)
    v_mfma_f32_16x16x32_bf16 v[128:131], a[64:67], a[32:35], v[192:195]
    v_exp_f32 v144, v144
    v_mfma_f32_16x16x32_bf16 v[128:131], a[68:71], a[36:39], v[128:131]
    s_waitcnt vmcnt(12)
    s_barrier
    ds_read_b128 a[96:99], v244 offset:8192
    v_mfma_f32_16x16x32_bf16 v[128:131], a[72:75], a[40:43], v[128:131]
    s_add_u32 s10, m0, 16384
    v_exp_f32 v145, v145
    v_mfma_f32_16x16x32_bf16 v[128:131], a[76:79], a[44:47], v[128:131]
    s_sub_u32 m0, m0, 147456
    ds_read_b128 a[100:103], v244 offset:9216
    ds_read_b128 a[104:107], v244 offset:10240
    v_mfma_f32_16x16x32_bf16 v[136:139], a[76:79], a[60:63], v[200:203]
    s_min_u32 m0, m0, s10
    v_exp_f32 v146, v146
    v_mfma_f32_16x16x32_bf16 v[136:139], a[72:75], a[56:59], v[136:139]
    s_add_u32 s35, s35, 16384
    ds_read_b128 a[108:111], v244 offset:11264
    ds_read_b128 a[112:115], v244 offset:12288
    v_mfma_f32_16x16x32_bf16 v[136:139], a[68:71], a[52:55], v[136:139]
    v_exp_f32 v147, v147
    v_mfma_f32_16x16x32_bf16 v[136:139], a[64:67], a[48:51], v[136:139]
    ds_read_b128 a[116:119], v244 offset:13312
    ds_read_b128 a[120:123], v244 offset:14336
    v_mfma_f32_16x16x32_bf16 v[140:143], a[80:83], a[48:51], v[204:207]
    buffer_load_dwordx4 v225, s[68:71], s35 offen offset:0 lds
    v_exp_f32 v148, v148
    v_mfma_f32_16x16x32_bf16 v[140:143], a[84:87], a[52:55], v[140:143]
    ds_read_b128 a[124:127], v244 offset:15360
    ds_read_b128 a[76:79], v238 offset:3072
    v_cvt_pk_bf16_f32 v168, v144, v145
    v_mfma_f32_16x16x32_bf16 v[140:143], a[88:91], a[56:59], v[140:143]
    v_exp_f32 v149, v149
    v_mfma_f32_16x16x32_bf16 v[140:143], a[92:95], a[60:63], v[140:143]
    ds_read_b128 a[72:75], v238 offset:2048
    ds_read_b128 a[68:71], v238 offset:1024
    v_mfma_f32_16x16x32_bf16 v[132:135], a[92:95], a[44:47], v[196:199]
    v_exp_f32 v150, v150
    v_mfma_f32_16x16x32_bf16 v[132:135], a[88:91], a[40:43], v[132:135]
    ds_read_b128 a[64:67], v238 offset:0
    v_cvt_pk_bf16_f32 v169, v146, v147
    v_mfma_f32_16x16x32_bf16 v[132:135], a[84:87], a[36:39], v[132:135]
    buffer_load_dwordx4 v225, s[68:71], s35 offen offset:1024 lds
    v_exp_f32 v151, v151
    v_mfma_f32_16x16x32_bf16 v[132:135], a[80:83], a[32:35], v[132:135]
    s_waitcnt lgkmcnt(8)
    ds_read_b128 a[92:95], v238 offset:7168
    ds_read_b128 a[88:91], v238 offset:6144
    v_mfma_f32_16x16x32_bf16 v[0:3], a[96:99], v[160:163], v[0:3]
    v_exp_f32 v152, v152
    v_mfma_f32_16x16x32_bf16 v[32:35], a[96:99], v[164:167], v[32:35]
    ds_read_b128 a[84:87], v238 offset:5120
    v_cvt_pk_bf16_f32 v170, v148, v149
    v_mfma_f32_16x16x32_bf16 v[36:39], a[100:103], v[164:167], v[36:39]
    v_exp_f32 v153, v153
    v_mfma_f32_16x16x32_bf16 v[4:7], a[100:103], v[160:163], v[4:7]
    buffer_load_dwordx4 v225, s[68:71], s35 offen offset:2048 lds
    v_mfma_f32_16x16x32_bf16 v[8:11], a[104:107], v[160:163], v[8:11]
    v_exp_f32 v154, v154
    v_mfma_f32_16x16x32_bf16 v[40:43], a[104:107], v[164:167], v[40:43]
    ds_read_b128 a[80:83], v238 offset:4096
    v_cvt_pk_bf16_f32 v171, v150, v151
    v_mfma_f32_16x16x32_bf16 v[44:47], a[108:111], v[164:167], v[44:47]
    v_exp_f32 v155, v155
    v_mfma_f32_16x16x32_bf16 v[12:15], a[108:111], v[160:163], v[12:15]
    s_waitcnt lgkmcnt(8)
    v_cvt_pk_bf16_f32 v172, v152, v153
    v_cvt_pk_bf16_f32 v173, v154, v155
    v_mfma_f32_16x16x32_bf16 v[16:19], a[112:115], v[160:163], v[16:19]
    v_exp_f32 v156, v156
    v_mfma_f32_16x16x32_bf16 v[48:51], a[112:115], v[164:167], v[48:51]
    buffer_load_dwordx4 v225, s[68:71], s35 offen offset:3072 lds
    v_mfma_f32_16x16x32_bf16 v[52:55], a[116:119], v[164:167], v[52:55]
    v_exp_f32 v157, v157
    v_mfma_f32_16x16x32_bf16 v[20:23], a[116:119], v[160:163], v[20:23]
    v_lshlrev_b32 v255, 3, v224
    v_subrev_u32 v247, 4608, v255
    v_mfma_f32_16x16x32_bf16 v[24:27], a[120:123], v[160:163], v[24:27]
    v_exp_f32 v158, v158
    v_mfma_f32_16x16x32_bf16 v[56:59], a[120:123], v[164:167], v[56:59]
    v_not_b32 v247, v247
    v_cvt_pk_bf16_f32 v174, v156, v157
    v_mfma_f32_16x16x32_bf16 v[60:63], a[124:127], v[164:167], v[60:63]
    s_lshl_b32 s93, s2, 2
    v_exp_f32 v159, v159
    v_and_b32 v247, 0x80000000, v247
    v_or_b32 v255, v255, v247
    s_add_u32 s93, s93, s3
    s_mul_i32 s93, s93, 4608
    buffer_load_dword v247, v255, s[76:79], s93 offen offset:0
    v_mfma_f32_16x16x32_bf16 v[28:31], a[124:127], v[160:163], v[28:31]
    v_cvt_pk_bf16_f32 v175, v158, v159
    s_waitcnt lgkmcnt(0)
    s_sub_u32 s38, 31, s32
    s_sub_u32 s34, 3, s3
    s_cmp_eq_u32 s34, 0
    s_cbranch_scc1 L_S1
.p2align 3
L_S0:
    s_waitcnt lgkmcnt(8)
    v_mfma_f32_16x16x32_bf16 v[144:147], a[64:67], a[32:35], v[192:195]
    s_add_u32 s11, s36, 32768
    v_exp_f32 v128, v128
    v_mfma_f32_16x16x32_bf16 v[144:147], a[68:71], a[36:39], v[144:147]
    s_sub_u32 s36, s11, 163840
    v_mfma_f32_16x16x32_bf16 v[144:147], a[72:75], a[40:43], v[144:147]
    s_min_u32 s36, s36, s11
    v_exp_f32 v129, v129
    v_mfma_f32_16x16x32_bf16 v[144:147], a[76:79], a[44:47], v[144:147]
    v_add_u32 v244, s36, v224
    v_cvt_pk_bf16_f32 v160, v128, v129
    v_mfma_f32_16x16x32_bf16 v[152:155], a[76:79], a[60:63], v[200:203]
    v_exp_f32 v130, v130
    v_mfma_f32_16x16x32_bf16 v[152:155], a[72:75], a[56:59], v[152:155]
    ds_read_b128 a[76:79], v244 offset:3072
    ds_read_b128 a[72:75], v244 offset:2048
    v_mfma_f32_16x16x32_bf16 v[152:155], a[68:71], a[52:55], v[152:155]
    v_exp_f32 v131, v131
    v_mfma_f32_16x16x32_bf16 v[152:155], a[64:67], a[48:51], v[152:155]
    ds_read_b128 a[68:71], v244 offset:1024
    ds_read_b128 a[64:67], v244 offset:0
    v_mfma_f32_16x16x32_bf16 v[156:159], a[80:83], a[48:51], v[204:207]
    v_exp_f32 v132, v132
    v_mfma_f32_16x16x32_bf16 v[156:159], a[84:87], a[52:55], v[156:159]
    v_cvt_pk_bf16_f32 v161, v130, v131
    v_mfma_f32_16x16x32_bf16 v[156:159], a[88:91], a[56:59], v[156:159]
    v_exp_f32 v133, v133
    v_mfma_f32_16x16x32_bf16 v[156:159], a[92:95], a[60:63], v[156:159]
    v_cvt_pk_bf16_f32 v162, v132, v133
    v_mfma_f32_16x16x32_bf16 v[148:151], a[92:95], a[44:47], v[196:199]
    v_exp_f32 v134, v134
    v_mfma_f32_16x16x32_bf16 v[148:151], a[88:91], a[40:43], v[148:151]
    ds_read_b128 a[92:95], v244 offset:7168
    ds_read_b128 a[88:91], v244 offset:6144
    v_mfma_f32_16x16x32_bf16 v[148:151], a[84:87], a[36:39], v[148:151]
    v_exp_f32 v135, v135
    v_mfma_f32_16x16x32_bf16 v[148:151], a[80:83], a[32:35], v[148:151]
    s_waitcnt lgkmcnt(6)
    ds_read_b128 a[84:87], v244 offset:5120
    ds_read_b128 a[80:83], v244 offset:4096
    v_mfma_f32_16x16x32_bf16 v[64:67], a[96:99], v[168:171], v[64:67]
    v_exp_f32 v136, v136
    v_mfma_f32_16x16x32_bf16 v[96:99], a[96:99], v[172:175], v[96:99]
    ds_read_b128 a[96:99], v238 offset:8192
    v_cvt_pk_bf16_f32 v163, v134, v135
    v_mfma_f32_16x16x32_bf16 v[100:103], a[100:103], v[172:175], v[100:103]
    v_exp_f32 v137, v137
    v_mfma_f32_16x16x32_bf16 v[68:71], a[100:103], v[168:171], v[68:71]
    ds_read_b128 a[100:103], v238 offset:9216
    v_cvt_pk_bf16_f32 v164, v136, v137
    v_mfma_f32_16x16x32_bf16 v[72:75], a[104:107], v[168:171], v[72:75]
    v_exp_f32 v138, v138
    v_mfma_f32_16x16x32_bf16 v[104:107], a[104:107], v[172:175], v[104:107]
    ds_read_b128 a[104:107], v238 offset:10240
    v_mfma_f32_16x16x32_bf16 v[108:111], a[108:111], v[172:175], v[108:111]
    v_exp_f32 v139, v139
    v_mfma_f32_16x16x32_bf16 v[76:79], a[108:111], v[168:171], v[76:79]
    ds_read_b128 a[108:111], v238 offset:11264
    v_cvt_pk_bf16_f32 v165, v138, v139
    v_mfma_f32_16x16x32_bf16 v[80:83], a[112:115], v[168:171], v[80:83]
    v_exp_f32 v140, v140
    v_mfma_f32_16x16x32_bf16 v[112:115], a[112:115], v[172:175], v[112:115]
    ds_read_b128 a[112:115], v238 offset:12288
    v_mfma_f32_16x16x32_bf16 v[116:119], a[116:119], v[172:175], v[116:119]
    v_exp_f32 v141, v141
    v_mfma_f32_16x16x32_bf16 v[84:87], a[116:119], v[168:171], v[84:87]
    ds_read_b128 a[116:119], v238 offset:13312
    v_cvt_pk_bf16_f32 v166, v140, v141
    v_mfma_f32_16x16x32_bf16 v[88:91], a[120:123], v[168:171], v[88:91]
    s_cmp_eq_u32 s38, 1
    v_exp_f32 v142, v142
    v_mfma_f32_16x16x32_bf16 v[120:123], a[120:123], v[172:175], v[120:123]
    s_cbranch_scc1 L_MASK_S0
L_MRET_S0:
    ds_read_b128 a[120:123], v238 offset:14336
    v_mfma_f32_16x16x32_bf16 v[124:127], a[124:127], v[172:175], v[124:127]
    v_exp_f32 v143, v143
    v_mfma_f32_16x16x32_bf16 v[92:95], a[124:127], v[168:171], v[92:95]
    ds_read_b128 a[124:127], v238 offset:15360
    v_cvt_pk_bf16_f32 v167, v142, v143
    v_mfma_f32_16x16x32_bf16 v[230:233], a[228:231], v[168:171], v[230:233]
    v_mfma_f32_16x16x32_bf16 v[234:237], a[228:231], v[172:175], v[234:237]
    s_waitcnt lgkmcnt(8)
    v_mfma_f32_16x16x32_bf16 v[128:131], a[64:67], a[32:35], v[192:195]
    s_add_u32 s11, s37, 32768
    v_exp_f32 v144, v144
    v_mfma_f32_16x16x32_bf16 v[128:131], a[68:71], a[36:39], v[128:131]
    s_waitcnt vmcnt(12)
    s_barrier
    s_sub_u32 s37, s11, 163840
    v_mfma_f32_16x16x32_bf16 v[128:131], a[72:75], a[40:43], v[128:131]
    s_min_u32 s37, s37, s11
    v_exp_f32 v145, v145
    v_mfma_f32_16x16x32_bf16 v[128:131], a[76:79], a[44:47], v[128:131]
    s_add_u32 s10, m0, 16384
    s_sub_u32 m0, m0, 147456
    v_add_u32 v238, s37, v224
    v_mfma_f32_16x16x32_bf16 v[136:139], a[76:79], a[60:63], v[200:203]
    s_min_u32 m0, m0, s10
    v_exp_f32 v146, v146
    v_mfma_f32_16x16x32_bf16 v[136:139], a[72:75], a[56:59], v[136:139]
    s_add_u32 s35, s35, 16384
    ds_read_b128 a[76:79], v238 offset:3072
    ds_read_b128 a[72:75], v238 offset:2048
    v_mfma_f32_16x16x32_bf16 v[136:139], a[68:71], a[52:55], v[136:139]
    v_exp_f32 v147, v147
    v_mfma_f32_16x16x32_bf16 v[136:139], a[64:67], a[48:51], v[136:139]
    buffer_load_dwordx4 v225, s[68:71], s35 offen offset:0 lds
    v_mfma_f32_16x16x32_bf16 v[140:143], a[80:83], a[48:51], v[204:207]
    v_exp_f32 v148, v148
    v_mfma_f32_16x16x32_bf16 v[140:143], a[84:87], a[52:55], v[140:143]
    ds_read_b128 a[68:71], v238 offset:1024
    v_cvt_pk_bf16_f32 v168, v144, v145
    v_mfma_f32_16x16x32_bf16 v[140:143], a[88:91], a[56:59], v[140:143]
    v_exp_f32 v149, v149
    v_mfma_f32_16x16x32_bf16 v[140:143], a[92:95], a[60:63], v[140:143]
    ds_read_b128 a[64:67], v238 offset:0
    v_cvt_pk_bf16_f32 v169, v146, v147
    v_mfma_f32_16x16x32_bf16 v[132:135], a[92:95], a[44:47], v[196:199]
    v_exp_f32 v150, v150
    v_mfma_f32_16x16x32_bf16 v[132:135], a[88:91], a[40:43], v[132:135]
    buffer_load_dwordx4 v225, s[68:71], s35 offen offset:1024 lds
    v_mfma_f32_16x16x32_bf16 v[132:135], a[84:87], a[36:39], v[132:135]
    v_exp_f32 v151, v151
    v_mfma_f32_16x16x32_bf16 v[132:135], a[80:83], a[32:35], v[132:135]
    s_waitcnt lgkmcnt(4)
    ds_read_b128 a[92:95], v238 offset:7168
    ds_read_b128 a[88:91], v238 offset:6144
    v_mfma_f32_16x16x32_bf16 v[64:67], a[96:99], v[160:163], v[64:67]
    v_exp_f32 v152, v152
    v_mfma_f32_16x16x32_bf16 v[96:99], a[96:99], v[164:167], v[96:99]
    ds_read_b128 a[84:87], v238 offset:5120
    v_cvt_pk_bf16_f32 v170, v148, v149
    v_mfma_f32_16x16x32_bf16 v[100:103], a[100:103], v[164:167], v[100:103]
    v_exp_f32 v153, v153
    v_mfma_f32_16x16x32_bf16 v[68:71], a[100:103], v[160:163], v[68:71]
    ds_read_b128 a[80:83], v238 offset:4096
    ds_read_b128 a[96:99], v244 offset:8192
    v_mfma_f32_16x16x32_bf16 v[72:75], a[104:107], v[160:163], v[72:75]
    buffer_load_dwordx4 v225, s[68:71], s35 offen offset:2048 lds
    v_exp_f32 v154, v154
    v_mfma_f32_16x16x32_bf16 v[104:107], a[104:107], v[164:167], v[104:107]
    ds_read_b128 a[100:103], v244 offset:9216
    v_cvt_pk_bf16_f32 v171, v150, v151
    v_mfma_f32_16x16x32_bf16 v[108:111], a[108:111], v[164:167], v[108:111]
    v_exp_f32 v155, v155
    v_mfma_f32_16x16x32_bf16 v[76:79], a[108:111], v[160:163], v[76:79]
    ds_read_b128 a[104:107], v244 offset:10240
    ds_read_b128 a[108:111], v244 offset:11264
    v_mfma_f32_16x16x32_bf16 v[80:83], a[112:115], v[160:163], v[80:83]
    v_exp_f32 v156, v156
    v_mfma_f32_16x16x32_bf16 v[112:115], a[112:115], v[164:167], v[112:115]
    ds_read_b128 a[112:115], v244 offset:12288
    v_cvt_pk_bf16_f32 v172, v152, v153
    v_mfma_f32_16x16x32_bf16 v[116:119], a[116:119], v[164:167], v[116:119]
    buffer_load_dwordx4 v225, s[68:71], s35 offen offset:3072 lds
    v_exp_f32 v157, v157
    v_mfma_f32_16x16x32_bf16 v[84:87], a[116:119], v[160:163], v[84:87]
    ds_read_b128 a[116:119], v244 offset:13312
    v_cvt_pk_bf16_f32 v173, v154, v155
    v_mfma_f32_16x16x32_bf16 v[88:91], a[120:123], v[160:163], v[88:91]
    s_sub_u32 s38, s38, 1
    v_exp_f32 v158, v158
    v_mfma_f32_16x16x32_bf16 v[120:123], a[120:123], v[164:167], v[120:123]
    s_sub_u32 s34, s34, 1
    ds_read_b128 a[120:123], v244 offset:14336
    v_cvt_pk_bf16_f32 v174, v156, v157
    v_mfma_f32_16x16x32_bf16 v[124:127], a[124:127], v[164:167], v[124:127]
    v_exp_f32 v159, v159
    v_mfma_f32_16x16x32_bf16 v[92:95], a[124:127], v[160:163], v[92:95]
    ds_read_b128 a[124:127], v244 offset:15360
    v_cvt_pk_bf16_f32 v175, v158, v159
    v_mfma_f32_16x16x32_bf16 v[230:233], a[228:231], v[160:163], v[230:233]
    v_mfma_f32_16x16x32_bf16 v[234:237], a[228:231], v[164:167], v[234:237]
    s_cmp_lg_u32 s34, 0
    s_cbranch_scc1 L_S0
L_S1:
    v_mov_b32 v248, v212
    v_mov_b32 v249, v214
    s_nop 0
    v_permlane16_swap_b32 v248, v212
    v_permlane16_swap_b32 v249, v214
    v_add_f32 v212, v212, v248
    v_add_f32 v214, v214, v249
    v_mov_b32 v248, v212
    v_mov_b32 v249, v214
    s_nop 0
    v_permlane32_swap_b32 v248, v212
    v_permlane32_swap_b32 v249, v214
    v_add_f32 v212, v212, v248
    v_add_f32 v214, v214, v249
    s_mov_b32 s8, 0x76800000
    s_mov_b32 s9, 0x17800000
    v_max_f32 v248, v212, v214
    v_min_f32 v249, v212, v214
    v_add_f32 v250, v212, v214
    v_rcp_f32 v212, v212
    v_rcp_f32 v214, v214
    v_cmp_nge_f32 vcc, s8, v248
    v_cmp_nle_f32 s[98:99], s9, v249
    v_cmp_u_f32 s[100:101], v250, v250
    s_nop 0
    s_or_b64 s[98:99], s[98:99], vcc
    s_or_b64 s[96:97], s[98:99], s[100:101]
    v_mov_b64 v[176:177], 0
    v_mov_b64 v[178:179], 0
    s_add_u32 s15, s94, 0
    v_pk_mul_f32 v[0:1], v[0:1], v[212:213] op_sel_hi:[1,0]
    v_pk_mul_f32 v[2:3], v[2:3], v[212:213] op_sel_hi:[1,0]
    v_pk_mul_f32 v[4:5], v[4:5], v[212:213] op_sel_hi:[1,0]
    v_pk_mul_f32 v[6:7], v[6:7], v[212:213] op_sel_hi:[1,0]
    v_cvt_pk_bf16_f32 v0, v0, v1
    v_cvt_pk_bf16_f32 v1, v2, v3
    v_cvt_pk_bf16_f32 v2, v4, v5
    v_cvt_pk_bf16_f32 v3, v6, v7
    buffer_store_dwordx4 v[0:3], v224, s[64:67], s15 offen offset:0 sc1
    v_pk_mul_f32 v[8:9], v[8:9], v[212:213] op_sel_hi:[1,0]
    v_pk_mul_f32 v[10:11], v[10:11], v[212:213] op_sel_hi:[1,0]
    v_pk_mul_f32 v[12:13], v[12:13], v[212:213] op_sel_hi:[1,0]
    v_pk_mul_f32 v[14:15], v[14:15], v[212:213] op_sel_hi:[1,0]
    v_cvt_pk_bf16_f32 v8, v8, v9
    v_cvt_pk_bf16_f32 v9, v10, v11
    v_cvt_pk_bf16_f32 v10, v12, v13
    v_cvt_pk_bf16_f32 v11, v14, v15
    buffer_store_dwordx4 v[8:11], v224, s[64:67], s15 offen offset:1024 sc1
    v_pk_mul_f32 v[16:17], v[16:17], v[212:213] op_sel_hi:[1,0]
    v_pk_mul_f32 v[18:19], v[18:19], v[212:213] op_sel_hi:[1,0]
    v_pk_mul_f32 v[20:21], v[20:21], v[212:213] op_sel_hi:[1,0]
    v_pk_mul_f32 v[22:23], v[22:23], v[212:213] op_sel_hi:[1,0]
    v_cvt_pk_bf16_f32 v16, v16, v17
    v_cvt_pk_bf16_f32 v17, v18, v19
    v_cvt_pk_bf16_f32 v18, v20, v21
    v_cvt_pk_bf16_f32 v19, v22, v23
    buffer_store_dwordx4 v[16:19], v224, s[64:67], s15 offen offset:2048 sc1
    v_pk_mul_f32 v[24:25], v[24:25], v[212:213] op_sel_hi:[1,0]
    v_pk_mul_f32 v[26:27], v[26:27], v[212:213] op_sel_hi:[1,0]
    v_pk_mul_f32 v[28:29], v[28:29], v[212:213] op_sel_hi:[1,0]
    v_pk_mul_f32 v[30:31], v[30:31], v[212:213] op_sel_hi:[1,0]
    v_cvt_pk_bf16_f32 v24, v24, v25
    v_cvt_pk_bf16_f32 v25, v26, v27
    v_cvt_pk_bf16_f32 v26, v28, v29
    v_cvt_pk_bf16_f32 v27, v30, v31
    buffer_store_dwordx4 v[24:27], v224, s[64:67], s15 offen offset:3072 sc1
    s_add_u32 s15, s94, 136192
    v_pk_mul_f32 v[32:33], v[32:33], v[214:215] op_sel_hi:[1,0]
    v_pk_mul_f32 v[34:35], v[34:35], v[214:215] op_sel_hi:[1,0]
    v_pk_mul_f32 v[36:37], v[36:37], v[214:215] op_sel_hi:[1,0]
    v_pk_mul_f32 v[38:39], v[38:39], v[214:215] op_sel_hi:[1,0]
    v_cvt_pk_bf16_f32 v32, v32, v33
    v_cvt_pk_bf16_f32 v33, v34, v35
    v_cvt_pk_bf16_f32 v34, v36, v37
    v_cvt_pk_bf16_f32 v35, v38, v39
    buffer_store_dwordx4 v[32:35], v224, s[64:67], s15 offen offset:0 sc1
    v_pk_mul_f32 v[40:41], v[40:41], v[214:215] op_sel_hi:[1,0]
    v_pk_mul_f32 v[42:43], v[42:43], v[214:215] op_sel_hi:[1,0]
    v_pk_mul_f32 v[44:45], v[44:45], v[214:215] op_sel_hi:[1,0]
    v_pk_mul_f32 v[46:47], v[46:47], v[214:215] op_sel_hi:[1,0]
    v_cvt_pk_bf16_f32 v40, v40, v41
    v_cvt_pk_bf16_f32 v41, v42, v43
    v_cvt_pk_bf16_f32 v42, v44, v45
    v_cvt_pk_bf16_f32 v43, v46, v47
    buffer_store_dwordx4 v[40:43], v224, s[64:67], s15 offen offset:1024 sc1
    v_pk_mul_f32 v[48:49], v[48:49], v[214:215] op_sel_hi:[1,0]
    v_pk_mul_f32 v[50:51], v[50:51], v[214:215] op_sel_hi:[1,0]
    v_pk_mul_f32 v[52:53], v[52:53], v[214:215] op_sel_hi:[1,0]
    v_pk_mul_f32 v[54:55], v[54:55], v[214:215] op_sel_hi:[1,0]
    v_cvt_pk_bf16_f32 v48, v48, v49
    v_cvt_pk_bf16_f32 v49, v50, v51
    v_cvt_pk_bf16_f32 v50, v52, v53
    v_cvt_pk_bf16_f32 v51, v54, v55
    buffer_store_dwordx4 v[48:51], v224, s[64:67], s15 offen offset:2048 sc1
    v_pk_mul_f32 v[56:57], v[56:57], v[214:215] op_sel_hi:[1,0]
    v_pk_mul_f32 v[58:59], v[58:59], v[214:215] op_sel_hi:[1,0]
    v_pk_mul_f32 v[60:61], v[60:61], v[214:215] op_sel_hi:[1,0]
    v_pk_mul_f32 v[62:63], v[62:63], v[214:215] op_sel_hi:[1,0]
    v_cvt_pk_bf16_f32 v56, v56, v57
    v_cvt_pk_bf16_f32 v57, v58, v59
    v_cvt_pk_bf16_f32 v58, v60, v61
    v_cvt_pk_bf16_f32 v59, v62, v63
    buffer_store_dwordx4 v[56:59], v224, s[64:67], s15 offen offset:3072 sc1
    s_nop 0
    v_mfma_f32_16x16x32_bf16 v[180:183], v[176:179], v[0:3], 0
    v_mfma_f32_16x16x32_bf16 v[180:183], v[176:179], v[8:11], v[180:183]
    v_mfma_f32_16x16x32_bf16 v[180:183], v[176:179], v[16:19], v[180:183]
    v_mfma_f32_16x16x32_bf16 v[180:183], v[176:179], v[24:27], v[180:183]
    v_mfma_f32_16x16x32_bf16 v[180:183], v[176:179], v[32:35], v[180:183]
    v_mfma_f32_16x16x32_bf16 v[180:183], v[176:179], v[40:43], v[180:183]
    v_mfma_f32_16x16x32_bf16 v[180:183], v[176:179], v[48:51], v[180:183]
    v_mfma_f32_16x16x32_bf16 v[180:183], v[176:179], v[56:59], v[180:183]
    s_cmp_eq_u32 s38, 0
    s_cbranch_scc1 L_DRAIN
.p2align 3
L_S:
    s_waitcnt lgkmcnt(8)
    v_mfma_f32_16x16x32_bf16 v[144:147], a[64:67], a[32:35], v[192:195]
    s_add_u32 s11, s36, 32768
    v_exp_f32 v128, v128
    v_mfma_f32_16x16x32_bf16 v[144:147], a[68:71], a[36:39], v[144:147]
    s_waitcnt vmcnt(12)
    s_barrier
    s_sub_u32 s36, s11, 163840
    v_mfma_f32_16x16x32_bf16 v[144:147], a[72:75], a[40:43], v[144:147]
    s_min_u32 s36, s36, s11
    v_exp_f32 v129, v129
    v_mfma_f32_16x16x32_bf16 v[144:147], a[76:79], a[44:47], v[144:147]
    s_add_u32 s10, m0, 16384
    s_sub_u32 m0, m0, 147456
    v_add_u32 v244, s36, v224
    v_mfma_f32_16x16x32_bf16 v[152:155], a[76:79], a[60:63], v[200:203]
    s_min_u32 m0, m0, s10
    v_exp_f32 v130, v130
    v_mfma_f32_16x16x32_bf16 v[152:155], a[72:75], a[56:59], v[152:155]
    s_add_u32 s35, s35, 16384
    ds_read_b128 a[76:79], v244 offset:3072
    ds_read_b128 a[72:75], v244 offset:2048
    v_mfma_f32_16x16x32_bf16 v[152:155], a[68:71], a[52:55], v[152:155]
    v_exp_f32 v131, v131
    v_mfma_f32_16x16x32_bf16 v[152:155], a[64:67], a[48:51], v[152:155]
    buffer_load_dwordx4 v225, s[68:71], s35 offen offset:0 lds
    v_mfma_f32_16x16x32_bf16 v[156:159], a[80:83], a[48:51], v[204:207]
    v_exp_f32 v132, v132
    v_mfma_f32_16x16x32_bf16 v[156:159], a[84:87], a[52:55], v[156:159]
    ds_read_b128 a[68:71], v244 offset:1024
    v_cvt_pk_bf16_f32 v160, v128, v129
    v_mfma_f32_16x16x32_bf16 v[156:159], a[88:91], a[56:59], v[156:159]
    v_exp_f32 v133, v133
    v_mfma_f32_16x16x32_bf16 v[156:159], a[92:95], a[60:63], v[156:159]
    ds_read_b128 a[64:67], v244 offset:0
    v_cvt_pk_bf16_f32 v161, v130, v131
    v_mfma_f32_16x16x32_bf16 v[148:151], a[92:95], a[44:47], v[196:199]
    v_exp_f32 v134, v134
    v_mfma_f32_16x16x32_bf16 v[148:151], a[88:91], a[40:43], v[148:151]
    buffer_load_dwordx4 v225, s[68:71], s35 offen offset:1024 lds
    v_mfma_f32_16x16x32_bf16 v[148:151], a[84:87], a[36:39], v[148:151]
    v_exp_f32 v135, v135
    v_mfma_f32_16x16x32_bf16 v[148:151], a[80:83], a[32:35], v[148:151]
    s_waitcnt lgkmcnt(4)
    ds_read_b128 a[92:95], v244 offset:7168
    ds_read_b128 a[88:91], v244 offset:6144
    v_mfma_f32_16x16x32_bf16 v[64:67], a[96:99], v[168:171], v[64:67]
    v_exp_f32 v136, v136
    v_mfma_f32_16x16x32_bf16 v[96:99], a[96:99], v[172:175], v[96:99]
    ds_read_b128 a[84:87], v244 offset:5120
    v_cvt_pk_bf16_f32 v162, v132, v133
    v_mfma_f32_16x16x32_bf16 v[100:103], a[100:103], v[172:175], v[100:103]
    v_exp_f32 v137, v137
    v_mfma_f32_16x16x32_bf16 v[68:71], a[100:103], v[168:171], v[68:71]
    ds_read_b128 a[80:83], v244 offset:4096
    ds_read_b128 a[96:99], v238 offset:8192
    v_mfma_f32_16x16x32_bf16 v[72:75], a[104:107], v[168:171], v[72:75]
    buffer_load_dwordx4 v225, s[68:71], s35 offen offset:2048 lds
    v_exp_f32 v138, v138
    v_mfma_f32_16x16x32_bf16 v[104:107], a[104:107], v[172:175], v[104:107]
    ds_read_b128 a[100:103], v238 offset:9216
    v_cvt_pk_bf16_f32 v163, v134, v135
    v_mfma_f32_16x16x32_bf16 v[108:111], a[108:111], v[172:175], v[108:111]
    v_exp_f32 v139, v139
    v_mfma_f32_16x16x32_bf16 v[76:79], a[108:111], v[168:171], v[76:79]
    ds_read_b128 a[104:107], v238 offset:10240
    ds_read_b128 a[108:111], v238 offset:11264
    v_mfma_f32_16x16x32_bf16 v[80:83], a[112:115], v[168:171], v[80:83]
    v_exp_f32 v140, v140
    v_mfma_f32_16x16x32_bf16 v[112:115], a[112:115], v[172:175], v[112:115]
    ds_read_b128 a[112:115], v238 offset:12288
    v_cvt_pk_bf16_f32 v164, v136, v137
    v_mfma_f32_16x16x32_bf16 v[116:119], a[116:119], v[172:175], v[116:119]
    buffer_load_dwordx4 v225, s[68:71], s35 offen offset:3072 lds
    v_exp_f32 v141, v141
    v_mfma_f32_16x16x32_bf16 v[84:87], a[116:119], v[168:171], v[84:87]
    ds_read_b128 a[116:119], v238 offset:13312
    v_cvt_pk_bf16_f32 v165, v138, v139
    v_mfma_f32_16x16x32_bf16 v[88:91], a[120:123], v[168:171], v[88:91]
    s_cmp_eq_u32 s38, 1
    v_exp_f32 v142, v142
    v_mfma_f32_16x16x32_bf16 v[120:123], a[120:123], v[172:175], v[120:123]
    s_cbranch_scc1 L_MASK_S
L_MRET_S:
    ds_read_b128 a[120:123], v238 offset:14336
    v_cvt_pk_bf16_f32 v166, v140, v141
    v_mfma_f32_16x16x32_bf16 v[124:127], a[124:127], v[172:175], v[124:127]
    v_exp_f32 v143, v143
    v_mfma_f32_16x16x32_bf16 v[92:95], a[124:127], v[168:171], v[92:95]
    ds_read_b128 a[124:127], v238 offset:15360
    v_cvt_pk_bf16_f32 v167, v142, v143
    v_mfma_f32_16x16x32_bf16 v[230:233], a[228:231], v[168:171], v[230:233]
    v_mfma_f32_16x16x32_bf16 v[234:237], a[228:231], v[172:175], v[234:237]
    s_waitcnt lgkmcnt(8)
    v_mfma_f32_16x16x32_bf16 v[128:131], a[64:67], a[32:35], v[192:195]
    s_add_u32 s11, s37, 32768
    v_exp_f32 v144, v144
    v_mfma_f32_16x16x32_bf16 v[128:131], a[68:71], a[36:39], v[128:131]
    s_waitcnt vmcnt(12)
    s_barrier
    s_sub_u32 s37, s11, 163840
    v_mfma_f32_16x16x32_bf16 v[128:131], a[72:75], a[40:43], v[128:131]
    s_min_u32 s37, s37, s11
    v_exp_f32 v145, v145
    v_mfma_f32_16x16x32_bf16 v[128:131], a[76:79], a[44:47], v[128:131]
    s_add_u32 s10, m0, 16384
    s_sub_u32 m0, m0, 147456
    v_add_u32 v238, s37, v224
    v_mfma_f32_16x16x32_bf16 v[136:139], a[76:79], a[60:63], v[200:203]
    s_min_u32 m0, m0, s10
    v_exp_f32 v146, v146
    v_mfma_f32_16x16x32_bf16 v[136:139], a[72:75], a[56:59], v[136:139]
    s_add_u32 s35, s35, 16384
    ds_read_b128 a[76:79], v238 offset:3072
    ds_read_b128 a[72:75], v238 offset:2048
    v_mfma_f32_16x16x32_bf16 v[136:139], a[68:71], a[52:55], v[136:139]
    v_exp_f32 v147, v147
    v_mfma_f32_16x16x32_bf16 v[136:139], a[64:67], a[48:51], v[136:139]
    buffer_load_dwordx4 v225, s[68:71], s35 offen offset:0 lds
    v_mfma_f32_16x16x32_bf16 v[140:143], a[80:83], a[48:51], v[204:207]
    v_exp_f32 v148, v148
    v_mfma_f32_16x16x32_bf16 v[140:143], a[84:87], a[52:55], v[140:143]
    ds_read_b128 a[68:71], v238 offset:1024
    v_cvt_pk_bf16_f32 v168, v144, v145
    v_mfma_f32_16x16x32_bf16 v[140:143], a[88:91], a[56:59], v[140:143]
    v_exp_f32 v149, v149
    v_mfma_f32_16x16x32_bf16 v[140:143], a[92:95], a[60:63], v[140:143]
    ds_read_b128 a[64:67], v238 offset:0
    v_cvt_pk_bf16_f32 v169, v146, v147
    v_mfma_f32_16x16x32_bf16 v[132:135], a[92:95], a[44:47], v[196:199]
    v_exp_f32 v150, v150
    v_mfma_f32_16x16x32_bf16 v[132:135], a[88:91], a[40:43], v[132:135]
    buffer_load_dwordx4 v225, s[68:71], s35 offen offset:1024 lds
    v_mfma_f32_16x16x32_bf16 v[132:135], a[84:87], a[36:39], v[132:135]
    v_exp_f32 v151, v151
    v_mfma_f32_16x16x32_bf16 v[132:135], a[80:83], a[32:35], v[132:135]
    s_waitcnt lgkmcnt(4)
    ds_read_b128 a[92:95], v238 offset:7168
    ds_read_b128 a[88:91], v238 offset:6144
    v_mfma_f32_16x16x32_bf16 v[64:67], a[96:99], v[160:163], v[64:67]
    v_exp_f32 v152, v152
    v_mfma_f32_16x16x32_bf16 v[96:99], a[96:99], v[164:167], v[96:99]
    ds_read_b128 a[84:87], v238 offset:5120
    v_cvt_pk_bf16_f32 v170, v148, v149
    v_mfma_f32_16x16x32_bf16 v[100:103], a[100:103], v[164:167], v[100:103]
    v_exp_f32 v153, v153
    v_mfma_f32_16x16x32_bf16 v[68:71], a[100:103], v[160:163], v[68:71]
    ds_read_b128 a[80:83], v238 offset:4096
    ds_read_b128 a[96:99], v244 offset:8192
    v_mfma_f32_16x16x32_bf16 v[72:75], a[104:107], v[160:163], v[72:75]
    buffer_load_dwordx4 v225, s[68:71], s35 offen offset:2048 lds
    v_exp_f32 v154, v154
    v_mfma_f32_16x16x32_bf16 v[104:107], a[104:107], v[164:167], v[104:107]
    ds_read_b128 a[100:103], v244 offset:9216
    v_cvt_pk_bf16_f32 v171, v150, v151
    v_mfma_f32_16x16x32_bf16 v[108:111], a[108:111], v[164:167], v[108:111]
    v_exp_f32 v155, v155
    v_mfma_f32_16x16x32_bf16 v[76:79], a[108:111], v[160:163], v[76:79]
    ds_read_b128 a[104:107], v244 offset:10240
    ds_read_b128 a[108:111], v244 offset:11264
    v_mfma_f32_16x16x32_bf16 v[80:83], a[112:115], v[160:163], v[80:83]
    v_exp_f32 v156, v156
    v_mfma_f32_16x16x32_bf16 v[112:115], a[112:115], v[164:167], v[112:115]
    ds_read_b128 a[112:115], v244 offset:12288
    v_cvt_pk_bf16_f32 v172, v152, v153
    v_mfma_f32_16x16x32_bf16 v[116:119], a[116:119], v[164:167], v[116:119]
    buffer_load_dwordx4 v225, s[68:71], s35 offen offset:3072 lds
    v_exp_f32 v157, v157
    v_mfma_f32_16x16x32_bf16 v[84:87], a[116:119], v[160:163], v[84:87]
    ds_read_b128 a[116:119], v244 offset:13312
    v_cvt_pk_bf16_f32 v173, v154, v155
    v_mfma_f32_16x16x32_bf16 v[88:91], a[120:123], v[160:163], v[88:91]
    s_sub_u32 s38, s38, 1
    v_exp_f32 v158, v158
    v_mfma_f32_16x16x32_bf16 v[120:123], a[120:123], v[164:167], v[120:123]
    ds_read_b128 a[120:123], v244 offset:14336
    v_cvt_pk_bf16_f32 v174, v156, v157
    v_mfma_f32_16x16x32_bf16 v[124:127], a[124:127], v[164:167], v[124:127]
    v_exp_f32 v159, v159
    v_mfma_f32_16x16x32_bf16 v[92:95], a[124:127], v[160:163], v[92:95]
    ds_read_b128 a[124:127], v244 offset:15360
    v_cvt_pk_bf16_f32 v175, v158, v159
    v_mfma_f32_16x16x32_bf16 v[230:233], a[228:231], v[160:163], v[230:233]
    v_mfma_f32_16x16x32_bf16 v[234:237], a[228:231], v[164:167], v[234:237]
    s_cmp_lg_u32 s38, 0
    s_cbranch_scc1 L_S
L_DRAIN:
    s_waitcnt vmcnt(0)
    s_mov_b32 s35, m0
    v_add_u32 v192, 8192, v226
    v_add_u32 v193, 16384, v226
    v_add_u32 v194, 24576, v226
    s_waitcnt lgkmcnt(0)
    v_mfma_f32_16x16x32_bf16 v[64:67], a[96:99], v[168:171], v[64:67]
    s_sub_u32 s10, m0, 16384
    v_exp_f32 v128, v128
    v_mfma_f32_16x16x32_bf16 v[96:99], a[96:99], v[172:175], v[96:99]
    s_add_u32 m0, m0, 147456
    s_min_u32 m0, m0, s10
    s_add_u32 s14, s41, 0
    s_mov_b32 s36, m0
    buffer_load_dwordx4 v226, s[76:79], s14 offen offset:0 lds
    v_exp_f32 v129, v129
    v_mfma_f32_16x16x32_bf16 v[100:103], a[100:103], v[172:175], v[100:103]
    v_exp_f32 v130, v130
    v_mfma_f32_16x16x32_bf16 v[68:71], a[100:103], v[168:171], v[68:71]
    ds_read_b128 a[96:99], v238 offset:8192
    v_exp_f32 v131, v131
    v_mfma_f32_16x16x32_bf16 v[72:75], a[104:107], v[168:171], v[72:75]
    buffer_load_dwordx4 v192, s[76:79], s14 offen offset:1024 lds
    v_exp_f32 v132, v132
    v_mfma_f32_16x16x32_bf16 v[104:107], a[104:107], v[172:175], v[104:107]
    ds_read_b128 a[100:103], v238 offset:9216
    v_exp_f32 v133, v133
    v_mfma_f32_16x16x32_bf16 v[108:111], a[108:111], v[172:175], v[108:111]
    v_exp_f32 v134, v134
    v_mfma_f32_16x16x32_bf16 v[76:79], a[108:111], v[168:171], v[76:79]
    ds_read_b128 a[104:107], v238 offset:10240
    buffer_load_dwordx4 v193, s[76:79], s14 offen offset:2048 lds
    v_exp_f32 v135, v135
    v_mfma_f32_16x16x32_bf16 v[80:83], a[112:115], v[168:171], v[80:83]
    v_exp_f32 v136, v136
    v_cvt_pk_bf16_f32 v160, v128, v129
    v_mfma_f32_16x16x32_bf16 v[112:115], a[112:115], v[172:175], v[112:115]
    ds_read_b128 a[108:111], v238 offset:11264
    v_exp_f32 v137, v137
    v_mfma_f32_16x16x32_bf16 v[116:119], a[116:119], v[172:175], v[116:119]
    buffer_load_dwordx4 v194, s[76:79], s14 offen offset:3072 lds
    v_exp_f32 v138, v138
    v_cvt_pk_bf16_f32 v161, v130, v131
    v_mfma_f32_16x16x32_bf16 v[84:87], a[116:119], v[168:171], v[84:87]
    ds_read_b128 a[112:115], v238 offset:12288
    v_exp_f32 v139, v139
    v_mfma_f32_16x16x32_bf16 v[88:91], a[120:123], v[168:171], v[88:91]
    s_sub_u32 s10, m0, 16384
    v_exp_f32 v140, v140
    v_cvt_pk_bf16_f32 v162, v132, v133
    v_mfma_f32_16x16x32_bf16 v[120:123], a[120:123], v[172:175], v[120:123]
    s_add_u32 m0, m0, 147456
    s_min_u32 m0, m0, s10
    s_add_u32 s14, s41, 36864
    s_mov_b32 s37, m0
    ds_read_b128 a[116:119], v238 offset:13312
    buffer_load_dwordx4 v226, s[76:79], s14 offen offset:0 lds
    v_exp_f32 v141, v141
    v_mfma_f32_16x16x32_bf16 v[124:127], a[124:127], v[172:175], v[124:127]
    v_exp_f32 v142, v142
    v_cvt_pk_bf16_f32 v163, v134, v135
    v_mfma_f32_16x16x32_bf16 v[92:95], a[124:127], v[168:171], v[92:95]
    ds_read_b128 a[120:123], v238 offset:14336
    v_exp_f32 v143, v143
    v_mfma_f32_16x16x32_bf16 v[230:233], a[228:231], v[168:171], v[230:233]
    buffer_load_dwordx4 v192, s[76:79], s14 offen offset:1024 lds
    v_cvt_pk_bf16_f32 v164, v136, v137
    v_mfma_f32_16x16x32_bf16 v[234:237], a[228:231], v[172:175], v[234:237]
    ds_read_b128 a[124:127], v238 offset:15360
    v_cvt_pk_bf16_f32 v165, v138, v139
    v_cvt_pk_bf16_f32 v166, v140, v141
    v_cvt_pk_bf16_f32 v167, v142, v143
    s_waitcnt lgkmcnt(4)
    v_mfma_f32_16x16x32_bf16 v[230:233], a[228:231], v[160:163], v[230:233]
    buffer_load_dwordx4 v193, s[76:79], s14 offen offset:2048 lds
    v_mfma_f32_16x16x32_bf16 v[234:237], a[228:231], v[164:167], v[234:237]
    v_mfma_f32_16x16x32_bf16 v[64:67], a[96:99], v[160:163], v[64:67]
    v_mfma_f32_16x16x32_bf16 v[96:99], a[96:99], v[164:167], v[96:99]
    buffer_load_dwordx4 v194, s[76:79], s14 offen offset:3072 lds
    v_mfma_f32_16x16x32_bf16 v[100:103], a[100:103], v[164:167], v[100:103]
    v_mfma_f32_16x16x32_bf16 v[68:71], a[100:103], v[160:163], v[68:71]
    v_mfma_f32_16x16x32_bf16 v[72:75], a[104:107], v[160:163], v[72:75]
    s_sub_u32 s10, m0, 16384
    s_add_u32 m0, m0, 147456
    s_min_u32 m0, m0, s10
    s_add_u32 s14, s41, 73728
    v_mfma_f32_16x16x32_bf16 v[104:107], a[104:107], v[164:167], v[104:107]
    s_mov_b32 s34, m0
    buffer_load_dwordx4 v226, s[76:79], s14 offen offset:0 lds
    v_add_f32 v216, v216, v230
    v_mfma_f32_16x16x32_bf16 v[108:111], a[108:111], v[164:167], v[108:111]
    v_add_f32 v218, v218, v234
    v_mov_b32 v248, v216
    v_mov_b32 v249, v218
    v_mfma_f32_16x16x32_bf16 v[76:79], a[108:111], v[160:163], v[76:79]
    s_waitcnt lgkmcnt(0)
    s_nop 0
    buffer_load_dwordx4 v192, s[76:79], s14 offen offset:1024 lds
    v_mfma_f32_16x16x32_bf16 v[80:83], a[112:115], v[160:163], v[80:83]
    v_permlane16_swap_b32 v248, v216
    v_permlane16_swap_b32 v249, v218
    v_add_f32 v216, v216, v248
    v_mfma_f32_16x16x32_bf16 v[112:115], a[112:115], v[164:167], v[112:115]
    v_add_f32 v218, v218, v249
    v_mov_b32 v248, v216
    v_mov_b32 v249, v218
    v_mfma_f32_16x16x32_bf16 v[116:119], a[116:119], v[164:167], v[116:119]
    s_nop 0
    buffer_load_dwordx4 v193, s[76:79], s14 offen offset:2048 lds
    v_permlane32_swap_b32 v248, v216
    v_mfma_f32_16x16x32_bf16 v[84:87], a[116:119], v[160:163], v[84:87]
    v_permlane32_swap_b32 v249, v218
    v_add_f32 v216, v216, v248
    v_add_f32 v218, v218, v249
    v_mfma_f32_16x16x32_bf16 v[88:91], a[120:123], v[160:163], v[88:91]
    s_mov_b32 s8, 0x76800000
    s_mov_b32 s9, 0x17800000
    v_max_f32 v248, v216, v218
    v_min_f32 v249, v216, v218
    v_mfma_f32_16x16x32_bf16 v[120:123], a[120:123], v[164:167], v[120:123]
    buffer_load_dwordx4 v194, s[76:79], s14 offen offset:3072 lds
    v_add_f32 v250, v216, v218
    v_mfma_f32_16x16x32_bf16 v[124:127], a[124:127], v[164:167], v[124:127]
    v_rcp_f32 v216, v216
    v_mfma_f32_16x16x32_bf16 v[92:95], a[124:127], v[160:163], v[92:95]
    v_rcp_f32 v218, v218
    v_cmp_nge_f32 vcc, s8, v248
    v_cmp_nle_f32 s[98:99], s9, v249
    v_cmp_u_f32 s[100:101], v250, v250
    s_nop 0
    s_or_b64 s[98:99], s[98:99], vcc
    s_or_b64 s[98:99], s[98:99], s[100:101]
    s_or_b64 s[96:97], s[96:97], s[98:99]
    s_nop 3
    s_add_u32 s15, s95, 0
    v_pk_mul_f32 v[64:65], v[64:65], v[216:217] op_sel_hi:[1,0]
    v_pk_mul_f32 v[66:67], v[66:67], v[216:217] op_sel_hi:[1,0]
    v_pk_mul_f32 v[68:69], v[68:69], v[216:217] op_sel_hi:[1,0]
    v_pk_mul_f32 v[70:71], v[70:71], v[216:217] op_sel_hi:[1,0]
    v_cvt_pk_bf16_f32 v64, v64, v65
    v_cvt_pk_bf16_f32 v65, v66, v67
    v_cvt_pk_bf16_f32 v66, v68, v69
    v_cvt_pk_bf16_f32 v67, v70, v71
    buffer_store_dwordx4 v[64:67], v224, s[64:67], s15 offen offset:0 sc1
    v_pk_mul_f32 v[72:73], v[72:73], v[216:217] op_sel_hi:[1,0]
    v_pk_mul_f32 v[74:75], v[74:75], v[216:217] op_sel_hi:[1,0]
    v_pk_mul_f32 v[76:77], v[76:77], v[216:217] op_sel_hi:[1,0]
    v_pk_mul_f32 v[78:79], v[78:79], v[216:217] op_sel_hi:[1,0]
    v_cvt_pk_bf16_f32 v72, v72, v73
    v_cvt_pk_bf16_f32 v73, v74, v75
    v_cvt_pk_bf16_f32 v74, v76, v77
    v_cvt_pk_bf16_f32 v75, v78, v79
    buffer_store_dwordx4 v[72:75], v224, s[64:67], s15 offen offset:1024 sc1
    v_pk_mul_f32 v[80:81], v[80:81], v[216:217] op_sel_hi:[1,0]
    v_pk_mul_f32 v[82:83], v[82:83], v[216:217] op_sel_hi:[1,0]
    v_pk_mul_f32 v[84:85], v[84:85], v[216:217] op_sel_hi:[1,0]
    v_pk_mul_f32 v[86:87], v[86:87], v[216:217] op_sel_hi:[1,0]
    v_cvt_pk_bf16_f32 v80, v80, v81
    v_cvt_pk_bf16_f32 v81, v82, v83
    v_cvt_pk_bf16_f32 v82, v84, v85
    v_cvt_pk_bf16_f32 v83, v86, v87
    buffer_store_dwordx4 v[80:83], v224, s[64:67], s15 offen offset:2048 sc1
    v_pk_mul_f32 v[88:89], v[88:89], v[216:217] op_sel_hi:[1,0]
    v_pk_mul_f32 v[90:91], v[90:91], v[216:217] op_sel_hi:[1,0]
    v_pk_mul_f32 v[92:93], v[92:93], v[216:217] op_sel_hi:[1,0]
    v_pk_mul_f32 v[94:95], v[94:95], v[216:217] op_sel_hi:[1,0]
    v_cvt_pk_bf16_f32 v88, v88, v89
    v_cvt_pk_bf16_f32 v89, v90, v91
    v_cvt_pk_bf16_f32 v90, v92, v93
    v_cvt_pk_bf16_f32 v91, v94, v95
    buffer_store_dwordx4 v[88:91], v224, s[64:67], s15 offen offset:3072 sc1
    s_add_u32 s15, s95, 136192
    v_pk_mul_f32 v[96:97], v[96:97], v[218:219] op_sel_hi:[1,0]
    v_pk_mul_f32 v[98:99], v[98:99], v[218:219] op_sel_hi:[1,0]
    v_pk_mul_f32 v[100:101], v[100:101], v[218:219] op_sel_hi:[1,0]
    v_pk_mul_f32 v[102:103], v[102:103], v[218:219] op_sel_hi:[1,0]
    v_cvt_pk_bf16_f32 v96, v96, v97
    v_cvt_pk_bf16_f32 v97, v98, v99
    v_cvt_pk_bf16_f32 v98, v100, v101
    v_cvt_pk_bf16_f32 v99, v102, v103
    buffer_store_dwordx4 v[96:99], v224, s[64:67], s15 offen offset:0 sc1
    v_pk_mul_f32 v[104:105], v[104:105], v[218:219] op_sel_hi:[1,0]
    v_pk_mul_f32 v[106:107], v[106:107], v[218:219] op_sel_hi:[1,0]
    v_pk_mul_f32 v[108:109], v[108:109], v[218:219] op_sel_hi:[1,0]
    v_pk_mul_f32 v[110:111], v[110:111], v[218:219] op_sel_hi:[1,0]
    v_cvt_pk_bf16_f32 v104, v104, v105
    v_cvt_pk_bf16_f32 v105, v106, v107
    v_cvt_pk_bf16_f32 v106, v108, v109
    v_cvt_pk_bf16_f32 v107, v110, v111
    buffer_store_dwordx4 v[104:107], v224, s[64:67], s15 offen offset:1024 sc1
    v_pk_mul_f32 v[112:113], v[112:113], v[218:219] op_sel_hi:[1,0]
    v_pk_mul_f32 v[114:115], v[114:115], v[218:219] op_sel_hi:[1,0]
    v_pk_mul_f32 v[116:117], v[116:117], v[218:219] op_sel_hi:[1,0]
    v_pk_mul_f32 v[118:119], v[118:119], v[218:219] op_sel_hi:[1,0]
    v_cvt_pk_bf16_f32 v112, v112, v113
    v_cvt_pk_bf16_f32 v113, v114, v115
    v_cvt_pk_bf16_f32 v114, v116, v117
    v_cvt_pk_bf16_f32 v115, v118, v119
    buffer_store_dwordx4 v[112:115], v224, s[64:67], s15 offen offset:2048 sc1
    v_pk_mul_f32 v[120:121], v[120:121], v[218:219] op_sel_hi:[1,0]
    v_pk_mul_f32 v[122:123], v[122:123], v[218:219] op_sel_hi:[1,0]
    v_pk_mul_f32 v[124:125], v[124:125], v[218:219] op_sel_hi:[1,0]
    v_pk_mul_f32 v[126:127], v[126:127], v[218:219] op_sel_hi:[1,0]
    v_cvt_pk_bf16_f32 v120, v120, v121
    v_cvt_pk_bf16_f32 v121, v122, v123
    v_cvt_pk_bf16_f32 v122, v124, v125
    v_cvt_pk_bf16_f32 v123, v126, v127
    buffer_store_dwordx4 v[120:123], v224, s[64:67], s15 offen offset:3072 sc1
    s_nop 0
    v_mfma_f32_16x16x32_bf16 v[180:183], v[176:179], v[64:67], v[180:183]
    v_mfma_f32_16x16x32_bf16 v[180:183], v[176:179], v[72:75], v[180:183]
    v_mfma_f32_16x16x32_bf16 v[180:183], v[176:179], v[80:83], v[180:183]
    v_mfma_f32_16x16x32_bf16 v[180:183], v[176:179], v[88:91], v[180:183]
    v_mfma_f32_16x16x32_bf16 v[180:183], v[176:179], v[96:99], v[180:183]
    v_mfma_f32_16x16x32_bf16 v[180:183], v[176:179], v[104:107], v[180:183]
    v_mfma_f32_16x16x32_bf16 v[180:183], v[176:179], v[112:115], v[180:183]
    v_mfma_f32_16x16x32_bf16 v[180:183], v[176:179], v[120:123], v[180:183]
    v_mov_b32 v249, s35
    s_sub_u32 s8, s35, s16
    v_mov_b32 v248, s8
    s_nop 4
    v_cmp_u_f32 vcc, v180, v180
    s_nop 0
    s_or_b64 vcc, vcc, s[96:97]
    s_cselect_b32 s8, 1, 0
    v_mov_b32 v250, s8
    ds_write_b32 v249, v250
    s_waitcnt lgkmcnt(0)
    s_barrier
    ds_read_b32 v128, v248 offset:0
    ds_read_b32 v129, v248 offset:4096
    ds_read_b32 v130, v248 offset:8192
    ds_read_b32 v131, v248 offset:12288
    v_bfe_u32 v251, v224, 7, 2
    v_subrev_u32 v252, s40, v229
    s_add_u32 s8, s3, 0
    s_and_b32 s8, s8, 3
    v_xor_b32 v196, s8, v251
    v_lshl_add_u32 v196, v196, 5, v252
    s_add_u32 s8, s3, 1
    s_and_b32 s8, s8, 3
    v_xor_b32 v197, s8, v251
    v_lshl_add_u32 v197, v197, 5, v252
    s_add_u32 s8, s3, 2
    s_and_b32 s8, s8, 3
    v_xor_b32 v198, s8, v251
    v_lshl_add_u32 v198, v198, 5, v252
    s_add_u32 s8, s3, 3
    s_and_b32 s8, s8, 3
    v_xor_b32 v199, s8, v251
    v_lshl_add_u32 v199, v199, 5, v252
    s_waitcnt vmcnt(8)
    v_add_u32 v200, s36, v196
    v_add_u32 v201, s36, v197
    v_add_u32 v202, s36, v198
    v_add_u32 v203, s36, v199
    ds_read_b64_tr_b16 a[80:81], v200 offset:0
    ds_read_b64_tr_b16 a[82:83], v200 offset:2048
    ds_read_b64_tr_b16 a[84:85], v201 offset:0
    ds_read_b64_tr_b16 a[86:87], v201 offset:2048
    ds_read_b64_tr_b16 a[88:89], v202 offset:0
    ds_read_b64_tr_b16 a[90:91], v202 offset:2048
    ds_read_b64_tr_b16 a[92:93], v203 offset:0
    ds_read_b64_tr_b16 a[94:95], v203 offset:2048
    v_add_u32 v200, s37, v196
    v_add_u32 v201, s37, v197
    v_add_u32 v202, s37, v198
    v_add_u32 v203, s37, v199
    ds_read_b64_tr_b16 a[96:97], v200 offset:0
    ds_read_b64_tr_b16 a[98:99], v200 offset:2048
    ds_read_b64_tr_b16 a[100:101], v201 offset:0
    ds_read_b64_tr_b16 a[102:103], v201 offset:2048
    ds_read_b64_tr_b16 a[104:105], v202 offset:0
    ds_read_b64_tr_b16 a[106:107], v202 offset:2048
    ds_read_b64_tr_b16 a[108:109], v203 offset:0
    ds_read_b64_tr_b16 a[110:111], v203 offset:2048
    v_add_u32 v200, s34, v196
    v_add_u32 v201, s34, v197
    v_add_u32 v202, s34, v198
    v_add_u32 v203, s34, v199
    ds_read_b64_tr_b16 a[112:113], v200 offset:0
    ds_read_b64_tr_b16 a[114:115], v200 offset:2048
    ds_read_b64_tr_b16 a[116:117], v201 offset:0
    ds_read_b64_tr_b16 a[118:119], v201 offset:2048
    ds_read_b64_tr_b16 a[120:121], v202 offset:0
    ds_read_b64_tr_b16 a[122:123], v202 offset:2048
    ds_read_b64_tr_b16 a[124:125], v203 offset:0
    ds_read_b64_tr_b16 a[126:127], v203 offset:2048
    s_waitcnt lgkmcnt(15)
    v_or_b32 v128, v128, v129
    v_or3_b32 v128, v128, v130, v131
    s_nop 0
    v_readfirstlane_b32 s8, v128
    s_nop 0
    s_andn2_b32 s8, s8, s39
    s_cbranch_scc1 L_FB
    s_waitcnt lgkmcnt(0)
    s_barrier
    v_add_u32 v230, 8192, v226
    v_add_u32 v231, 16384, v226
    v_add_u32 v232, 24576, v226
    s_add_u32 m0, s40, 24576
    s_add_u32 s14, s41, 110592
    buffer_load_dwordx4 v226, s[76:79], s14 offen offset:0 lds
    v_bfe_u32 v251, v224, 7, 2
    s_add_u32 s9, s3, 0
    s_and_b32 s9, s9, 3
    v_xor_b32 v252, s9, v251
    v_lshl_add_u32 v240, v252, 5, v229
    s_add_u32 s9, s3, 1
    s_and_b32 s9, s9, 3
    buffer_load_dwordx4 v230, s[76:79], s14 offen offset:1024 lds
    v_xor_b32 v252, s9, v251
    v_lshl_add_u32 v241, v252, 5, v229
    s_add_u32 s9, s3, 2
    s_and_b32 s9, s9, 3
    v_xor_b32 v252, s9, v251
    v_lshl_add_u32 v242, v252, 5, v229
    s_add_u32 s9, s3, 3
    s_and_b32 s9, s9, 3
    v_xor_b32 v252, s9, v251
    v_lshl_add_u32 v243, v252, 5, v229
    buffer_load_dwordx4 v231, s[76:79], s14 offen offset:2048 lds
    v_or_b32 v233, s42, v224
    v_add_u32 v234, 136192, v233
    v_add_u32 v235, 272384, v233
    v_add_u32 v236, 408576, v233
    v_add_u32 v237, 544768, v233
    v_mfma_f32_16x16x32_bf16 v[208:211], a[232:235], a[152:155], 0
    s_mov_b64 s[92:93], 0xffff
    s_mov_b32 s13, 0x3fb8aa3b
    s_mov_b32 s12, 0x358637bd
    buffer_load_dwordx4 v232, s[76:79], s14 offen offset:3072 lds
    v_mfma_f32_16x16x32_bf16 v[208:211], a[232:235], a[156:159], v[208:211]
    v_accvgpr_read_b32 v160, a216
    v_accvgpr_read_b32 v161, a217
    v_mfma_f32_16x16x32_bf16 v[208:211], a[232:235], a[160:163], v[208:211]
    v_accvgpr_read_b32 v162, a218
    v_accvgpr_read_b32 v163, a219
    v_mfma_f32_16x16x32_bf16 v[208:211], a[232:235], a[164:167], v[208:211]
    v_accvgpr_read_b32 v164, a220
    v_accvgpr_read_b32 v165, a221
    v_mfma_f32_16x16x32_bf16 v[208:211], a[232:235], a[168:171], v[208:211]
    s_waitcnt vmcnt(4)
    s_barrier
    buffer_store_dword v246, v245, s[64:67], s28 offen sc1
    v_accvgpr_read_b32 v166, a222
    v_accvgpr_read_b32 v167, a223
    v_mfma_f32_16x16x32_bf16 v[208:211], a[232:235], a[172:175], v[208:211]
    v_accvgpr_read_b32 v168, a224
    v_accvgpr_read_b32 v169, a225
    v_mfma_f32_16x16x32_bf16 v[208:211], a[232:235], a[176:179], v[208:211]
    v_accvgpr_read_b32 v170, a226
    v_accvgpr_read_b32 v171, a227
    v_mfma_f32_16x16x32_bf16 v[208:211], a[232:235], a[180:183], v[208:211]
    v_add_f32 v160, v160, v160 row_ror:8
    buffer_store_dword v246, v245, s[64:67], s29 offen sc1
    v_add_f32 v161, v161, v161 row_ror:8
    v_mfma_f32_16x16x32_bf16 v[208:211], a[232:235], a[184:187], v[208:211]
    v_add_f32 v162, v162, v162 row_ror:8
    v_add_f32 v163, v163, v163 row_ror:8
    v_mfma_f32_16x16x32_bf16 v[208:211], a[232:235], a[188:191], v[208:211]
    v_add_f32 v164, v164, v164 row_ror:8
    v_add_f32 v165, v165, v165 row_ror:8
    v_mfma_f32_16x16x32_bf16 v[208:211], a[232:235], a[192:195], v[208:211]
    v_add_f32 v166, v166, v166 row_ror:8
    s_add_u32 m0, s40, 28672
    s_add_u32 s14, s41, 147456
    buffer_load_dwordx4 v226, s[76:79], s14 offen offset:0 lds
    v_add_f32 v167, v167, v167 row_ror:8
    v_mfma_f32_16x16x32_bf16 v[208:211], a[232:235], a[196:199], v[208:211]
    v_add_f32 v168, v168, v168 row_ror:8
    v_add_f32 v169, v169, v169 row_ror:8
    v_mfma_f32_16x16x32_bf16 v[208:211], a[232:235], a[200:203], v[208:211]
    v_add_f32 v170, v170, v170 row_ror:8
    v_add_f32 v171, v171, v171 row_ror:8
    v_mfma_f32_16x16x32_bf16 v[208:211], a[232:235], a[204:207], v[208:211]
    v_add_f32 v160, v160, v160 row_ror:4
    v_add_f32 v161, v161, v161 row_ror:4
    buffer_load_dwordx4 v230, s[76:79], s14 offen offset:1024 lds
    v_mfma_f32_16x16x32_bf16 v[208:211], a[232:235], a[208:211], v[208:211]
    v_add_f32 v162, v162, v162 row_ror:4
    v_add_f32 v163, v163, v163 row_ror:4
    v_mfma_f32_16x16x32_bf16 v[208:211], a[232:235], a[212:215], v[208:211]
    v_add_f32 v164, v164, v164 row_ror:4
    v_add_f32 v165, v165, v165 row_ror:4
    v_mfma_f32_16x16x32_bf16 v[212:215], a[236:239], a[152:155], 0
    v_add_f32 v166, v166, v166 row_ror:4
    v_add_f32 v167, v167, v167 row_ror:4
    buffer_load_dwordx4 v231, s[76:79], s14 offen offset:2048 lds
    v_mfma_f32_16x16x32_bf16 v[212:215], a[236:239], a[156:159], v[212:215]
    v_add_f32 v168, v168, v168 row_ror:4
    v_add_f32 v169, v169, v169 row_ror:4
    v_mfma_f32_16x16x32_bf16 v[212:215], a[236:239], a[160:163], v[212:215]
    v_add_f32 v170, v170, v170 row_ror:4
    v_add_f32 v171, v171, v171 row_ror:4
    v_mfma_f32_16x16x32_bf16 v[212:215], a[236:239], a[164:167], v[212:215]
    v_add_f32 v160, v160, v160 row_ror:2
    v_add_f32 v161, v161, v161 row_ror:2
    v_mfma_f32_16x16x32_bf16 v[212:215], a[236:239], a[168:171], v[212:215]
    buffer_load_dwordx4 v232, s[76:79], s14 offen offset:3072 lds
    v_add_f32 v162, v162, v162 row_ror:2
    v_add_f32 v163, v163, v163 row_ror:2
    v_mfma_f32_16x16x32_bf16 v[212:215], a[236:239], a[172:175], v[212:215]
    v_add_f32 v164, v164, v164 row_ror:2
    v_add_f32 v165, v165, v165 row_ror:2
    v_mfma_f32_16x16x32_bf16 v[212:215], a[236:239], a[176:179], v[212:215]
    v_add_f32 v166, v166, v166 row_ror:2
    v_add_f32 v167, v167, v167 row_ror:2
    v_mfma_f32_16x16x32_bf16 v[212:215], a[236:239], a[180:183], v[212:215]
    v_add_f32 v168, v168, v168 row_ror:2
    s_add_u32 m0, s40, 32768
    s_add_u32 s14, s41, 184320
    buffer_load_dwordx4 v226, s[76:79], s14 offen offset:0 lds
    v_add_f32 v169, v169, v169 row_ror:2
    v_mfma_f32_16x16x32_bf16 v[212:215], a[236:239], a[184:187], v[212:215]
    v_add_f32 v170, v170, v170 row_ror:2
    v_add_f32 v171, v171, v171 row_ror:2
    v_mfma_f32_16x16x32_bf16 v[212:215], a[236:239], a[188:191], v[212:215]
    v_add_f32 v160, v160, v160 row_ror:1
    v_add_f32 v161, v161, v161 row_ror:1
    v_mfma_f32_16x16x32_bf16 v[212:215], a[236:239], a[192:195], v[212:215]
    v_add_f32 v162, v162, v162 row_ror:1
    buffer_load_dwordx4 v230, s[76:79], s14 offen offset:1024 lds
    v_add_f32 v163, v163, v163 row_ror:1
    v_mfma_f32_16x16x32_bf16 v[212:215], a[236:239], a[196:199], v[212:215]
    v_add_f32 v164, v164, v164 row_ror:1
    v_add_f32 v165, v165, v165 row_ror:1
    v_mfma_f32_16x16x32_bf16 v[212:215], a[236:239], a[200:203], v[212:215]
    v_add_f32 v166, v166, v166 row_ror:1
    v_add_f32 v167, v167, v167 row_ror:1
    v_mfma_f32_16x16x32_bf16 v[212:215], a[236:239], a[204:207], v[212:215]
    v_add_f32 v168, v168, v168 row_ror:1
    v_add_f32 v169, v169, v169 row_ror:1
    buffer_load_dwordx4 v231, s[76:79], s14 offen offset:2048 lds
    v_mfma_f32_16x16x32_bf16 v[212:215], a[236:239], a[208:211], v[212:215]
    v_add_f32 v170, v170, v170 row_ror:1
    v_add_f32 v171, v171, v171 row_ror:1
    v_mfma_f32_16x16x32_bf16 v[212:215], a[236:239], a[212:215], v[212:215]
    v_cndmask_b32 v172, 0, v164, s[92:93]
    v_cndmask_b32 v164, v164, 0, s[92:93]
    v_mfma_f32_16x16x32_bf16 v[216:219], a[240:243], a[152:155], 0
    v_cndmask_b32 v173, 0, v165, s[92:93]
    v_cndmask_b32 v165, v165, 0, s[92:93]
    v_mfma_f32_16x16x32_bf16 v[216:219], a[240:243], a[156:159], v[216:219]
    buffer_load_dwordx4 v232, s[76:79], s14 offen offset:3072 lds
    v_cndmask_b32 v168, 0, v168, s[92:93]
    v_cndmask_b32 v169, 0, v169, s[92:93]
    v_mfma_f32_16x16x32_bf16 v[216:219], a[240:243], a[160:163], v[216:219]
    v_cndmask_b32 v170, 0, v170, s[92:93]
    v_cndmask_b32 v171, 0, v171, s[92:93]
    v_mfma_f32_16x16x32_bf16 v[216:219], a[240:243], a[164:167], v[216:219]
    v_accvgpr_read_b32 v176, a128
    v_accvgpr_read_b32 v177, a129
    v_mfma_f32_16x16x32_bf16 v[216:219], a[240:243], a[168:171], v[216:219]
    s_add_u32 m0, s40, 36864
    s_add_u32 s14, s41, 221184
    buffer_load_dwordx4 v226, s[76:79], s14 offen offset:0 lds
    v_accvgpr_read_b32 v178, a130
    v_accvgpr_read_b32 v179, a131
    v_mfma_f32_16x16x32_bf16 v[216:219], a[240:243], a[172:175], v[216:219]
    v_accvgpr_read_b32 v180, a132
    v_accvgpr_read_b32 v181, a133
    v_mfma_f32_16x16x32_bf16 v[216:219], a[240:243], a[176:179], v[216:219]
    v_accvgpr_read_b32 v182, a134
    v_accvgpr_read_b32 v183, a135
    v_mfma_f32_16x16x32_bf16 v[216:219], a[240:243], a[180:183], v[216:219]
    v_mul_f32 v200, s13, v176
    buffer_load_dwordx4 v230, s[76:79], s14 offen offset:1024 lds
    v_mul_f32 v201, s13, v177
    v_mfma_f32_16x16x32_bf16 v[216:219], a[240:243], a[184:187], v[216:219]
    v_mul_f32 v202, s13, v178
    v_mul_f32 v203, s13, v179
    v_mfma_f32_16x16x32_bf16 v[216:219], a[240:243], a[188:191], v[216:219]
    v_mul_f32 v204, s13, v180
    v_mul_f32 v205, s13, v181
    v_mfma_f32_16x16x32_bf16 v[216:219], a[240:243], a[192:195], v[216:219]
    v_mul_f32 v206, s13, v182
    buffer_load_dwordx4 v231, s[76:79], s14 offen offset:2048 lds
    v_mul_f32 v207, s13, v183
    v_mfma_f32_16x16x32_bf16 v[216:219], a[240:243], a[196:199], v[216:219]
    v_exp_f32 v200, v200 clamp
    v_mfma_f32_16x16x32_bf16 v[216:219], a[240:243], a[200:203], v[216:219]
    v_exp_f32 v201, v201 clamp
    v_mfma_f32_16x16x32_bf16 v[216:219], a[240:243], a[204:207], v[216:219]
    v_exp_f32 v202, v202 clamp
    v_mfma_f32_16x16x32_bf16 v[216:219], a[240:243], a[208:211], v[216:219]
    v_exp_f32 v203, v203 clamp
    v_mfma_f32_16x16x32_bf16 v[216:219], a[240:243], a[212:215], v[216:219]
    buffer_load_dwordx4 v232, s[76:79], s14 offen offset:3072 lds
    v_exp_f32 v204, v204 clamp
    v_exp_f32 v205, v205 clamp
    v_exp_f32 v206, v206 clamp
    v_exp_f32 v207, v207 clamp
    v_max_f32 v176, 0, v176
    v_max_f32 v177, 0, v177
    v_max_f32 v178, 0, v178
    v_max_f32 v179, 0, v179
    v_max_f32 v180, 0, v180
    v_max_f32 v181, 0, v181
    s_add_u32 m0, s40, 0
    s_add_u32 s14, s41, 258048
    buffer_load_dwordx4 v226, s[76:79], s14 offen offset:0 lds
    v_max_f32 v182, 0, v182
    v_max_f32 v183, 0, v183
    v_add_f32 v200, s12, v200
    v_add_f32 v201, s12, v201
    v_add_f32 v202, s12, v202
    v_add_f32 v203, s12, v203
    v_add_f32 v204, s12, v204
    v_add_f32 v205, s12, v205
    v_add_f32 v206, s12, v206
    buffer_load_dwordx4 v230, s[76:79], s14 offen offset:1024 lds
    v_add_f32 v207, s12, v207
    v_add_f32 v176, v176, v200
    v_add_f32 v177, v177, v201
    v_add_f32 v178, v178, v202
    v_add_f32 v179, v179, v203
    v_add_f32 v180, v180, v204
    v_add_f32 v181, v181, v205
    v_add_f32 v182, v182, v206
    v_add_f32 v183, v183, v207
    v_accvgpr_read_b32 v184, a136
    buffer_load_dwordx4 v231, s[76:79], s14 offen offset:2048 lds
    v_accvgpr_read_b32 v185, a137
    v_accvgpr_read_b32 v186, a138
    v_accvgpr_read_b32 v187, a139
    v_accvgpr_read_b32 v188, a140
    v_accvgpr_read_b32 v189, a141
    v_accvgpr_read_b32 v190, a142
    v_accvgpr_read_b32 v191, a143
    v_mul_f32 v200, s13, v184
    v_mul_f32 v201, s13, v185
    v_mul_f32 v202, s13, v186
    buffer_load_dwordx4 v232, s[76:79], s14 offen offset:3072 lds
    v_mul_f32 v203, s13, v187
    v_mul_f32 v204, s13, v188
    v_mul_f32 v205, s13, v189
    v_mul_f32 v206, s13, v190
    v_mul_f32 v207, s13, v191
    v_exp_f32 v200, v200 clamp
    v_exp_f32 v201, v201 clamp
    v_exp_f32 v202, v202 clamp
    v_exp_f32 v203, v203 clamp
    s_add_u32 m0, s40, 4096
    s_add_u32 s14, s41, 294912
    buffer_load_dwordx4 v226, s[76:79], s14 offen offset:0 lds
    v_exp_f32 v204, v204 clamp
    v_exp_f32 v205, v205 clamp
    v_exp_f32 v206, v206 clamp
    v_exp_f32 v207, v207 clamp
    v_max_f32 v184, 0, v184
    v_max_f32 v185, 0, v185
    v_max_f32 v186, 0, v186
    v_max_f32 v187, 0, v187
    v_max_f32 v188, 0, v188
    v_max_f32 v189, 0, v189
    buffer_load_dwordx4 v230, s[76:79], s14 offen offset:1024 lds
    v_max_f32 v190, 0, v190
    v_max_f32 v191, 0, v191
    v_add_f32 v200, s12, v200
    v_add_f32 v201, s12, v201
    v_add_f32 v202, s12, v202
    v_add_f32 v203, s12, v203
    v_add_f32 v204, s12, v204
    v_add_f32 v205, s12, v205
    v_add_f32 v206, s12, v206
    buffer_load_dwordx4 v231, s[76:79], s14 offen offset:2048 lds
    v_add_f32 v207, s12, v207
    v_add_f32 v184, v184, v200
    v_add_f32 v185, v185, v201
    v_add_f32 v186, v186, v202
    v_add_f32 v187, v187, v203
    v_add_f32 v188, v188, v204
    v_add_f32 v189, v189, v205
    v_add_f32 v190, v190, v206
    v_add_f32 v191, v191, v207
    v_mov_b32 v207, 0
    buffer_load_dwordx4 v232, s[76:79], s14 offen offset:3072 lds
    v_cvt_pk_bf16_f32 v208, v208, v209
    v_cvt_pk_bf16_f32 v209, v210, v211
    s_mul_i32 vcc_lo, s47, 0xfff0fff0
    s_mov_b32 vcc_hi, vcc_lo
    v_cndmask_b32 v208, v208, v207, vcc
    v_cndmask_b32 v209, v209, v207, vcc
    buffer_store_dwordx2 v[208:209], v227, s[64:67], s18 offen sc1
    v_cvt_pk_bf16_f32 v212, v212, v213
    v_cvt_pk_bf16_f32 v213, v214, v215
    s_add_u32 s8, s18, 81920
    s_add_u32 m0, s40, 8192
    s_add_u32 s14, s41, 331776
    buffer_load_dwordx4 v226, s[76:79], s14 offen offset:0 lds
    v_cndmask_b32 v212, v212, v207, vcc
    v_cndmask_b32 v213, v213, v207, vcc
    buffer_store_dwordx2 v[212:213], v227, s[64:67], s8 offen sc1
    v_cvt_pk_bf16_f32 v216, v216, v217
    v_cvt_pk_bf16_f32 v217, v218, v219
    v_cndmask_b32 v216, v216, v207, vcc
    v_cndmask_b32 v217, v217, v207, vcc
    buffer_store_dwordx2 v[216:217], v227, s[64:67], s20 offen sc1
    v_accvgpr_read_b32 v192, a144
    buffer_load_dwordx4 v230, s[76:79], s14 offen offset:1024 lds
    v_accvgpr_read_b32 v193, a145
    v_accvgpr_read_b32 v194, a146
    v_accvgpr_read_b32 v195, a147
    v_accvgpr_read_b32 v196, a148
    v_accvgpr_read_b32 v197, a149
    v_accvgpr_read_b32 v198, a150
    v_accvgpr_read_b32 v199, a151
    v_mul_f32 v200, s13, v192
    v_mul_f32 v201, s13, v193
    v_mul_f32 v202, s13, v194
    buffer_load_dwordx4 v231, s[76:79], s14 offen offset:2048 lds
    v_mul_f32 v203, s13, v195
    v_mul_f32 v204, s13, v196
    v_mul_f32 v205, s13, v197
    v_mul_f32 v206, s13, v198
    v_mul_f32 v207, s13, v199
    v_exp_f32 v200, v200 clamp
    v_exp_f32 v201, v201 clamp
    v_exp_f32 v202, v202 clamp
    v_exp_f32 v203, v203 clamp
    buffer_load_dwordx4 v232, s[76:79], s14 offen offset:3072 lds
    v_exp_f32 v204, v204 clamp
    v_exp_f32 v205, v205 clamp
    v_exp_f32 v206, v206 clamp
    v_exp_f32 v207, v207 clamp
    v_max_f32 v192, 0, v192
    v_max_f32 v193, 0, v193
    v_max_f32 v194, 0, v194
    v_max_f32 v195, 0, v195
    v_max_f32 v196, 0, v196
    v_max_f32 v197, 0, v197
    s_add_u32 m0, s40, 12288
    s_add_u32 s14, s41, 368640
    buffer_load_dwordx4 v226, s[76:79], s14 offen offset:0 lds
    v_max_f32 v198, 0, v198
    v_max_f32 v199, 0, v199
    v_add_f32 v200, s12, v200
    v_add_f32 v201, s12, v201
    v_add_f32 v202, s12, v202
    v_add_f32 v203, s12, v203
    v_add_f32 v204, s12, v204
    v_add_f32 v205, s12, v205
    v_add_f32 v206, s12, v206
    v_add_f32 v207, s12, v207
    buffer_load_dwordx4 v230, s[76:79], s14 offen offset:1024 lds
    v_add_f32 v192, v192, v200
    v_add_f32 v193, v193, v201
    v_add_f32 v194, v194, v202
    v_add_f32 v195, v195, v203
    v_add_f32 v196, v196, v204
    v_add_f32 v197, v197, v205
    v_add_f32 v198, v198, v206
    v_add_f32 v199, v199, v207
    v_mul_f32 v200, v176, v160
    buffer_load_dwordx4 v231, s[76:79], s14 offen offset:2048 lds
    v_mul_f32 v201, v184, v164
    v_fmac_f32 v200, v177, v161
    v_fmac_f32 v201, v185, v165
    v_fmac_f32 v200, v178, v162
    v_fmac_f32 v201, v186, v166
    v_fmac_f32 v200, v179, v163
    v_fmac_f32 v201, v187, v167
    v_fmac_f32 v200, v184, v172
    v_fmac_f32 v200, v185, v173
    v_fmac_f32 v201, v192, v168
    buffer_load_dwordx4 v232, s[76:79], s14 offen offset:3072 lds
    v_fmac_f32 v201, v193, v169
    v_fmac_f32 v201, v194, v170
    v_fmac_f32 v201, v195, v171
    v_mul_f32 v202, v180, v160
    v_mul_f32 v203, v188, v164
    v_fmac_f32 v202, v181, v161
    v_fmac_f32 v203, v189, v165
    v_fmac_f32 v202, v182, v162
    v_fmac_f32 v203, v190, v166
    v_fmac_f32 v202, v183, v163
    s_add_u32 m0, s40, 16384
    s_add_u32 s14, s41, 405504
    buffer_load_dwordx4 v226, s[76:79], s14 offen offset:0 lds
    v_fmac_f32 v203, v191, v167
    v_fmac_f32 v202, v188, v172
    v_fmac_f32 v202, v189, v173
    v_fmac_f32 v203, v196, v168
    v_fmac_f32 v203, v197, v169
    v_fmac_f32 v203, v198, v170
    v_fmac_f32 v203, v199, v171
    v_mov_b32 v204, v200
    v_mov_b32 v205, v201
    s_nop 0
    v_permlane16_swap_b32 v204, v200
    v_permlane16_swap_b32 v205, v201
    buffer_load_dwordx4 v230, s[76:79], s14 offen offset:1024 lds
    v_add_f32 v200, v200, v204
    v_add_f32 v201, v201, v205
    v_mov_b32 v204, v200
    v_mov_b32 v205, v201
    s_nop 0
    v_permlane32_swap_b32 v204, v200
    v_permlane32_swap_b32 v205, v201
    buffer_load_dwordx4 v231, s[76:79], s14 offen offset:2048 lds
    v_add_f32 v200, v200, v204
    v_add_f32 v201, v201, v205
    v_mov_b32 v204, v202
    v_mov_b32 v205, v203
    s_nop 0
    v_permlane16_swap_b32 v204, v202
    v_permlane16_swap_b32 v205, v203
    v_add_f32 v202, v202, v204
    v_add_f32 v203, v203, v205
    buffer_load_dwordx4 v232, s[76:79], s14 offen offset:3072 lds
    v_mov_b32 v204, v202
    v_mov_b32 v205, v203
    s_nop 0
    v_permlane32_swap_b32 v204, v202
    v_permlane32_swap_b32 v205, v203
    v_add_f32 v202, v202, v204
    v_add_f32 v203, v203, v205
    v_add_f32 v200, s12, v200
    v_add_f32 v201, s12, v201
    v_add_f32 v202, s12, v202
    s_add_u32 m0, s40, 20480
    s_add_u32 s14, s41, 442368
    buffer_load_dwordx4 v226, s[76:79], s14 offen offset:0 lds
    v_add_f32 v203, s12, v203
    v_rcp_f32 v200, v200
    v_rcp_f32 v201, v201
    v_rcp_f32 v202, v202
    v_rcp_f32 v203, v203
    v_bfrev_b32 v206, 1
    v_lshrrev_b32 v207, 1, v224
    v_cndmask_b32 v206, v206, v207, s[92:93]
    s_add_u32 s8, s50, 18432
    s_add_u32 s9, s51, 18432
    buffer_load_dwordx4 v230, s[76:79], s14 offen offset:1024 lds
    v_cndmask_b32 v207, v201, v200, s[92:93]
    v_mul_f32 v176, v176, v200
    v_mul_f32 v177, v177, v200
    v_mul_f32 v178, v178, v200
    v_mul_f32 v179, v179, v200
    v_mul_f32 v184, v184, v207
    v_mul_f32 v185, v185, v207
    v_mul_f32 v186, v186, v201
    v_mul_f32 v187, v187, v201
    buffer_load_dwordx4 v231, s[76:79], s14 offen offset:2048 lds
    v_mul_f32 v192, v192, v201
    v_mul_f32 v193, v193, v201
    v_mul_f32 v194, v194, v201
    v_mul_f32 v195, v195, v201
    v_cvt_pk_bf16_f32 v176, v176, v177
    v_cvt_pk_bf16_f32 v177, v178, v179
    v_cvt_pk_bf16_f32 v178, v184, v185
    v_cvt_pk_bf16_f32 v179, v186, v187
    v_cvt_pk_bf16_f32 v192, v192, v193
    v_cvt_pk_bf16_f32 v193, v194, v195
    buffer_load_dwordx4 v232, s[76:79], s14 offen offset:3072 lds
    buffer_store_dwordx4 v[176:179], v224, s[64:67], s50 offen sc1
    buffer_store_dwordx2 v[192:193], v206, s[64:67], s51 offen sc1
    v_cndmask_b32 v207, v203, v202, s[92:93]
    v_mul_f32 v180, v180, v202
    v_mul_f32 v181, v181, v202
    v_mul_f32 v182, v182, v202
    v_mul_f32 v183, v183, v202
    v_mul_f32 v188, v188, v207
    v_mul_f32 v189, v189, v207
    v_mul_f32 v190, v190, v203
    s_waitcnt vmcnt(43)
    ds_read_b64_tr_b16 v[80:81], v240 offset:24576
    ds_read_b64_tr_b16 v[82:83], v240 offset:26624
    ds_read_b64_tr_b16 v[84:85], v241 offset:24576
    ds_read_b64_tr_b16 v[86:87], v241 offset:26624
    ds_read_b64_tr_b16 v[88:89], v242 offset:24576
    ds_read_b64_tr_b16 v[90:91], v242 offset:26624
    ds_read_b64_tr_b16 v[92:93], v243 offset:24576
    ds_read_b64_tr_b16 v[94:95], v243 offset:26624
    s_waitcnt lgkmcnt(0)
    s_add_u32 m0, s40, 24576
    s_add_u32 s14, s41, 479232
    buffer_load_dwordx4 v226, s[76:79], s14 offen offset:0 lds
    v_mul_f32 v191, v191, v203
    v_mul_f32 v196, v196, v203
    v_mul_f32 v197, v197, v203
    v_mul_f32 v198, v198, v203
    v_mul_f32 v199, v199, v203
    v_cvt_pk_bf16_f32 v180, v180, v181
    v_cvt_pk_bf16_f32 v181, v182, v183
    v_cvt_pk_bf16_f32 v182, v188, v189
    v_cvt_pk_bf16_f32 v183, v190, v191
    buffer_load_dwordx4 v230, s[76:79], s14 offen offset:1024 lds
    v_cvt_pk_bf16_f32 v196, v196, v197
    v_cvt_pk_bf16_f32 v197, v198, v199
    buffer_store_dwordx4 v[180:183], v224, s[64:67], s8 offen sc1
    buffer_store_dwordx2 v[196:197], v206, s[64:67], s9 offen sc1
    buffer_load_dwordx4 v231, s[76:79], s14 offen offset:2048 lds
    buffer_load_dwordx4 v232, s[76:79], s14 offen offset:3072 lds
    s_waitcnt vmcnt(43)
    ds_read_b64_tr_b16 v[96:97], v240 offset:28672
    ds_read_b64_tr_b16 v[98:99], v240 offset:30720
    ds_read_b64_tr_b16 v[100:101], v241 offset:28672
    ds_read_b64_tr_b16 v[102:103], v241 offset:30720
    ds_read_b64_tr_b16 v[104:105], v242 offset:28672
    ds_read_b64_tr_b16 v[106:107], v242 offset:30720
    ds_read_b64_tr_b16 v[108:109], v243 offset:28672
    ds_read_b64_tr_b16 v[110:111], v243 offset:30720
    s_waitcnt lgkmcnt(0)
    s_add_u32 m0, s40, 28672
    s_add_u32 s14, s41, 516096
    buffer_load_dwordx4 v226, s[76:79], s14 offen offset:0 lds
    buffer_load_dwordx4 v230, s[76:79], s14 offen offset:1024 lds
    buffer_load_dwordx4 v231, s[76:79], s14 offen offset:2048 lds
    buffer_load_dwordx4 v232, s[76:79], s14 offen offset:3072 lds
    s_waitcnt vmcnt(43)
    ds_read_b64_tr_b16 v[112:113], v240 offset:32768
    ds_read_b64_tr_b16 v[114:115], v240 offset:34816
    ds_read_b64_tr_b16 v[116:117], v241 offset:32768
    ds_read_b64_tr_b16 v[118:119], v241 offset:34816
    ds_read_b64_tr_b16 v[120:121], v242 offset:32768
    ds_read_b64_tr_b16 v[122:123], v242 offset:34816
    ds_read_b64_tr_b16 v[124:125], v243 offset:32768
    ds_read_b64_tr_b16 v[126:127], v243 offset:34816
    s_waitcnt lgkmcnt(0)
    s_add_u32 m0, s40, 32768
    s_add_u32 s14, s41, 552960
    buffer_load_dwordx4 v226, s[76:79], s14 offen offset:0 lds
    buffer_load_dwordx4 v230, s[76:79], s14 offen offset:1024 lds
    buffer_load_dwordx4 v231, s[76:79], s14 offen offset:2048 lds
    buffer_load_dwordx4 v232, s[76:79], s14 offen offset:3072 lds
    s_waitcnt vmcnt(43)
    ds_read_b64_tr_b16 v[128:129], v240 offset:36864
    ds_read_b64_tr_b16 v[130:131], v240 offset:38912
    ds_read_b64_tr_b16 v[132:133], v241 offset:36864
    ds_read_b64_tr_b16 v[134:135], v241 offset:38912
    ds_read_b64_tr_b16 v[136:137], v242 offset:36864
    ds_read_b64_tr_b16 v[138:139], v242 offset:38912
    ds_read_b64_tr_b16 v[140:141], v243 offset:36864
    ds_read_b64_tr_b16 v[142:143], v243 offset:38912
    s_waitcnt lgkmcnt(0)
    s_add_u32 m0, s40, 36864
    s_add_u32 s14, s41, 589824
    buffer_load_dwordx4 v226, s[76:79], s14 offen offset:0 lds
    buffer_load_dwordx4 v230, s[76:79], s14 offen offset:1024 lds
    buffer_load_dwordx4 v231, s[76:79], s14 offen offset:2048 lds
    buffer_load_dwordx4 v232, s[76:79], s14 offen offset:3072 lds
    s_waitcnt vmcnt(43)
    ds_read_b64_tr_b16 v[144:145], v240 offset:0
    ds_read_b64_tr_b16 v[146:147], v240 offset:2048
    ds_read_b64_tr_b16 v[148:149], v241 offset:0
    ds_read_b64_tr_b16 v[150:151], v241 offset:2048
    ds_read_b64_tr_b16 v[152:153], v242 offset:0
    ds_read_b64_tr_b16 v[154:155], v242 offset:2048
    ds_read_b64_tr_b16 v[156:157], v243 offset:0
    ds_read_b64_tr_b16 v[158:159], v243 offset:2048
    s_waitcnt lgkmcnt(0)
    s_add_u32 m0, s40, 0
    s_add_u32 s14, s41, 626688
    buffer_load_dwordx4 v226, s[76:79], s14 offen offset:0 lds
    buffer_load_dwordx4 v230, s[76:79], s14 offen offset:1024 lds
    buffer_load_dwordx4 v231, s[76:79], s14 offen offset:2048 lds
    buffer_load_dwordx4 v232, s[76:79], s14 offen offset:3072 lds
    buffer_load_dword v247, v228, s[64:67], s49 offen sc1
    s_waitcnt vmcnt(44)
    ds_read_b64_tr_b16 a[128:129], v240 offset:4096
    ds_read_b64_tr_b16 a[130:131], v240 offset:6144
    ds_read_b64_tr_b16 a[132:133], v241 offset:4096
    ds_read_b64_tr_b16 a[134:135], v241 offset:6144
    ds_read_b64_tr_b16 a[136:137], v242 offset:4096
    ds_read_b64_tr_b16 a[138:139], v242 offset:6144
    ds_read_b64_tr_b16 a[140:141], v243 offset:4096
    ds_read_b64_tr_b16 a[142:143], v243 offset:6144
    s_waitcnt lgkmcnt(0)
    s_add_u32 m0, s40, 4096
    s_add_u32 s14, s41, 663552
    buffer_load_dwordx4 v226, s[76:79], s14 offen offset:0 lds
    buffer_load_dwordx4 v230, s[76:79], s14 offen offset:1024 lds
    buffer_load_dwordx4 v231, s[76:79], s14 offen offset:2048 lds
    buffer_load_dwordx4 v232, s[76:79], s14 offen offset:3072 lds
    s_waitcnt vmcnt(41)
    ds_read_b64_tr_b16 a[144:145], v240 offset:8192
    ds_read_b64_tr_b16 a[146:147], v240 offset:10240
    ds_read_b64_tr_b16 a[148:149], v241 offset:8192
    ds_read_b64_tr_b16 a[150:151], v241 offset:10240
    ds_read_b64_tr_b16 a[152:153], v242 offset:8192
    ds_read_b64_tr_b16 a[154:155], v242 offset:10240
    ds_read_b64_tr_b16 a[156:157], v243 offset:8192
    ds_read_b64_tr_b16 a[158:159], v243 offset:10240
    s_waitcnt lgkmcnt(0)
    s_add_u32 m0, s40, 8192
    s_add_u32 s14, s41, 700416
    buffer_load_dwordx4 v226, s[76:79], s14 offen offset:0 lds
    buffer_load_dwordx4 v230, s[76:79], s14 offen offset:1024 lds
    buffer_load_dwordx4 v231, s[76:79], s14 offen offset:2048 lds
    buffer_load_dwordx4 v232, s[76:79], s14 offen offset:3072 lds
    s_waitcnt vmcnt(41)
    ds_read_b64_tr_b16 a[160:161], v240 offset:12288
    ds_read_b64_tr_b16 a[162:163], v240 offset:14336
    ds_read_b64_tr_b16 a[164:165], v241 offset:12288
    ds_read_b64_tr_b16 a[166:167], v241 offset:14336
    ds_read_b64_tr_b16 a[168:169], v242 offset:12288
    ds_read_b64_tr_b16 a[170:171], v242 offset:14336
    ds_read_b64_tr_b16 a[172:173], v243 offset:12288
    ds_read_b64_tr_b16 a[174:175], v243 offset:14336
    s_waitcnt lgkmcnt(0)
    s_add_u32 m0, s40, 12288
    s_add_u32 s14, s41, 737280
    buffer_load_dwordx4 v226, s[76:79], s14 offen offset:0 lds
    buffer_load_dwordx4 v230, s[76:79], s14 offen offset:1024 lds
    buffer_load_dwordx4 v231, s[76:79], s14 offen offset:2048 lds
    buffer_load_dwordx4 v232, s[76:79], s14 offen offset:3072 lds
    s_waitcnt vmcnt(41)
    ds_read_b64_tr_b16 a[176:177], v240 offset:16384
    ds_read_b64_tr_b16 a[178:179], v240 offset:18432
    ds_read_b64_tr_b16 a[180:181], v241 offset:16384
    ds_read_b64_tr_b16 a[182:183], v241 offset:18432
    ds_read_b64_tr_b16 a[184:185], v242 offset:16384
    ds_read_b64_tr_b16 a[186:187], v242 offset:18432
    ds_read_b64_tr_b16 a[188:189], v243 offset:16384
    ds_read_b64_tr_b16 a[190:191], v243 offset:18432
    s_waitcnt lgkmcnt(0)
    s_add_u32 m0, s40, 16384
    s_add_u32 s14, s41, 774144
    buffer_load_dwordx4 v226, s[76:79], s14 offen offset:0 lds
    buffer_load_dwordx4 v230, s[76:79], s14 offen offset:1024 lds
    buffer_load_dwordx4 v231, s[76:79], s14 offen offset:2048 lds
    buffer_load_dwordx4 v232, s[76:79], s14 offen offset:3072 lds
    s_waitcnt vmcnt(16)
    v_cmp_ne_u32 vcc, 1, v247
    s_nop 0
    s_cbranch_vccnz L_SPIN_C
L_BACK_C:
    s_cmp_lg_u32 s43, 0
    s_cbranch_scc1 L_OUT4
    s_add_u32 s15, s44, 0
    buffer_load_dwordx4 a[0:3], v233, s[64:67], s15 offen offset:0
    buffer_load_dwordx4 a[4:7], v234, s[64:67], s15 offen offset:0
    buffer_load_dwordx4 a[8:11], v235, s[64:67], s15 offen offset:0
    buffer_load_dwordx4 a[12:15], v236, s[64:67], s15 offen offset:0
    buffer_load_dwordx4 a[16:19], v237, s[64:67], s15 offen offset:0
    buffer_load_dwordx4 a[20:23], v233, s[64:67], s15 offen offset:1024
    buffer_load_dwordx4 a[24:27], v234, s[64:67], s15 offen offset:1024
    buffer_load_dwordx4 a[28:31], v235, s[64:67], s15 offen offset:1024
    buffer_load_dwordx4 a[32:35], v236, s[64:67], s15 offen offset:1024
    buffer_load_dwordx4 a[36:39], v237, s[64:67], s15 offen offset:1024
    buffer_load_dwordx4 a[40:43], v233, s[64:67], s15 offen offset:2048
    buffer_load_dwordx4 a[44:47], v234, s[64:67], s15 offen offset:2048
    buffer_load_dwordx4 a[48:51], v235, s[64:67], s15 offen offset:2048
    buffer_load_dwordx4 a[52:55], v236, s[64:67], s15 offen offset:2048
    buffer_load_dwordx4 a[56:59], v237, s[64:67], s15 offen offset:2048
    buffer_load_dwordx4 a[60:63], v233, s[64:67], s15 offen offset:3072
    buffer_load_dwordx4 a[64:67], v234, s[64:67], s15 offen offset:3072
    buffer_load_dwordx4 a[68:71], v235, s[64:67], s15 offen offset:3072
    buffer_load_dwordx4 a[72:75], v236, s[64:67], s15 offen offset:3072
    buffer_load_dwordx4 a[76:79], v237, s[64:67], s15 offen offset:3072
    s_waitcnt vmcnt(15)
    v_mfma_f32_16x16x32_bf16 v[0:3], a[80:83], a[0:3], 0
    v_mfma_f32_16x16x32_bf16 v[20:23], a[84:87], a[0:3], 0
    v_mfma_f32_16x16x32_bf16 v[40:43], a[88:91], a[0:3], 0
    v_mfma_f32_16x16x32_bf16 v[60:63], a[92:95], a[0:3], 0
    s_add_u32 s15, s44, 4096
    buffer_load_dwordx4 a[0:3], v233, s[64:67], s15 offen offset:0
    v_mfma_f32_16x16x32_bf16 v[64:67], a[92:95], a[4:7], 0
    v_mfma_f32_16x16x32_bf16 v[44:47], a[88:91], a[4:7], 0
    v_mfma_f32_16x16x32_bf16 v[24:27], a[84:87], a[4:7], 0
    v_mfma_f32_16x16x32_bf16 v[4:7], a[80:83], a[4:7], 0
    buffer_load_dwordx4 a[4:7], v234, s[64:67], s15 offen offset:0
    v_mfma_f32_16x16x32_bf16 v[8:11], a[80:83], a[8:11], 0
    v_mfma_f32_16x16x32_bf16 v[28:31], a[84:87], a[8:11], 0
    v_mfma_f32_16x16x32_bf16 v[48:51], a[88:91], a[8:11], 0
    v_mfma_f32_16x16x32_bf16 v[68:71], a[92:95], a[8:11], 0
    buffer_load_dwordx4 a[8:11], v235, s[64:67], s15 offen offset:0
    v_mfma_f32_16x16x32_bf16 v[72:75], a[92:95], a[12:15], 0
    v_mfma_f32_16x16x32_bf16 v[52:55], a[88:91], a[12:15], 0
    v_mfma_f32_16x16x32_bf16 v[32:35], a[84:87], a[12:15], 0
    v_mfma_f32_16x16x32_bf16 v[12:15], a[80:83], a[12:15], 0
    buffer_load_dwordx4 a[12:15], v236, s[64:67], s15 offen offset:0
    v_mfma_f32_16x16x32_bf16 v[16:19], a[80:83], a[16:19], 0
    v_mfma_f32_16x16x32_bf16 v[36:39], a[84:87], a[16:19], 0
    v_mfma_f32_16x16x32_bf16 v[56:59], a[88:91], a[16:19], 0
    v_mfma_f32_16x16x32_bf16 v[76:79], a[92:95], a[16:19], 0
    s_waitcnt vmcnt(14)
    buffer_load_dwordx4 a[16:19], v237, s[64:67], s15 offen offset:0
    v_mfma_f32_16x16x32_bf16 v[0:3], a[96:99], a[20:23], v[0:3]
    v_mfma_f32_16x16x32_bf16 v[20:23], a[100:103], a[20:23], v[20:23]
    v_mfma_f32_16x16x32_bf16 v[40:43], a[104:107], a[20:23], v[40:43]
    v_mfma_f32_16x16x32_bf16 v[60:63], a[108:111], a[20:23], v[60:63]
    buffer_load_dwordx4 a[20:23], v233, s[64:67], s15 offen offset:1024
    v_mfma_f32_16x16x32_bf16 v[64:67], a[108:111], a[24:27], v[64:67]
    s_barrier
    buffer_store_dword v246, v245, s[64:67], s30 offen sc1
    v_mfma_f32_16x16x32_bf16 v[44:47], a[104:107], a[24:27], v[44:47]
    v_mfma_f32_16x16x32_bf16 v[24:27], a[100:103], a[24:27], v[24:27]
    v_mfma_f32_16x16x32_bf16 v[4:7], a[96:99], a[24:27], v[4:7]
    buffer_load_dwordx4 a[24:27], v234, s[64:67], s15 offen offset:1024
    v_mfma_f32_16x16x32_bf16 v[8:11], a[96:99], a[28:31], v[8:11]
    v_mfma_f32_16x16x32_bf16 v[28:31], a[100:103], a[28:31], v[28:31]
    v_mfma_f32_16x16x32_bf16 v[48:51], a[104:107], a[28:31], v[48:51]
    v_mfma_f32_16x16x32_bf16 v[68:71], a[108:111], a[28:31], v[68:71]
    buffer_load_dwordx4 a[28:31], v235, s[64:67], s15 offen offset:1024
    v_mfma_f32_16x16x32_bf16 v[72:75], a[108:111], a[32:35], v[72:75]
    v_mfma_f32_16x16x32_bf16 v[52:55], a[104:107], a[32:35], v[52:55]
    v_mfma_f32_16x16x32_bf16 v[32:35], a[100:103], a[32:35], v[32:35]
    v_mfma_f32_16x16x32_bf16 v[12:15], a[96:99], a[32:35], v[12:15]
    buffer_load_dwordx4 a[32:35], v236, s[64:67], s15 offen offset:1024
    v_mfma_f32_16x16x32_bf16 v[16:19], a[96:99], a[36:39], v[16:19]
    v_mfma_f32_16x16x32_bf16 v[36:39], a[100:103], a[36:39], v[36:39]
    v_mfma_f32_16x16x32_bf16 v[56:59], a[104:107], a[36:39], v[56:59]
    v_mfma_f32_16x16x32_bf16 v[76:79], a[108:111], a[36:39], v[76:79]
    s_waitcnt vmcnt(15)
    buffer_load_dwordx4 a[36:39], v237, s[64:67], s15 offen offset:1024
    v_mfma_f32_16x16x32_bf16 v[0:3], a[112:115], a[40:43], v[0:3]
    v_mfma_f32_16x16x32_bf16 v[20:23], a[116:119], a[40:43], v[20:23]
    v_mfma_f32_16x16x32_bf16 v[40:43], a[120:123], a[40:43], v[40:43]
    v_mfma_f32_16x16x32_bf16 v[60:63], a[124:127], a[40:43], v[60:63]
    buffer_load_dwordx4 a[40:43], v233, s[64:67], s15 offen offset:2048
    v_mfma_f32_16x16x32_bf16 v[64:67], a[124:127], a[44:47], v[64:67]
    v_mfma_f32_16x16x32_bf16 v[44:47], a[120:123], a[44:47], v[44:47]
    v_mfma_f32_16x16x32_bf16 v[24:27], a[116:119], a[44:47], v[24:27]
    v_mfma_f32_16x16x32_bf16 v[4:7], a[112:115], a[44:47], v[4:7]
    buffer_load_dwordx4 a[44:47], v234, s[64:67], s15 offen offset:2048
    v_mfma_f32_16x16x32_bf16 v[8:11], a[112:115], a[48:51], v[8:11]
    v_mfma_f32_16x16x32_bf16 v[28:31], a[116:119], a[48:51], v[28:31]
    v_mfma_f32_16x16x32_bf16 v[48:51], a[120:123], a[48:51], v[48:51]
    v_mfma_f32_16x16x32_bf16 v[68:71], a[124:127], a[48:51], v[68:71]
    buffer_load_dwordx4 a[48:51], v235, s[64:67], s15 offen offset:2048
    v_mfma_f32_16x16x32_bf16 v[72:75], a[124:127], a[52:55], v[72:75]
    v_mfma_f32_16x16x32_bf16 v[52:55], a[120:123], a[52:55], v[52:55]
    v_mfma_f32_16x16x32_bf16 v[32:35], a[116:119], a[52:55], v[32:35]
    v_mfma_f32_16x16x32_bf16 v[12:15], a[112:115], a[52:55], v[12:15]
    buffer_load_dwordx4 a[52:55], v236, s[64:67], s15 offen offset:2048
    v_mfma_f32_16x16x32_bf16 v[16:19], a[112:115], a[56:59], v[16:19]
    v_mfma_f32_16x16x32_bf16 v[36:39], a[116:119], a[56:59], v[36:39]
    v_mfma_f32_16x16x32_bf16 v[56:59], a[120:123], a[56:59], v[56:59]
    v_mfma_f32_16x16x32_bf16 v[76:79], a[124:127], a[56:59], v[76:79]
    s_waitcnt vmcnt(15)
    buffer_load_dwordx4 a[56:59], v237, s[64:67], s15 offen offset:2048
    v_mfma_f32_16x16x32_bf16 v[0:3], v[80:83], a[60:63], v[0:3]
    v_mfma_f32_16x16x32_bf16 v[20:23], v[84:87], a[60:63], v[20:23]
    v_mfma_f32_16x16x32_bf16 v[40:43], v[88:91], a[60:63], v[40:43]
    v_mfma_f32_16x16x32_bf16 v[60:63], v[92:95], a[60:63], v[60:63]
    buffer_load_dwordx4 a[60:63], v233, s[64:67], s15 offen offset:3072
    v_mfma_f32_16x16x32_bf16 v[64:67], v[92:95], a[64:67], v[64:67]
    v_mfma_f32_16x16x32_bf16 v[44:47], v[88:91], a[64:67], v[44:47]
    v_mfma_f32_16x16x32_bf16 v[24:27], v[84:87], a[64:67], v[24:27]
    v_mfma_f32_16x16x32_bf16 v[4:7], v[80:83], a[64:67], v[4:7]
    buffer_load_dwordx4 a[64:67], v234, s[64:67], s15 offen offset:3072
    v_mfma_f32_16x16x32_bf16 v[8:11], v[80:83], a[68:71], v[8:11]
    v_mfma_f32_16x16x32_bf16 v[28:31], v[84:87], a[68:71], v[28:31]
    v_mfma_f32_16x16x32_bf16 v[48:51], v[88:91], a[68:71], v[48:51]
    v_mfma_f32_16x16x32_bf16 v[68:71], v[92:95], a[68:71], v[68:71]
    buffer_load_dwordx4 a[68:71], v235, s[64:67], s15 offen offset:3072
    v_mfma_f32_16x16x32_bf16 v[72:75], v[92:95], a[72:75], v[72:75]
    v_mfma_f32_16x16x32_bf16 v[52:55], v[88:91], a[72:75], v[52:55]
    v_mfma_f32_16x16x32_bf16 v[32:35], v[84:87], a[72:75], v[32:35]
    v_mfma_f32_16x16x32_bf16 v[12:15], v[80:83], a[72:75], v[12:15]
    buffer_load_dwordx4 a[72:75], v236, s[64:67], s15 offen offset:3072
    v_mfma_f32_16x16x32_bf16 v[16:19], v[80:83], a[76:79], v[16:19]
    v_mfma_f32_16x16x32_bf16 v[36:39], v[84:87], a[76:79], v[36:39]
    v_mfma_f32_16x16x32_bf16 v[56:59], v[88:91], a[76:79], v[56:59]
    v_mfma_f32_16x16x32_bf16 v[76:79], v[92:95], a[76:79], v[76:79]
    s_waitcnt vmcnt(15)
    buffer_load_dwordx4 a[76:79], v237, s[64:67], s15 offen offset:3072
    v_mfma_f32_16x16x32_bf16 v[0:3], v[96:99], a[0:3], v[0:3]
    v_mfma_f32_16x16x32_bf16 v[20:23], v[100:103], a[0:3], v[20:23]
    v_mfma_f32_16x16x32_bf16 v[40:43], v[104:107], a[0:3], v[40:43]
    v_mfma_f32_16x16x32_bf16 v[60:63], v[108:111], a[0:3], v[60:63]
    s_add_u32 s15, s44, 8192
    buffer_load_dwordx4 a[0:3], v233, s[64:67], s15 offen offset:0
    v_mfma_f32_16x16x32_bf16 v[64:67], v[108:111], a[4:7], v[64:67]
    v_mfma_f32_16x16x32_bf16 v[44:47], v[104:107], a[4:7], v[44:47]
    v_mfma_f32_16x16x32_bf16 v[24:27], v[100:103], a[4:7], v[24:27]
    v_mfma_f32_16x16x32_bf16 v[4:7], v[96:99], a[4:7], v[4:7]
    buffer_load_dwordx4 a[4:7], v234, s[64:67], s15 offen offset:0
    v_mfma_f32_16x16x32_bf16 v[8:11], v[96:99], a[8:11], v[8:11]
    v_mfma_f32_16x16x32_bf16 v[28:31], v[100:103], a[8:11], v[28:31]
    v_mfma_f32_16x16x32_bf16 v[48:51], v[104:107], a[8:11], v[48:51]
    v_mfma_f32_16x16x32_bf16 v[68:71], v[108:111], a[8:11], v[68:71]
    buffer_load_dwordx4 a[8:11], v235, s[64:67], s15 offen offset:0
    v_mfma_f32_16x16x32_bf16 v[72:75], v[108:111], a[12:15], v[72:75]
    v_mfma_f32_16x16x32_bf16 v[52:55], v[104:107], a[12:15], v[52:55]
    v_mfma_f32_16x16x32_bf16 v[32:35], v[100:103], a[12:15], v[32:35]
    v_mfma_f32_16x16x32_bf16 v[12:15], v[96:99], a[12:15], v[12:15]
    buffer_load_dwordx4 a[12:15], v236, s[64:67], s15 offen offset:0
    v_mfma_f32_16x16x32_bf16 v[16:19], v[96:99], a[16:19], v[16:19]
    v_mfma_f32_16x16x32_bf16 v[36:39], v[100:103], a[16:19], v[36:39]
    v_mfma_f32_16x16x32_bf16 v[56:59], v[104:107], a[16:19], v[56:59]
    v_mfma_f32_16x16x32_bf16 v[76:79], v[108:111], a[16:19], v[76:79]
    s_waitcnt vmcnt(14)
    buffer_load_dwordx4 a[16:19], v237, s[64:67], s15 offen offset:0
    v_mfma_f32_16x16x32_bf16 v[0:3], v[112:115], a[20:23], v[0:3]
    v_mfma_f32_16x16x32_bf16 v[20:23], v[116:119], a[20:23], v[20:23]
    v_mfma_f32_16x16x32_bf16 v[40:43], v[120:123], a[20:23], v[40:43]
    v_mfma_f32_16x16x32_bf16 v[60:63], v[124:127], a[20:23], v[60:63]
    buffer_load_dwordx4 a[20:23], v233, s[64:67], s15 offen offset:1024
    v_mfma_f32_16x16x32_bf16 v[64:67], v[124:127], a[24:27], v[64:67]
    v_mfma_f32_16x16x32_bf16 v[44:47], v[120:123], a[24:27], v[44:47]
    v_mfma_f32_16x16x32_bf16 v[24:27], v[116:119], a[24:27], v[24:27]
    v_mfma_f32_16x16x32_bf16 v[4:7], v[112:115], a[24:27], v[4:7]
    buffer_load_dwordx4 a[24:27], v234, s[64:67], s15 offen offset:1024
    v_mfma_f32_16x16x32_bf16 v[8:11], v[112:115], a[28:31], v[8:11]
    v_mfma_f32_16x16x32_bf16 v[28:31], v[116:119], a[28:31], v[28:31]
    v_mfma_f32_16x16x32_bf16 v[48:51], v[120:123], a[28:31], v[48:51]
    v_mfma_f32_16x16x32_bf16 v[68:71], v[124:127], a[28:31], v[68:71]
    buffer_load_dwordx4 a[28:31], v235, s[64:67], s15 offen offset:1024
    v_mfma_f32_16x16x32_bf16 v[72:75], v[124:127], a[32:35], v[72:75]
    v_mfma_f32_16x16x32_bf16 v[52:55], v[120:123], a[32:35], v[52:55]
    v_mfma_f32_16x16x32_bf16 v[32:35], v[116:119], a[32:35], v[32:35]
    v_mfma_f32_16x16x32_bf16 v[12:15], v[112:115], a[32:35], v[12:15]
    buffer_load_dwordx4 a[32:35], v236, s[64:67], s15 offen offset:1024
    v_mfma_f32_16x16x32_bf16 v[16:19], v[112:115], a[36:39], v[16:19]
    v_mfma_f32_16x16x32_bf16 v[36:39], v[116:119], a[36:39], v[36:39]
    v_mfma_f32_16x16x32_bf16 v[56:59], v[120:123], a[36:39], v[56:59]
    v_mfma_f32_16x16x32_bf16 v[76:79], v[124:127], a[36:39], v[76:79]
    s_waitcnt vmcnt(14)
    buffer_load_dwordx4 a[36:39], v237, s[64:67], s15 offen offset:1024
    v_mfma_f32_16x16x32_bf16 v[0:3], v[128:131], a[40:43], v[0:3]
    v_mfma_f32_16x16x32_bf16 v[20:23], v[132:135], a[40:43], v[20:23]
    v_mfma_f32_16x16x32_bf16 v[40:43], v[136:139], a[40:43], v[40:43]
    v_mfma_f32_16x16x32_bf16 v[60:63], v[140:143], a[40:43], v[60:63]
    buffer_load_dwordx4 a[40:43], v233, s[64:67], s15 offen offset:2048
    v_mfma_f32_16x16x32_bf16 v[64:67], v[140:143], a[44:47], v[64:67]
    v_mfma_f32_16x16x32_bf16 v[44:47], v[136:139], a[44:47], v[44:47]
    v_mfma_f32_16x16x32_bf16 v[24:27], v[132:135], a[44:47], v[24:27]
    v_mfma_f32_16x16x32_bf16 v[4:7], v[128:131], a[44:47], v[4:7]
    buffer_load_dwordx4 a[44:47], v234, s[64:67], s15 offen offset:2048
    v_mfma_f32_16x16x32_bf16 v[8:11], v[128:131], a[48:51], v[8:11]
    v_mfma_f32_16x16x32_bf16 v[28:31], v[132:135], a[48:51], v[28:31]
    v_mfma_f32_16x16x32_bf16 v[48:51], v[136:139], a[48:51], v[48:51]
    v_mfma_f32_16x16x32_bf16 v[68:71], v[140:143], a[48:51], v[68:71]
    buffer_load_dwordx4 a[48:51], v235, s[64:67], s15 offen offset:2048
    v_mfma_f32_16x16x32_bf16 v[72:75], v[140:143], a[52:55], v[72:75]
    v_mfma_f32_16x16x32_bf16 v[52:55], v[136:139], a[52:55], v[52:55]
    v_mfma_f32_16x16x32_bf16 v[32:35], v[132:135], a[52:55], v[32:35]
    v_mfma_f32_16x16x32_bf16 v[12:15], v[128:131], a[52:55], v[12:15]
    buffer_load_dwordx4 a[52:55], v236, s[64:67], s15 offen offset:2048
    v_mfma_f32_16x16x32_bf16 v[16:19], v[128:131], a[56:59], v[16:19]
    v_mfma_f32_16x16x32_bf16 v[36:39], v[132:135], a[56:59], v[36:39]
    v_mfma_f32_16x16x32_bf16 v[56:59], v[136:139], a[56:59], v[56:59]
    v_mfma_f32_16x16x32_bf16 v[76:79], v[140:143], a[56:59], v[76:79]
    s_waitcnt vmcnt(14)
    buffer_load_dwordx4 a[56:59], v237, s[64:67], s15 offen offset:2048
    v_mfma_f32_16x16x32_bf16 v[0:3], v[144:147], a[60:63], v[0:3]
    v_mfma_f32_16x16x32_bf16 v[20:23], v[148:151], a[60:63], v[20:23]
    v_mfma_f32_16x16x32_bf16 v[40:43], v[152:155], a[60:63], v[40:43]
    v_mfma_f32_16x16x32_bf16 v[60:63], v[156:159], a[60:63], v[60:63]
    buffer_load_dwordx4 a[60:63], v233, s[64:67], s15 offen offset:3072
    v_mfma_f32_16x16x32_bf16 v[64:67], v[156:159], a[64:67], v[64:67]
    v_mfma_f32_16x16x32_bf16 v[44:47], v[152:155], a[64:67], v[44:47]
    v_mfma_f32_16x16x32_bf16 v[24:27], v[148:151], a[64:67], v[24:27]
    v_mfma_f32_16x16x32_bf16 v[4:7], v[144:147], a[64:67], v[4:7]
    buffer_load_dwordx4 a[64:67], v234, s[64:67], s15 offen offset:3072
    v_mfma_f32_16x16x32_bf16 v[8:11], v[144:147], a[68:71], v[8:11]
    v_mfma_f32_16x16x32_bf16 v[28:31], v[148:151], a[68:71], v[28:31]
    v_mfma_f32_16x16x32_bf16 v[48:51], v[152:155], a[68:71], v[48:51]
    v_mfma_f32_16x16x32_bf16 v[68:71], v[156:159], a[68:71], v[68:71]
    buffer_load_dwordx4 a[68:71], v235, s[64:67], s15 offen offset:3072
    v_mfma_f32_16x16x32_bf16 v[72:75], v[156:159], a[72:75], v[72:75]
    v_mfma_f32_16x16x32_bf16 v[52:55], v[152:155], a[72:75], v[52:55]
    v_mfma_f32_16x16x32_bf16 v[32:35], v[148:151], a[72:75], v[32:35]
    v_mfma_f32_16x16x32_bf16 v[12:15], v[144:147], a[72:75], v[12:15]
    buffer_load_dwordx4 a[72:75], v236, s[64:67], s15 offen offset:3072
    v_mfma_f32_16x16x32_bf16 v[16:19], v[144:147], a[76:79], v[16:19]
    v_mfma_f32_16x16x32_bf16 v[36:39], v[148:151], a[76:79], v[36:39]
    v_mfma_f32_16x16x32_bf16 v[56:59], v[152:155], a[76:79], v[56:59]
    v_mfma_f32_16x16x32_bf16 v[76:79], v[156:159], a[76:79], v[76:79]
    s_waitcnt vmcnt(14)
    buffer_load_dwordx4 a[76:79], v237, s[64:67], s15 offen offset:3072
    v_mfma_f32_16x16x32_bf16 v[0:3], a[128:131], a[0:3], v[0:3]
    v_mfma_f32_16x16x32_bf16 v[20:23], a[132:135], a[0:3], v[20:23]
    v_mfma_f32_16x16x32_bf16 v[40:43], a[136:139], a[0:3], v[40:43]
    v_mfma_f32_16x16x32_bf16 v[60:63], a[140:143], a[0:3], v[60:63]
    s_add_u32 s15, s44, 12288
    buffer_load_dwordx4 a[0:3], v233, s[64:67], s15 offen offset:0
    v_mfma_f32_16x16x32_bf16 v[64:67], a[140:143], a[4:7], v[64:67]
    v_mfma_f32_16x16x32_bf16 v[44:47], a[136:139], a[4:7], v[44:47]
    v_mfma_f32_16x16x32_bf16 v[24:27], a[132:135], a[4:7], v[24:27]
    v_mfma_f32_16x16x32_bf16 v[4:7], a[128:131], a[4:7], v[4:7]
    buffer_load_dwordx4 a[4:7], v234, s[64:67], s15 offen offset:0
    v_mfma_f32_16x16x32_bf16 v[8:11], a[128:131], a[8:11], v[8:11]
    v_mfma_f32_16x16x32_bf16 v[28:31], a[132:135], a[8:11], v[28:31]
    v_mfma_f32_16x16x32_bf16 v[48:51], a[136:139], a[8:11], v[48:51]
    v_mfma_f32_16x16x32_bf16 v[68:71], a[140:143], a[8:11], v[68:71]
    buffer_load_dwordx4 a[8:11], v235, s[64:67], s15 offen offset:0
    v_mfma_f32_16x16x32_bf16 v[72:75], a[140:143], a[12:15], v[72:75]
    v_mfma_f32_16x16x32_bf16 v[52:55], a[136:139], a[12:15], v[52:55]
    v_mfma_f32_16x16x32_bf16 v[32:35], a[132:135], a[12:15], v[32:35]
    v_mfma_f32_16x16x32_bf16 v[12:15], a[128:131], a[12:15], v[12:15]
    buffer_load_dwordx4 a[12:15], v236, s[64:67], s15 offen offset:0
    v_mfma_f32_16x16x32_bf16 v[16:19], a[128:131], a[16:19], v[16:19]
    v_mfma_f32_16x16x32_bf16 v[36:39], a[132:135], a[16:19], v[36:39]
    v_mfma_f32_16x16x32_bf16 v[56:59], a[136:139], a[16:19], v[56:59]
    v_mfma_f32_16x16x32_bf16 v[76:79], a[140:143], a[16:19], v[76:79]
    s_waitcnt vmcnt(14)
    buffer_load_dwordx4 a[16:19], v237, s[64:67], s15 offen offset:0
    v_mfma_f32_16x16x32_bf16 v[0:3], a[144:147], a[20:23], v[0:3]
    v_mfma_f32_16x16x32_bf16 v[20:23], a[148:151], a[20:23], v[20:23]
    v_mfma_f32_16x16x32_bf16 v[40:43], a[152:155], a[20:23], v[40:43]
    v_mfma_f32_16x16x32_bf16 v[60:63], a[156:159], a[20:23], v[60:63]
    buffer_load_dwordx4 a[20:23], v233, s[64:67], s15 offen offset:1024
    v_mfma_f32_16x16x32_bf16 v[64:67], a[156:159], a[24:27], v[64:67]
    v_mfma_f32_16x16x32_bf16 v[44:47], a[152:155], a[24:27], v[44:47]
    v_mfma_f32_16x16x32_bf16 v[24:27], a[148:151], a[24:27], v[24:27]
    v_mfma_f32_16x16x32_bf16 v[4:7], a[144:147], a[24:27], v[4:7]
    buffer_load_dwordx4 a[24:27], v234, s[64:67], s15 offen offset:1024
    v_mfma_f32_16x16x32_bf16 v[8:11], a[144:147], a[28:31], v[8:11]
    v_mfma_f32_16x16x32_bf16 v[28:31], a[148:151], a[28:31], v[28:31]
    v_mfma_f32_16x16x32_bf16 v[48:51], a[152:155], a[28:31], v[48:51]
    v_mfma_f32_16x16x32_bf16 v[68:71], a[156:159], a[28:31], v[68:71]
    buffer_load_dwordx4 a[28:31], v235, s[64:67], s15 offen offset:1024
    v_mfma_f32_16x16x32_bf16 v[72:75], a[156:159], a[32:35], v[72:75]
    v_mfma_f32_16x16x32_bf16 v[52:55], a[152:155], a[32:35], v[52:55]
    v_mfma_f32_16x16x32_bf16 v[32:35], a[148:151], a[32:35], v[32:35]
    v_mfma_f32_16x16x32_bf16 v[12:15], a[144:147], a[32:35], v[12:15]
    buffer_load_dwordx4 a[32:35], v236, s[64:67], s15 offen offset:1024
    v_mfma_f32_16x16x32_bf16 v[16:19], a[144:147], a[36:39], v[16:19]
    v_mfma_f32_16x16x32_bf16 v[36:39], a[148:151], a[36:39], v[36:39]
    v_mfma_f32_16x16x32_bf16 v[56:59], a[152:155], a[36:39], v[56:59]
    v_mfma_f32_16x16x32_bf16 v[76:79], a[156:159], a[36:39], v[76:79]
    s_waitcnt vmcnt(14)
    buffer_load_dwordx4 a[36:39], v237, s[64:67], s15 offen offset:1024
    v_mfma_f32_16x16x32_bf16 v[0:3], a[160:163], a[40:43], v[0:3]
    s_and_b32 s8, s2, 1
    s_lshl_b32 s8, s8, 5
    s_lshr_b32 s9, s2, 3
    s_add_u32 s8, s8, s9
    v_mfma_f32_16x16x32_bf16 v[20:23], a[164:167], a[40:43], v[20:23]
    s_mul_i32 s9, s8, 37
    s_lshr_b32 s9, s9, 8
    s_mul_i32 s9, s9, 7
    s_sub_u32 s8, s8, s9
    v_mfma_f32_16x16x32_bf16 v[40:43], a[168:171], a[40:43], v[40:43]
    s_mul_i32 s9, s8, -1
    s_mul_i32 s8, s9, 36864
    s_add_u32 s100, s48, s8
    s_mul_i32 s8, s9, 18432
    v_mfma_f32_16x16x32_bf16 v[60:63], a[172:175], a[40:43], v[60:63]
    s_add_u32 s46, s46, s8
    buffer_load_dwordx4 a[40:43], v233, s[64:67], s15 offen offset:2048
    v_or_b32 v207, s42, v224
    v_mfma_f32_16x16x32_bf16 v[64:67], a[172:175], a[44:47], v[64:67]
    v_add_u32 v208, 18432, v207
    v_add_u32 v209, 36864, v207
    v_add_u32 v210, 55296, v207
    v_mfma_f32_16x16x32_bf16 v[44:47], a[168:171], a[44:47], v[44:47]
    v_bfe_u32 v222, v224, 4, 4
    v_mul_u32_u24 v222, 2304, v222
    v_lshrrev_b32 v223, 8, v224
    v_mfma_f32_16x16x32_bf16 v[24:27], a[164:167], a[44:47], v[24:27]
    v_lshl_add_u32 v196, v223, 3, v222
    v_or_b32 v196, s42, v196
    v_add_u32 v197, 36864, v196
    v_mfma_f32_16x16x32_bf16 v[4:7], a[160:163], a[44:47], v[4:7]
    buffer_load_dwordx4 a[44:47], v234, s[64:67], s15 offen offset:2048
    v_add_u32 v198, 73728, v196
    v_mfma_f32_16x16x32_bf16 v[8:11], a[160:163], a[48:51], v[8:11]
    v_add_u32 v199, 110592, v196
    v_add_u32 v200, 147456, v196
    v_mfma_f32_16x16x32_bf16 v[28:31], a[164:167], a[48:51], v[28:31]
    s_add_u32 s8, s3, 1
    s_lshr_b32 s8, s8, 2
    s_lshr_b32 s101, 1024, s8
    s_add_u32 s98, s46, 1024
    v_mfma_f32_16x16x32_bf16 v[48:51], a[168:171], a[48:51], v[48:51]
    v_lshrrev_b32 v248, 1, v224
    v_mul_u32_u24 v248, s8, v248
    v_sub_u32 v215, v207, v248
    v_mfma_f32_16x16x32_bf16 v[68:71], a[172:175], a[48:51], v[68:71]
    buffer_load_dwordx4 a[48:51], v235, s[64:67], s15 offen offset:2048
    v_sub_u32 v216, v208, v248
    v_mfma_f32_16x16x32_bf16 v[72:75], a[172:175], a[52:55], v[72:75]
    v_sub_u32 v217, v209, v248
    v_sub_u32 v218, v210, v248
    v_lshrrev_b32 v223, 1, v224
    v_mfma_f32_16x16x32_bf16 v[52:55], a[168:171], a[52:55], v[52:55]
    v_add_u32 v223, s40, v223
    v_mfma_f32_16x16x32_bf16 v[32:35], a[164:167], a[52:55], v[32:35]
    s_add_u32 s8, s3, 0
    s_and_b32 s8, s8, 3
    s_lshl_b32 s8, s8, 10
    v_add_u32 v248, s8, v223
    v_mfma_f32_16x16x32_bf16 v[12:15], a[160:163], a[52:55], v[12:15]
    s_add_u32 s8, s3, 1
    s_and_b32 s8, s8, 3
    s_lshl_b32 s8, s8, 10
    v_add_u32 v249, s8, v223
    v_mfma_f32_16x16x32_bf16 v[16:19], a[160:163], a[56:59], v[16:19]
    s_add_u32 s8, s3, 2
    s_and_b32 s8, s8, 3
    s_lshl_b32 s8, s8, 10
    v_add_u32 v250, s8, v223
    v_mfma_f32_16x16x32_bf16 v[36:39], a[164:167], a[56:59], v[36:39]
    s_add_u32 s8, s3, 3
    s_and_b32 s8, s8, 3
    s_lshl_b32 s8, s8, 10
    v_add_u32 v251, s8, v223
    v_mfma_f32_16x16x32_bf16 v[56:59], a[168:171], a[56:59], v[56:59]
    buffer_load_dwordx4 a[52:55], v236, s[64:67], s15 offen offset:2048
    v_add_u32 v192, s40, v224
    v_mfma_f32_16x16x32_bf16 v[76:79], a[172:175], a[56:59], v[76:79]
    s_waitcnt vmcnt(14)
    s_sub_u32 s8, s3, 1
    s_and_b32 s8, s8, 3
    v_mfma_f32_16x16x32_bf16 v[0:3], a[176:179], a[60:63], v[0:3]
    s_mul_i32 s8, s8, 40960
    buffer_load_dwordx4 a[56:59], v237, s[64:67], s15 offen offset:2048
    ds_read_b64_tr_b16 a[224:225], v240 offset:20480
    v_mfma_f32_16x16x32_bf16 v[20:23], a[180:183], a[60:63], v[20:23]
    ds_read_b64_tr_b16 a[226:227], v240 offset:22528
    ds_read_b64_tr_b16 a[228:229], v241 offset:20480
    v_add_u32 v193, s8, v224
    v_mfma_f32_16x16x32_bf16 v[40:43], a[184:187], a[60:63], v[40:43]
    s_sub_u32 s8, s3, 2
    s_and_b32 s8, s8, 3
    s_mul_i32 s8, s8, 40960
    ds_read_b64_tr_b16 a[230:231], v241 offset:22528
    v_mfma_f32_16x16x32_bf16 v[60:63], a[188:191], a[60:63], v[60:63]
    buffer_load_dwordx4 a[60:63], v233, s[64:67], s15 offen offset:3072
    ds_read_b64_tr_b16 a[232:233], v242 offset:20480
    v_mfma_f32_16x16x32_bf16 v[64:67], a[188:191], a[64:67], v[64:67]
    ds_read_b64_tr_b16 a[234:235], v242 offset:22528
    ds_read_b64_tr_b16 a[236:237], v243 offset:20480
    v_add_u32 v194, s8, v224
    v_mfma_f32_16x16x32_bf16 v[44:47], a[184:187], a[64:67], v[44:47]
    s_sub_u32 s8, s3, 3
    s_and_b32 s8, s8, 3
    s_mul_i32 s8, s8, 40960
    ds_read_b64_tr_b16 a[238:239], v243 offset:22528
    v_mfma_f32_16x16x32_bf16 v[24:27], a[180:183], a[64:67], v[24:27]
    v_add_u32 v195, s8, v224
    v_bfe_u32 v222, v224, 4, 3
    v_lshrrev_b32 v223, 9, v224
    v_mfma_f32_16x16x32_bf16 v[4:7], a[176:179], a[64:67], v[4:7]
    s_lshl_b32 s8, s3, 1
    buffer_load_dwordx4 a[64:67], v234, s[64:67], s15 offen offset:3072
    v_add_u32 v223, s8, v223
    v_mfma_f32_16x16x32_bf16 v[8:11], a[176:179], a[68:71], v[8:11]
    v_xor_b32 v222, v222, v223
    v_bfe_u32 v223, v224, 4, 4
    v_lshlrev_b32 v223, 7, v223
    v_mfma_f32_16x16x32_bf16 v[28:31], a[180:183], a[68:71], v[28:31]
    v_lshl_add_u32 v222, v222, 4, v223
    v_bfe_u32 v223, v224, 8, 1
    v_lshl_add_u32 v222, v223, 3, v222
    v_mfma_f32_16x16x32_bf16 v[48:51], a[184:187], a[68:71], v[48:51]
    v_add_u32 v176, 0, v222
    v_add_u32 v177, 40960, v222
    v_add_u32 v178, 81920, v222
    v_mfma_f32_16x16x32_bf16 v[68:71], a[188:191], a[68:71], v[68:71]
    buffer_load_dwordx4 a[68:71], v235, s[64:67], s15 offen offset:3072
    v_lshrrev_b32 v222, 7, v224
    v_mfma_f32_16x16x32_bf16 v[72:75], a[188:191], a[72:75], v[72:75]
    v_bfe_u32 v223, v224, 4, 3
    v_xor_b32 v223, v223, v222
    v_lshlrev_b32 v223, 4, v223
    v_mfma_f32_16x16x32_bf16 v[52:55], a[184:187], a[72:75], v[52:55]
    v_lshl_add_u32 v223, v222, 7, v223
    v_mfma_f32_16x16x32_bf16 v[32:35], a[180:183], a[72:75], v[32:35]
    s_lshl_b32 s8, s3, 10
    v_add_u32 v223, s8, v223
    v_add_u32 v179, 0, v223
    v_add_u32 v180, 40960, v223
    v_mfma_f32_16x16x32_bf16 v[12:15], a[176:179], a[72:75], v[12:15]
    buffer_load_dwordx4 a[72:75], v236, s[64:67], s15 offen offset:3072
    v_add_u32 v181, 81920, v223
    v_mfma_f32_16x16x32_bf16 v[16:19], a[176:179], a[76:79], v[16:19]
    s_lshl_b32 s8, s3, 3
    v_add_u32 v222, s8, v222
    v_mul_u32_u24 v222, 2304, v222
    v_and_b32 v223, 0x70, v224
    v_mfma_f32_16x16x32_bf16 v[36:39], a[180:183], a[76:79], v[36:39]
    v_add_u32 v222, v222, v223
    v_or_b32 v222, s42, v222
    v_mfma_f32_16x16x32_bf16 v[56:59], a[184:187], a[76:79], v[56:59]
    s_lshl_b32 s8, s3, 5
    s_sub_u32 s11, s48, s8
    s_sub_u32 s12, s100, s8
    s_lshr_b32 s9, s3, 1
    v_mfma_f32_16x16x32_bf16 v[76:79], a[188:191], a[76:79], v[76:79]
    s_waitcnt vmcnt(14)
    s_waitcnt lgkmcnt(0)
    buffer_load_dwordx4 a[76:79], v237, s[64:67], s15 offen offset:3072
    v_mfma_f32_16x16x32_bf16 v[0:3], a[224:227], a[0:3], v[0:3]
    ds_read_b64_tr_b16 a[240:241], v240 offset:24576
    ds_read_b64_tr_b16 a[242:243], v240 offset:26624
    v_add_u32 v182, 0, v222
    v_mfma_f32_16x16x32_bf16 v[20:23], a[228:231], a[0:3], v[20:23]
    s_add_u32 m0, s40, 20480
    s_add_u32 s14, s41, 811008
    buffer_load_dwordx4 v226, s[76:79], s14 offen offset:0 lds
    v_mfma_f32_16x16x32_bf16 v[40:43], a[232:235], a[0:3], v[40:43]
    buffer_load_dwordx4 v230, s[76:79], s14 offen offset:1024 lds
    ds_read_b64_tr_b16 a[244:245], v241 offset:24576
    v_mfma_f32_16x16x32_bf16 v[60:63], a[236:239], a[0:3], v[60:63]
    s_add_u32 s15, s44, 16384
    buffer_load_dwordx4 a[0:3], v233, s[64:67], s15 offen offset:0
    ds_read_b64_tr_b16 a[246:247], v241 offset:26624
    v_mfma_f32_16x16x32_bf16 v[64:67], a[236:239], a[4:7], v[64:67]
    ds_read_b64_tr_b16 a[248:249], v242 offset:24576
    ds_read_b64_tr_b16 a[250:251], v242 offset:26624
    v_add_u32 v183, 73728, v222
    v_mfma_f32_16x16x32_bf16 v[44:47], a[232:235], a[4:7], v[44:47]
    ds_read_b64_tr_b16 a[252:253], v243 offset:24576
    ds_read_b64_tr_b16 a[254:255], v243 offset:26624
    v_add_u32 v184, 147456, v222
    v_mfma_f32_16x16x32_bf16 v[24:27], a[228:231], a[4:7], v[24:27]
    s_lshl_b32 s8, s9, 31
    buffer_load_dwordx4 v231, s[76:79], s14 offen offset:2048 lds
    v_or_b32 v184, s8, v184
    v_mfma_f32_16x16x32_bf16 v[4:7], a[224:227], a[4:7], v[4:7]
    buffer_load_dwordx4 v232, s[76:79], s14 offen offset:3072 lds
    v_add_u32 v185, 0, v222
    v_mfma_f32_16x16x32_bf16 v[8:11], a[224:227], a[8:11], v[8:11]
    buffer_load_dwordx4 a[4:7], v234, s[64:67], s15 offen offset:0
    v_add_u32 v186, 73728, v222
    v_mfma_f32_16x16x32_bf16 v[28:31], a[228:231], a[8:11], v[28:31]
    v_and_b32 v223, 0x3c0, v224
    v_add_u32 v223, v223, v224
    v_mfma_f32_16x16x32_bf16 v[48:51], a[232:235], a[8:11], v[48:51]
    s_mov_b32 s99, 59064320
    v_mfma_f32_16x16x32_bf16 v[68:71], a[236:239], a[8:11], v[68:71]
    buffer_load_dwordx4 a[8:11], v235, s[64:67], s15 offen offset:0
    v_mfma_f32_16x16x32_bf16 v[72:75], a[236:239], a[12:15], v[72:75]
    v_mfma_f32_16x16x32_bf16 v[52:55], a[232:235], a[12:15], v[52:55]
    v_mfma_f32_16x16x32_bf16 v[32:35], a[228:231], a[12:15], v[32:35]
    v_mfma_f32_16x16x32_bf16 v[12:15], a[224:227], a[12:15], v[12:15]
    buffer_load_dwordx4 a[12:15], v236, s[64:67], s15 offen offset:0
    v_mfma_f32_16x16x32_bf16 v[16:19], a[224:227], a[16:19], v[16:19]
    v_mfma_f32_16x16x32_bf16 v[36:39], a[228:231], a[16:19], v[36:39]
    v_mfma_f32_16x16x32_bf16 v[56:59], a[232:235], a[16:19], v[56:59]
    v_mfma_f32_16x16x32_bf16 v[76:79], a[236:239], a[16:19], v[76:79]
    s_waitcnt vmcnt(18)
    s_waitcnt lgkmcnt(0)
    buffer_load_dwordx4 a[16:19], v237, s[64:67], s15 offen offset:0
    v_mfma_f32_16x16x32_bf16 v[0:3], a[240:243], a[20:23], v[0:3]
    ds_read_b64_tr_b16 a[224:225], v240 offset:28672
    ds_read_b64_tr_b16 a[226:227], v240 offset:30720
    v_mfma_f32_16x16x32_bf16 v[20:23], a[244:247], a[20:23], v[20:23]
    s_add_u32 m0, s40, 24576
    s_add_u32 s14, s41, 847872
    buffer_load_dwordx4 v226, s[76:79], s14 offen offset:0 lds
    v_mfma_f32_16x16x32_bf16 v[40:43], a[248:251], a[20:23], v[40:43]
    buffer_load_dwordx4 v230, s[76:79], s14 offen offset:1024 lds
    ds_read_b64_tr_b16 a[228:229], v241 offset:28672
    v_mfma_f32_16x16x32_bf16 v[60:63], a[252:255], a[20:23], v[60:63]
    buffer_load_dwordx4 a[20:23], v233, s[64:67], s15 offen offset:1024
    ds_read_b64_tr_b16 a[230:231], v241 offset:30720
    v_mfma_f32_16x16x32_bf16 v[64:67], a[252:255], a[24:27], v[64:67]
    ds_read_b64_tr_b16 a[232:233], v242 offset:28672
    ds_read_b64_tr_b16 a[234:235], v242 offset:30720
    v_mfma_f32_16x16x32_bf16 v[44:47], a[248:251], a[24:27], v[44:47]
    ds_read_b64_tr_b16 a[236:237], v243 offset:28672
    ds_read_b64_tr_b16 a[238:239], v243 offset:30720
    v_mfma_f32_16x16x32_bf16 v[24:27], a[244:247], a[24:27], v[24:27]
    buffer_load_dwordx4 v231, s[76:79], s14 offen offset:2048 lds
    v_mfma_f32_16x16x32_bf16 v[4:7], a[240:243], a[24:27], v[4:7]
    buffer_load_dwordx4 v232, s[76:79], s14 offen offset:3072 lds
    v_mfma_f32_16x16x32_bf16 v[8:11], a[240:243], a[28:31], v[8:11]
    buffer_load_dwordx4 a[24:27], v234, s[64:67], s15 offen offset:1024
    v_mfma_f32_16x16x32_bf16 v[28:31], a[244:247], a[28:31], v[28:31]
    v_mfma_f32_16x16x32_bf16 v[48:51], a[248:251], a[28:31], v[48:51]
    v_mfma_f32_16x16x32_bf16 v[68:71], a[252:255], a[28:31], v[68:71]
    buffer_load_dwordx4 a[28:31], v235, s[64:67], s15 offen offset:1024
    v_mfma_f32_16x16x32_bf16 v[72:75], a[252:255], a[32:35], v[72:75]
    v_mfma_f32_16x16x32_bf16 v[52:55], a[248:251], a[32:35], v[52:55]
    v_mfma_f32_16x16x32_bf16 v[32:35], a[244:247], a[32:35], v[32:35]
    v_mfma_f32_16x16x32_bf16 v[12:15], a[240:243], a[32:35], v[12:15]
    buffer_load_dwordx4 a[32:35], v236, s[64:67], s15 offen offset:1024
    v_mfma_f32_16x16x32_bf16 v[16:19], a[240:243], a[36:39], v[16:19]
    v_mfma_f32_16x16x32_bf16 v[36:39], a[244:247], a[36:39], v[36:39]
    v_mfma_f32_16x16x32_bf16 v[56:59], a[248:251], a[36:39], v[56:59]
    v_mfma_f32_16x16x32_bf16 v[76:79], a[252:255], a[36:39], v[76:79]
    s_waitcnt vmcnt(22)
    s_waitcnt lgkmcnt(0)
    buffer_load_dwordx4 a[36:39], v237, s[64:67], s15 offen offset:1024
    v_mfma_f32_16x16x32_bf16 v[0:3], a[224:227], a[40:43], v[0:3]
    ds_read_b64_tr_b16 a[240:241], v240 offset:32768
    ds_read_b64_tr_b16 a[242:243], v240 offset:34816
    v_mfma_f32_16x16x32_bf16 v[20:23], a[228:231], a[40:43], v[20:23]
    s_add_u32 m0, s40, 28672
    s_add_u32 s14, s41, 884736
    buffer_load_dwordx4 v226, s[76:79], s14 offen offset:0 lds
    v_mfma_f32_16x16x32_bf16 v[40:43], a[232:235], a[40:43], v[40:43]
    buffer_load_dwordx4 v230, s[76:79], s14 offen offset:1024 lds
    ds_read_b64_tr_b16 a[244:245], v241 offset:32768
    v_mfma_f32_16x16x32_bf16 v[60:63], a[236:239], a[40:43], v[60:63]
    buffer_load_dwordx4 a[40:43], v233, s[64:67], s15 offen offset:2048
    ds_read_b64_tr_b16 a[246:247], v241 offset:34816
    v_mfma_f32_16x16x32_bf16 v[64:67], a[236:239], a[44:47], v[64:67]
    ds_read_b64_tr_b16 a[248:249], v242 offset:32768
    ds_read_b64_tr_b16 a[250:251], v242 offset:34816
    v_mfma_f32_16x16x32_bf16 v[44:47], a[232:235], a[44:47], v[44:47]
    ds_read_b64_tr_b16 a[252:253], v243 offset:32768
    ds_read_b64_tr_b16 a[254:255], v243 offset:34816
    v_mfma_f32_16x16x32_bf16 v[24:27], a[228:231], a[44:47], v[24:27]
    buffer_load_dwordx4 v231, s[76:79], s14 offen offset:2048 lds
    v_mfma_f32_16x16x32_bf16 v[4:7], a[224:227], a[44:47], v[4:7]
    buffer_load_dwordx4 v232, s[76:79], s14 offen offset:3072 lds
    v_mfma_f32_16x16x32_bf16 v[8:11], a[224:227], a[48:51], v[8:11]
    buffer_load_dwordx4 a[44:47], v234, s[64:67], s15 offen offset:2048
    v_mfma_f32_16x16x32_bf16 v[28:31], a[228:231], a[48:51], v[28:31]
    v_mfma_f32_16x16x32_bf16 v[48:51], a[232:235], a[48:51], v[48:51]
    v_mfma_f32_16x16x32_bf16 v[68:71], a[236:239], a[48:51], v[68:71]
    buffer_load_dwordx4 a[48:51], v235, s[64:67], s15 offen offset:2048
    v_mfma_f32_16x16x32_bf16 v[72:75], a[236:239], a[52:55], v[72:75]
    v_mfma_f32_16x16x32_bf16 v[52:55], a[232:235], a[52:55], v[52:55]
    v_mfma_f32_16x16x32_bf16 v[32:35], a[228:231], a[52:55], v[32:35]
    v_mfma_f32_16x16x32_bf16 v[12:15], a[224:227], a[52:55], v[12:15]
    buffer_load_dwordx4 a[52:55], v236, s[64:67], s15 offen offset:2048
    v_mfma_f32_16x16x32_bf16 v[16:19], a[224:227], a[56:59], v[16:19]
    v_mfma_f32_16x16x32_bf16 v[36:39], a[228:231], a[56:59], v[36:39]
    v_mfma_f32_16x16x32_bf16 v[56:59], a[232:235], a[56:59], v[56:59]
    v_mfma_f32_16x16x32_bf16 v[76:79], a[236:239], a[56:59], v[76:79]
    s_waitcnt vmcnt(26)
    s_waitcnt lgkmcnt(0)
    buffer_load_dwordx4 a[56:59], v237, s[64:67], s15 offen offset:2048
    v_mfma_f32_16x16x32_bf16 v[0:3], a[240:243], a[60:63], v[0:3]
    ds_read_b64_tr_b16 a[224:225], v240 offset:36864
    ds_read_b64_tr_b16 a[226:227], v240 offset:38912
    v_mfma_f32_16x16x32_bf16 v[20:23], a[244:247], a[60:63], v[20:23]
    s_add_u32 m0, s40, 32768
    s_add_u32 s14, s41, 921600
    buffer_load_dwordx4 v226, s[76:79], s14 offen offset:0 lds
    v_mfma_f32_16x16x32_bf16 v[40:43], a[248:251], a[60:63], v[40:43]
    buffer_load_dwordx4 v230, s[76:79], s14 offen offset:1024 lds
    ds_read_b64_tr_b16 a[228:229], v241 offset:36864
    v_mfma_f32_16x16x32_bf16 v[60:63], a[252:255], a[60:63], v[60:63]
    buffer_load_dwordx4 a[60:63], v233, s[64:67], s15 offen offset:3072
    ds_read_b64_tr_b16 a[230:231], v241 offset:38912
    v_mfma_f32_16x16x32_bf16 v[64:67], a[252:255], a[64:67], v[64:67]
    ds_read_b64_tr_b16 a[232:233], v242 offset:36864
    ds_read_b64_tr_b16 a[234:235], v242 offset:38912
    v_mfma_f32_16x16x32_bf16 v[44:47], a[248:251], a[64:67], v[44:47]
    ds_read_b64_tr_b16 a[236:237], v243 offset:36864
    ds_read_b64_tr_b16 a[238:239], v243 offset:38912
    v_mfma_f32_16x16x32_bf16 v[24:27], a[244:247], a[64:67], v[24:27]
    buffer_load_dwordx4 v231, s[76:79], s14 offen offset:2048 lds
    v_mfma_f32_16x16x32_bf16 v[4:7], a[240:243], a[64:67], v[4:7]
    buffer_load_dwordx4 v232, s[76:79], s14 offen offset:3072 lds
    v_mfma_f32_16x16x32_bf16 v[8:11], a[240:243], a[68:71], v[8:11]
    buffer_load_dwordx4 a[64:67], v234, s[64:67], s15 offen offset:3072
    v_mfma_f32_16x16x32_bf16 v[28:31], a[244:247], a[68:71], v[28:31]
    v_mfma_f32_16x16x32_bf16 v[48:51], a[248:251], a[68:71], v[48:51]
    v_mfma_f32_16x16x32_bf16 v[68:71], a[252:255], a[68:71], v[68:71]
    buffer_load_dwordx4 a[68:71], v235, s[64:67], s15 offen offset:3072
    v_mfma_f32_16x16x32_bf16 v[72:75], a[252:255], a[72:75], v[72:75]
    v_mfma_f32_16x16x32_bf16 v[52:55], a[248:251], a[72:75], v[52:55]
    v_mfma_f32_16x16x32_bf16 v[32:35], a[244:247], a[72:75], v[32:35]
    v_mfma_f32_16x16x32_bf16 v[12:15], a[240:243], a[72:75], v[12:15]
    buffer_load_dwordx4 a[72:75], v236, s[64:67], s15 offen offset:3072
    v_mfma_f32_16x16x32_bf16 v[16:19], a[240:243], a[76:79], v[16:19]
    v_mfma_f32_16x16x32_bf16 v[36:39], a[244:247], a[76:79], v[36:39]
    v_mfma_f32_16x16x32_bf16 v[56:59], a[248:251], a[76:79], v[56:59]
    v_mfma_f32_16x16x32_bf16 v[76:79], a[252:255], a[76:79], v[76:79]
    s_waitcnt vmcnt(26)
    s_waitcnt lgkmcnt(0)
    buffer_load_dwordx4 a[76:79], v237, s[64:67], s15 offen offset:3072
    v_mfma_f32_16x16x32_bf16 v[0:3], a[224:227], a[0:3], v[0:3]
    ds_read_b64_tr_b16 a[240:241], v240 offset:0
    ds_read_b64_tr_b16 a[242:243], v240 offset:2048
    v_mfma_f32_16x16x32_bf16 v[20:23], a[228:231], a[0:3], v[20:23]
    s_add_u32 m0, s40, 36864
    s_add_u32 s14, s41, 958464
    buffer_load_dwordx4 v226, s[76:79], s14 offen offset:0 lds
    v_mfma_f32_16x16x32_bf16 v[40:43], a[232:235], a[0:3], v[40:43]
    buffer_load_dwordx4 v230, s[76:79], s14 offen offset:1024 lds
    ds_read_b64_tr_b16 a[244:245], v241 offset:0
    v_mfma_f32_16x16x32_bf16 v[60:63], a[236:239], a[0:3], v[60:63]
    s_add_u32 s15, s44, 20480
    buffer_load_dwordx4 a[0:3], v233, s[64:67], s15 offen offset:0
    ds_read_b64_tr_b16 a[246:247], v241 offset:2048
    v_mfma_f32_16x16x32_bf16 v[64:67], a[236:239], a[4:7], v[64:67]
    ds_read_b64_tr_b16 a[248:249], v242 offset:0
    ds_read_b64_tr_b16 a[250:251], v242 offset:2048
    v_mfma_f32_16x16x32_bf16 v[44:47], a[232:235], a[4:7], v[44:47]
    ds_read_b64_tr_b16 a[252:253], v243 offset:0
    ds_read_b64_tr_b16 a[254:255], v243 offset:2048
    v_mfma_f32_16x16x32_bf16 v[24:27], a[228:231], a[4:7], v[24:27]
    buffer_load_dwordx4 v231, s[76:79], s14 offen offset:2048 lds
    v_mfma_f32_16x16x32_bf16 v[4:7], a[224:227], a[4:7], v[4:7]
    buffer_load_dwordx4 v232, s[76:79], s14 offen offset:3072 lds
    v_mfma_f32_16x16x32_bf16 v[8:11], a[224:227], a[8:11], v[8:11]
    buffer_load_dwordx4 a[4:7], v234, s[64:67], s15 offen offset:0
    v_mfma_f32_16x16x32_bf16 v[28:31], a[228:231], a[8:11], v[28:31]
    v_mfma_f32_16x16x32_bf16 v[48:51], a[232:235], a[8:11], v[48:51]
    v_mfma_f32_16x16x32_bf16 v[68:71], a[236:239], a[8:11], v[68:71]
    buffer_load_dwordx4 a[8:11], v235, s[64:67], s15 offen offset:0
    v_mfma_f32_16x16x32_bf16 v[72:75], a[236:239], a[12:15], v[72:75]
    v_mfma_f32_16x16x32_bf16 v[52:55], a[232:235], a[12:15], v[52:55]
    v_mfma_f32_16x16x32_bf16 v[32:35], a[228:231], a[12:15], v[32:35]
    v_mfma_f32_16x16x32_bf16 v[12:15], a[224:227], a[12:15], v[12:15]
    buffer_load_dwordx4 a[12:15], v236, s[64:67], s15 offen offset:0
    v_mfma_f32_16x16x32_bf16 v[16:19], a[224:227], a[16:19], v[16:19]
    v_mfma_f32_16x16x32_bf16 v[36:39], a[228:231], a[16:19], v[36:39]
    v_mfma_f32_16x16x32_bf16 v[56:59], a[232:235], a[16:19], v[56:59]
    v_mfma_f32_16x16x32_bf16 v[76:79], a[236:239], a[16:19], v[76:79]
    s_waitcnt vmcnt(26)
    s_waitcnt lgkmcnt(0)
    buffer_load_dwordx4 a[16:19], v237, s[64:67], s15 offen offset:0
    v_mfma_f32_16x16x32_bf16 v[0:3], a[240:243], a[20:23], v[0:3]
    ds_read_b64_tr_b16 a[224:225], v240 offset:4096
    ds_read_b64_tr_b16 a[226:227], v240 offset:6144
    v_mfma_f32_16x16x32_bf16 v[20:23], a[244:247], a[20:23], v[20:23]
    s_add_u32 m0, s40, 0
    s_add_u32 s14, s41, 995328
    buffer_load_dwordx4 v226, s[76:79], s14 offen offset:0 lds
    v_mfma_f32_16x16x32_bf16 v[40:43], a[248:251], a[20:23], v[40:43]
    buffer_load_dwordx4 v230, s[76:79], s14 offen offset:1024 lds
    ds_read_b64_tr_b16 a[228:229], v241 offset:4096
    v_mfma_f32_16x16x32_bf16 v[60:63], a[252:255], a[20:23], v[60:63]
    buffer_load_dwordx4 a[20:23], v233, s[64:67], s15 offen offset:1024
    ds_read_b64_tr_b16 a[230:231], v241 offset:6144
    v_mfma_f32_16x16x32_bf16 v[64:67], a[252:255], a[24:27], v[64:67]
    ds_read_b64_tr_b16 a[232:233], v242 offset:4096
    ds_read_b64_tr_b16 a[234:235], v242 offset:6144
    v_mfma_f32_16x16x32_bf16 v[44:47], a[248:251], a[24:27], v[44:47]
    ds_read_b64_tr_b16 a[236:237], v243 offset:4096
    ds_read_b64_tr_b16 a[238:239], v243 offset:6144
    v_mfma_f32_16x16x32_bf16 v[24:27], a[244:247], a[24:27], v[24:27]
    buffer_load_dwordx4 v231, s[76:79], s14 offen offset:2048 lds
    v_mfma_f32_16x16x32_bf16 v[4:7], a[240:243], a[24:27], v[4:7]
    buffer_load_dwordx4 v232, s[76:79], s14 offen offset:3072 lds
    v_mfma_f32_16x16x32_bf16 v[8:11], a[240:243], a[28:31], v[8:11]
    buffer_load_dwordx4 a[24:27], v234, s[64:67], s15 offen offset:1024
    v_mfma_f32_16x16x32_bf16 v[28:31], a[244:247], a[28:31], v[28:31]
    v_mfma_f32_16x16x32_bf16 v[48:51], a[248:251], a[28:31], v[48:51]
    v_mfma_f32_16x16x32_bf16 v[68:71], a[252:255], a[28:31], v[68:71]
    buffer_load_dwordx4 a[28:31], v235, s[64:67], s15 offen offset:1024
    v_mfma_f32_16x16x32_bf16 v[72:75], a[252:255], a[32:35], v[72:75]
    v_mfma_f32_16x16x32_bf16 v[52:55], a[248:251], a[32:35], v[52:55]
    v_mfma_f32_16x16x32_bf16 v[32:35], a[244:247], a[32:35], v[32:35]
    v_mfma_f32_16x16x32_bf16 v[12:15], a[240:243], a[32:35], v[12:15]
    buffer_load_dwordx4 a[32:35], v236, s[64:67], s15 offen offset:1024
    v_mfma_f32_16x16x32_bf16 v[16:19], a[240:243], a[36:39], v[16:19]
    v_mfma_f32_16x16x32_bf16 v[36:39], a[244:247], a[36:39], v[36:39]
    v_mfma_f32_16x16x32_bf16 v[56:59], a[248:251], a[36:39], v[56:59]
    v_mfma_f32_16x16x32_bf16 v[76:79], a[252:255], a[36:39], v[76:79]
    s_waitcnt vmcnt(26)
    s_waitcnt lgkmcnt(0)
    buffer_load_dwordx4 a[36:39], v237, s[64:67], s15 offen offset:1024
    v_mfma_f32_16x16x32_bf16 v[0:3], a[224:227], a[40:43], v[0:3]
    ds_read_b64_tr_b16 a[240:241], v240 offset:8192
    ds_read_b64_tr_b16 a[242:243], v240 offset:10240
    v_mfma_f32_16x16x32_bf16 v[20:23], a[228:231], a[40:43], v[20:23]
    s_add_u32 m0, s40, 4096
    s_add_u32 s14, s41, 1032192
    buffer_load_dwordx4 v226, s[76:79], s14 offen offset:0 lds
    v_mfma_f32_16x16x32_bf16 v[40:43], a[232:235], a[40:43], v[40:43]
    buffer_load_dwordx4 v230, s[76:79], s14 offen offset:1024 lds
    ds_read_b64_tr_b16 a[244:245], v241 offset:8192
    v_mfma_f32_16x16x32_bf16 v[60:63], a[236:239], a[40:43], v[60:63]
    buffer_load_dwordx4 a[40:43], v233, s[64:67], s15 offen offset:2048
    ds_read_b64_tr_b16 a[246:247], v241 offset:10240
    v_mfma_f32_16x16x32_bf16 v[64:67], a[236:239], a[44:47], v[64:67]
    ds_read_b64_tr_b16 a[248:249], v242 offset:8192
    ds_read_b64_tr_b16 a[250:251], v242 offset:10240
    v_mfma_f32_16x16x32_bf16 v[44:47], a[232:235], a[44:47], v[44:47]
    ds_read_b64_tr_b16 a[252:253], v243 offset:8192
    ds_read_b64_tr_b16 a[254:255], v243 offset:10240
    v_mfma_f32_16x16x32_bf16 v[24:27], a[228:231], a[44:47], v[24:27]
    buffer_load_dwordx4 v231, s[76:79], s14 offen offset:2048 lds
    v_mfma_f32_16x16x32_bf16 v[4:7], a[224:227], a[44:47], v[4:7]
    buffer_load_dwordx4 v232, s[76:79], s14 offen offset:3072 lds
    v_mfma_f32_16x16x32_bf16 v[8:11], a[224:227], a[48:51], v[8:11]
    buffer_load_dwordx4 a[44:47], v234, s[64:67], s15 offen offset:2048
    v_mfma_f32_16x16x32_bf16 v[28:31], a[228:231], a[48:51], v[28:31]
    v_mfma_f32_16x16x32_bf16 v[48:51], a[232:235], a[48:51], v[48:51]
    v_mfma_f32_16x16x32_bf16 v[68:71], a[236:239], a[48:51], v[68:71]
    buffer_load_dwordx4 a[48:51], v235, s[64:67], s15 offen offset:2048
    v_mfma_f32_16x16x32_bf16 v[72:75], a[236:239], a[52:55], v[72:75]
    v_mfma_f32_16x16x32_bf16 v[52:55], a[232:235], a[52:55], v[52:55]
    v_mfma_f32_16x16x32_bf16 v[32:35], a[228:231], a[52:55], v[32:35]
    v_mfma_f32_16x16x32_bf16 v[12:15], a[224:227], a[52:55], v[12:15]
    buffer_load_dwordx4 a[52:55], v236, s[64:67], s15 offen offset:2048
    v_mfma_f32_16x16x32_bf16 v[16:19], a[224:227], a[56:59], v[16:19]
    v_mfma_f32_16x16x32_bf16 v[36:39], a[228:231], a[56:59], v[36:39]
    v_mfma_f32_16x16x32_bf16 v[56:59], a[232:235], a[56:59], v[56:59]
    v_mfma_f32_16x16x32_bf16 v[76:79], a[236:239], a[56:59], v[76:79]
    s_waitcnt vmcnt(26)
    s_waitcnt lgkmcnt(0)
    buffer_load_dwordx4 a[56:59], v237, s[64:67], s15 offen offset:2048
    v_mfma_f32_16x16x32_bf16 v[0:3], a[240:243], a[60:63], v[0:3]
    ds_read_b64_tr_b16 a[224:225], v240 offset:12288
    ds_read_b64_tr_b16 a[226:227], v240 offset:14336
    v_mfma_f32_16x16x32_bf16 v[20:23], a[244:247], a[60:63], v[20:23]
    s_add_u32 m0, s40, 8192
    s_add_u32 s14, s41, 1069056
    buffer_load_dwordx4 v226, s[76:79], s14 offen offset:0 lds
    v_mfma_f32_16x16x32_bf16 v[40:43], a[248:251], a[60:63], v[40:43]
    buffer_load_dwordx4 v230, s[76:79], s14 offen offset:1024 lds
    ds_read_b64_tr_b16 a[228:229], v241 offset:12288
    v_mfma_f32_16x16x32_bf16 v[60:63], a[252:255], a[60:63], v[60:63]
    buffer_load_dwordx4 a[60:63], v233, s[64:67], s15 offen offset:3072
    ds_read_b64_tr_b16 a[230:231], v241 offset:14336
    v_mfma_f32_16x16x32_bf16 v[64:67], a[252:255], a[64:67], v[64:67]
    ds_read_b64_tr_b16 a[232:233], v242 offset:12288
    ds_read_b64_tr_b16 a[234:235], v242 offset:14336
    v_mfma_f32_16x16x32_bf16 v[44:47], a[248:251], a[64:67], v[44:47]
    ds_read_b64_tr_b16 a[236:237], v243 offset:12288
    ds_read_b64_tr_b16 a[238:239], v243 offset:14336
    v_mfma_f32_16x16x32_bf16 v[24:27], a[244:247], a[64:67], v[24:27]
    buffer_load_dwordx4 v231, s[76:79], s14 offen offset:2048 lds
    v_mfma_f32_16x16x32_bf16 v[4:7], a[240:243], a[64:67], v[4:7]
    buffer_load_dwordx4 v232, s[76:79], s14 offen offset:3072 lds
    v_mfma_f32_16x16x32_bf16 v[8:11], a[240:243], a[68:71], v[8:11]
    buffer_load_dwordx4 a[64:67], v234, s[64:67], s15 offen offset:3072
    v_mfma_f32_16x16x32_bf16 v[28:31], a[244:247], a[68:71], v[28:31]
    v_mfma_f32_16x16x32_bf16 v[48:51], a[248:251], a[68:71], v[48:51]
    v_mfma_f32_16x16x32_bf16 v[68:71], a[252:255], a[68:71], v[68:71]
    buffer_load_dwordx4 a[68:71], v235, s[64:67], s15 offen offset:3072
    v_mfma_f32_16x16x32_bf16 v[72:75], a[252:255], a[72:75], v[72:75]
    v_mfma_f32_16x16x32_bf16 v[52:55], a[248:251], a[72:75], v[52:55]
    v_mfma_f32_16x16x32_bf16 v[32:35], a[244:247], a[72:75], v[32:35]
    v_mfma_f32_16x16x32_bf16 v[12:15], a[240:243], a[72:75], v[12:15]
    buffer_load_dwordx4 a[72:75], v236, s[64:67], s15 offen offset:3072
    v_mfma_f32_16x16x32_bf16 v[16:19], a[240:243], a[76:79], v[16:19]
    v_mfma_f32_16x16x32_bf16 v[36:39], a[244:247], a[76:79], v[36:39]
    v_mfma_f32_16x16x32_bf16 v[56:59], a[248:251], a[76:79], v[56:59]
    v_mfma_f32_16x16x32_bf16 v[76:79], a[252:255], a[76:79], v[76:79]
    s_waitcnt vmcnt(26)
    s_waitcnt lgkmcnt(0)
    buffer_load_dwordx4 a[76:79], v237, s[64:67], s15 offen offset:3072
    v_mfma_f32_16x16x32_bf16 v[0:3], a[224:227], a[0:3], v[0:3]
    ds_read_b64_tr_b16 a[240:241], v240 offset:16384
    ds_read_b64_tr_b16 a[242:243], v240 offset:18432
    v_mfma_f32_16x16x32_bf16 v[20:23], a[228:231], a[0:3], v[20:23]
    s_add_u32 m0, s40, 12288
    s_add_u32 s14, s41, 1105920
    buffer_load_dwordx4 v226, s[76:79], s14 offen offset:0 lds
    v_mfma_f32_16x16x32_bf16 v[40:43], a[232:235], a[0:3], v[40:43]
    buffer_load_dwordx4 v230, s[76:79], s14 offen offset:1024 lds
    ds_read_b64_tr_b16 a[244:245], v241 offset:16384
    v_mfma_f32_16x16x32_bf16 v[60:63], a[236:239], a[0:3], v[60:63]
    s_add_u32 s15, s44, 24576
    buffer_load_dwordx4 a[0:3], v233, s[64:67], s15 offen offset:0
    ds_read_b64_tr_b16 a[246:247], v241 offset:18432
    v_mfma_f32_16x16x32_bf16 v[64:67], a[236:239], a[4:7], v[64:67]
    ds_read_b64_tr_b16 a[248:249], v242 offset:16384
    ds_read_b64_tr_b16 a[250:251], v242 offset:18432
    v_mfma_f32_16x16x32_bf16 v[44:47], a[232:235], a[4:7], v[44:47]
    ds_read_b64_tr_b16 a[252:253], v243 offset:16384
    ds_read_b64_tr_b16 a[254:255], v243 offset:18432
    v_mfma_f32_16x16x32_bf16 v[24:27], a[228:231], a[4:7], v[24:27]
    buffer_load_dwordx4 v231, s[76:79], s14 offen offset:2048 lds
    v_mfma_f32_16x16x32_bf16 v[4:7], a[224:227], a[4:7], v[4:7]
    buffer_load_dwordx4 v232, s[76:79], s14 offen offset:3072 lds
    v_mfma_f32_16x16x32_bf16 v[8:11], a[224:227], a[8:11], v[8:11]
    buffer_load_dwordx4 a[4:7], v234, s[64:67], s15 offen offset:0
    v_mfma_f32_16x16x32_bf16 v[28:31], a[228:231], a[8:11], v[28:31]
    v_mfma_f32_16x16x32_bf16 v[48:51], a[232:235], a[8:11], v[48:51]
    v_mfma_f32_16x16x32_bf16 v[68:71], a[236:239], a[8:11], v[68:71]
    buffer_load_dwordx4 a[8:11], v235, s[64:67], s15 offen offset:0
    v_mfma_f32_16x16x32_bf16 v[72:75], a[236:239], a[12:15], v[72:75]
    v_mfma_f32_16x16x32_bf16 v[52:55], a[232:235], a[12:15], v[52:55]
    v_mfma_f32_16x16x32_bf16 v[32:35], a[228:231], a[12:15], v[32:35]
    v_mfma_f32_16x16x32_bf16 v[12:15], a[224:227], a[12:15], v[12:15]
    buffer_load_dwordx4 a[12:15], v236, s[64:67], s15 offen offset:0
    v_mfma_f32_16x16x32_bf16 v[16:19], a[224:227], a[16:19], v[16:19]
    v_mfma_f32_16x16x32_bf16 v[36:39], a[228:231], a[16:19], v[36:39]
    v_mfma_f32_16x16x32_bf16 v[56:59], a[232:235], a[16:19], v[56:59]
    v_mfma_f32_16x16x32_bf16 v[76:79], a[236:239], a[16:19], v[76:79]
    s_waitcnt vmcnt(26)
    s_waitcnt lgkmcnt(0)
    buffer_load_dwordx4 a[16:19], v237, s[64:67], s15 offen offset:0
    v_mfma_f32_16x16x32_bf16 v[0:3], a[240:243], a[20:23], v[0:3]
    ds_read_b64_tr_b16 a[224:225], v240 offset:20480
    ds_read_b64_tr_b16 a[226:227], v240 offset:22528
    v_mfma_f32_16x16x32_bf16 v[20:23], a[244:247], a[20:23], v[20:23]
    s_add_u32 m0, s40, 16384
    s_add_u32 s14, s41, 1142784
    buffer_load_dwordx4 v226, s[76:79], s14 offen offset:0 lds
    v_mfma_f32_16x16x32_bf16 v[40:43], a[248:251], a[20:23], v[40:43]
    buffer_load_dwordx4 v230, s[76:79], s14 offen offset:1024 lds
    ds_read_b64_tr_b16 a[228:229], v241 offset:20480
    v_mfma_f32_16x16x32_bf16 v[60:63], a[252:255], a[20:23], v[60:63]
    buffer_load_dwordx4 a[20:23], v233, s[64:67], s15 offen offset:1024
    ds_read_b64_tr_b16 a[230:231], v241 offset:22528
    v_mfma_f32_16x16x32_bf16 v[64:67], a[252:255], a[24:27], v[64:67]
    ds_read_b64_tr_b16 a[232:233], v242 offset:20480
    ds_read_b64_tr_b16 a[234:235], v242 offset:22528
    v_mfma_f32_16x16x32_bf16 v[44:47], a[248:251], a[24:27], v[44:47]
    ds_read_b64_tr_b16 a[236:237], v243 offset:20480
    ds_read_b64_tr_b16 a[238:239], v243 offset:22528
    v_mfma_f32_16x16x32_bf16 v[24:27], a[244:247], a[24:27], v[24:27]
    buffer_load_dwordx4 v231, s[76:79], s14 offen offset:2048 lds
    v_mfma_f32_16x16x32_bf16 v[4:7], a[240:243], a[24:27], v[4:7]
    buffer_load_dwordx4 v232, s[76:79], s14 offen offset:3072 lds
    v_mfma_f32_16x16x32_bf16 v[8:11], a[240:243], a[28:31], v[8:11]
    buffer_load_dwordx4 a[24:27], v234, s[64:67], s15 offen offset:1024
    v_mfma_f32_16x16x32_bf16 v[28:31], a[244:247], a[28:31], v[28:31]
    v_mfma_f32_16x16x32_bf16 v[48:51], a[248:251], a[28:31], v[48:51]
    v_mfma_f32_16x16x32_bf16 v[68:71], a[252:255], a[28:31], v[68:71]
    buffer_load_dwordx4 a[28:31], v235, s[64:67], s15 offen offset:1024
    v_mfma_f32_16x16x32_bf16 v[72:75], a[252:255], a[32:35], v[72:75]
    v_mfma_f32_16x16x32_bf16 v[52:55], a[248:251], a[32:35], v[52:55]
    v_mfma_f32_16x16x32_bf16 v[32:35], a[244:247], a[32:35], v[32:35]
    v_mfma_f32_16x16x32_bf16 v[12:15], a[240:243], a[32:35], v[12:15]
    buffer_load_dwordx4 a[32:35], v236, s[64:67], s15 offen offset:1024
    v_mfma_f32_16x16x32_bf16 v[16:19], a[240:243], a[36:39], v[16:19]
    v_mfma_f32_16x16x32_bf16 v[36:39], a[244:247], a[36:39], v[36:39]
    v_mfma_f32_16x16x32_bf16 v[56:59], a[248:251], a[36:39], v[56:59]
    v_mfma_f32_16x16x32_bf16 v[76:79], a[252:255], a[36:39], v[76:79]
    s_waitcnt vmcnt(26)
    s_waitcnt lgkmcnt(0)
    buffer_load_dwordx4 a[36:39], v237, s[64:67], s15 offen offset:1024
    v_mfma_f32_16x16x32_bf16 v[0:3], a[224:227], a[40:43], v[0:3]
    ds_read_b64_tr_b16 a[240:241], v240 offset:24576
    ds_read_b64_tr_b16 a[242:243], v240 offset:26624
    v_mfma_f32_16x16x32_bf16 v[20:23], a[228:231], a[40:43], v[20:23]
    ds_read_b64_tr_b16 a[244:245], v241 offset:24576
    ds_read_b64_tr_b16 a[246:247], v241 offset:26624
    v_mfma_f32_16x16x32_bf16 v[40:43], a[232:235], a[40:43], v[40:43]
    ds_read_b64_tr_b16 a[248:249], v242 offset:24576
    ds_read_b64_tr_b16 a[250:251], v242 offset:26624
    v_mfma_f32_16x16x32_bf16 v[60:63], a[236:239], a[40:43], v[60:63]
    buffer_load_dwordx4 a[40:43], v233, s[64:67], s15 offen offset:2048
    ds_read_b64_tr_b16 a[252:253], v243 offset:24576
    v_mfma_f32_16x16x32_bf16 v[64:67], a[236:239], a[44:47], v[64:67]
    ds_read_b64_tr_b16 a[254:255], v243 offset:26624
    v_mfma_f32_16x16x32_bf16 v[44:47], a[232:235], a[44:47], v[44:47]
    v_mfma_f32_16x16x32_bf16 v[24:27], a[228:231], a[44:47], v[24:27]
    v_mfma_f32_16x16x32_bf16 v[4:7], a[224:227], a[44:47], v[4:7]
    buffer_load_dwordx4 a[44:47], v234, s[64:67], s15 offen offset:2048
    v_mfma_f32_16x16x32_bf16 v[8:11], a[224:227], a[48:51], v[8:11]
    v_mfma_f32_16x16x32_bf16 v[28:31], a[228:231], a[48:51], v[28:31]
    v_mfma_f32_16x16x32_bf16 v[48:51], a[232:235], a[48:51], v[48:51]
    v_mfma_f32_16x16x32_bf16 v[68:71], a[236:239], a[48:51], v[68:71]
    buffer_load_dwordx4 a[48:51], v235, s[64:67], s15 offen offset:2048
    v_mfma_f32_16x16x32_bf16 v[72:75], a[236:239], a[52:55], v[72:75]
    v_mfma_f32_16x16x32_bf16 v[52:55], a[232:235], a[52:55], v[52:55]
    v_mfma_f32_16x16x32_bf16 v[32:35], a[228:231], a[52:55], v[32:35]
    v_mfma_f32_16x16x32_bf16 v[12:15], a[224:227], a[52:55], v[12:15]
    buffer_load_dwordx4 a[52:55], v236, s[64:67], s15 offen offset:2048
    v_mfma_f32_16x16x32_bf16 v[16:19], a[224:227], a[56:59], v[16:19]
    v_mfma_f32_16x16x32_bf16 v[36:39], a[228:231], a[56:59], v[36:39]
    v_mfma_f32_16x16x32_bf16 v[56:59], a[232:235], a[56:59], v[56:59]
    v_mfma_f32_16x16x32_bf16 v[76:79], a[236:239], a[56:59], v[76:79]
    s_waitcnt vmcnt(22)
    s_waitcnt lgkmcnt(0)
    buffer_load_dwordx4 a[56:59], v237, s[64:67], s15 offen offset:2048
    v_mfma_f32_16x16x32_bf16 v[0:3], a[240:243], a[60:63], v[0:3]
    ds_read_b64_tr_b16 a[224:225], v240 offset:28672
    ds_read_b64_tr_b16 a[226:227], v240 offset:30720
    v_mfma_f32_16x16x32_bf16 v[20:23], a[244:247], a[60:63], v[20:23]
    ds_read_b64_tr_b16 a[228:229], v241 offset:28672
    ds_read_b64_tr_b16 a[230:231], v241 offset:30720
    v_mfma_f32_16x16x32_bf16 v[40:43], a[248:251], a[60:63], v[40:43]
    ds_read_b64_tr_b16 a[232:233], v242 offset:28672
    ds_read_b64_tr_b16 a[234:235], v242 offset:30720
    v_mfma_f32_16x16x32_bf16 v[60:63], a[252:255], a[60:63], v[60:63]
    buffer_load_dwordx4 a[60:63], v233, s[64:67], s15 offen offset:3072
    ds_read_b64_tr_b16 a[236:237], v243 offset:28672
    v_mfma_f32_16x16x32_bf16 v[64:67], a[252:255], a[64:67], v[64:67]
    ds_read_b64_tr_b16 a[238:239], v243 offset:30720
    v_mfma_f32_16x16x32_bf16 v[44:47], a[248:251], a[64:67], v[44:47]
    v_mfma_f32_16x16x32_bf16 v[24:27], a[244:247], a[64:67], v[24:27]
    v_mfma_f32_16x16x32_bf16 v[4:7], a[240:243], a[64:67], v[4:7]
    buffer_load_dwordx4 a[64:67], v234, s[64:67], s15 offen offset:3072
    v_mfma_f32_16x16x32_bf16 v[8:11], a[240:243], a[68:71], v[8:11]
    v_mfma_f32_16x16x32_bf16 v[28:31], a[244:247], a[68:71], v[28:31]
    v_mfma_f32_16x16x32_bf16 v[48:51], a[248:251], a[68:71], v[48:51]
    v_mfma_f32_16x16x32_bf16 v[68:71], a[252:255], a[68:71], v[68:71]
    buffer_load_dwordx4 a[68:71], v235, s[64:67], s15 offen offset:3072
    v_mfma_f32_16x16x32_bf16 v[72:75], a[252:255], a[72:75], v[72:75]
    v_mfma_f32_16x16x32_bf16 v[52:55], a[248:251], a[72:75], v[52:55]
    v_mfma_f32_16x16x32_bf16 v[32:35], a[244:247], a[72:75], v[32:35]
    v_mfma_f32_16x16x32_bf16 v[12:15], a[240:243], a[72:75], v[12:15]
    buffer_load_dwordx4 a[72:75], v236, s[64:67], s15 offen offset:3072
    v_mfma_f32_16x16x32_bf16 v[16:19], a[240:243], a[76:79], v[16:19]
    v_mfma_f32_16x16x32_bf16 v[36:39], a[244:247], a[76:79], v[36:39]
    v_mfma_f32_16x16x32_bf16 v[56:59], a[248:251], a[76:79], v[56:59]
    v_mfma_f32_16x16x32_bf16 v[76:79], a[252:255], a[76:79], v[76:79]
    s_waitcnt vmcnt(18)
    s_waitcnt lgkmcnt(0)
    buffer_load_dwordx4 a[76:79], v237, s[64:67], s15 offen offset:3072
    v_mfma_f32_16x16x32_bf16 v[0:3], a[224:227], a[0:3], v[0:3]
    buffer_load_dwordx4 v[160:163], v223, s[64:67], s99 offen sc1
    ds_read_b64_tr_b16 a[240:241], v240 offset:32768
    v_mfma_f32_16x16x32_bf16 v[20:23], a[228:231], a[0:3], v[20:23]
    ds_read_b64_tr_b16 a[242:243], v240 offset:34816
    ds_read_b64_tr_b16 a[244:245], v241 offset:32768
    v_mfma_f32_16x16x32_bf16 v[40:43], a[232:235], a[0:3], v[40:43]
    ds_read_b64_tr_b16 a[246:247], v241 offset:34816
    ds_read_b64_tr_b16 a[248:249], v242 offset:32768
    v_mfma_f32_16x16x32_bf16 v[60:63], a[236:239], a[0:3], v[60:63]
    s_add_u32 s15, s44, 28672
    buffer_load_dwordx4 a[0:3], v233, s[64:67], s15 offen offset:0
    ds_read_b64_tr_b16 a[250:251], v242 offset:34816
    v_mfma_f32_16x16x32_bf16 v[64:67], a[236:239], a[4:7], v[64:67]
    ds_read_b64_tr_b16 a[252:253], v243 offset:32768
    ds_read_b64_tr_b16 a[254:255], v243 offset:34816
    v_mfma_f32_16x16x32_bf16 v[44:47], a[232:235], a[4:7], v[44:47]
    v_mfma_f32_16x16x32_bf16 v[24:27], a[228:231], a[4:7], v[24:27]
    v_mfma_f32_16x16x32_bf16 v[4:7], a[224:227], a[4:7], v[4:7]
    buffer_load_dwordx4 a[4:7], v234, s[64:67], s15 offen offset:0
    v_mfma_f32_16x16x32_bf16 v[8:11], a[224:227], a[8:11], v[8:11]
    v_mfma_f32_16x16x32_bf16 v[28:31], a[228:231], a[8:11], v[28:31]
    v_mfma_f32_16x16x32_bf16 v[48:51], a[232:235], a[8:11], v[48:51]
    v_mfma_f32_16x16x32_bf16 v[68:71], a[236:239], a[8:11], v[68:71]
    buffer_load_dwordx4 a[8:11], v235, s[64:67], s15 offen offset:0
    v_mfma_f32_16x16x32_bf16 v[72:75], a[236:239], a[12:15], v[72:75]
    v_mfma_f32_16x16x32_bf16 v[52:55], a[232:235], a[12:15], v[52:55]
    v_mfma_f32_16x16x32_bf16 v[32:35], a[228:231], a[12:15], v[32:35]
    v_mfma_f32_16x16x32_bf16 v[12:15], a[224:227], a[12:15], v[12:15]
    buffer_load_dwordx4 a[12:15], v236, s[64:67], s15 offen offset:0
    v_mfma_f32_16x16x32_bf16 v[16:19], a[224:227], a[16:19], v[16:19]
    v_mfma_f32_16x16x32_bf16 v[36:39], a[228:231], a[16:19], v[36:39]
    v_mfma_f32_16x16x32_bf16 v[56:59], a[232:235], a[16:19], v[56:59]
    v_mfma_f32_16x16x32_bf16 v[76:79], a[236:239], a[16:19], v[76:79]
    s_waitcnt vmcnt(15)
    s_waitcnt lgkmcnt(0)
    buffer_load_dwordx4 a[16:19], v237, s[64:67], s15 offen offset:0
    v_mfma_f32_16x16x32_bf16 v[0:3], a[240:243], a[20:23], v[0:3]
    ds_read_b64_tr_b16 a[224:225], v240 offset:36864
    ds_read_b64_tr_b16 a[226:227], v240 offset:38912
    v_mfma_f32_16x16x32_bf16 v[20:23], a[244:247], a[20:23], v[20:23]
    ds_read_b64_tr_b16 a[228:229], v241 offset:36864
    ds_read_b64_tr_b16 a[230:231], v241 offset:38912
    v_mfma_f32_16x16x32_bf16 v[40:43], a[248:251], a[20:23], v[40:43]
    ds_read_b64_tr_b16 a[232:233], v242 offset:36864
    ds_read_b64_tr_b16 a[234:235], v242 offset:38912
    v_mfma_f32_16x16x32_bf16 v[60:63], a[252:255], a[20:23], v[60:63]
    buffer_load_dwordx4 a[20:23], v233, s[64:67], s15 offen offset:1024
    ds_read_b64_tr_b16 a[236:237], v243 offset:36864
    v_mfma_f32_16x16x32_bf16 v[64:67], a[252:255], a[24:27], v[64:67]
    ds_read_b64_tr_b16 a[238:239], v243 offset:38912
    v_mfma_f32_16x16x32_bf16 v[44:47], a[248:251], a[24:27], v[44:47]
    v_mfma_f32_16x16x32_bf16 v[24:27], a[244:247], a[24:27], v[24:27]
    v_mfma_f32_16x16x32_bf16 v[4:7], a[240:243], a[24:27], v[4:7]
    buffer_load_dwordx4 a[24:27], v234, s[64:67], s15 offen offset:1024
    v_mfma_f32_16x16x32_bf16 v[8:11], a[240:243], a[28:31], v[8:11]
    v_mfma_f32_16x16x32_bf16 v[28:31], a[244:247], a[28:31], v[28:31]
    v_mfma_f32_16x16x32_bf16 v[48:51], a[248:251], a[28:31], v[48:51]
    v_mfma_f32_16x16x32_bf16 v[68:71], a[252:255], a[28:31], v[68:71]
    buffer_load_dwordx4 a[28:31], v235, s[64:67], s15 offen offset:1024
    v_mfma_f32_16x16x32_bf16 v[72:75], a[252:255], a[32:35], v[72:75]
    v_mfma_f32_16x16x32_bf16 v[52:55], a[248:251], a[32:35], v[52:55]
    v_mfma_f32_16x16x32_bf16 v[32:35], a[244:247], a[32:35], v[32:35]
    v_mfma_f32_16x16x32_bf16 v[12:15], a[240:243], a[32:35], v[12:15]
    buffer_load_dwordx4 a[32:35], v236, s[64:67], s15 offen offset:1024
    v_mfma_f32_16x16x32_bf16 v[16:19], a[240:243], a[36:39], v[16:19]
    v_mfma_f32_16x16x32_bf16 v[36:39], a[244:247], a[36:39], v[36:39]
    v_mfma_f32_16x16x32_bf16 v[56:59], a[248:251], a[36:39], v[56:59]
    v_mfma_f32_16x16x32_bf16 v[76:79], a[252:255], a[36:39], v[76:79]
    s_waitcnt vmcnt(15)
    s_waitcnt lgkmcnt(0)
    buffer_load_dwordx4 a[36:39], v237, s[64:67], s15 offen offset:1024
    v_mfma_f32_16x16x32_bf16 v[0:3], a[224:227], a[40:43], v[0:3]
    ds_read_b64_tr_b16 a[240:241], v240 offset:0
    ds_read_b64_tr_b16 a[242:243], v240 offset:2048
    v_mfma_f32_16x16x32_bf16 v[20:23], a[228:231], a[40:43], v[20:23]
    ds_read_b64_tr_b16 a[244:245], v241 offset:0
    ds_read_b64_tr_b16 a[246:247], v241 offset:2048
    v_mfma_f32_16x16x32_bf16 v[40:43], a[232:235], a[40:43], v[40:43]
    ds_read_b64_tr_b16 a[248:249], v242 offset:0
    ds_read_b64_tr_b16 a[250:251], v242 offset:2048
    v_mfma_f32_16x16x32_bf16 v[60:63], a[236:239], a[40:43], v[60:63]
    buffer_load_dwordx4 a[40:43], v233, s[64:67], s15 offen offset:2048
    ds_read_b64_tr_b16 a[252:253], v243 offset:0
    v_mfma_f32_16x16x32_bf16 v[64:67], a[236:239], a[44:47], v[64:67]
    ds_read_b64_tr_b16 a[254:255], v243 offset:2048
    v_mfma_f32_16x16x32_bf16 v[44:47], a[232:235], a[44:47], v[44:47]
    v_mfma_f32_16x16x32_bf16 v[24:27], a[228:231], a[44:47], v[24:27]
    v_mfma_f32_16x16x32_bf16 v[4:7], a[224:227], a[44:47], v[4:7]
    buffer_load_dwordx4 a[44:47], v234, s[64:67], s15 offen offset:2048
    v_mfma_f32_16x16x32_bf16 v[8:11], a[224:227], a[48:51], v[8:11]
    v_mfma_f32_16x16x32_bf16 v[28:31], a[228:231], a[48:51], v[28:31]
    v_mfma_f32_16x16x32_bf16 v[48:51], a[232:235], a[48:51], v[48:51]
    v_mfma_f32_16x16x32_bf16 v[68:71], a[236:239], a[48:51], v[68:71]
    buffer_load_dwordx4 a[48:51], v235, s[64:67], s15 offen offset:2048
    v_mfma_f32_16x16x32_bf16 v[72:75], a[236:239], a[52:55], v[72:75]
    v_mfma_f32_16x16x32_bf16 v[52:55], a[232:235], a[52:55], v[52:55]
    v_mfma_f32_16x16x32_bf16 v[32:35], a[228:231], a[52:55], v[32:35]
    v_mfma_f32_16x16x32_bf16 v[12:15], a[224:227], a[52:55], v[12:15]
    buffer_load_dwordx4 a[52:55], v236, s[64:67], s15 offen offset:2048
    v_mfma_f32_16x16x32_bf16 v[16:19], a[224:227], a[56:59], v[16:19]
    v_mfma_f32_16x16x32_bf16 v[36:39], a[228:231], a[56:59], v[36:39]
    v_mfma_f32_16x16x32_bf16 v[56:59], a[232:235], a[56:59], v[56:59]
    v_mfma_f32_16x16x32_bf16 v[76:79], a[236:239], a[56:59], v[76:79]
    s_waitcnt vmcnt(15)
    s_waitcnt lgkmcnt(0)
    buffer_load_dwordx4 a[56:59], v237, s[64:67], s15 offen offset:2048
    v_mfma_f32_16x16x32_bf16 v[0:3], a[240:243], a[60:63], v[0:3]
    ds_read_b64_tr_b16 a[224:225], v240 offset:4096
    ds_read_b64_tr_b16 a[226:227], v240 offset:6144
    v_mfma_f32_16x16x32_bf16 v[20:23], a[244:247], a[60:63], v[20:23]
    ds_read_b64_tr_b16 a[228:229], v241 offset:4096
    ds_read_b64_tr_b16 a[230:231], v241 offset:6144
    v_mfma_f32_16x16x32_bf16 v[40:43], a[248:251], a[60:63], v[40:43]
    ds_read_b64_tr_b16 a[232:233], v242 offset:4096
    ds_read_b64_tr_b16 a[234:235], v242 offset:6144
    v_mfma_f32_16x16x32_bf16 v[60:63], a[252:255], a[60:63], v[60:63]
    buffer_load_dwordx4 a[60:63], v233, s[64:67], s15 offen offset:3072
    ds_read_b64_tr_b16 a[236:237], v243 offset:4096
    v_mfma_f32_16x16x32_bf16 v[64:67], a[252:255], a[64:67], v[64:67]
    ds_read_b64_tr_b16 a[238:239], v243 offset:6144
    v_mfma_f32_16x16x32_bf16 v[44:47], a[248:251], a[64:67], v[44:47]
    v_mfma_f32_16x16x32_bf16 v[24:27], a[244:247], a[64:67], v[24:27]
    v_mfma_f32_16x16x32_bf16 v[4:7], a[240:243], a[64:67], v[4:7]
    buffer_load_dwordx4 a[64:67], v234, s[64:67], s15 offen offset:3072
    v_mfma_f32_16x16x32_bf16 v[8:11], a[240:243], a[68:71], v[8:11]
    v_mfma_f32_16x16x32_bf16 v[28:31], a[244:247], a[68:71], v[28:31]
    v_mfma_f32_16x16x32_bf16 v[48:51], a[248:251], a[68:71], v[48:51]
    v_mfma_f32_16x16x32_bf16 v[68:71], a[252:255], a[68:71], v[68:71]
    buffer_load_dwordx4 a[68:71], v235, s[64:67], s15 offen offset:3072
    v_mfma_f32_16x16x32_bf16 v[72:75], a[252:255], a[72:75], v[72:75]
    v_mfma_f32_16x16x32_bf16 v[52:55], a[248:251], a[72:75], v[52:55]
    v_mfma_f32_16x16x32_bf16 v[32:35], a[244:247], a[72:75], v[32:35]
    v_mfma_f32_16x16x32_bf16 v[12:15], a[240:243], a[72:75], v[12:15]
    buffer_load_dwordx4 a[72:75], v236, s[64:67], s15 offen offset:3072
    v_mfma_f32_16x16x32_bf16 v[16:19], a[240:243], a[76:79], v[16:19]
    v_mfma_f32_16x16x32_bf16 v[36:39], a[244:247], a[76:79], v[36:39]
    v_mfma_f32_16x16x32_bf16 v[56:59], a[248:251], a[76:79], v[56:59]
    v_mfma_f32_16x16x32_bf16 v[76:79], a[252:255], a[76:79], v[76:79]
    s_waitcnt vmcnt(14)
    s_waitcnt lgkmcnt(0)
    buffer_load_dwordx4 a[76:79], v237, s[64:67], s15 offen offset:3072
    v_mfma_f32_16x16x32_bf16 v[0:3], a[224:227], a[0:3], v[0:3]
    ds_read_b64_tr_b16 a[240:241], v240 offset:8192
    ds_read_b64_tr_b16 a[242:243], v240 offset:10240
    v_and_b32 v160, v160, v161
    v_mfma_f32_16x16x32_bf16 v[20:23], a[228:231], a[0:3], v[20:23]
    ds_read_b64_tr_b16 a[244:245], v241 offset:8192
    ds_read_b64_tr_b16 a[246:247], v241 offset:10240
    v_and_b32 v162, v162, v163
    v_mfma_f32_16x16x32_bf16 v[40:43], a[232:235], a[0:3], v[40:43]
    v_and_b32 v160, v160, v162
    v_cmp_ne_u32 vcc, 1, v160
    s_nop 0
    s_cbranch_vccnz L_SPIN_S5
L_BACK_S5:
    v_add_u32 v233, 0, v207
    v_add_u32 v234, 19456, v207
    v_add_u32 v235, 38912, v207
    v_add_u32 v236, 58368, v207
    v_mfma_f32_16x16x32_bf16 v[60:63], a[236:239], a[0:3], v[60:63]
    ds_read_b64_tr_b16 a[248:249], v242 offset:8192
    ds_read_b64_tr_b16 a[250:251], v242 offset:10240
    v_mfma_f32_16x16x32_bf16 v[64:67], a[236:239], a[4:7], v[64:67]
    ds_read_b64_tr_b16 a[252:253], v243 offset:8192
    ds_read_b64_tr_b16 a[254:255], v243 offset:10240
    v_mfma_f32_16x16x32_bf16 v[44:47], a[232:235], a[4:7], v[44:47]
    v_mfma_f32_16x16x32_bf16 v[24:27], a[228:231], a[4:7], v[24:27]
    v_mfma_f32_16x16x32_bf16 v[4:7], a[224:227], a[4:7], v[4:7]
    v_mfma_f32_16x16x32_bf16 v[8:11], a[224:227], a[8:11], v[8:11]
    v_mfma_f32_16x16x32_bf16 v[28:31], a[228:231], a[8:11], v[28:31]
    v_mfma_f32_16x16x32_bf16 v[48:51], a[232:235], a[8:11], v[48:51]
    v_mfma_f32_16x16x32_bf16 v[68:71], a[236:239], a[8:11], v[68:71]
    v_mfma_f32_16x16x32_bf16 v[72:75], a[236:239], a[12:15], v[72:75]
    v_mfma_f32_16x16x32_bf16 v[52:55], a[232:235], a[12:15], v[52:55]
    v_mfma_f32_16x16x32_bf16 v[32:35], a[228:231], a[12:15], v[32:35]
    v_mfma_f32_16x16x32_bf16 v[12:15], a[224:227], a[12:15], v[12:15]
    v_mfma_f32_16x16x32_bf16 v[16:19], a[224:227], a[16:19], v[16:19]
    v_mfma_f32_16x16x32_bf16 v[36:39], a[228:231], a[16:19], v[36:39]
    v_mfma_f32_16x16x32_bf16 v[56:59], a[232:235], a[16:19], v[56:59]
    v_mfma_f32_16x16x32_bf16 v[76:79], a[236:239], a[16:19], v[76:79]
    s_waitcnt vmcnt(10)
    s_waitcnt lgkmcnt(0)
    v_mfma_f32_16x16x32_bf16 v[0:3], a[240:243], a[20:23], v[0:3]
    ds_read_b64_tr_b16 a[224:225], v240 offset:12288
    ds_read_b64_tr_b16 a[226:227], v240 offset:14336
    v_mfma_f32_16x16x32_bf16 v[20:23], a[244:247], a[20:23], v[20:23]
    s_add_u32 m0, s40, 20480
    ds_read_b64_tr_b16 a[228:229], v241 offset:12288
    ds_read_b64_tr_b16 a[230:231], v241 offset:14336
    v_mfma_f32_16x16x32_bf16 v[40:43], a[248:251], a[20:23], v[40:43]
    s_add_u32 s14, s45, 0
    ds_read_b64_tr_b16 a[232:233], v242 offset:12288
    ds_read_b64_tr_b16 a[234:235], v242 offset:14336
    v_mfma_f32_16x16x32_bf16 v[60:63], a[252:255], a[20:23], v[60:63]
    ds_read_b64_tr_b16 a[236:237], v243 offset:12288
    ds_read_b64_tr_b16 a[238:239], v243 offset:14336
    v_mfma_f32_16x16x32_bf16 v[64:67], a[252:255], a[24:27], v[64:67]
    buffer_load_dwordx4 v233, s[64:67], s14 offen offset:0 sc1 lds
    v_mfma_f32_16x16x32_bf16 v[44:47], a[248:251], a[24:27], v[44:47]
    v_mfma_f32_16x16x32_bf16 v[24:27], a[244:247], a[24:27], v[24:27]
    buffer_load_dwordx4 v234, s[64:67], s14 offen offset:1024 sc1 lds
    v_mfma_f32_16x16x32_bf16 v[4:7], a[240:243], a[24:27], v[4:7]
    buffer_load_dwordx4 v235, s[64:67], s14 offen offset:2048 sc1 lds
    v_mfma_f32_16x16x32_bf16 v[8:11], a[240:243], a[28:31], v[8:11]
    v_mfma_f32_16x16x32_bf16 v[28:31], a[244:247], a[28:31], v[28:31]
    buffer_load_dwordx4 v236, s[64:67], s14 offen offset:3072 sc1 lds
    v_mfma_f32_16x16x32_bf16 v[48:51], a[248:251], a[28:31], v[48:51]
    v_mfma_f32_16x16x32_bf16 v[68:71], a[252:255], a[28:31], v[68:71]
    buffer_load_dwordx4 a[80:83], v207, s[64:67], s46 offen sc1
    v_mfma_f32_16x16x32_bf16 v[72:75], a[252:255], a[32:35], v[72:75]
    buffer_load_dwordx4 a[84:87], v208, s[64:67], s46 offen sc1
    v_mfma_f32_16x16x32_bf16 v[52:55], a[248:251], a[32:35], v[52:55]
    v_mfma_f32_16x16x32_bf16 v[32:35], a[244:247], a[32:35], v[32:35]
    buffer_load_dwordx4 a[88:91], v209, s[64:67], s46 offen sc1
    v_mfma_f32_16x16x32_bf16 v[12:15], a[240:243], a[32:35], v[12:15]
    v_mfma_f32_16x16x32_bf16 v[16:19], a[240:243], a[36:39], v[16:19]
    buffer_load_dwordx4 a[92:95], v210, s[64:67], s46 offen sc1
    v_mfma_f32_16x16x32_bf16 v[36:39], a[244:247], a[36:39], v[36:39]
    v_mfma_f32_16x16x32_bf16 v[56:59], a[248:251], a[36:39], v[56:59]
    v_mfma_f32_16x16x32_bf16 v[76:79], a[252:255], a[36:39], v[76:79]
    s_waitcnt vmcnt(13)
    s_waitcnt lgkmcnt(0)
    v_mfma_f32_16x16x32_bf16 v[0:3], a[224:227], a[40:43], v[0:3]
    ds_read_b64_tr_b16 a[240:241], v240 offset:16384
    ds_read_b64_tr_b16 a[242:243], v240 offset:18432
    v_mfma_f32_16x16x32_bf16 v[20:23], a[228:231], a[40:43], v[20:23]
    s_add_u32 m0, s40, 24576
    ds_read_b64_tr_b16 a[244:245], v241 offset:16384
    ds_read_b64_tr_b16 a[246:247], v241 offset:18432
    v_mfma_f32_16x16x32_bf16 v[40:43], a[232:235], a[40:43], v[40:43]
    s_add_u32 s14, s45, 1024
    ds_read_b64_tr_b16 a[248:249], v242 offset:16384
    ds_read_b64_tr_b16 a[250:251], v242 offset:18432
    v_mfma_f32_16x16x32_bf16 v[60:63], a[236:239], a[40:43], v[60:63]
    ds_read_b64_tr_b16 a[252:253], v243 offset:16384
    ds_read_b64_tr_b16 a[254:255], v243 offset:18432
    v_mfma_f32_16x16x32_bf16 v[64:67], a[236:239], a[44:47], v[64:67]
    buffer_load_dwordx4 v233, s[64:67], s14 offen offset:0 sc1 lds
    v_mfma_f32_16x16x32_bf16 v[44:47], a[232:235], a[44:47], v[44:47]
    v_mfma_f32_16x16x32_bf16 v[24:27], a[228:231], a[44:47], v[24:27]
    buffer_load_dwordx4 v234, s[64:67], s14 offen offset:1024 sc1 lds
    v_mfma_f32_16x16x32_bf16 v[4:7], a[224:227], a[44:47], v[4:7]
    buffer_load_dwordx4 v235, s[64:67], s14 offen offset:2048 sc1 lds
    v_mfma_f32_16x16x32_bf16 v[8:11], a[224:227], a[48:51], v[8:11]
    v_mfma_f32_16x16x32_bf16 v[28:31], a[228:231], a[48:51], v[28:31]
    buffer_load_dwordx4 v236, s[64:67], s14 offen offset:3072 sc1 lds
    v_mfma_f32_16x16x32_bf16 v[48:51], a[232:235], a[48:51], v[48:51]
    v_mfma_f32_16x16x32_bf16 v[68:71], a[236:239], a[48:51], v[68:71]
    buffer_load_dwordx4 a[96:99], v215, s[64:67], s98 offen sc1
    v_mfma_f32_16x16x32_bf16 v[72:75], a[236:239], a[52:55], v[72:75]
    buffer_load_dwordx4 a[100:103], v216, s[64:67], s98 offen sc1
    v_mfma_f32_16x16x32_bf16 v[52:55], a[232:235], a[52:55], v[52:55]
    v_mfma_f32_16x16x32_bf16 v[32:35], a[228:231], a[52:55], v[32:35]
    buffer_load_dwordx4 a[104:107], v217, s[64:67], s98 offen sc1
    v_mfma_f32_16x16x32_bf16 v[12:15], a[224:227], a[52:55], v[12:15]
    v_mfma_f32_16x16x32_bf16 v[16:19], a[224:227], a[56:59], v[16:19]
    buffer_load_dwordx4 a[108:111], v218, s[64:67], s98 offen sc1
    v_mfma_f32_16x16x32_bf16 v[36:39], a[228:231], a[56:59], v[36:39]
    v_mfma_f32_16x16x32_bf16 v[56:59], a[232:235], a[56:59], v[56:59]
    v_mfma_f32_16x16x32_bf16 v[76:79], a[236:239], a[56:59], v[76:79]
    s_waitcnt vmcnt(12)
    s_waitcnt lgkmcnt(0)
    v_mfma_f32_16x16x32_bf16 v[0:3], a[240:243], a[60:63], v[0:3]
    ds_read_b64_tr_b16 a[224:225], v248 offset:20480
    ds_read_b64_tr_b16 a[226:227], v248 offset:20992
    v_mfma_f32_16x16x32_bf16 v[20:23], a[244:247], a[60:63], v[20:23]
    s_add_u32 m0, s40, 28672
    ds_read_b64_tr_b16 a[228:229], v249 offset:20480
    ds_read_b64_tr_b16 a[230:231], v249 offset:20992
    v_mfma_f32_16x16x32_bf16 v[40:43], a[248:251], a[60:63], v[40:43]
    s_add_u32 s14, s45, 2048
    ds_read_b64_tr_b16 a[232:233], v250 offset:20480
    ds_read_b64_tr_b16 a[234:235], v250 offset:20992
    v_mfma_f32_16x16x32_bf16 v[60:63], a[252:255], a[60:63], v[60:63]
    ds_read_b64_tr_b16 a[236:237], v251 offset:20480
    ds_read_b64_tr_b16 a[238:239], v251 offset:20992
    v_mfma_f32_16x16x32_bf16 v[64:67], a[252:255], a[64:67], v[64:67]
    buffer_load_dwordx4 v233, s[64:67], s14 offen offset:0 sc1 lds
    v_mfma_f32_16x16x32_bf16 v[44:47], a[248:251], a[64:67], v[44:47]
    buffer_load_dwordx4 v234, s[64:67], s14 offen offset:1024 sc1 lds
    v_mfma_f32_16x16x32_bf16 v[24:27], a[244:247], a[64:67], v[24:27]
    v_mfma_f32_16x16x32_bf16 v[4:7], a[240:243], a[64:67], v[4:7]
    buffer_load_dwordx4 v235, s[64:67], s14 offen offset:2048 sc1 lds
    v_mfma_f32_16x16x32_bf16 v[8:11], a[240:243], a[68:71], v[8:11]
    buffer_load_dwordx4 v236, s[64:67], s14 offen offset:3072 sc1 lds
    v_mfma_f32_16x16x32_bf16 v[28:31], a[244:247], a[68:71], v[28:31]
    v_mfma_f32_16x16x32_bf16 v[48:51], a[248:251], a[68:71], v[48:51]
    s_add_u32 s98, s98, s101
    v_mfma_f32_16x16x32_bf16 v[68:71], a[252:255], a[68:71], v[68:71]
    buffer_load_dwordx4 a[112:115], v215, s[64:67], s98 offen sc1
    v_mfma_f32_16x16x32_bf16 v[72:75], a[252:255], a[72:75], v[72:75]
    v_mfma_f32_16x16x32_bf16 v[52:55], a[248:251], a[72:75], v[52:55]
    buffer_load_dwordx4 a[116:119], v216, s[64:67], s98 offen sc1
    v_mfma_f32_16x16x32_bf16 v[32:35], a[244:247], a[72:75], v[32:35]
    buffer_load_dwordx4 a[120:123], v217, s[64:67], s98 offen sc1
    v_mfma_f32_16x16x32_bf16 v[12:15], a[240:243], a[72:75], v[12:15]
    v_mfma_f32_16x16x32_bf16 v[16:19], a[240:243], a[76:79], v[16:19]
    buffer_load_dwordx4 a[124:127], v218, s[64:67], s98 offen sc1
    v_mfma_f32_16x16x32_bf16 v[36:39], a[244:247], a[76:79], v[36:39]
    v_mfma_f32_16x16x32_bf16 v[56:59], a[248:251], a[76:79], v[56:59]
    v_mfma_f32_16x16x32_bf16 v[76:79], a[252:255], a[76:79], v[76:79]
    s_waitcnt vmcnt(12)
    s_waitcnt lgkmcnt(0)
    v_mfma_f32_16x16x32_bf16 v[80:83], a[224:227], a[80:83], 0
    ds_read_b64_tr_b16 a[240:241], v248 offset:24576
    ds_read_b64_tr_b16 a[242:243], v248 offset:25088
    v_mfma_f32_16x16x32_bf16 v[96:99], a[228:231], a[80:83], 0
    s_add_u32 m0, s40, 32768
    ds_read_b64_tr_b16 a[244:245], v249 offset:24576
    ds_read_b64_tr_b16 a[246:247], v249 offset:25088
    v_mfma_f32_16x16x32_bf16 v[112:115], a[232:235], a[80:83], 0
    s_add_u32 s14, s45, 3072
    ds_read_b64_tr_b16 a[248:249], v250 offset:24576
    ds_read_b64_tr_b16 a[250:251], v250 offset:25088
    v_mfma_f32_16x16x32_bf16 v[128:131], a[236:239], a[80:83], 0
    buffer_load_dwordx4 v233, s[64:67], s14 offen offset:0 sc1 lds
    ds_read_b64_tr_b16 a[252:253], v251 offset:24576
    v_mfma_f32_16x16x32_bf16 v[132:135], a[236:239], a[84:87], 0
    buffer_load_dwordx4 v234, s[64:67], s14 offen offset:1024 sc1 lds
    ds_read_b64_tr_b16 a[254:255], v251 offset:25088
    v_mfma_f32_16x16x32_bf16 v[116:119], a[232:235], a[84:87], 0
    buffer_load_dwordx4 v235, s[64:67], s14 offen offset:2048 sc1 lds
    v_mfma_f32_16x16x32_bf16 v[100:103], a[228:231], a[84:87], 0
    buffer_load_dwordx4 v236, s[64:67], s14 offen offset:3072 sc1 lds
    ds_write_b128 v192, v[20:23] offset:0
    v_mfma_f32_16x16x32_bf16 v[84:87], a[224:227], a[84:87], 0
    ds_write_b128 v192, v[24:27] offset:1024
    ds_write_b128 v192, v[28:31] offset:2048
    v_mfma_f32_16x16x32_bf16 v[88:91], a[224:227], a[88:91], 0
    s_add_u32 s98, s98, s101
    ds_write_b128 v192, v[32:35] offset:3072
    ds_write_b128 v192, v[36:39] offset:4096
    v_mfma_f32_16x16x32_bf16 v[104:107], a[228:231], a[88:91], 0
    buffer_load_dwordx4 a[128:131], v215, s[64:67], s98 offen sc1
    ds_write_b128 v192, v[40:43] offset:5120
    v_mfma_f32_16x16x32_bf16 v[120:123], a[232:235], a[88:91], 0
    buffer_load_dwordx4 a[132:135], v216, s[64:67], s98 offen sc1
    ds_write_b128 v192, v[44:47] offset:6144
    v_mfma_f32_16x16x32_bf16 v[136:139], a[236:239], a[88:91], 0
    buffer_load_dwordx4 a[136:139], v217, s[64:67], s98 offen sc1
    ds_write_b128 v192, v[48:51] offset:7168
    v_mfma_f32_16x16x32_bf16 v[140:143], a[236:239], a[92:95], 0
    buffer_load_dwordx4 a[140:143], v218, s[64:67], s98 offen sc1
    ds_write_b128 v192, v[52:55] offset:8192
    v_mfma_f32_16x16x32_bf16 v[124:127], a[232:235], a[92:95], 0
    ds_write_b128 v192, v[56:59] offset:9216
    ds_write_b128 v192, v[60:63] offset:10240
    v_mfma_f32_16x16x32_bf16 v[108:111], a[228:231], a[92:95], 0
    ds_write_b128 v192, v[64:67] offset:11264
    ds_write_b128 v192, v[68:71] offset:12288
    v_mfma_f32_16x16x32_bf16 v[92:95], a[224:227], a[92:95], 0
    s_waitcnt vmcnt(12)
    s_waitcnt lgkmcnt(13)
    ds_write_b128 v192, v[72:75] offset:13312
    ds_write_b128 v192, v[76:79] offset:14336
    v_mfma_f32_16x16x32_bf16 v[80:83], a[240:243], a[96:99], v[80:83]
    ds_read_b64_tr_b16 a[224:225], v248 offset:28672
    ds_read_b64_tr_b16 a[226:227], v248 offset:29184
    v_mfma_f32_16x16x32_bf16 v[96:99], a[244:247], a[96:99], v[96:99]
    s_add_u32 m0, s40, 36864
    ds_read_b64_tr_b16 a[228:229], v249 offset:28672
    ds_read_b64_tr_b16 a[230:231], v249 offset:29184
    v_mfma_f32_16x16x32_bf16 v[112:115], a[248:251], a[96:99], v[112:115]
    s_add_u32 s14, s45, 4096
    ds_read_b64_tr_b16 a[232:233], v250 offset:28672
    ds_read_b64_tr_b16 a[234:235], v250 offset:29184
    v_mfma_f32_16x16x32_bf16 v[128:131], a[252:255], a[96:99], v[128:131]
    buffer_load_dwordx4 v233, s[64:67], s14 offen offset:0 sc1 lds
    ds_read_b64_tr_b16 a[236:237], v251 offset:28672
    v_mfma_f32_16x16x32_bf16 v[132:135], a[252:255], a[100:103], v[132:135]
    buffer_load_dwordx4 v234, s[64:67], s14 offen offset:1024 sc1 lds
    ds_read_b64_tr_b16 a[238:239], v251 offset:29184
    v_mfma_f32_16x16x32_bf16 v[116:119], a[248:251], a[100:103], v[116:119]
    buffer_load_dwordx4 v235, s[64:67], s14 offen offset:2048 sc1 lds
    v_mfma_f32_16x16x32_bf16 v[100:103], a[244:247], a[100:103], v[100:103]
    buffer_load_dwordx4 v236, s[64:67], s14 offen offset:3072 sc1 lds
    v_mfma_f32_16x16x32_bf16 v[84:87], a[240:243], a[100:103], v[84:87]
    v_mfma_f32_16x16x32_bf16 v[88:91], a[240:243], a[104:107], v[88:91]
    s_add_u32 s98, s98, s101
    v_mfma_f32_16x16x32_bf16 v[104:107], a[244:247], a[104:107], v[104:107]
    buffer_load_dwordx4 a[144:147], v215, s[64:67], s98 offen sc1
    v_mfma_f32_16x16x32_bf16 v[120:123], a[248:251], a[104:107], v[120:123]
    buffer_load_dwordx4 a[148:151], v216, s[64:67], s98 offen sc1
    v_mfma_f32_16x16x32_bf16 v[136:139], a[252:255], a[104:107], v[136:139]
    buffer_load_dwordx4 a[152:155], v217, s[64:67], s98 offen sc1
    v_mfma_f32_16x16x32_bf16 v[140:143], a[252:255], a[108:111], v[140:143]
    buffer_load_dwordx4 a[156:159], v218, s[64:67], s98 offen sc1
    v_mfma_f32_16x16x32_bf16 v[124:127], a[248:251], a[108:111], v[124:127]
    v_mfma_f32_16x16x32_bf16 v[108:111], a[244:247], a[108:111], v[108:111]
    v_mfma_f32_16x16x32_bf16 v[92:95], a[240:243], a[108:111], v[92:95]
    s_waitcnt vmcnt(12)
    s_waitcnt lgkmcnt(0)
    v_mfma_f32_16x16x32_bf16 v[80:83], a[224:227], a[112:115], v[80:83]
    ds_read_b64_tr_b16 a[240:241], v248 offset:32768
    ds_read_b64_tr_b16 a[242:243], v248 offset:33280
    v_mfma_f32_16x16x32_bf16 v[96:99], a[228:231], a[112:115], v[96:99]
    ds_read_b64_tr_b16 a[244:245], v249 offset:32768
    ds_read_b64_tr_b16 a[246:247], v249 offset:33280
    v_mfma_f32_16x16x32_bf16 v[112:115], a[232:235], a[112:115], v[112:115]
    s_barrier
    ds_read_b64_tr_b16 a[248:249], v250 offset:32768
    ds_read_b64_tr_b16 a[250:251], v250 offset:33280
    v_mfma_f32_16x16x32_bf16 v[128:131], a[236:239], a[112:115], v[128:131]
    ds_read_b64_tr_b16 a[252:253], v251 offset:32768
    ds_read_b64_tr_b16 a[254:255], v251 offset:33280
    v_mfma_f32_16x16x32_bf16 v[132:135], a[236:239], a[116:119], v[132:135]
    ds_read_b128 v[20:23], v193 offset:0
    ds_read_b128 v[40:43], v194 offset:5120
    v_mfma_f32_16x16x32_bf16 v[116:119], a[232:235], a[116:119], v[116:119]
    ds_read_b128 v[60:63], v195 offset:10240
    ds_read_b128 v[24:27], v193 offset:1024
    v_mfma_f32_16x16x32_bf16 v[100:103], a[228:231], a[116:119], v[100:103]
    ds_read_b128 v[44:47], v194 offset:6144
    ds_read_b128 v[64:67], v195 offset:11264
    v_mfma_f32_16x16x32_bf16 v[84:87], a[224:227], a[116:119], v[84:87]
    ds_read_b128 v[28:31], v193 offset:2048
    ds_read_b128 v[48:51], v194 offset:7168
    v_mfma_f32_16x16x32_bf16 v[88:91], a[224:227], a[120:123], v[88:91]
    ds_read_b128 v[68:71], v195 offset:12288
    ds_read_b128 v[32:35], v193 offset:3072
    v_mfma_f32_16x16x32_bf16 v[104:107], a[228:231], a[120:123], v[104:107]
    ds_read_b128 v[52:55], v194 offset:8192
    ds_read_b128 v[72:75], v195 offset:13312
    v_mfma_f32_16x16x32_bf16 v[120:123], a[232:235], a[120:123], v[120:123]
    ds_read_b128 v[36:39], v193 offset:4096
    ds_read_b128 v[56:59], v194 offset:9216
    v_mfma_f32_16x16x32_bf16 v[136:139], a[236:239], a[120:123], v[136:139]
    ds_read_b128 v[76:79], v195 offset:14336
    s_waitcnt lgkmcnt(12)
    v_add_f32 v0, v0, v20
    v_add_f32 v1, v1, v21
    v_mfma_f32_16x16x32_bf16 v[140:143], a[236:239], a[124:127], v[140:143]
    v_add_f32 v2, v2, v22
    v_add_f32 v3, v3, v23
    v_add_f32 v40, v40, v60
    v_mfma_f32_16x16x32_bf16 v[124:127], a[232:235], a[124:127], v[124:127]
    v_add_f32 v41, v41, v61
    v_add_f32 v42, v42, v62
    v_add_f32 v43, v43, v63
    v_mfma_f32_16x16x32_bf16 v[108:111], a[228:231], a[124:127], v[108:111]
    v_add_f32 v0, v0, v40
    v_add_f32 v1, v1, v41
    v_add_f32 v2, v2, v42
    v_mfma_f32_16x16x32_bf16 v[92:95], a[224:227], a[124:127], v[92:95]
    s_waitcnt vmcnt(4)
    v_add_f32 v3, v3, v43
    v_cvt_pk_bf16_f32 v0, v0, v1
    v_mfma_f32_16x16x32_bf16 v[80:83], a[240:243], a[128:131], v[80:83]
    ds_read_b64_tr_b16 a[224:225], v248 offset:36864
    ds_read_b64_tr_b16 a[226:227], v248 offset:37376
    v_cvt_pk_bf16_f32 v1, v2, v3
    v_mfma_f32_16x16x32_bf16 v[96:99], a[244:247], a[128:131], v[96:99]
    ds_read_b64_tr_b16 a[228:229], v249 offset:36864
    ds_read_b64_tr_b16 a[230:231], v249 offset:37376
    v_mfma_f32_16x16x32_bf16 v[112:115], a[248:251], a[128:131], v[112:115]
    ds_read_b64_tr_b16 a[232:233], v250 offset:36864
    ds_read_b64_tr_b16 a[234:235], v250 offset:37376
    v_mfma_f32_16x16x32_bf16 v[128:131], a[252:255], a[128:131], v[128:131]
    ds_read_b64_tr_b16 a[236:237], v251 offset:36864
    ds_read_b64_tr_b16 a[238:239], v251 offset:37376
    v_mfma_f32_16x16x32_bf16 v[132:135], a[252:255], a[132:135], v[132:135]
    ds_write_b64 v176, v[0:1] offset:16384
    s_waitcnt lgkmcnt(15)
    v_add_f32 v4, v4, v24
    v_add_f32 v5, v5, v25
    v_mfma_f32_16x16x32_bf16 v[116:119], a[248:251], a[132:135], v[116:119]
    v_add_f32 v6, v6, v26
    v_add_f32 v7, v7, v27
    v_add_f32 v44, v44, v64
    v_mfma_f32_16x16x32_bf16 v[100:103], a[244:247], a[132:135], v[100:103]
    v_add_f32 v45, v45, v65
    v_add_f32 v46, v46, v66
    v_add_f32 v47, v47, v67
    v_mfma_f32_16x16x32_bf16 v[84:87], a[240:243], a[132:135], v[84:87]
    v_add_f32 v4, v4, v44
    v_add_f32 v5, v5, v45
    v_add_f32 v6, v6, v46
    v_mfma_f32_16x16x32_bf16 v[88:91], a[240:243], a[136:139], v[88:91]
    v_add_f32 v7, v7, v47
    v_cvt_pk_bf16_f32 v4, v4, v5
    v_cvt_pk_bf16_f32 v5, v6, v7
    v_mfma_f32_16x16x32_bf16 v[104:107], a[244:247], a[136:139], v[104:107]
    ds_write_b64 v176, v[4:5] offset:18432
    v_add_f32 v8, v8, v28
    v_add_f32 v9, v9, v29
    v_mfma_f32_16x16x32_bf16 v[120:123], a[248:251], a[136:139], v[120:123]
    v_add_f32 v10, v10, v30
    v_add_f32 v11, v11, v31
    v_add_f32 v48, v48, v68
    v_mfma_f32_16x16x32_bf16 v[136:139], a[252:255], a[136:139], v[136:139]
    v_add_f32 v49, v49, v69
    v_add_f32 v50, v50, v70
    v_add_f32 v51, v51, v71
    v_mfma_f32_16x16x32_bf16 v[140:143], a[252:255], a[140:143], v[140:143]
    v_add_f32 v8, v8, v48
    v_add_f32 v9, v9, v49
    v_add_f32 v10, v10, v50
    v_mfma_f32_16x16x32_bf16 v[124:127], a[248:251], a[140:143], v[124:127]
    v_add_f32 v11, v11, v51
    v_cvt_pk_bf16_f32 v8, v8, v9
    v_cvt_pk_bf16_f32 v9, v10, v11
    v_mfma_f32_16x16x32_bf16 v[108:111], a[244:247], a[140:143], v[108:111]
    ds_write_b64 v177, v[8:9] offset:16384
    s_waitcnt lgkmcnt(14)
    v_add_f32 v12, v12, v32
    v_add_f32 v13, v13, v33
    v_mfma_f32_16x16x32_bf16 v[92:95], a[240:243], a[140:143], v[92:95]
    s_waitcnt vmcnt(0)
    s_waitcnt lgkmcnt(3)
    v_add_f32 v14, v14, v34
    v_add_f32 v15, v15, v35
    v_mfma_f32_16x16x32_bf16 v[96:99], a[228:231], a[144:147], v[96:99]
    v_add_f32 v52, v52, v72
    v_add_f32 v53, v53, v73
    v_add_f32 v54, v54, v74
    v_mfma_f32_16x16x32_bf16 v[100:103], a[228:231], a[148:151], v[100:103]
    v_add_f32 v55, v55, v75
    v_add_f32 v12, v12, v52
    v_add_f32 v13, v13, v53
    v_mfma_f32_16x16x32_bf16 v[104:107], a[228:231], a[152:155], v[104:107]
    v_add_f32 v14, v14, v54
    v_add_f32 v15, v15, v55
    v_cvt_pk_bf16_f32 v12, v12, v13
    v_cvt_pk_bf16_f32 v13, v14, v15
    ds_write_b64 v177, v[12:13] offset:18432
    v_add_f32 v16, v16, v36
    v_add_f32 v17, v17, v37
    v_add_f32 v18, v18, v38
    v_add_f32 v19, v19, v39
    v_add_f32 v56, v56, v76
    v_add_f32 v57, v57, v77
    v_add_f32 v58, v58, v78
    v_add_f32 v59, v59, v79
    v_add_f32 v16, v16, v56
    v_add_f32 v17, v17, v57
    v_add_f32 v18, v18, v58
    v_add_f32 v19, v19, v59
    v_cvt_pk_bf16_f32 v16, v16, v17
    v_cvt_pk_bf16_f32 v17, v18, v19
    ds_write_b64 v178, v[16:17] offset:16384
    v_mfma_f32_16x16x32_bf16 v[108:111], a[228:231], a[156:159], v[108:111]
    v_mfma_f32_16x16x32_bf16 v[112:115], a[232:235], a[144:147], v[112:115]
    v_mfma_f32_16x16x32_bf16 v[116:119], a[232:235], a[148:151], v[116:119]
    v_mfma_f32_16x16x32_bf16 v[120:123], a[232:235], a[152:155], v[120:123]
    v_mfma_f32_16x16x32_bf16 v[124:127], a[232:235], a[156:159], v[124:127]
    v_mfma_f32_16x16x32_bf16 v[128:131], a[236:239], a[144:147], v[128:131]
    ds_write_b128 v192, v[96:99] offset:20480
    v_mfma_f32_16x16x32_bf16 v[132:135], a[236:239], a[148:151], v[132:135]
    ds_write_b128 v192, v[100:103] offset:21504
    v_mfma_f32_16x16x32_bf16 v[136:139], a[236:239], a[152:155], v[136:139]
    ds_write_b128 v192, v[104:107] offset:22528
    v_mfma_f32_16x16x32_bf16 v[140:143], a[236:239], a[156:159], v[140:143]
    ds_write_b128 v192, v[108:111] offset:23552
    v_mfma_f32_16x16x32_bf16 v[80:83], a[224:227], a[144:147], v[80:83]
    ds_write_b128 v192, v[112:115] offset:24576
    v_mfma_f32_16x16x32_bf16 v[84:87], a[224:227], a[148:151], v[84:87]
    ds_write_b128 v192, v[116:119] offset:25600
    v_mfma_f32_16x16x32_bf16 v[88:91], a[224:227], a[152:155], v[88:91]
    ds_write_b128 v192, v[120:123] offset:26624
    v_mfma_f32_16x16x32_bf16 v[92:95], a[224:227], a[156:159], v[92:95]
    ds_write_b128 v192, v[124:127] offset:27648
    s_nop 3
    ds_write_b128 v192, v[128:131] offset:28672
    ds_write_b128 v192, v[132:135] offset:29696
    ds_write_b128 v192, v[136:139] offset:30720
    ds_write_b128 v192, v[140:143] offset:31744
    s_waitcnt lgkmcnt(0)
    s_barrier
    ds_read_b128 v[20:23], v179 offset:16384
    ds_read_b128 v[24:27], v180 offset:16384
    ds_read_b128 v[28:31], v181 offset:16384
    ds_read_b128 v[96:99], v193 offset:20480
    ds_read_b128 v[112:115], v194 offset:24576
    ds_read_b128 v[128:131], v195 offset:28672
    ds_read_b128 v[100:103], v193 offset:21504
    ds_read_b128 v[116:119], v194 offset:25600
    ds_read_b128 v[132:135], v195 offset:29696
    ds_read_b128 v[104:107], v193 offset:22528
    ds_read_b128 v[120:123], v194 offset:26624
    ds_read_b128 v[136:139], v195 offset:30720
    ds_read_b128 v[108:111], v193 offset:23552
    ds_read_b128 v[124:127], v194 offset:27648
    ds_read_b128 v[140:143], v195 offset:31744
    s_waitcnt lgkmcnt(14)
    buffer_store_dwordx4 v[20:23], v182, s[80:83], s11 offen offset:0 sc1
    s_waitcnt lgkmcnt(13)
    buffer_store_dwordx4 v[24:27], v183, s[80:83], s11 offen offset:0 sc1
    s_waitcnt lgkmcnt(12)
    buffer_store_dwordx4 v[28:31], v184, s[80:83], s11 offen offset:0 sc1
    s_waitcnt lgkmcnt(9)
    v_pk_add_f32 v[80:81], v[80:81], v[96:97]
    v_pk_add_f32 v[82:83], v[82:83], v[98:99]
    v_pk_add_f32 v[112:113], v[112:113], v[128:129]
    v_pk_add_f32 v[114:115], v[114:115], v[130:131]
    v_pk_add_f32 v[80:81], v[80:81], v[112:113]
    v_pk_add_f32 v[82:83], v[82:83], v[114:115]
    v_cvt_pk_bf16_f32 v80, v80, v81
    v_cvt_pk_bf16_f32 v81, v82, v83
    ds_write_b64 v176, v[80:81] offset:0
    s_waitcnt lgkmcnt(7)
    v_pk_add_f32 v[84:85], v[84:85], v[100:101]
    v_pk_add_f32 v[86:87], v[86:87], v[102:103]
    v_pk_add_f32 v[116:117], v[116:117], v[132:133]
    v_pk_add_f32 v[118:119], v[118:119], v[134:135]
    v_pk_add_f32 v[84:85], v[84:85], v[116:117]
    v_pk_add_f32 v[86:87], v[86:87], v[118:119]
    v_cvt_pk_bf16_f32 v84, v84, v85
    v_cvt_pk_bf16_f32 v85, v86, v87
    ds_write_b64 v176, v[84:85] offset:2048
    s_waitcnt lgkmcnt(5)
    v_pk_add_f32 v[88:89], v[88:89], v[104:105]
    v_pk_add_f32 v[90:91], v[90:91], v[106:107]
    v_pk_add_f32 v[120:121], v[120:121], v[136:137]
    v_pk_add_f32 v[122:123], v[122:123], v[138:139]
    v_pk_add_f32 v[88:89], v[88:89], v[120:121]
    v_pk_add_f32 v[90:91], v[90:91], v[122:123]
    v_cvt_pk_bf16_f32 v88, v88, v89
    v_cvt_pk_bf16_f32 v89, v90, v91
    ds_write_b64 v177, v[88:89] offset:0
    s_waitcnt lgkmcnt(3)
    v_pk_add_f32 v[92:93], v[92:93], v[108:109]
    v_pk_add_f32 v[94:95], v[94:95], v[110:111]
    v_pk_add_f32 v[124:125], v[124:125], v[140:141]
    v_pk_add_f32 v[126:127], v[126:127], v[142:143]
    v_pk_add_f32 v[92:93], v[92:93], v[124:125]
    v_pk_add_f32 v[94:95], v[94:95], v[126:127]
    v_cvt_pk_bf16_f32 v92, v92, v93
    v_cvt_pk_bf16_f32 v93, v94, v95
    ds_write_b64 v177, v[92:93] offset:2048
    s_waitcnt lgkmcnt(0)
    s_barrier
    ds_read_b128 v[40:43], v179 offset:0
    ds_read_b128 v[44:47], v180 offset:0
    s_waitcnt lgkmcnt(1)
    buffer_store_dwordx4 v[40:43], v185, s[80:83], s12 offen offset:1152 sc1
    s_waitcnt lgkmcnt(0)
    buffer_store_dwordx4 v[44:47], v186, s[80:83], s12 offen offset:1152 sc1
    s_endpgm
L_OUT4:
    s_add_u32 s15, s44, 0
    buffer_load_dwordx4 a[0:3], v233, s[64:67], s15 offen offset:0
    buffer_load_dwordx4 a[4:7], v234, s[64:67], s15 offen offset:0
    buffer_load_dwordx4 a[8:11], v235, s[64:67], s15 offen offset:0
    buffer_load_dwordx4 a[12:15], v236, s[64:67], s15 offen offset:0
    buffer_load_dwordx4 a[20:23], v233, s[64:67], s15 offen offset:1024
    buffer_load_dwordx4 a[24:27], v234, s[64:67], s15 offen offset:1024
    buffer_load_dwordx4 a[28:31], v235, s[64:67], s15 offen offset:1024
    buffer_load_dwordx4 a[32:35], v236, s[64:67], s15 offen offset:1024
    buffer_load_dwordx4 a[40:43], v233, s[64:67], s15 offen offset:2048
    buffer_load_dwordx4 a[44:47], v234, s[64:67], s15 offen offset:2048
    buffer_load_dwordx4 a[48:51], v235, s[64:67], s15 offen offset:2048
    buffer_load_dwordx4 a[52:55], v236, s[64:67], s15 offen offset:2048
    buffer_load_dwordx4 a[60:63], v233, s[64:67], s15 offen offset:3072
    buffer_load_dwordx4 a[64:67], v234, s[64:67], s15 offen offset:3072
    buffer_load_dwordx4 a[68:71], v235, s[64:67], s15 offen offset:3072
    buffer_load_dwordx4 a[72:75], v236, s[64:67], s15 offen offset:3072
    s_waitcnt vmcnt(12)
    v_mfma_f32_16x16x32_bf16 v[0:3], a[80:83], a[0:3], 0
    v_mfma_f32_16x16x32_bf16 v[20:23], a[84:87], a[0:3], 0
    v_mfma_f32_16x16x32_bf16 v[40:43], a[88:91], a[0:3], 0
    v_mfma_f32_16x16x32_bf16 v[60:63], a[92:95], a[0:3], 0
    s_add_u32 s15, s44, 4096
    buffer_load_dwordx4 a[0:3], v233, s[64:67], s15 offen offset:0
    v_mfma_f32_16x16x32_bf16 v[64:67], a[92:95], a[4:7], 0
    v_mfma_f32_16x16x32_bf16 v[44:47], a[88:91], a[4:7], 0
    v_mfma_f32_16x16x32_bf16 v[24:27], a[84:87], a[4:7], 0
    v_mfma_f32_16x16x32_bf16 v[4:7], a[80:83], a[4:7], 0
    buffer_load_dwordx4 a[4:7], v234, s[64:67], s15 offen offset:0
    v_mfma_f32_16x16x32_bf16 v[8:11], a[80:83], a[8:11], 0
    v_mfma_f32_16x16x32_bf16 v[28:31], a[84:87], a[8:11], 0
    v_mfma_f32_16x16x32_bf16 v[48:51], a[88:91], a[8:11], 0
    v_mfma_f32_16x16x32_bf16 v[68:71], a[92:95], a[8:11], 0
    buffer_load_dwordx4 a[8:11], v235, s[64:67], s15 offen offset:0
    v_mfma_f32_16x16x32_bf16 v[72:75], a[92:95], a[12:15], 0
    v_mfma_f32_16x16x32_bf16 v[52:55], a[88:91], a[12:15], 0
    v_mfma_f32_16x16x32_bf16 v[32:35], a[84:87], a[12:15], 0
    v_mfma_f32_16x16x32_bf16 v[12:15], a[80:83], a[12:15], 0
    s_waitcnt vmcnt(11)
    buffer_load_dwordx4 a[12:15], v236, s[64:67], s15 offen offset:0
    v_mfma_f32_16x16x32_bf16 v[0:3], a[96:99], a[20:23], v[0:3]
    v_mfma_f32_16x16x32_bf16 v[20:23], a[100:103], a[20:23], v[20:23]
    v_mfma_f32_16x16x32_bf16 v[40:43], a[104:107], a[20:23], v[40:43]
    v_mfma_f32_16x16x32_bf16 v[60:63], a[108:111], a[20:23], v[60:63]
    buffer_load_dwordx4 a[20:23], v233, s[64:67], s15 offen offset:1024
    v_mfma_f32_16x16x32_bf16 v[64:67], a[108:111], a[24:27], v[64:67]
    s_barrier
    buffer_store_dword v246, v245, s[64:67], s30 offen sc1
    v_mfma_f32_16x16x32_bf16 v[44:47], a[104:107], a[24:27], v[44:47]
    v_mfma_f32_16x16x32_bf16 v[24:27], a[100:103], a[24:27], v[24:27]
    v_mfma_f32_16x16x32_bf16 v[4:7], a[96:99], a[24:27], v[4:7]
    buffer_load_dwordx4 a[24:27], v234, s[64:67], s15 offen offset:1024
    v_mfma_f32_16x16x32_bf16 v[8:11], a[96:99], a[28:31], v[8:11]
    v_mfma_f32_16x16x32_bf16 v[28:31], a[100:103], a[28:31], v[28:31]
    v_mfma_f32_16x16x32_bf16 v[48:51], a[104:107], a[28:31], v[48:51]
    v_mfma_f32_16x16x32_bf16 v[68:71], a[108:111], a[28:31], v[68:71]
    buffer_load_dwordx4 a[28:31], v235, s[64:67], s15 offen offset:1024
    v_mfma_f32_16x16x32_bf16 v[72:75], a[108:111], a[32:35], v[72:75]
    v_mfma_f32_16x16x32_bf16 v[52:55], a[104:107], a[32:35], v[52:55]
    v_mfma_f32_16x16x32_bf16 v[32:35], a[100:103], a[32:35], v[32:35]
    v_mfma_f32_16x16x32_bf16 v[12:15], a[96:99], a[32:35], v[12:15]
    s_waitcnt vmcnt(12)
    buffer_load_dwordx4 a[32:35], v236, s[64:67], s15 offen offset:1024
    v_mfma_f32_16x16x32_bf16 v[0:3], a[112:115], a[40:43], v[0:3]
    v_mfma_f32_16x16x32_bf16 v[20:23], a[116:119], a[40:43], v[20:23]
    v_mfma_f32_16x16x32_bf16 v[40:43], a[120:123], a[40:43], v[40:43]
    v_mfma_f32_16x16x32_bf16 v[60:63], a[124:127], a[40:43], v[60:63]
    buffer_load_dwordx4 a[40:43], v233, s[64:67], s15 offen offset:2048
    v_mfma_f32_16x16x32_bf16 v[64:67], a[124:127], a[44:47], v[64:67]
    v_mfma_f32_16x16x32_bf16 v[44:47], a[120:123], a[44:47], v[44:47]
    v_mfma_f32_16x16x32_bf16 v[24:27], a[116:119], a[44:47], v[24:27]
    v_mfma_f32_16x16x32_bf16 v[4:7], a[112:115], a[44:47], v[4:7]
    buffer_load_dwordx4 a[44:47], v234, s[64:67], s15 offen offset:2048
    v_mfma_f32_16x16x32_bf16 v[8:11], a[112:115], a[48:51], v[8:11]
    v_mfma_f32_16x16x32_bf16 v[28:31], a[116:119], a[48:51], v[28:31]
    v_mfma_f32_16x16x32_bf16 v[48:51], a[120:123], a[48:51], v[48:51]
    v_mfma_f32_16x16x32_bf16 v[68:71], a[124:127], a[48:51], v[68:71]
    buffer_load_dwordx4 a[48:51], v235, s[64:67], s15 offen offset:2048
    v_mfma_f32_16x16x32_bf16 v[72:75], a[124:127], a[52:55], v[72:75]
    v_mfma_f32_16x16x32_bf16 v[52:55], a[120:123], a[52:55], v[52:55]
    v_mfma_f32_16x16x32_bf16 v[32:35], a[116:119], a[52:55], v[32:35]
    v_mfma_f32_16x16x32_bf16 v[12:15], a[112:115], a[52:55], v[12:15]
    s_waitcnt vmcnt(12)
    buffer_load_dwordx4 a[52:55], v236, s[64:67], s15 offen offset:2048
    v_mfma_f32_16x16x32_bf16 v[0:3], v[80:83], a[60:63], v[0:3]
    v_mfma_f32_16x16x32_bf16 v[20:23], v[84:87], a[60:63], v[20:23]
    v_mfma_f32_16x16x32_bf16 v[40:43], v[88:91], a[60:63], v[40:43]
    v_mfma_f32_16x16x32_bf16 v[60:63], v[92:95], a[60:63], v[60:63]
    buffer_load_dwordx4 a[60:63], v233, s[64:67], s15 offen offset:3072
    v_mfma_f32_16x16x32_bf16 v[64:67], v[92:95], a[64:67], v[64:67]
    v_mfma_f32_16x16x32_bf16 v[44:47], v[88:91], a[64:67], v[44:47]
    v_mfma_f32_16x16x32_bf16 v[24:27], v[84:87], a[64:67], v[24:27]
    v_mfma_f32_16x16x32_bf16 v[4:7], v[80:83], a[64:67], v[4:7]
    buffer_load_dwordx4 a[64:67], v234, s[64:67], s15 offen offset:3072
    v_mfma_f32_16x16x32_bf16 v[8:11], v[80:83], a[68:71], v[8:11]
    v_mfma_f32_16x16x32_bf16 v[28:31], v[84:87], a[68:71], v[28:31]
    v_mfma_f32_16x16x32_bf16 v[48:51], v[88:91], a[68:71], v[48:51]
    v_mfma_f32_16x16x32_bf16 v[68:71], v[92:95], a[68:71], v[68:71]
    buffer_load_dwordx4 a[68:71], v235, s[64:67], s15 offen offset:3072
    v_mfma_f32_16x16x32_bf16 v[72:75], v[92:95], a[72:75], v[72:75]
    v_mfma_f32_16x16x32_bf16 v[52:55], v[88:91], a[72:75], v[52:55]
    v_mfma_f32_16x16x32_bf16 v[32:35], v[84:87], a[72:75], v[32:35]
    v_mfma_f32_16x16x32_bf16 v[12:15], v[80:83], a[72:75], v[12:15]
    s_waitcnt vmcnt(12)
    buffer_load_dwordx4 a[72:75], v236, s[64:67], s15 offen offset:3072
    v_mfma_f32_16x16x32_bf16 v[0:3], v[96:99], a[0:3], v[0:3]
    v_mfma_f32_16x16x32_bf16 v[20:23], v[100:103], a[0:3], v[20:23]
    v_mfma_f32_16x16x32_bf16 v[40:43], v[104:107], a[0:3], v[40:43]
    v_mfma_f32_16x16x32_bf16 v[60:63], v[108:111], a[0:3], v[60:63]
    s_add_u32 s15, s44, 8192
    buffer_load_dwordx4 a[0:3], v233, s[64:67], s15 offen offset:0
    v_mfma_f32_16x16x32_bf16 v[64:67], v[108:111], a[4:7], v[64:67]
    v_mfma_f32_16x16x32_bf16 v[44:47], v[104:107], a[4:7], v[44:47]
    v_mfma_f32_16x16x32_bf16 v[24:27], v[100:103], a[4:7], v[24:27]
    v_mfma_f32_16x16x32_bf16 v[4:7], v[96:99], a[4:7], v[4:7]
    buffer_load_dwordx4 a[4:7], v234, s[64:67], s15 offen offset:0
    v_mfma_f32_16x16x32_bf16 v[8:11], v[96:99], a[8:11], v[8:11]
    v_mfma_f32_16x16x32_bf16 v[28:31], v[100:103], a[8:11], v[28:31]
    v_mfma_f32_16x16x32_bf16 v[48:51], v[104:107], a[8:11], v[48:51]
    v_mfma_f32_16x16x32_bf16 v[68:71], v[108:111], a[8:11], v[68:71]
    buffer_load_dwordx4 a[8:11], v235, s[64:67], s15 offen offset:0
    v_mfma_f32_16x16x32_bf16 v[72:75], v[108:111], a[12:15], v[72:75]
    v_mfma_f32_16x16x32_bf16 v[52:55], v[104:107], a[12:15], v[52:55]
    v_mfma_f32_16x16x32_bf16 v[32:35], v[100:103], a[12:15], v[32:35]
    v_mfma_f32_16x16x32_bf16 v[12:15], v[96:99], a[12:15], v[12:15]
    s_waitcnt vmcnt(11)
    buffer_load_dwordx4 a[12:15], v236, s[64:67], s15 offen offset:0
    v_mfma_f32_16x16x32_bf16 v[0:3], v[112:115], a[20:23], v[0:3]
    v_mfma_f32_16x16x32_bf16 v[20:23], v[116:119], a[20:23], v[20:23]
    v_mfma_f32_16x16x32_bf16 v[40:43], v[120:123], a[20:23], v[40:43]
    v_mfma_f32_16x16x32_bf16 v[60:63], v[124:127], a[20:23], v[60:63]
    buffer_load_dwordx4 a[20:23], v233, s[64:67], s15 offen offset:1024
    v_mfma_f32_16x16x32_bf16 v[64:67], v[124:127], a[24:27], v[64:67]
    v_mfma_f32_16x16x32_bf16 v[44:47], v[120:123], a[24:27], v[44:47]
    v_mfma_f32_16x16x32_bf16 v[24:27], v[116:119], a[24:27], v[24:27]
    v_mfma_f32_16x16x32_bf16 v[4:7], v[112:115], a[24:27], v[4:7]
    buffer_load_dwordx4 a[24:27], v234, s[64:67], s15 offen offset:1024
    v_mfma_f32_16x16x32_bf16 v[8:11], v[112:115], a[28:31], v[8:11]
    v_mfma_f32_16x16x32_bf16 v[28:31], v[116:119], a[28:31], v[28:31]
    v_mfma_f32_16x16x32_bf16 v[48:51], v[120:123], a[28:31], v[48:51]
    v_mfma_f32_16x16x32_bf16 v[68:71], v[124:127], a[28:31], v[68:71]
    buffer_load_dwordx4 a[28:31], v235, s[64:67], s15 offen offset:1024
    v_mfma_f32_16x16x32_bf16 v[72:75], v[124:127], a[32:35], v[72:75]
    v_mfma_f32_16x16x32_bf16 v[52:55], v[120:123], a[32:35], v[52:55]
    v_mfma_f32_16x16x32_bf16 v[32:35], v[116:119], a[32:35], v[32:35]
    v_mfma_f32_16x16x32_bf16 v[12:15], v[112:115], a[32:35], v[12:15]
    s_waitcnt vmcnt(11)
    buffer_load_dwordx4 a[32:35], v236, s[64:67], s15 offen offset:1024
    v_mfma_f32_16x16x32_bf16 v[0:3], v[128:131], a[40:43], v[0:3]
    v_mfma_f32_16x16x32_bf16 v[20:23], v[132:135], a[40:43], v[20:23]
    v_mfma_f32_16x16x32_bf16 v[40:43], v[136:139], a[40:43], v[40:43]
    v_mfma_f32_16x16x32_bf16 v[60:63], v[140:143], a[40:43], v[60:63]
    buffer_load_dwordx4 a[40:43], v233, s[64:67], s15 offen offset:2048
    v_mfma_f32_16x16x32_bf16 v[64:67], v[140:143], a[44:47], v[64:67]
    v_mfma_f32_16x16x32_bf16 v[44:47], v[136:139], a[44:47], v[44:47]
    v_mfma_f32_16x16x32_bf16 v[24:27], v[132:135], a[44:47], v[24:27]
    v_mfma_f32_16x16x32_bf16 v[4:7], v[128:131], a[44:47], v[4:7]
    buffer_load_dwordx4 a[44:47], v234, s[64:67], s15 offen offset:2048
    v_mfma_f32_16x16x32_bf16 v[8:11], v[128:131], a[48:51], v[8:11]
    v_mfma_f32_16x16x32_bf16 v[28:31], v[132:135], a[48:51], v[28:31]
    v_mfma_f32_16x16x32_bf16 v[48:51], v[136:139], a[48:51], v[48:51]
    v_mfma_f32_16x16x32_bf16 v[68:71], v[140:143], a[48:51], v[68:71]
    buffer_load_dwordx4 a[48:51], v235, s[64:67], s15 offen offset:2048
    v_mfma_f32_16x16x32_bf16 v[72:75], v[140:143], a[52:55], v[72:75]
    v_mfma_f32_16x16x32_bf16 v[52:55], v[136:139], a[52:55], v[52:55]
    v_mfma_f32_16x16x32_bf16 v[32:35], v[132:135], a[52:55], v[32:35]
    v_mfma_f32_16x16x32_bf16 v[12:15], v[128:131], a[52:55], v[12:15]
    s_waitcnt vmcnt(11)
    buffer_load_dwordx4 a[52:55], v236, s[64:67], s15 offen offset:2048
    v_mfma_f32_16x16x32_bf16 v[0:3], v[144:147], a[60:63], v[0:3]
    v_mfma_f32_16x16x32_bf16 v[20:23], v[148:151], a[60:63], v[20:23]
    v_mfma_f32_16x16x32_bf16 v[40:43], v[152:155], a[60:63], v[40:43]
    v_mfma_f32_16x16x32_bf16 v[60:63], v[156:159], a[60:63], v[60:63]
    buffer_load_dwordx4 a[60:63], v233, s[64:67], s15 offen offset:3072
    v_mfma_f32_16x16x32_bf16 v[64:67], v[156:159], a[64:67], v[64:67]
    v_mfma_f32_16x16x32_bf16 v[44:47], v[152:155], a[64:67], v[44:47]
    v_mfma_f32_16x16x32_bf16 v[24:27], v[148:151], a[64:67], v[24:27]
    v_mfma_f32_16x16x32_bf16 v[4:7], v[144:147], a[64:67], v[4:7]
    buffer_load_dwordx4 a[64:67], v234, s[64:67], s15 offen offset:3072
    v_mfma_f32_16x16x32_bf16 v[8:11], v[144:147], a[68:71], v[8:11]
    v_mfma_f32_16x16x32_bf16 v[28:31], v[148:151], a[68:71], v[28:31]
    v_mfma_f32_16x16x32_bf16 v[48:51], v[152:155], a[68:71], v[48:51]
    v_mfma_f32_16x16x32_bf16 v[68:71], v[156:159], a[68:71], v[68:71]
    buffer_load_dwordx4 a[68:71], v235, s[64:67], s15 offen offset:3072
    v_mfma_f32_16x16x32_bf16 v[72:75], v[156:159], a[72:75], v[72:75]
    v_mfma_f32_16x16x32_bf16 v[52:55], v[152:155], a[72:75], v[52:55]
    v_mfma_f32_16x16x32_bf16 v[32:35], v[148:151], a[72:75], v[32:35]
    v_mfma_f32_16x16x32_bf16 v[12:15], v[144:147], a[72:75], v[12:15]
    s_waitcnt vmcnt(11)
    buffer_load_dwordx4 a[72:75], v236, s[64:67], s15 offen offset:3072
    v_mfma_f32_16x16x32_bf16 v[0:3], a[128:131], a[0:3], v[0:3]
    v_mfma_f32_16x16x32_bf16 v[20:23], a[132:135], a[0:3], v[20:23]
    v_mfma_f32_16x16x32_bf16 v[40:43], a[136:139], a[0:3], v[40:43]
    v_mfma_f32_16x16x32_bf16 v[60:63], a[140:143], a[0:3], v[60:63]
    s_add_u32 s15, s44, 12288
    buffer_load_dwordx4 a[0:3], v233, s[64:67], s15 offen offset:0
    v_mfma_f32_16x16x32_bf16 v[64:67], a[140:143], a[4:7], v[64:67]
    v_mfma_f32_16x16x32_bf16 v[44:47], a[136:139], a[4:7], v[44:47]
    v_mfma_f32_16x16x32_bf16 v[24:27], a[132:135], a[4:7], v[24:27]
    v_mfma_f32_16x16x32_bf16 v[4:7], a[128:131], a[4:7], v[4:7]
    buffer_load_dwordx4 a[4:7], v234, s[64:67], s15 offen offset:0
    v_mfma_f32_16x16x32_bf16 v[8:11], a[128:131], a[8:11], v[8:11]
    v_mfma_f32_16x16x32_bf16 v[28:31], a[132:135], a[8:11], v[28:31]
    v_mfma_f32_16x16x32_bf16 v[48:51], a[136:139], a[8:11], v[48:51]
    v_mfma_f32_16x16x32_bf16 v[68:71], a[140:143], a[8:11], v[68:71]
    buffer_load_dwordx4 a[8:11], v235, s[64:67], s15 offen offset:0
    v_mfma_f32_16x16x32_bf16 v[72:75], a[140:143], a[12:15], v[72:75]
    v_mfma_f32_16x16x32_bf16 v[52:55], a[136:139], a[12:15], v[52:55]
    v_mfma_f32_16x16x32_bf16 v[32:35], a[132:135], a[12:15], v[32:35]
    v_mfma_f32_16x16x32_bf16 v[12:15], a[128:131], a[12:15], v[12:15]
    s_waitcnt vmcnt(11)
    buffer_load_dwordx4 a[12:15], v236, s[64:67], s15 offen offset:0
    v_mfma_f32_16x16x32_bf16 v[0:3], a[144:147], a[20:23], v[0:3]
    v_mfma_f32_16x16x32_bf16 v[20:23], a[148:151], a[20:23], v[20:23]
    v_mfma_f32_16x16x32_bf16 v[40:43], a[152:155], a[20:23], v[40:43]
    v_mfma_f32_16x16x32_bf16 v[60:63], a[156:159], a[20:23], v[60:63]
    buffer_load_dwordx4 a[20:23], v233, s[64:67], s15 offen offset:1024
    v_mfma_f32_16x16x32_bf16 v[64:67], a[156:159], a[24:27], v[64:67]
    v_mfma_f32_16x16x32_bf16 v[44:47], a[152:155], a[24:27], v[44:47]
    v_mfma_f32_16x16x32_bf16 v[24:27], a[148:151], a[24:27], v[24:27]
    v_mfma_f32_16x16x32_bf16 v[4:7], a[144:147], a[24:27], v[4:7]
    buffer_load_dwordx4 a[24:27], v234, s[64:67], s15 offen offset:1024
    v_mfma_f32_16x16x32_bf16 v[8:11], a[144:147], a[28:31], v[8:11]
    v_mfma_f32_16x16x32_bf16 v[28:31], a[148:151], a[28:31], v[28:31]
    v_mfma_f32_16x16x32_bf16 v[48:51], a[152:155], a[28:31], v[48:51]
    v_mfma_f32_16x16x32_bf16 v[68:71], a[156:159], a[28:31], v[68:71]
    buffer_load_dwordx4 a[28:31], v235, s[64:67], s15 offen offset:1024
    v_mfma_f32_16x16x32_bf16 v[72:75], a[156:159], a[32:35], v[72:75]
    v_mfma_f32_16x16x32_bf16 v[52:55], a[152:155], a[32:35], v[52:55]
    v_mfma_f32_16x16x32_bf16 v[32:35], a[148:151], a[32:35], v[32:35]
    v_mfma_f32_16x16x32_bf16 v[12:15], a[144:147], a[32:35], v[12:15]
    s_waitcnt vmcnt(11)
    buffer_load_dwordx4 a[32:35], v236, s[64:67], s15 offen offset:1024
    v_mfma_f32_16x16x32_bf16 v[0:3], a[160:163], a[40:43], v[0:3]
    s_and_b32 s8, s2, 1
    s_lshl_b32 s8, s8, 5
    s_lshr_b32 s9, s2, 3
    s_add_u32 s8, s8, s9
    v_mfma_f32_16x16x32_bf16 v[20:23], a[164:167], a[40:43], v[20:23]
    s_mul_i32 s9, s8, 37
    s_lshr_b32 s9, s9, 8
    s_mul_i32 s9, s9, 7
    s_sub_u32 s8, s8, s9
    v_mfma_f32_16x16x32_bf16 v[40:43], a[168:171], a[40:43], v[40:43]
    s_mul_i32 s10, s8, 6
    s_add_u32 s10, s10, 4294967288
    s_mul_i32 s9, s8, 2
    s_add_u32 s9, s9, 4294967284
    v_mfma_f32_16x16x32_bf16 v[60:63], a[172:175], a[40:43], v[60:63]
    s_mul_i32 s8, s9, 36864
    s_add_u32 s100, s48, s8
    s_mul_i32 s8, s9, 18432
    s_add_u32 s46, s46, s8
    v_mfma_f32_16x16x32_bf16 v[64:67], a[172:175], a[44:47], v[64:67]
    buffer_load_dwordx4 a[40:43], v233, s[64:67], s15 offen offset:2048
    v_or_b32 v207, s42, v224
    v_mfma_f32_16x16x32_bf16 v[44:47], a[168:171], a[44:47], v[44:47]
    v_add_u32 v208, 18432, v207
    v_add_u32 v209, 36864, v207
    v_add_u32 v210, 55296, v207
    v_mfma_f32_16x16x32_bf16 v[24:27], a[164:167], a[44:47], v[24:27]
    v_add_u32 v211, 73728, v207
    v_add_u32 v212, 92160, v207
    v_bfe_u32 v222, v224, 4, 4
    v_mfma_f32_16x16x32_bf16 v[4:7], a[160:163], a[44:47], v[4:7]
    buffer_load_dwordx4 a[44:47], v234, s[64:67], s15 offen offset:2048
    v_mul_u32_u24 v222, 2304, v222
    v_mfma_f32_16x16x32_bf16 v[8:11], a[160:163], a[48:51], v[8:11]
    v_lshrrev_b32 v223, 8, v224
    v_lshl_add_u32 v196, v223, 3, v222
    v_or_b32 v196, s42, v196
    v_mfma_f32_16x16x32_bf16 v[28:31], a[164:167], a[48:51], v[28:31]
    v_add_u32 v197, 36864, v196
    v_add_u32 v198, 73728, v196
    v_add_u32 v199, 110592, v196
    v_mfma_f32_16x16x32_bf16 v[48:51], a[168:171], a[48:51], v[48:51]
    v_add_u32 v200, 147456, v196
    v_add_u32 v201, 184320, v196
    v_mfma_f32_16x16x32_bf16 v[68:71], a[172:175], a[48:51], v[68:71]
    s_add_u32 s8, s10, 4
    s_lshr_b32 s8, s8, 5
    s_lshl_b32 s8, s8, 31
    v_or_b32 v211, s8, v211
    v_mfma_f32_16x16x32_bf16 v[72:75], a[172:175], a[52:55], v[72:75]
    buffer_load_dwordx4 a[48:51], v235, s[64:67], s15 offen offset:2048
    v_or_b32 v200, s8, v200
    v_mfma_f32_16x16x32_bf16 v[52:55], a[168:171], a[52:55], v[52:55]
    s_add_u32 s8, s10, 5
    s_lshr_b32 s8, s8, 5
    s_lshl_b32 s8, s8, 31
    v_or_b32 v212, s8, v212
    v_mfma_f32_16x16x32_bf16 v[32:35], a[164:167], a[52:55], v[32:35]
    v_or_b32 v201, s8, v201
    v_mfma_f32_16x16x32_bf16 v[12:15], a[160:163], a[52:55], v[12:15]
    s_waitcnt vmcnt(11)
    s_add_u32 s8, s3, 1
    s_lshr_b32 s8, s8, 2
    v_mfma_f32_16x16x32_bf16 v[0:3], a[176:179], a[60:63], v[0:3]
    s_lshr_b32 s101, 1024, s8
    s_add_u32 s98, s46, 1024
    buffer_load_dwordx4 a[52:55], v236, s[64:67], s15 offen offset:2048
    v_mfma_f32_16x16x32_bf16 v[20:23], a[180:183], a[60:63], v[20:23]
    ds_read_b64_tr_b16 a[224:225], v240 offset:20480
    ds_read_b64_tr_b16 a[226:227], v240 offset:22528
    v_lshrrev_b32 v248, 1, v224
    v_mfma_f32_16x16x32_bf16 v[40:43], a[184:187], a[60:63], v[40:43]
    ds_read_b64_tr_b16 a[228:229], v241 offset:20480
    ds_read_b64_tr_b16 a[230:231], v241 offset:22528
    v_mul_u32_u24 v248, s8, v248
    v_mfma_f32_16x16x32_bf16 v[60:63], a[188:191], a[60:63], v[60:63]
    buffer_load_dwordx4 a[60:63], v233, s[64:67], s15 offen offset:3072
    ds_read_b64_tr_b16 a[232:233], v242 offset:20480
    v_mfma_f32_16x16x32_bf16 v[64:67], a[188:191], a[64:67], v[64:67]
    ds_read_b64_tr_b16 a[234:235], v242 offset:22528
    ds_read_b64_tr_b16 a[236:237], v243 offset:20480
    v_sub_u32 v215, v207, v248
    v_mfma_f32_16x16x32_bf16 v[44:47], a[184:187], a[64:67], v[44:47]
    ds_read_b64_tr_b16 a[238:239], v243 offset:22528
    v_sub_u32 v216, v208, v248
    v_sub_u32 v217, v209, v248
    v_mfma_f32_16x16x32_bf16 v[24:27], a[180:183], a[64:67], v[24:27]
    v_sub_u32 v218, v210, v248
    v_sub_u32 v219, v211, v248
    v_sub_u32 v220, v212, v248
    v_mfma_f32_16x16x32_bf16 v[4:7], a[176:179], a[64:67], v[4:7]
    buffer_load_dwordx4 a[64:67], v234, s[64:67], s15 offen offset:3072
    v_lshrrev_b32 v223, 1, v224
    v_mfma_f32_16x16x32_bf16 v[8:11], a[176:179], a[68:71], v[8:11]
    v_add_u32 v223, s40, v223
    v_mfma_f32_16x16x32_bf16 v[28:31], a[180:183], a[68:71], v[28:31]
    s_add_u32 s8, s3, 0
    s_and_b32 s8, s8, 3
    s_lshl_b32 s8, s8, 10
    v_add_u32 v248, s8, v223
    v_mfma_f32_16x16x32_bf16 v[48:51], a[184:187], a[68:71], v[48:51]
    s_add_u32 s8, s3, 1
    s_and_b32 s8, s8, 3
    s_lshl_b32 s8, s8, 10
    v_add_u32 v249, s8, v223
    v_mfma_f32_16x16x32_bf16 v[68:71], a[188:191], a[68:71], v[68:71]
    s_add_u32 s8, s3, 2
    s_and_b32 s8, s8, 3
    s_lshl_b32 s8, s8, 10
    v_add_u32 v250, s8, v223
    v_mfma_f32_16x16x32_bf16 v[72:75], a[188:191], a[72:75], v[72:75]
    s_add_u32 s8, s3, 3
    s_and_b32 s8, s8, 3
    s_lshl_b32 s8, s8, 10
    v_add_u32 v251, s8, v223
    v_mfma_f32_16x16x32_bf16 v[52:55], a[184:187], a[72:75], v[52:55]
    buffer_load_dwordx4 a[68:71], v235, s[64:67], s15 offen offset:3072
    v_add_u32 v192, s40, v224
    v_mfma_f32_16x16x32_bf16 v[32:35], a[180:183], a[72:75], v[32:35]
    s_sub_u32 s8, s3, 1
    s_and_b32 s8, s8, 3
    s_mul_i32 s8, s8, 40960
    v_add_u32 v193, s8, v224
    v_mfma_f32_16x16x32_bf16 v[12:15], a[176:179], a[72:75], v[12:15]
    s_waitcnt vmcnt(11)
    s_waitcnt lgkmcnt(0)
    s_sub_u32 s8, s3, 2
    s_and_b32 s8, s8, 3
    v_mfma_f32_16x16x32_bf16 v[0:3], a[224:227], a[0:3], v[0:3]
    s_mul_i32 s8, s8, 40960
    buffer_load_dwordx4 a[72:75], v236, s[64:67], s15 offen offset:3072
    ds_read_b64_tr_b16 a[240:241], v240 offset:24576
    v_mfma_f32_16x16x32_bf16 v[20:23], a[228:231], a[0:3], v[20:23]
    s_add_u32 m0, s40, 20480
    s_add_u32 s14, s41, 811008
    buffer_load_dwordx4 v226, s[76:79], s14 offen offset:0 lds
    v_mfma_f32_16x16x32_bf16 v[40:43], a[232:235], a[0:3], v[40:43]
    buffer_load_dwordx4 v230, s[76:79], s14 offen offset:1024 lds
    ds_read_b64_tr_b16 a[242:243], v240 offset:26624
    v_mfma_f32_16x16x32_bf16 v[60:63], a[236:239], a[0:3], v[60:63]
    s_add_u32 s15, s44, 16384
    buffer_load_dwordx4 a[0:3], v233, s[64:67], s15 offen offset:0
    ds_read_b64_tr_b16 a[244:245], v241 offset:24576
    v_mfma_f32_16x16x32_bf16 v[64:67], a[236:239], a[4:7], v[64:67]
    ds_read_b64_tr_b16 a[246:247], v241 offset:26624
    ds_read_b64_tr_b16 a[248:249], v242 offset:24576
    v_add_u32 v194, s8, v224
    v_mfma_f32_16x16x32_bf16 v[44:47], a[232:235], a[4:7], v[44:47]
    s_sub_u32 s8, s3, 3
    s_and_b32 s8, s8, 3
    s_mul_i32 s8, s8, 40960
    ds_read_b64_tr_b16 a[250:251], v242 offset:26624
    v_mfma_f32_16x16x32_bf16 v[24:27], a[228:231], a[4:7], v[24:27]
    ds_read_b64_tr_b16 a[252:253], v243 offset:24576
    ds_read_b64_tr_b16 a[254:255], v243 offset:26624
    v_add_u32 v195, s8, v224
    v_mfma_f32_16x16x32_bf16 v[4:7], a[224:227], a[4:7], v[4:7]
    buffer_load_dwordx4 v231, s[76:79], s14 offen offset:2048 lds
    v_bfe_u32 v222, v224, 4, 3
    v_mfma_f32_16x16x32_bf16 v[8:11], a[224:227], a[8:11], v[8:11]
    buffer_load_dwordx4 v232, s[76:79], s14 offen offset:3072 lds
    v_lshrrev_b32 v223, 9, v224
    v_mfma_f32_16x16x32_bf16 v[28:31], a[228:231], a[8:11], v[28:31]
    s_lshl_b32 s8, s3, 1
    buffer_load_dwordx4 a[4:7], v234, s[64:67], s15 offen offset:0
    v_add_u32 v223, s8, v223
    v_mfma_f32_16x16x32_bf16 v[48:51], a[232:235], a[8:11], v[48:51]
    v_xor_b32 v222, v222, v223
    v_bfe_u32 v223, v224, 4, 4
    v_lshlrev_b32 v223, 7, v223
    v_mfma_f32_16x16x32_bf16 v[68:71], a[236:239], a[8:11], v[68:71]
    buffer_load_dwordx4 a[8:11], v235, s[64:67], s15 offen offset:0
    v_lshl_add_u32 v222, v222, 4, v223
    v_mfma_f32_16x16x32_bf16 v[72:75], a[236:239], a[12:15], v[72:75]
    v_bfe_u32 v223, v224, 8, 1
    v_lshl_add_u32 v222, v223, 3, v222
    v_add_u32 v176, 0, v222
    v_mfma_f32_16x16x32_bf16 v[52:55], a[232:235], a[12:15], v[52:55]
    v_add_u32 v177, 40960, v222
    v_add_u32 v178, 81920, v222
    v_lshrrev_b32 v222, 7, v224
    v_mfma_f32_16x16x32_bf16 v[32:35], a[228:231], a[12:15], v[32:35]
    v_bfe_u32 v223, v224, 4, 3
    v_xor_b32 v223, v223, v222
    v_lshlrev_b32 v223, 4, v223
    v_mfma_f32_16x16x32_bf16 v[12:15], a[224:227], a[12:15], v[12:15]
    s_waitcnt vmcnt(15)
    s_waitcnt lgkmcnt(0)
    buffer_load_dwordx4 a[12:15], v236, s[64:67], s15 offen offset:0
    v_mfma_f32_16x16x32_bf16 v[0:3], a[240:243], a[20:23], v[0:3]
    ds_read_b64_tr_b16 a[224:225], v240 offset:28672
    ds_read_b64_tr_b16 a[226:227], v240 offset:30720
    v_lshl_add_u32 v223, v222, 7, v223
    v_mfma_f32_16x16x32_bf16 v[20:23], a[244:247], a[20:23], v[20:23]
    s_add_u32 m0, s40, 24576
    s_add_u32 s14, s41, 847872
    s_lshl_b32 s8, s3, 10
    ds_read_b64_tr_b16 a[228:229], v241 offset:28672
    v_mfma_f32_16x16x32_bf16 v[40:43], a[248:251], a[20:23], v[40:43]
    buffer_load_dwordx4 v226, s[76:79], s14 offen offset:0 lds
    ds_read_b64_tr_b16 a[230:231], v241 offset:30720
    v_mfma_f32_16x16x32_bf16 v[60:63], a[252:255], a[20:23], v[60:63]
    buffer_load_dwordx4 v230, s[76:79], s14 offen offset:1024 lds
    ds_read_b64_tr_b16 a[232:233], v242 offset:28672
    v_mfma_f32_16x16x32_bf16 v[64:67], a[252:255], a[24:27], v[64:67]
    buffer_load_dwordx4 a[20:23], v233, s[64:67], s15 offen offset:1024
    ds_read_b64_tr_b16 a[234:235], v242 offset:30720
    v_mfma_f32_16x16x32_bf16 v[44:47], a[248:251], a[24:27], v[44:47]
    ds_read_b64_tr_b16 a[236:237], v243 offset:28672
    ds_read_b64_tr_b16 a[238:239], v243 offset:30720
    v_add_u32 v223, s8, v223
    v_mfma_f32_16x16x32_bf16 v[24:27], a[244:247], a[24:27], v[24:27]
    buffer_load_dwordx4 v231, s[76:79], s14 offen offset:2048 lds
    v_add_u32 v179, 0, v223
    v_mfma_f32_16x16x32_bf16 v[4:7], a[240:243], a[24:27], v[4:7]
    buffer_load_dwordx4 v232, s[76:79], s14 offen offset:3072 lds
    v_add_u32 v180, 40960, v223
    v_mfma_f32_16x16x32_bf16 v[8:11], a[240:243], a[28:31], v[8:11]
    buffer_load_dwordx4 a[24:27], v234, s[64:67], s15 offen offset:1024
    v_add_u32 v181, 81920, v223
    v_mfma_f32_16x16x32_bf16 v[28:31], a[244:247], a[28:31], v[28:31]
    s_lshl_b32 s8, s3, 3
    v_add_u32 v222, s8, v222
    v_mul_u32_u24 v222, 2304, v222
    v_and_b32 v223, 0x70, v224
    v_mfma_f32_16x16x32_bf16 v[48:51], a[248:251], a[28:31], v[48:51]
    v_add_u32 v222, v222, v223
    v_or_b32 v222, s42, v222
    v_mfma_f32_16x16x32_bf16 v[68:71], a[252:255], a[28:31], v[68:71]
    s_lshl_b32 s8, s3, 5
    s_sub_u32 s11, s48, s8
    s_sub_u32 s12, s100, s8
    s_lshr_b32 s9, s3, 1
    v_mfma_f32_16x16x32_bf16 v[72:75], a[252:255], a[32:35], v[72:75]
    buffer_load_dwordx4 a[28:31], v235, s[64:67], s15 offen offset:1024
    v_add_u32 v182, 0, v222
    v_mfma_f32_16x16x32_bf16 v[52:55], a[248:251], a[32:35], v[52:55]
    v_add_u32 v183, 73728, v222
    v_add_u32 v185, 0, v222
    v_add_u32 v186, 73728, v222
    v_mfma_f32_16x16x32_bf16 v[32:35], a[244:247], a[32:35], v[32:35]
    v_add_u32 v187, 147456, v222
    v_mfma_f32_16x16x32_bf16 v[12:15], a[240:243], a[32:35], v[12:15]
    s_waitcnt vmcnt(19)
    s_waitcnt lgkmcnt(0)
    s_add_u32 s8, s10, s9
    s_add_u32 s8, s8, 4
    v_mfma_f32_16x16x32_bf16 v[0:3], a[224:227], a[40:43], v[0:3]
    s_lshr_b32 s8, s8, 5
    s_lshl_b32 s8, s8, 31
    buffer_load_dwordx4 a[32:35], v236, s[64:67], s15 offen offset:1024
    v_mfma_f32_16x16x32_bf16 v[20:23], a[228:231], a[40:43], v[20:23]
    s_add_u32 m0, s40, 28672
    s_add_u32 s14, s41, 884736
    buffer_load_dwordx4 v226, s[76:79], s14 offen offset:0 lds
    v_mfma_f32_16x16x32_bf16 v[40:43], a[232:235], a[40:43], v[40:43]
    buffer_load_dwordx4 v230, s[76:79], s14 offen offset:1024 lds
    ds_read_b64_tr_b16 a[240:241], v240 offset:32768
    v_mfma_f32_16x16x32_bf16 v[60:63], a[236:239], a[40:43], v[60:63]
    buffer_load_dwordx4 a[40:43], v233, s[64:67], s15 offen offset:2048
    ds_read_b64_tr_b16 a[242:243], v240 offset:34816
    v_mfma_f32_16x16x32_bf16 v[64:67], a[236:239], a[44:47], v[64:67]
    ds_read_b64_tr_b16 a[244:245], v241 offset:32768
    ds_read_b64_tr_b16 a[246:247], v241 offset:34816
    v_or_b32 v187, s8, v187
    v_mfma_f32_16x16x32_bf16 v[44:47], a[232:235], a[44:47], v[44:47]
    ds_read_b64_tr_b16 a[248:249], v242 offset:32768
    ds_read_b64_tr_b16 a[250:251], v242 offset:34816
    v_and_b32 v223, 0x3c0, v224
    v_mfma_f32_16x16x32_bf16 v[24:27], a[228:231], a[44:47], v[24:27]
    ds_read_b64_tr_b16 a[252:253], v243 offset:32768
    ds_read_b64_tr_b16 a[254:255], v243 offset:34816
    v_add_u32 v223, v223, v224
    v_mfma_f32_16x16x32_bf16 v[4:7], a[224:227], a[44:47], v[4:7]
    s_mov_b32 s99, 59064320
    buffer_load_dwordx4 v231, s[76:79], s14 offen offset:2048 lds
    v_mfma_f32_16x16x32_bf16 v[8:11], a[224:227], a[48:51], v[8:11]
    buffer_load_dwordx4 v232, s[76:79], s14 offen offset:3072 lds
    v_mfma_f32_16x16x32_bf16 v[28:31], a[228:231], a[48:51], v[28:31]
    buffer_load_dwordx4 a[44:47], v234, s[64:67], s15 offen offset:2048
    v_mfma_f32_16x16x32_bf16 v[48:51], a[232:235], a[48:51], v[48:51]
    v_mfma_f32_16x16x32_bf16 v[68:71], a[236:239], a[48:51], v[68:71]
    buffer_load_dwordx4 a[48:51], v235, s[64:67], s15 offen offset:2048
    v_mfma_f32_16x16x32_bf16 v[72:75], a[236:239], a[52:55], v[72:75]
    v_mfma_f32_16x16x32_bf16 v[52:55], a[232:235], a[52:55], v[52:55]
    v_mfma_f32_16x16x32_bf16 v[32:35], a[228:231], a[52:55], v[32:35]
    v_mfma_f32_16x16x32_bf16 v[12:15], a[224:227], a[52:55], v[12:15]
    s_waitcnt vmcnt(23)
    s_waitcnt lgkmcnt(0)
    buffer_load_dwordx4 a[52:55], v236, s[64:67], s15 offen offset:2048
    v_mfma_f32_16x16x32_bf16 v[0:3], a[240:243], a[60:63], v[0:3]
    ds_read_b64_tr_b16 a[224:225], v240 offset:36864
    ds_read_b64_tr_b16 a[226:227], v240 offset:38912
    v_mfma_f32_16x16x32_bf16 v[20:23], a[244:247], a[60:63], v[20:23]
    s_add_u32 m0, s40, 32768
    s_add_u32 s14, s41, 921600
    buffer_load_dwordx4 v226, s[76:79], s14 offen offset:0 lds
    v_mfma_f32_16x16x32_bf16 v[40:43], a[248:251], a[60:63], v[40:43]
    buffer_load_dwordx4 v230, s[76:79], s14 offen offset:1024 lds
    ds_read_b64_tr_b16 a[228:229], v241 offset:36864
    v_mfma_f32_16x16x32_bf16 v[60:63], a[252:255], a[60:63], v[60:63]
    buffer_load_dwordx4 a[60:63], v233, s[64:67], s15 offen offset:3072
    ds_read_b64_tr_b16 a[230:231], v241 offset:38912
    v_mfma_f32_16x16x32_bf16 v[64:67], a[252:255], a[64:67], v[64:67]
    ds_read_b64_tr_b16 a[232:233], v242 offset:36864
    ds_read_b64_tr_b16 a[234:235], v242 offset:38912
    v_mfma_f32_16x16x32_bf16 v[44:47], a[248:251], a[64:67], v[44:47]
    ds_read_b64_tr_b16 a[236:237], v243 offset:36864
    ds_read_b64_tr_b16 a[238:239], v243 offset:38912
    v_mfma_f32_16x16x32_bf16 v[24:27], a[244:247], a[64:67], v[24:27]
    buffer_load_dwordx4 v231, s[76:79], s14 offen offset:2048 lds
    v_mfma_f32_16x16x32_bf16 v[4:7], a[240:243], a[64:67], v[4:7]
    buffer_load_dwordx4 v232, s[76:79], s14 offen offset:3072 lds
    v_mfma_f32_16x16x32_bf16 v[8:11], a[240:243], a[68:71], v[8:11]
    buffer_load_dwordx4 a[64:67], v234, s[64:67], s15 offen offset:3072
    v_mfma_f32_16x16x32_bf16 v[28:31], a[244:247], a[68:71], v[28:31]
    v_mfma_f32_16x16x32_bf16 v[48:51], a[248:251], a[68:71], v[48:51]
    v_mfma_f32_16x16x32_bf16 v[68:71], a[252:255], a[68:71], v[68:71]
    buffer_load_dwordx4 a[68:71], v235, s[64:67], s15 offen offset:3072
    v_mfma_f32_16x16x32_bf16 v[72:75], a[252:255], a[72:75], v[72:75]
    v_mfma_f32_16x16x32_bf16 v[52:55], a[248:251], a[72:75], v[52:55]
    v_mfma_f32_16x16x32_bf16 v[32:35], a[244:247], a[72:75], v[32:35]
    v_mfma_f32_16x16x32_bf16 v[12:15], a[240:243], a[72:75], v[12:15]
    s_waitcnt vmcnt(23)
    s_waitcnt lgkmcnt(0)
    buffer_load_dwordx4 a[72:75], v236, s[64:67], s15 offen offset:3072
    v_mfma_f32_16x16x32_bf16 v[0:3], a[224:227], a[0:3], v[0:3]
    ds_read_b64_tr_b16 a[240:241], v240 offset:0
    ds_read_b64_tr_b16 a[242:243], v240 offset:2048
    v_mfma_f32_16x16x32_bf16 v[20:23], a[228:231], a[0:3], v[20:23]
    s_add_u32 m0, s40, 36864
    s_add_u32 s14, s41, 958464
    buffer_load_dwordx4 v226, s[76:79], s14 offen offset:0 lds
    v_mfma_f32_16x16x32_bf16 v[40:43], a[232:235], a[0:3], v[40:43]
    buffer_load_dwordx4 v230, s[76:79], s14 offen offset:1024 lds
    ds_read_b64_tr_b16 a[244:245], v241 offset:0
    v_mfma_f32_16x16x32_bf16 v[60:63], a[236:239], a[0:3], v[60:63]
    s_add_u32 s15, s44, 20480
    buffer_load_dwordx4 a[0:3], v233, s[64:67], s15 offen offset:0
    ds_read_b64_tr_b16 a[246:247], v241 offset:2048
    v_mfma_f32_16x16x32_bf16 v[64:67], a[236:239], a[4:7], v[64:67]
    ds_read_b64_tr_b16 a[248:249], v242 offset:0
    ds_read_b64_tr_b16 a[250:251], v242 offset:2048
    v_mfma_f32_16x16x32_bf16 v[44:47], a[232:235], a[4:7], v[44:47]
    ds_read_b64_tr_b16 a[252:253], v243 offset:0
    ds_read_b64_tr_b16 a[254:255], v243 offset:2048
    v_mfma_f32_16x16x32_bf16 v[24:27], a[228:231], a[4:7], v[24:27]
    buffer_load_dwordx4 v231, s[76:79], s14 offen offset:2048 lds
    v_mfma_f32_16x16x32_bf16 v[4:7], a[224:227], a[4:7], v[4:7]
    buffer_load_dwordx4 v232, s[76:79], s14 offen offset:3072 lds
    v_mfma_f32_16x16x32_bf16 v[8:11], a[224:227], a[8:11], v[8:11]
    buffer_load_dwordx4 a[4:7], v234, s[64:67], s15 offen offset:0
    v_mfma_f32_16x16x32_bf16 v[28:31], a[228:231], a[8:11], v[28:31]
    v_mfma_f32_16x16x32_bf16 v[48:51], a[232:235], a[8:11], v[48:51]
    v_mfma_f32_16x16x32_bf16 v[68:71], a[236:239], a[8:11], v[68:71]
    buffer_load_dwordx4 a[8:11], v235, s[64:67], s15 offen offset:0
    v_mfma_f32_16x16x32_bf16 v[72:75], a[236:239], a[12:15], v[72:75]
    v_mfma_f32_16x16x32_bf16 v[52:55], a[232:235], a[12:15], v[52:55]
    v_mfma_f32_16x16x32_bf16 v[32:35], a[228:231], a[12:15], v[32:35]
    v_mfma_f32_16x16x32_bf16 v[12:15], a[224:227], a[12:15], v[12:15]
    s_waitcnt vmcnt(23)
    s_waitcnt lgkmcnt(0)
    buffer_load_dwordx4 a[12:15], v236, s[64:67], s15 offen offset:0
    v_mfma_f32_16x16x32_bf16 v[0:3], a[240:243], a[20:23], v[0:3]
    ds_read_b64_tr_b16 a[224:225], v240 offset:4096
    ds_read_b64_tr_b16 a[226:227], v240 offset:6144
    v_mfma_f32_16x16x32_bf16 v[20:23], a[244:247], a[20:23], v[20:23]
    s_add_u32 m0, s40, 0
    s_add_u32 s14, s41, 995328
    buffer_load_dwordx4 v226, s[76:79], s14 offen offset:0 lds
    v_mfma_f32_16x16x32_bf16 v[40:43], a[248:251], a[20:23], v[40:43]
    buffer_load_dwordx4 v230, s[76:79], s14 offen offset:1024 lds
    ds_read_b64_tr_b16 a[228:229], v241 offset:4096
    v_mfma_f32_16x16x32_bf16 v[60:63], a[252:255], a[20:23], v[60:63]
    buffer_load_dwordx4 a[20:23], v233, s[64:67], s15 offen offset:1024
    ds_read_b64_tr_b16 a[230:231], v241 offset:6144
    v_mfma_f32_16x16x32_bf16 v[64:67], a[252:255], a[24:27], v[64:67]
    ds_read_b64_tr_b16 a[232:233], v242 offset:4096
    ds_read_b64_tr_b16 a[234:235], v242 offset:6144
    v_mfma_f32_16x16x32_bf16 v[44:47], a[248:251], a[24:27], v[44:47]
    ds_read_b64_tr_b16 a[236:237], v243 offset:4096
    ds_read_b64_tr_b16 a[238:239], v243 offset:6144
    v_mfma_f32_16x16x32_bf16 v[24:27], a[244:247], a[24:27], v[24:27]
    buffer_load_dwordx4 v231, s[76:79], s14 offen offset:2048 lds
    v_mfma_f32_16x16x32_bf16 v[4:7], a[240:243], a[24:27], v[4:7]
    buffer_load_dwordx4 v232, s[76:79], s14 offen offset:3072 lds
    v_mfma_f32_16x16x32_bf16 v[8:11], a[240:243], a[28:31], v[8:11]
    buffer_load_dwordx4 a[24:27], v234, s[64:67], s15 offen offset:1024
    v_mfma_f32_16x16x32_bf16 v[28:31], a[244:247], a[28:31], v[28:31]
    v_mfma_f32_16x16x32_bf16 v[48:51], a[248:251], a[28:31], v[48:51]
    v_mfma_f32_16x16x32_bf16 v[68:71], a[252:255], a[28:31], v[68:71]
    buffer_load_dwordx4 a[28:31], v235, s[64:67], s15 offen offset:1024
    v_mfma_f32_16x16x32_bf16 v[72:75], a[252:255], a[32:35], v[72:75]
    v_mfma_f32_16x16x32_bf16 v[52:55], a[248:251], a[32:35], v[52:55]
    v_mfma_f32_16x16x32_bf16 v[32:35], a[244:247], a[32:35], v[32:35]
    v_mfma_f32_16x16x32_bf16 v[12:15], a[240:243], a[32:35], v[12:15]
    s_waitcnt vmcnt(23)
    s_waitcnt lgkmcnt(0)
    buffer_load_dwordx4 a[32:35], v236, s[64:67], s15 offen offset:1024
    v_mfma_f32_16x16x32_bf16 v[0:3], a[224:227], a[40:43], v[0:3]
    ds_read_b64_tr_b16 a[240:241], v240 offset:8192
    ds_read_b64_tr_b16 a[242:243], v240 offset:10240
    v_mfma_f32_16x16x32_bf16 v[20:23], a[228:231], a[40:43], v[20:23]
    s_add_u32 m0, s40, 4096
    s_add_u32 s14, s41, 1032192
    buffer_load_dwordx4 v226, s[76:79], s14 offen offset:0 lds
    v_mfma_f32_16x16x32_bf16 v[40:43], a[232:235], a[40:43], v[40:43]
    buffer_load_dwordx4 v230, s[76:79], s14 offen offset:1024 lds
    ds_read_b64_tr_b16 a[244:245], v241 offset:8192
    v_mfma_f32_16x16x32_bf16 v[60:63], a[236:239], a[40:43], v[60:63]
    buffer_load_dwordx4 a[40:43], v233, s[64:67], s15 offen offset:2048
    ds_read_b64_tr_b16 a[246:247], v241 offset:10240
    v_mfma_f32_16x16x32_bf16 v[64:67], a[236:239], a[44:47], v[64:67]
    ds_read_b64_tr_b16 a[248:249], v242 offset:8192
    ds_read_b64_tr_b16 a[250:251], v242 offset:10240
    v_mfma_f32_16x16x32_bf16 v[44:47], a[232:235], a[44:47], v[44:47]
    ds_read_b64_tr_b16 a[252:253], v243 offset:8192
    ds_read_b64_tr_b16 a[254:255], v243 offset:10240
    v_mfma_f32_16x16x32_bf16 v[24:27], a[228:231], a[44:47], v[24:27]
    buffer_load_dwordx4 v231, s[76:79], s14 offen offset:2048 lds
    v_mfma_f32_16x16x32_bf16 v[4:7], a[224:227], a[44:47], v[4:7]
    buffer_load_dwordx4 v232, s[76:79], s14 offen offset:3072 lds
    v_mfma_f32_16x16x32_bf16 v[8:11], a[224:227], a[48:51], v[8:11]
    buffer_load_dwordx4 a[44:47], v234, s[64:67], s15 offen offset:2048
    v_mfma_f32_16x16x32_bf16 v[28:31], a[228:231], a[48:51], v[28:31]
    v_mfma_f32_16x16x32_bf16 v[48:51], a[232:235], a[48:51], v[48:51]
    v_mfma_f32_16x16x32_bf16 v[68:71], a[236:239], a[48:51], v[68:71]
    buffer_load_dwordx4 a[48:51], v235, s[64:67], s15 offen offset:2048
    v_mfma_f32_16x16x32_bf16 v[72:75], a[236:239], a[52:55], v[72:75]
    v_mfma_f32_16x16x32_bf16 v[52:55], a[232:235], a[52:55], v[52:55]
    v_mfma_f32_16x16x32_bf16 v[32:35], a[228:231], a[52:55], v[32:35]
    v_mfma_f32_16x16x32_bf16 v[12:15], a[224:227], a[52:55], v[12:15]
    s_waitcnt vmcnt(23)
    s_waitcnt lgkmcnt(0)
    buffer_load_dwordx4 a[52:55], v236, s[64:67], s15 offen offset:2048
    v_mfma_f32_16x16x32_bf16 v[0:3], a[240:243], a[60:63], v[0:3]
    ds_read_b64_tr_b16 a[224:225], v240 offset:12288
    ds_read_b64_tr_b16 a[226:227], v240 offset:14336
    v_mfma_f32_16x16x32_bf16 v[20:23], a[244:247], a[60:63], v[20:23]
    s_add_u32 m0, s40, 8192
    s_add_u32 s14, s41, 1069056
    buffer_load_dwordx4 v226, s[76:79], s14 offen offset:0 lds
    v_mfma_f32_16x16x32_bf16 v[40:43], a[248:251], a[60:63], v[40:43]
    buffer_load_dwordx4 v230, s[76:79], s14 offen offset:1024 lds
    ds_read_b64_tr_b16 a[228:229], v241 offset:12288
    v_mfma_f32_16x16x32_bf16 v[60:63], a[252:255], a[60:63], v[60:63]
    buffer_load_dwordx4 a[60:63], v233, s[64:67], s15 offen offset:3072
    ds_read_b64_tr_b16 a[230:231], v241 offset:14336
    v_mfma_f32_16x16x32_bf16 v[64:67], a[252:255], a[64:67], v[64:67]
    ds_read_b64_tr_b16 a[232:233], v242 offset:12288
    ds_read_b64_tr_b16 a[234:235], v242 offset:14336
    v_mfma_f32_16x16x32_bf16 v[44:47], a[248:251], a[64:67], v[44:47]
    ds_read_b64_tr_b16 a[236:237], v243 offset:12288
    ds_read_b64_tr_b16 a[238:239], v243 offset:14336
    v_mfma_f32_16x16x32_bf16 v[24:27], a[244:247], a[64:67], v[24:27]
    buffer_load_dwordx4 v231, s[76:79], s14 offen offset:2048 lds
    v_mfma_f32_16x16x32_bf16 v[4:7], a[240:243], a[64:67], v[4:7]
    buffer_load_dwordx4 v232, s[76:79], s14 offen offset:3072 lds
    v_mfma_f32_16x16x32_bf16 v[8:11], a[240:243], a[68:71], v[8:11]
    buffer_load_dwordx4 a[64:67], v234, s[64:67], s15 offen offset:3072
    v_mfma_f32_16x16x32_bf16 v[28:31], a[244:247], a[68:71], v[28:31]
    v_mfma_f32_16x16x32_bf16 v[48:51], a[248:251], a[68:71], v[48:51]
    v_mfma_f32_16x16x32_bf16 v[68:71], a[252:255], a[68:71], v[68:71]
    buffer_load_dwordx4 a[68:71], v235, s[64:67], s15 offen offset:3072
    v_mfma_f32_16x16x32_bf16 v[72:75], a[252:255], a[72:75], v[72:75]
    v_mfma_f32_16x16x32_bf16 v[52:55], a[248:251], a[72:75], v[52:55]
    v_mfma_f32_16x16x32_bf16 v[32:35], a[244:247], a[72:75], v[32:35]
    v_mfma_f32_16x16x32_bf16 v[12:15], a[240:243], a[72:75], v[12:15]
    s_waitcnt vmcnt(23)
    s_waitcnt lgkmcnt(0)
    buffer_load_dwordx4 a[72:75], v236, s[64:67], s15 offen offset:3072
    v_mfma_f32_16x16x32_bf16 v[0:3], a[224:227], a[0:3], v[0:3]
    ds_read_b64_tr_b16 a[240:241], v240 offset:16384
    ds_read_b64_tr_b16 a[242:243], v240 offset:18432
    v_mfma_f32_16x16x32_bf16 v[20:23], a[228:231], a[0:3], v[20:23]
    s_add_u32 m0, s40, 12288
    s_add_u32 s14, s41, 1105920
    buffer_load_dwordx4 v226, s[76:79], s14 offen offset:0 lds
    v_mfma_f32_16x16x32_bf16 v[40:43], a[232:235], a[0:3], v[40:43]
    buffer_load_dwordx4 v230, s[76:79], s14 offen offset:1024 lds
    ds_read_b64_tr_b16 a[244:245], v241 offset:16384
    v_mfma_f32_16x16x32_bf16 v[60:63], a[236:239], a[0:3], v[60:63]
    s_add_u32 s15, s44, 24576
    buffer_load_dwordx4 a[0:3], v233, s[64:67], s15 offen offset:0
    ds_read_b64_tr_b16 a[246:247], v241 offset:18432
    v_mfma_f32_16x16x32_bf16 v[64:67], a[236:239], a[4:7], v[64:67]
    ds_read_b64_tr_b16 a[248:249], v242 offset:16384
    ds_read_b64_tr_b16 a[250:251], v242 offset:18432
    v_mfma_f32_16x16x32_bf16 v[44:47], a[232:235], a[4:7], v[44:47]
    ds_read_b64_tr_b16 a[252:253], v243 offset:16384
    ds_read_b64_tr_b16 a[254:255], v243 offset:18432
    v_mfma_f32_16x16x32_bf16 v[24:27], a[228:231], a[4:7], v[24:27]
    buffer_load_dwordx4 v231, s[76:79], s14 offen offset:2048 lds
    v_mfma_f32_16x16x32_bf16 v[4:7], a[224:227], a[4:7], v[4:7]
    buffer_load_dwordx4 v232, s[76:79], s14 offen offset:3072 lds
    v_mfma_f32_16x16x32_bf16 v[8:11], a[224:227], a[8:11], v[8:11]
    buffer_load_dwordx4 a[4:7], v234, s[64:67], s15 offen offset:0
    v_mfma_f32_16x16x32_bf16 v[28:31], a[228:231], a[8:11], v[28:31]
    v_mfma_f32_16x16x32_bf16 v[48:51], a[232:235], a[8:11], v[48:51]
    v_mfma_f32_16x16x32_bf16 v[68:71], a[236:239], a[8:11], v[68:71]
    buffer_load_dwordx4 a[8:11], v235, s[64:67], s15 offen offset:0
    v_mfma_f32_16x16x32_bf16 v[72:75], a[236:239], a[12:15], v[72:75]
    v_mfma_f32_16x16x32_bf16 v[52:55], a[232:235], a[12:15], v[52:55]
    v_mfma_f32_16x16x32_bf16 v[32:35], a[228:231], a[12:15], v[32:35]
    v_mfma_f32_16x16x32_bf16 v[12:15], a[224:227], a[12:15], v[12:15]
    s_waitcnt vmcnt(23)
    s_waitcnt lgkmcnt(0)
    buffer_load_dwordx4 a[12:15], v236, s[64:67], s15 offen offset:0
    v_mfma_f32_16x16x32_bf16 v[0:3], a[240:243], a[20:23], v[0:3]
    ds_read_b64_tr_b16 a[224:225], v240 offset:20480
    ds_read_b64_tr_b16 a[226:227], v240 offset:22528
    v_mfma_f32_16x16x32_bf16 v[20:23], a[244:247], a[20:23], v[20:23]
    s_add_u32 m0, s40, 16384
    s_add_u32 s14, s41, 1142784
    buffer_load_dwordx4 v226, s[76:79], s14 offen offset:0 lds
    v_mfma_f32_16x16x32_bf16 v[40:43], a[248:251], a[20:23], v[40:43]
    buffer_load_dwordx4 v230, s[76:79], s14 offen offset:1024 lds
    ds_read_b64_tr_b16 a[228:229], v241 offset:20480
    v_mfma_f32_16x16x32_bf16 v[60:63], a[252:255], a[20:23], v[60:63]
    buffer_load_dwordx4 a[20:23], v233, s[64:67], s15 offen offset:1024
    ds_read_b64_tr_b16 a[230:231], v241 offset:22528
    v_mfma_f32_16x16x32_bf16 v[64:67], a[252:255], a[24:27], v[64:67]
    ds_read_b64_tr_b16 a[232:233], v242 offset:20480
    ds_read_b64_tr_b16 a[234:235], v242 offset:22528
    v_mfma_f32_16x16x32_bf16 v[44:47], a[248:251], a[24:27], v[44:47]
    ds_read_b64_tr_b16 a[236:237], v243 offset:20480
    ds_read_b64_tr_b16 a[238:239], v243 offset:22528
    v_mfma_f32_16x16x32_bf16 v[24:27], a[244:247], a[24:27], v[24:27]
    buffer_load_dwordx4 v231, s[76:79], s14 offen offset:2048 lds
    v_mfma_f32_16x16x32_bf16 v[4:7], a[240:243], a[24:27], v[4:7]
    buffer_load_dwordx4 v232, s[76:79], s14 offen offset:3072 lds
    v_mfma_f32_16x16x32_bf16 v[8:11], a[240:243], a[28:31], v[8:11]
    buffer_load_dwordx4 a[24:27], v234, s[64:67], s15 offen offset:1024
    v_mfma_f32_16x16x32_bf16 v[28:31], a[244:247], a[28:31], v[28:31]
    v_mfma_f32_16x16x32_bf16 v[48:51], a[248:251], a[28:31], v[48:51]
    v_mfma_f32_16x16x32_bf16 v[68:71], a[252:255], a[28:31], v[68:71]
    buffer_load_dwordx4 a[28:31], v235, s[64:67], s15 offen offset:1024
    v_mfma_f32_16x16x32_bf16 v[72:75], a[252:255], a[32:35], v[72:75]
    v_mfma_f32_16x16x32_bf16 v[52:55], a[248:251], a[32:35], v[52:55]
    v_mfma_f32_16x16x32_bf16 v[32:35], a[244:247], a[32:35], v[32:35]
    v_mfma_f32_16x16x32_bf16 v[12:15], a[240:243], a[32:35], v[12:15]
    s_waitcnt vmcnt(23)
    s_waitcnt lgkmcnt(0)
    buffer_load_dwordx4 a[32:35], v236, s[64:67], s15 offen offset:1024
    v_mfma_f32_16x16x32_bf16 v[0:3], a[224:227], a[40:43], v[0:3]
    ds_read_b64_tr_b16 a[240:241], v240 offset:24576
    ds_read_b64_tr_b16 a[242:243], v240 offset:26624
    v_mfma_f32_16x16x32_bf16 v[20:23], a[228:231], a[40:43], v[20:23]
    ds_read_b64_tr_b16 a[244:245], v241 offset:24576
    ds_read_b64_tr_b16 a[246:247], v241 offset:26624
    v_mfma_f32_16x16x32_bf16 v[40:43], a[232:235], a[40:43], v[40:43]
    ds_read_b64_tr_b16 a[248:249], v242 offset:24576
    ds_read_b64_tr_b16 a[250:251], v242 offset:26624
    v_mfma_f32_16x16x32_bf16 v[60:63], a[236:239], a[40:43], v[60:63]
    buffer_load_dwordx4 a[40:43], v233, s[64:67], s15 offen offset:2048
    ds_read_b64_tr_b16 a[252:253], v243 offset:24576
    v_mfma_f32_16x16x32_bf16 v[64:67], a[236:239], a[44:47], v[64:67]
    ds_read_b64_tr_b16 a[254:255], v243 offset:26624
    v_mfma_f32_16x16x32_bf16 v[44:47], a[232:235], a[44:47], v[44:47]
    v_mfma_f32_16x16x32_bf16 v[24:27], a[228:231], a[44:47], v[24:27]
    v_mfma_f32_16x16x32_bf16 v[4:7], a[224:227], a[44:47], v[4:7]
    buffer_load_dwordx4 a[44:47], v234, s[64:67], s15 offen offset:2048
    v_mfma_f32_16x16x32_bf16 v[8:11], a[224:227], a[48:51], v[8:11]
    v_mfma_f32_16x16x32_bf16 v[28:31], a[228:231], a[48:51], v[28:31]
    v_mfma_f32_16x16x32_bf16 v[48:51], a[232:235], a[48:51], v[48:51]
    v_mfma_f32_16x16x32_bf16 v[68:71], a[236:239], a[48:51], v[68:71]
    buffer_load_dwordx4 a[48:51], v235, s[64:67], s15 offen offset:2048
    v_mfma_f32_16x16x32_bf16 v[72:75], a[236:239], a[52:55], v[72:75]
    v_mfma_f32_16x16x32_bf16 v[52:55], a[232:235], a[52:55], v[52:55]
    v_mfma_f32_16x16x32_bf16 v[32:35], a[228:231], a[52:55], v[32:35]
    v_mfma_f32_16x16x32_bf16 v[12:15], a[224:227], a[52:55], v[12:15]
    s_waitcnt vmcnt(19)
    s_waitcnt lgkmcnt(0)
    buffer_load_dwordx4 a[52:55], v236, s[64:67], s15 offen offset:2048
    v_mfma_f32_16x16x32_bf16 v[0:3], a[240:243], a[60:63], v[0:3]
    ds_read_b64_tr_b16 a[224:225], v240 offset:28672
    ds_read_b64_tr_b16 a[226:227], v240 offset:30720
    v_mfma_f32_16x16x32_bf16 v[20:23], a[244:247], a[60:63], v[20:23]
    ds_read_b64_tr_b16 a[228:229], v241 offset:28672
    ds_read_b64_tr_b16 a[230:231], v241 offset:30720
    v_mfma_f32_16x16x32_bf16 v[40:43], a[248:251], a[60:63], v[40:43]
    ds_read_b64_tr_b16 a[232:233], v242 offset:28672
    ds_read_b64_tr_b16 a[234:235], v242 offset:30720
    v_mfma_f32_16x16x32_bf16 v[60:63], a[252:255], a[60:63], v[60:63]
    buffer_load_dwordx4 a[60:63], v233, s[64:67], s15 offen offset:3072
    ds_read_b64_tr_b16 a[236:237], v243 offset:28672
    v_mfma_f32_16x16x32_bf16 v[64:67], a[252:255], a[64:67], v[64:67]
    ds_read_b64_tr_b16 a[238:239], v243 offset:30720
    v_mfma_f32_16x16x32_bf16 v[44:47], a[248:251], a[64:67], v[44:47]
    v_mfma_f32_16x16x32_bf16 v[24:27], a[244:247], a[64:67], v[24:27]
    v_mfma_f32_16x16x32_bf16 v[4:7], a[240:243], a[64:67], v[4:7]
    buffer_load_dwordx4 a[64:67], v234, s[64:67], s15 offen offset:3072
    v_mfma_f32_16x16x32_bf16 v[8:11], a[240:243], a[68:71], v[8:11]
    v_mfma_f32_16x16x32_bf16 v[28:31], a[244:247], a[68:71], v[28:31]
    v_mfma_f32_16x16x32_bf16 v[48:51], a[248:251], a[68:71], v[48:51]
    v_mfma_f32_16x16x32_bf16 v[68:71], a[252:255], a[68:71], v[68:71]
    buffer_load_dwordx4 a[68:71], v235, s[64:67], s15 offen offset:3072
    v_mfma_f32_16x16x32_bf16 v[72:75], a[252:255], a[72:75], v[72:75]
    v_mfma_f32_16x16x32_bf16 v[52:55], a[248:251], a[72:75], v[52:55]
    v_mfma_f32_16x16x32_bf16 v[32:35], a[244:247], a[72:75], v[32:35]
    v_mfma_f32_16x16x32_bf16 v[12:15], a[240:243], a[72:75], v[12:15]
    s_waitcnt vmcnt(15)
    s_waitcnt lgkmcnt(0)
    buffer_load_dwordx4 a[72:75], v236, s[64:67], s15 offen offset:3072
    v_mfma_f32_16x16x32_bf16 v[0:3], a[224:227], a[0:3], v[0:3]
    buffer_load_dwordx4 v[160:163], v223, s[64:67], s99 offen sc1
    ds_read_b64_tr_b16 a[240:241], v240 offset:32768
    v_mfma_f32_16x16x32_bf16 v[20:23], a[228:231], a[0:3], v[20:23]
    ds_read_b64_tr_b16 a[242:243], v240 offset:34816
    ds_read_b64_tr_b16 a[244:245], v241 offset:32768
    v_mfma_f32_16x16x32_bf16 v[40:43], a[232:235], a[0:3], v[40:43]
    ds_read_b64_tr_b16 a[246:247], v241 offset:34816
    ds_read_b64_tr_b16 a[248:249], v242 offset:32768
    v_mfma_f32_16x16x32_bf16 v[60:63], a[236:239], a[0:3], v[60:63]
    s_add_u32 s15, s44, 28672
    buffer_load_dwordx4 a[0:3], v233, s[64:67], s15 offen offset:0
    ds_read_b64_tr_b16 a[250:251], v242 offset:34816
    v_mfma_f32_16x16x32_bf16 v[64:67], a[236:239], a[4:7], v[64:67]
    ds_read_b64_tr_b16 a[252:253], v243 offset:32768
    ds_read_b64_tr_b16 a[254:255], v243 offset:34816
    v_mfma_f32_16x16x32_bf16 v[44:47], a[232:235], a[4:7], v[44:47]
    v_mfma_f32_16x16x32_bf16 v[24:27], a[228:231], a[4:7], v[24:27]
    v_mfma_f32_16x16x32_bf16 v[4:7], a[224:227], a[4:7], v[4:7]
    buffer_load_dwordx4 a[4:7], v234, s[64:67], s15 offen offset:0
    v_mfma_f32_16x16x32_bf16 v[8:11], a[224:227], a[8:11], v[8:11]
    v_mfma_f32_16x16x32_bf16 v[28:31], a[228:231], a[8:11], v[28:31]
    v_mfma_f32_16x16x32_bf16 v[48:51], a[232:235], a[8:11], v[48:51]
    v_mfma_f32_16x16x32_bf16 v[68:71], a[236:239], a[8:11], v[68:71]
    buffer_load_dwordx4 a[8:11], v235, s[64:67], s15 offen offset:0
    v_mfma_f32_16x16x32_bf16 v[72:75], a[236:239], a[12:15], v[72:75]
    v_mfma_f32_16x16x32_bf16 v[52:55], a[232:235], a[12:15], v[52:55]
    v_mfma_f32_16x16x32_bf16 v[32:35], a[228:231], a[12:15], v[32:35]
    v_mfma_f32_16x16x32_bf16 v[12:15], a[224:227], a[12:15], v[12:15]
    s_waitcnt vmcnt(12)
    s_waitcnt lgkmcnt(0)
    buffer_load_dwordx4 a[12:15], v236, s[64:67], s15 offen offset:0
    v_mfma_f32_16x16x32_bf16 v[0:3], a[240:243], a[20:23], v[0:3]
    ds_read_b64_tr_b16 a[224:225], v240 offset:36864
    ds_read_b64_tr_b16 a[226:227], v240 offset:38912
    v_mfma_f32_16x16x32_bf16 v[20:23], a[244:247], a[20:23], v[20:23]
    ds_read_b64_tr_b16 a[228:229], v241 offset:36864
    ds_read_b64_tr_b16 a[230:231], v241 offset:38912
    v_mfma_f32_16x16x32_bf16 v[40:43], a[248:251], a[20:23], v[40:43]
    ds_read_b64_tr_b16 a[232:233], v242 offset:36864
    ds_read_b64_tr_b16 a[234:235], v242 offset:38912
    v_mfma_f32_16x16x32_bf16 v[60:63], a[252:255], a[20:23], v[60:63]
    buffer_load_dwordx4 a[20:23], v233, s[64:67], s15 offen offset:1024
    ds_read_b64_tr_b16 a[236:237], v243 offset:36864
    v_mfma_f32_16x16x32_bf16 v[64:67], a[252:255], a[24:27], v[64:67]
    ds_read_b64_tr_b16 a[238:239], v243 offset:38912
    v_mfma_f32_16x16x32_bf16 v[44:47], a[248:251], a[24:27], v[44:47]
    v_mfma_f32_16x16x32_bf16 v[24:27], a[244:247], a[24:27], v[24:27]
    v_mfma_f32_16x16x32_bf16 v[4:7], a[240:243], a[24:27], v[4:7]
    buffer_load_dwordx4 a[24:27], v234, s[64:67], s15 offen offset:1024
    v_mfma_f32_16x16x32_bf16 v[8:11], a[240:243], a[28:31], v[8:11]
    v_mfma_f32_16x16x32_bf16 v[28:31], a[244:247], a[28:31], v[28:31]
    v_mfma_f32_16x16x32_bf16 v[48:51], a[248:251], a[28:31], v[48:51]
    v_mfma_f32_16x16x32_bf16 v[68:71], a[252:255], a[28:31], v[68:71]
    buffer_load_dwordx4 a[28:31], v235, s[64:67], s15 offen offset:1024
    v_mfma_f32_16x16x32_bf16 v[72:75], a[252:255], a[32:35], v[72:75]
    v_mfma_f32_16x16x32_bf16 v[52:55], a[248:251], a[32:35], v[52:55]
    v_mfma_f32_16x16x32_bf16 v[32:35], a[244:247], a[32:35], v[32:35]
    v_mfma_f32_16x16x32_bf16 v[12:15], a[240:243], a[32:35], v[12:15]
    s_waitcnt vmcnt(12)
    s_waitcnt lgkmcnt(0)
    buffer_load_dwordx4 a[32:35], v236, s[64:67], s15 offen offset:1024
    v_mfma_f32_16x16x32_bf16 v[0:3], a[224:227], a[40:43], v[0:3]
    ds_read_b64_tr_b16 a[240:241], v240 offset:0
    ds_read_b64_tr_b16 a[242:243], v240 offset:2048
    v_mfma_f32_16x16x32_bf16 v[20:23], a[228:231], a[40:43], v[20:23]
    ds_read_b64_tr_b16 a[244:245], v241 offset:0
    ds_read_b64_tr_b16 a[246:247], v241 offset:2048
    v_mfma_f32_16x16x32_bf16 v[40:43], a[232:235], a[40:43], v[40:43]
    ds_read_b64_tr_b16 a[248:249], v242 offset:0
    ds_read_b64_tr_b16 a[250:251], v242 offset:2048
    v_mfma_f32_16x16x32_bf16 v[60:63], a[236:239], a[40:43], v[60:63]
    buffer_load_dwordx4 a[40:43], v233, s[64:67], s15 offen offset:2048
    ds_read_b64_tr_b16 a[252:253], v243 offset:0
    v_mfma_f32_16x16x32_bf16 v[64:67], a[236:239], a[44:47], v[64:67]
    ds_read_b64_tr_b16 a[254:255], v243 offset:2048
    v_mfma_f32_16x16x32_bf16 v[44:47], a[232:235], a[44:47], v[44:47]
    v_mfma_f32_16x16x32_bf16 v[24:27], a[228:231], a[44:47], v[24:27]
    v_mfma_f32_16x16x32_bf16 v[4:7], a[224:227], a[44:47], v[4:7]
    buffer_load_dwordx4 a[44:47], v234, s[64:67], s15 offen offset:2048
    v_mfma_f32_16x16x32_bf16 v[8:11], a[224:227], a[48:51], v[8:11]
    v_mfma_f32_16x16x32_bf16 v[28:31], a[228:231], a[48:51], v[28:31]
    v_mfma_f32_16x16x32_bf16 v[48:51], a[232:235], a[48:51], v[48:51]
    v_mfma_f32_16x16x32_bf16 v[68:71], a[236:239], a[48:51], v[68:71]
    buffer_load_dwordx4 a[48:51], v235, s[64:67], s15 offen offset:2048
    v_mfma_f32_16x16x32_bf16 v[72:75], a[236:239], a[52:55], v[72:75]
    v_mfma_f32_16x16x32_bf16 v[52:55], a[232:235], a[52:55], v[52:55]
    v_mfma_f32_16x16x32_bf16 v[32:35], a[228:231], a[52:55], v[32:35]
    v_mfma_f32_16x16x32_bf16 v[12:15], a[224:227], a[52:55], v[12:15]
    s_waitcnt vmcnt(12)
    s_waitcnt lgkmcnt(0)
    buffer_load_dwordx4 a[52:55], v236, s[64:67], s15 offen offset:2048
    v_mfma_f32_16x16x32_bf16 v[0:3], a[240:243], a[60:63], v[0:3]
    ds_read_b64_tr_b16 a[224:225], v240 offset:4096
    ds_read_b64_tr_b16 a[226:227], v240 offset:6144
    v_mfma_f32_16x16x32_bf16 v[20:23], a[244:247], a[60:63], v[20:23]
    ds_read_b64_tr_b16 a[228:229], v241 offset:4096
    ds_read_b64_tr_b16 a[230:231], v241 offset:6144
    v_mfma_f32_16x16x32_bf16 v[40:43], a[248:251], a[60:63], v[40:43]
    ds_read_b64_tr_b16 a[232:233], v242 offset:4096
    ds_read_b64_tr_b16 a[234:235], v242 offset:6144
    v_mfma_f32_16x16x32_bf16 v[60:63], a[252:255], a[60:63], v[60:63]
    buffer_load_dwordx4 a[60:63], v233, s[64:67], s15 offen offset:3072
    ds_read_b64_tr_b16 a[236:237], v243 offset:4096
    v_mfma_f32_16x16x32_bf16 v[64:67], a[252:255], a[64:67], v[64:67]
    ds_read_b64_tr_b16 a[238:239], v243 offset:6144
    v_mfma_f32_16x16x32_bf16 v[44:47], a[248:251], a[64:67], v[44:47]
    v_mfma_f32_16x16x32_bf16 v[24:27], a[244:247], a[64:67], v[24:27]
    v_mfma_f32_16x16x32_bf16 v[4:7], a[240:243], a[64:67], v[4:7]
    buffer_load_dwordx4 a[64:67], v234, s[64:67], s15 offen offset:3072
    v_mfma_f32_16x16x32_bf16 v[8:11], a[240:243], a[68:71], v[8:11]
    v_mfma_f32_16x16x32_bf16 v[28:31], a[244:247], a[68:71], v[28:31]
    v_mfma_f32_16x16x32_bf16 v[48:51], a[248:251], a[68:71], v[48:51]
    v_mfma_f32_16x16x32_bf16 v[68:71], a[252:255], a[68:71], v[68:71]
    buffer_load_dwordx4 a[68:71], v235, s[64:67], s15 offen offset:3072
    v_mfma_f32_16x16x32_bf16 v[72:75], a[252:255], a[72:75], v[72:75]
    v_mfma_f32_16x16x32_bf16 v[52:55], a[248:251], a[72:75], v[52:55]
    v_mfma_f32_16x16x32_bf16 v[32:35], a[244:247], a[72:75], v[32:35]
    v_mfma_f32_16x16x32_bf16 v[12:15], a[240:243], a[72:75], v[12:15]
    s_waitcnt vmcnt(11)
    s_waitcnt lgkmcnt(0)
    buffer_load_dwordx4 a[72:75], v236, s[64:67], s15 offen offset:3072
    v_mfma_f32_16x16x32_bf16 v[0:3], a[224:227], a[0:3], v[0:3]
    ds_read_b64_tr_b16 a[240:241], v240 offset:8192
    ds_read_b64_tr_b16 a[242:243], v240 offset:10240
    v_and_b32 v160, v160, v161
    v_mfma_f32_16x16x32_bf16 v[20:23], a[228:231], a[0:3], v[20:23]
    ds_read_b64_tr_b16 a[244:245], v241 offset:8192
    ds_read_b64_tr_b16 a[246:247], v241 offset:10240
    v_and_b32 v162, v162, v163
    v_mfma_f32_16x16x32_bf16 v[40:43], a[232:235], a[0:3], v[40:43]
    v_and_b32 v160, v160, v162
    v_cmp_ne_u32 vcc, 1, v160
    s_nop 0
    s_cbranch_vccnz L_SPIN_S4
L_BACK_S4:
    v_add_u32 v233, 0, v207
    v_add_u32 v234, 19456, v207
    v_add_u32 v235, 38912, v207
    v_add_u32 v236, 58368, v207
    v_mfma_f32_16x16x32_bf16 v[60:63], a[236:239], a[0:3], v[60:63]
    ds_read_b64_tr_b16 a[248:249], v242 offset:8192
    ds_read_b64_tr_b16 a[250:251], v242 offset:10240
    v_mfma_f32_16x16x32_bf16 v[64:67], a[236:239], a[4:7], v[64:67]
    ds_read_b64_tr_b16 a[252:253], v243 offset:8192
    ds_read_b64_tr_b16 a[254:255], v243 offset:10240
    v_mfma_f32_16x16x32_bf16 v[44:47], a[232:235], a[4:7], v[44:47]
    v_mfma_f32_16x16x32_bf16 v[24:27], a[228:231], a[4:7], v[24:27]
    v_mfma_f32_16x16x32_bf16 v[4:7], a[224:227], a[4:7], v[4:7]
    v_mfma_f32_16x16x32_bf16 v[8:11], a[224:227], a[8:11], v[8:11]
    v_mfma_f32_16x16x32_bf16 v[28:31], a[228:231], a[8:11], v[28:31]
    v_mfma_f32_16x16x32_bf16 v[48:51], a[232:235], a[8:11], v[48:51]
    v_mfma_f32_16x16x32_bf16 v[68:71], a[236:239], a[8:11], v[68:71]
    v_mfma_f32_16x16x32_bf16 v[72:75], a[236:239], a[12:15], v[72:75]
    v_mfma_f32_16x16x32_bf16 v[52:55], a[232:235], a[12:15], v[52:55]
    v_mfma_f32_16x16x32_bf16 v[32:35], a[228:231], a[12:15], v[32:35]
    v_mfma_f32_16x16x32_bf16 v[12:15], a[224:227], a[12:15], v[12:15]
    s_waitcnt vmcnt(8)
    s_waitcnt lgkmcnt(0)
    v_mfma_f32_16x16x32_bf16 v[0:3], a[240:243], a[20:23], v[0:3]
    ds_read_b64_tr_b16 a[224:225], v240 offset:12288
    ds_read_b64_tr_b16 a[226:227], v240 offset:14336
    v_mfma_f32_16x16x32_bf16 v[20:23], a[244:247], a[20:23], v[20:23]
    s_add_u32 m0, s40, 20480
    ds_read_b64_tr_b16 a[228:229], v241 offset:12288
    ds_read_b64_tr_b16 a[230:231], v241 offset:14336
    v_mfma_f32_16x16x32_bf16 v[40:43], a[248:251], a[20:23], v[40:43]
    s_add_u32 s14, s45, 0
    ds_read_b64_tr_b16 a[232:233], v242 offset:12288
    ds_read_b64_tr_b16 a[234:235], v242 offset:14336
    v_mfma_f32_16x16x32_bf16 v[60:63], a[252:255], a[20:23], v[60:63]
    buffer_load_dwordx4 v233, s[64:67], s14 offen offset:0 sc1 lds
    ds_read_b64_tr_b16 a[236:237], v243 offset:12288
    v_mfma_f32_16x16x32_bf16 v[64:67], a[252:255], a[24:27], v[64:67]
    buffer_load_dwordx4 v234, s[64:67], s14 offen offset:1024 sc1 lds
    ds_read_b64_tr_b16 a[238:239], v243 offset:14336
    v_mfma_f32_16x16x32_bf16 v[44:47], a[248:251], a[24:27], v[44:47]
    buffer_load_dwordx4 v235, s[64:67], s14 offen offset:2048 sc1 lds
    v_mfma_f32_16x16x32_bf16 v[24:27], a[244:247], a[24:27], v[24:27]
    buffer_load_dwordx4 v236, s[64:67], s14 offen offset:3072 sc1 lds
    v_mfma_f32_16x16x32_bf16 v[4:7], a[240:243], a[24:27], v[4:7]
    buffer_load_dwordx4 a[80:83], v207, s[64:67], s46 offen sc1
    v_mfma_f32_16x16x32_bf16 v[8:11], a[240:243], a[28:31], v[8:11]
    buffer_load_dwordx4 a[84:87], v208, s[64:67], s46 offen sc1
    v_mfma_f32_16x16x32_bf16 v[28:31], a[244:247], a[28:31], v[28:31]
    buffer_load_dwordx4 a[88:91], v209, s[64:67], s46 offen sc1
    v_mfma_f32_16x16x32_bf16 v[48:51], a[248:251], a[28:31], v[48:51]
    buffer_load_dwordx4 a[92:95], v210, s[64:67], s46 offen sc1
    v_mfma_f32_16x16x32_bf16 v[68:71], a[252:255], a[28:31], v[68:71]
    buffer_load_dwordx4 a[96:99], v211, s[64:67], s46 offen sc1
    v_mfma_f32_16x16x32_bf16 v[72:75], a[252:255], a[32:35], v[72:75]
    buffer_load_dwordx4 a[100:103], v212, s[64:67], s46 offen sc1
    v_mfma_f32_16x16x32_bf16 v[52:55], a[248:251], a[32:35], v[52:55]
    v_mfma_f32_16x16x32_bf16 v[32:35], a[244:247], a[32:35], v[32:35]
    v_mfma_f32_16x16x32_bf16 v[12:15], a[240:243], a[32:35], v[12:15]
    s_waitcnt vmcnt(14)
    s_waitcnt lgkmcnt(0)
    v_mfma_f32_16x16x32_bf16 v[0:3], a[224:227], a[40:43], v[0:3]
    ds_read_b64_tr_b16 a[240:241], v240 offset:16384
    ds_read_b64_tr_b16 a[242:243], v240 offset:18432
    v_mfma_f32_16x16x32_bf16 v[20:23], a[228:231], a[40:43], v[20:23]
    s_add_u32 m0, s40, 24576
    ds_read_b64_tr_b16 a[244:245], v241 offset:16384
    ds_read_b64_tr_b16 a[246:247], v241 offset:18432
    v_mfma_f32_16x16x32_bf16 v[40:43], a[232:235], a[40:43], v[40:43]
    s_add_u32 s14, s45, 1024
    ds_read_b64_tr_b16 a[248:249], v242 offset:16384
    ds_read_b64_tr_b16 a[250:251], v242 offset:18432
    v_mfma_f32_16x16x32_bf16 v[60:63], a[236:239], a[40:43], v[60:63]
    buffer_load_dwordx4 v233, s[64:67], s14 offen offset:0 sc1 lds
    ds_read_b64_tr_b16 a[252:253], v243 offset:16384
    v_mfma_f32_16x16x32_bf16 v[64:67], a[236:239], a[44:47], v[64:67]
    buffer_load_dwordx4 v234, s[64:67], s14 offen offset:1024 sc1 lds
    ds_read_b64_tr_b16 a[254:255], v243 offset:18432
    v_mfma_f32_16x16x32_bf16 v[44:47], a[232:235], a[44:47], v[44:47]
    buffer_load_dwordx4 v235, s[64:67], s14 offen offset:2048 sc1 lds
    v_mfma_f32_16x16x32_bf16 v[24:27], a[228:231], a[44:47], v[24:27]
    buffer_load_dwordx4 v236, s[64:67], s14 offen offset:3072 sc1 lds
    v_mfma_f32_16x16x32_bf16 v[4:7], a[224:227], a[44:47], v[4:7]
    buffer_load_dwordx4 a[104:107], v215, s[64:67], s98 offen sc1
    v_mfma_f32_16x16x32_bf16 v[8:11], a[224:227], a[48:51], v[8:11]
    buffer_load_dwordx4 a[108:111], v216, s[64:67], s98 offen sc1
    v_mfma_f32_16x16x32_bf16 v[28:31], a[228:231], a[48:51], v[28:31]
    buffer_load_dwordx4 a[112:115], v217, s[64:67], s98 offen sc1
    v_mfma_f32_16x16x32_bf16 v[48:51], a[232:235], a[48:51], v[48:51]
    buffer_load_dwordx4 a[116:119], v218, s[64:67], s98 offen sc1
    v_mfma_f32_16x16x32_bf16 v[68:71], a[236:239], a[48:51], v[68:71]
    buffer_load_dwordx4 a[120:123], v219, s[64:67], s98 offen sc1
    v_mfma_f32_16x16x32_bf16 v[72:75], a[236:239], a[52:55], v[72:75]
    buffer_load_dwordx4 a[124:127], v220, s[64:67], s98 offen sc1
    v_mfma_f32_16x16x32_bf16 v[52:55], a[232:235], a[52:55], v[52:55]
    v_mfma_f32_16x16x32_bf16 v[32:35], a[228:231], a[52:55], v[32:35]
    v_mfma_f32_16x16x32_bf16 v[12:15], a[224:227], a[52:55], v[12:15]
    s_waitcnt vmcnt(16)
    s_waitcnt lgkmcnt(0)
    v_mfma_f32_16x16x32_bf16 v[0:3], a[240:243], a[60:63], v[0:3]
    ds_read_b64_tr_b16 a[224:225], v248 offset:20480
    ds_read_b64_tr_b16 a[226:227], v248 offset:20992
    v_mfma_f32_16x16x32_bf16 v[20:23], a[244:247], a[60:63], v[20:23]
    s_add_u32 m0, s40, 28672
    ds_read_b64_tr_b16 a[228:229], v249 offset:20480
    ds_read_b64_tr_b16 a[230:231], v249 offset:20992
    v_mfma_f32_16x16x32_bf16 v[40:43], a[248:251], a[60:63], v[40:43]
    s_add_u32 s14, s45, 2048
    ds_read_b64_tr_b16 a[232:233], v250 offset:20480
    ds_read_b64_tr_b16 a[234:235], v250 offset:20992
    v_mfma_f32_16x16x32_bf16 v[60:63], a[252:255], a[60:63], v[60:63]
    buffer_load_dwordx4 v233, s[64:67], s14 offen offset:0 sc1 lds
    ds_read_b64_tr_b16 a[236:237], v251 offset:20480
    v_mfma_f32_16x16x32_bf16 v[64:67], a[252:255], a[64:67], v[64:67]
    buffer_load_dwordx4 v234, s[64:67], s14 offen offset:1024 sc1 lds
    ds_read_b64_tr_b16 a[238:239], v251 offset:20992
    v_mfma_f32_16x16x32_bf16 v[44:47], a[248:251], a[64:67], v[44:47]
    buffer_load_dwordx4 v235, s[64:67], s14 offen offset:2048 sc1 lds
    v_mfma_f32_16x16x32_bf16 v[24:27], a[244:247], a[64:67], v[24:27]
    buffer_load_dwordx4 v236, s[64:67], s14 offen offset:3072 sc1 lds
    v_mfma_f32_16x16x32_bf16 v[4:7], a[240:243], a[64:67], v[4:7]
    s_add_u32 s98, s98, s101
    v_mfma_f32_16x16x32_bf16 v[8:11], a[240:243], a[68:71], v[8:11]
    buffer_load_dwordx4 a[128:131], v215, s[64:67], s98 offen sc1
    v_mfma_f32_16x16x32_bf16 v[28:31], a[244:247], a[68:71], v[28:31]
    buffer_load_dwordx4 a[132:135], v216, s[64:67], s98 offen sc1
    v_mfma_f32_16x16x32_bf16 v[48:51], a[248:251], a[68:71], v[48:51]
    buffer_load_dwordx4 a[136:139], v217, s[64:67], s98 offen sc1
    v_mfma_f32_16x16x32_bf16 v[68:71], a[252:255], a[68:71], v[68:71]
    buffer_load_dwordx4 a[140:143], v218, s[64:67], s98 offen sc1
    v_mfma_f32_16x16x32_bf16 v[72:75], a[252:255], a[72:75], v[72:75]
    buffer_load_dwordx4 a[144:147], v219, s[64:67], s98 offen sc1
    v_mfma_f32_16x16x32_bf16 v[52:55], a[248:251], a[72:75], v[52:55]
    buffer_load_dwordx4 a[148:151], v220, s[64:67], s98 offen sc1
    v_mfma_f32_16x16x32_bf16 v[32:35], a[244:247], a[72:75], v[32:35]
    v_mfma_f32_16x16x32_bf16 v[12:15], a[240:243], a[72:75], v[12:15]
    s_waitcnt vmcnt(16)
    s_waitcnt lgkmcnt(0)
    v_mfma_f32_16x16x32_bf16 v[80:83], a[224:227], a[80:83], 0
    ds_read_b64_tr_b16 a[240:241], v248 offset:24576
    ds_read_b64_tr_b16 a[242:243], v248 offset:25088
    v_mfma_f32_16x16x32_bf16 v[104:107], a[228:231], a[80:83], 0
    s_add_u32 m0, s40, 32768
    ds_read_b64_tr_b16 a[244:245], v249 offset:24576
    ds_read_b64_tr_b16 a[246:247], v249 offset:25088
    v_mfma_f32_16x16x32_bf16 v[128:131], a[232:235], a[80:83], 0
    s_add_u32 s14, s45, 3072
    ds_read_b64_tr_b16 a[248:249], v250 offset:24576
    ds_read_b64_tr_b16 a[250:251], v250 offset:25088
    v_mfma_f32_16x16x32_bf16 v[152:155], a[236:239], a[80:83], 0
    ds_read_b64_tr_b16 a[252:253], v251 offset:24576
    ds_read_b64_tr_b16 a[254:255], v251 offset:25088
    v_mfma_f32_16x16x32_bf16 v[156:159], a[236:239], a[84:87], 0
    buffer_load_dwordx4 v233, s[64:67], s14 offen offset:0 sc1 lds
    v_mfma_f32_16x16x32_bf16 v[132:135], a[232:235], a[84:87], 0
    buffer_load_dwordx4 v234, s[64:67], s14 offen offset:1024 sc1 lds
    v_mfma_f32_16x16x32_bf16 v[108:111], a[228:231], a[84:87], 0
    ds_write_b128 v192, v[20:23] offset:0
    ds_write_b128 v192, v[24:27] offset:1024
    v_mfma_f32_16x16x32_bf16 v[84:87], a[224:227], a[84:87], 0
    buffer_load_dwordx4 v235, s[64:67], s14 offen offset:2048 sc1 lds
    ds_write_b128 v192, v[28:31] offset:2048
    v_mfma_f32_16x16x32_bf16 v[88:91], a[224:227], a[88:91], 0
    ds_write_b128 v192, v[32:35] offset:3072
    ds_write_b128 v192, v[40:43] offset:4096
    v_mfma_f32_16x16x32_bf16 v[112:115], a[228:231], a[88:91], 0
    buffer_load_dwordx4 v236, s[64:67], s14 offen offset:3072 sc1 lds
    ds_write_b128 v192, v[44:47] offset:5120
    v_mfma_f32_16x16x32_bf16 v[136:139], a[232:235], a[88:91], 0
    s_add_u32 s98, s98, s101
    ds_write_b128 v192, v[48:51] offset:6144
    ds_write_b128 v192, v[52:55] offset:7168
    v_mfma_f32_16x16x32_bf16 v[160:163], a[236:239], a[88:91], 0
    ds_write_b128 v192, v[60:63] offset:8192
    ds_write_b128 v192, v[64:67] offset:9216
    v_mfma_f32_16x16x32_bf16 v[164:167], a[236:239], a[92:95], 0
    buffer_load_dwordx4 a[152:155], v215, s[64:67], s98 offen sc1
    ds_write_b128 v192, v[68:71] offset:10240
    v_mfma_f32_16x16x32_bf16 v[140:143], a[232:235], a[92:95], 0
    buffer_load_dwordx4 a[156:159], v216, s[64:67], s98 offen sc1
    ds_write_b128 v192, v[72:75] offset:11264
    v_mfma_f32_16x16x32_bf16 v[116:119], a[228:231], a[92:95], 0
    v_mfma_f32_16x16x32_bf16 v[92:95], a[224:227], a[92:95], 0
    buffer_load_dwordx4 a[160:163], v217, s[64:67], s98 offen sc1
    v_mfma_f32_16x16x32_bf16 v[96:99], a[224:227], a[96:99], 0
    v_mfma_f32_16x16x32_bf16 v[120:123], a[228:231], a[96:99], 0
    buffer_load_dwordx4 a[164:167], v218, s[64:67], s98 offen sc1
    v_mfma_f32_16x16x32_bf16 v[144:147], a[232:235], a[96:99], 0
    buffer_load_dwordx4 a[168:171], v219, s[64:67], s98 offen sc1
    v_mfma_f32_16x16x32_bf16 v[168:171], a[236:239], a[96:99], 0
    v_mfma_f32_16x16x32_bf16 v[172:175], a[236:239], a[100:103], 0
    buffer_load_dwordx4 a[172:175], v220, s[64:67], s98 offen sc1
    v_mfma_f32_16x16x32_bf16 v[148:151], a[232:235], a[100:103], 0
    v_mfma_f32_16x16x32_bf16 v[124:127], a[228:231], a[100:103], 0
    v_mfma_f32_16x16x32_bf16 v[100:103], a[224:227], a[100:103], 0
    s_waitcnt vmcnt(16)
    s_waitcnt lgkmcnt(12)
    v_mfma_f32_16x16x32_bf16 v[80:83], a[240:243], a[104:107], v[80:83]
    ds_read_b64_tr_b16 a[224:225], v248 offset:28672
    ds_read_b64_tr_b16 a[226:227], v248 offset:29184
    v_mfma_f32_16x16x32_bf16 v[104:107], a[244:247], a[104:107], v[104:107]
    s_add_u32 m0, s40, 36864
    ds_read_b64_tr_b16 a[228:229], v249 offset:28672
    ds_read_b64_tr_b16 a[230:231], v249 offset:29184
    v_mfma_f32_16x16x32_bf16 v[128:131], a[248:251], a[104:107], v[128:131]
    s_add_u32 s14, s45, 4096
    ds_read_b64_tr_b16 a[232:233], v250 offset:28672
    ds_read_b64_tr_b16 a[234:235], v250 offset:29184
    v_mfma_f32_16x16x32_bf16 v[152:155], a[252:255], a[104:107], v[152:155]
    ds_read_b64_tr_b16 a[236:237], v251 offset:28672
    ds_read_b64_tr_b16 a[238:239], v251 offset:29184
    v_mfma_f32_16x16x32_bf16 v[156:159], a[252:255], a[108:111], v[156:159]
    buffer_load_dwordx4 v233, s[64:67], s14 offen offset:0 sc1 lds
    v_mfma_f32_16x16x32_bf16 v[132:135], a[248:251], a[108:111], v[132:135]
    buffer_load_dwordx4 v234, s[64:67], s14 offen offset:1024 sc1 lds
    v_mfma_f32_16x16x32_bf16 v[108:111], a[244:247], a[108:111], v[108:111]
    v_mfma_f32_16x16x32_bf16 v[84:87], a[240:243], a[108:111], v[84:87]
    buffer_load_dwordx4 v235, s[64:67], s14 offen offset:2048 sc1 lds
    v_mfma_f32_16x16x32_bf16 v[88:91], a[240:243], a[112:115], v[88:91]
    v_mfma_f32_16x16x32_bf16 v[112:115], a[244:247], a[112:115], v[112:115]
    buffer_load_dwordx4 v236, s[64:67], s14 offen offset:3072 sc1 lds
    v_mfma_f32_16x16x32_bf16 v[136:139], a[248:251], a[112:115], v[136:139]
    s_add_u32 s98, s98, s101
    v_mfma_f32_16x16x32_bf16 v[160:163], a[252:255], a[112:115], v[160:163]
    v_mfma_f32_16x16x32_bf16 v[164:167], a[252:255], a[116:119], v[164:167]
    buffer_load_dwordx4 a[176:179], v215, s[64:67], s98 offen sc1
    v_mfma_f32_16x16x32_bf16 v[140:143], a[248:251], a[116:119], v[140:143]
    buffer_load_dwordx4 a[180:183], v216, s[64:67], s98 offen sc1
    v_mfma_f32_16x16x32_bf16 v[116:119], a[244:247], a[116:119], v[116:119]
    v_mfma_f32_16x16x32_bf16 v[92:95], a[240:243], a[116:119], v[92:95]
    buffer_load_dwordx4 a[184:187], v217, s[64:67], s98 offen sc1
    v_mfma_f32_16x16x32_bf16 v[96:99], a[240:243], a[120:123], v[96:99]
    v_mfma_f32_16x16x32_bf16 v[120:123], a[244:247], a[120:123], v[120:123]
    buffer_load_dwordx4 a[188:191], v218, s[64:67], s98 offen sc1
    v_mfma_f32_16x16x32_bf16 v[144:147], a[248:251], a[120:123], v[144:147]
    buffer_load_dwordx4 a[192:195], v219, s[64:67], s98 offen sc1
    v_mfma_f32_16x16x32_bf16 v[168:171], a[252:255], a[120:123], v[168:171]
    v_mfma_f32_16x16x32_bf16 v[172:175], a[252:255], a[124:127], v[172:175]
    buffer_load_dwordx4 a[196:199], v220, s[64:67], s98 offen sc1
    v_mfma_f32_16x16x32_bf16 v[148:151], a[248:251], a[124:127], v[148:151]
    v_mfma_f32_16x16x32_bf16 v[124:127], a[244:247], a[124:127], v[124:127]
    v_mfma_f32_16x16x32_bf16 v[100:103], a[240:243], a[124:127], v[100:103]
    s_waitcnt vmcnt(16)
    s_waitcnt lgkmcnt(0)
    v_mfma_f32_16x16x32_bf16 v[80:83], a[224:227], a[128:131], v[80:83]
    ds_read_b64_tr_b16 a[240:241], v248 offset:32768
    ds_read_b64_tr_b16 a[242:243], v248 offset:33280
    v_mfma_f32_16x16x32_bf16 v[104:107], a[228:231], a[128:131], v[104:107]
    ds_read_b64_tr_b16 a[244:245], v249 offset:32768
    ds_read_b64_tr_b16 a[246:247], v249 offset:33280
    v_mfma_f32_16x16x32_bf16 v[128:131], a[232:235], a[128:131], v[128:131]
    s_barrier
    ds_read_b64_tr_b16 a[248:249], v250 offset:32768
    ds_read_b64_tr_b16 a[250:251], v250 offset:33280
    v_mfma_f32_16x16x32_bf16 v[152:155], a[236:239], a[128:131], v[152:155]
    ds_read_b64_tr_b16 a[252:253], v251 offset:32768
    ds_read_b64_tr_b16 a[254:255], v251 offset:33280
    v_mfma_f32_16x16x32_bf16 v[156:159], a[236:239], a[132:135], v[156:159]
    ds_read_b128 v[20:23], v193 offset:0
    ds_read_b128 v[40:43], v194 offset:4096
    v_mfma_f32_16x16x32_bf16 v[132:135], a[232:235], a[132:135], v[132:135]
    ds_read_b128 v[60:63], v195 offset:8192
    ds_read_b128 v[24:27], v193 offset:1024
    v_mfma_f32_16x16x32_bf16 v[108:111], a[228:231], a[132:135], v[108:111]
    ds_read_b128 v[44:47], v194 offset:5120
    ds_read_b128 v[64:67], v195 offset:9216
    v_mfma_f32_16x16x32_bf16 v[84:87], a[224:227], a[132:135], v[84:87]
    ds_read_b128 v[28:31], v193 offset:2048
    ds_read_b128 v[48:51], v194 offset:6144
    v_mfma_f32_16x16x32_bf16 v[88:91], a[224:227], a[136:139], v[88:91]
    ds_read_b128 v[68:71], v195 offset:10240
    ds_read_b128 v[32:35], v193 offset:3072
    v_mfma_f32_16x16x32_bf16 v[112:115], a[228:231], a[136:139], v[112:115]
    ds_read_b128 v[52:55], v194 offset:7168
    ds_read_b128 v[72:75], v195 offset:11264
    s_waitcnt lgkmcnt(9)
    v_add_f32 v0, v0, v20
    v_mfma_f32_16x16x32_bf16 v[136:139], a[232:235], a[136:139], v[136:139]
    v_add_f32 v1, v1, v21
    v_add_f32 v2, v2, v22
    v_add_f32 v3, v3, v23
    v_mfma_f32_16x16x32_bf16 v[160:163], a[236:239], a[136:139], v[160:163]
    v_add_f32 v40, v40, v60
    v_add_f32 v41, v41, v61
    v_add_f32 v42, v42, v62
    v_mfma_f32_16x16x32_bf16 v[164:167], a[236:239], a[140:143], v[164:167]
    v_add_f32 v43, v43, v63
    v_add_f32 v0, v0, v40
    v_add_f32 v1, v1, v41
    v_mfma_f32_16x16x32_bf16 v[140:143], a[232:235], a[140:143], v[140:143]
    v_add_f32 v2, v2, v42
    v_add_f32 v3, v3, v43
    v_cvt_pk_bf16_f32 v0, v0, v1
    v_mfma_f32_16x16x32_bf16 v[116:119], a[228:231], a[140:143], v[116:119]
    v_cvt_pk_bf16_f32 v1, v2, v3
    v_mfma_f32_16x16x32_bf16 v[92:95], a[224:227], a[140:143], v[92:95]
    ds_write_b64 v176, v[0:1] offset:12288
    s_waitcnt lgkmcnt(7)
    v_add_f32 v4, v4, v24
    v_add_f32 v5, v5, v25
    v_mfma_f32_16x16x32_bf16 v[96:99], a[224:227], a[144:147], v[96:99]
    v_add_f32 v6, v6, v26
    v_add_f32 v7, v7, v27
    v_add_f32 v44, v44, v64
    v_mfma_f32_16x16x32_bf16 v[120:123], a[228:231], a[144:147], v[120:123]
    v_add_f32 v45, v45, v65
    v_add_f32 v46, v46, v66
    v_add_f32 v47, v47, v67
    v_mfma_f32_16x16x32_bf16 v[144:147], a[232:235], a[144:147], v[144:147]
    v_add_f32 v4, v4, v44
    v_add_f32 v5, v5, v45
    v_add_f32 v6, v6, v46
    v_mfma_f32_16x16x32_bf16 v[168:171], a[236:239], a[144:147], v[168:171]
    v_add_f32 v7, v7, v47
    v_cvt_pk_bf16_f32 v4, v4, v5
    v_cvt_pk_bf16_f32 v5, v6, v7
    v_mfma_f32_16x16x32_bf16 v[172:175], a[236:239], a[148:151], v[172:175]
    ds_write_b64 v176, v[4:5] offset:14336
    s_waitcnt lgkmcnt(5)
    v_add_f32 v8, v8, v28
    v_add_f32 v9, v9, v29
    v_mfma_f32_16x16x32_bf16 v[148:151], a[232:235], a[148:151], v[148:151]
    v_add_f32 v10, v10, v30
    v_add_f32 v11, v11, v31
    v_add_f32 v48, v48, v68
    v_mfma_f32_16x16x32_bf16 v[124:127], a[228:231], a[148:151], v[124:127]
    v_add_f32 v49, v49, v69
    v_add_f32 v50, v50, v70
    v_add_f32 v51, v51, v71
    v_mfma_f32_16x16x32_bf16 v[100:103], a[224:227], a[148:151], v[100:103]
    s_waitcnt vmcnt(6)
    v_add_f32 v8, v8, v48
    v_add_f32 v9, v9, v49
    v_mfma_f32_16x16x32_bf16 v[80:83], a[240:243], a[152:155], v[80:83]
    ds_read_b64_tr_b16 a[224:225], v248 offset:36864
    ds_read_b64_tr_b16 a[226:227], v248 offset:37376
    v_add_f32 v10, v10, v50
    v_mfma_f32_16x16x32_bf16 v[104:107], a[244:247], a[152:155], v[104:107]
    ds_read_b64_tr_b16 a[228:229], v249 offset:36864
    ds_read_b64_tr_b16 a[230:231], v249 offset:37376
    v_add_f32 v11, v11, v51
    v_mfma_f32_16x16x32_bf16 v[128:131], a[248:251], a[152:155], v[128:131]
    ds_read_b64_tr_b16 a[232:233], v250 offset:36864
    ds_read_b64_tr_b16 a[234:235], v250 offset:37376
    v_cvt_pk_bf16_f32 v8, v8, v9
    v_mfma_f32_16x16x32_bf16 v[152:155], a[252:255], a[152:155], v[152:155]
    ds_read_b64_tr_b16 a[236:237], v251 offset:36864
    ds_read_b64_tr_b16 a[238:239], v251 offset:37376
    v_cvt_pk_bf16_f32 v9, v10, v11
    v_mfma_f32_16x16x32_bf16 v[156:159], a[252:255], a[156:159], v[156:159]
    ds_write_b64 v177, v[8:9] offset:12288
    s_waitcnt lgkmcnt(11)
    v_add_f32 v12, v12, v32
    v_add_f32 v13, v13, v33
    v_mfma_f32_16x16x32_bf16 v[132:135], a[248:251], a[156:159], v[132:135]
    v_add_f32 v14, v14, v34
    v_add_f32 v15, v15, v35
    v_add_f32 v52, v52, v72
    v_mfma_f32_16x16x32_bf16 v[108:111], a[244:247], a[156:159], v[108:111]
    v_add_f32 v53, v53, v73
    v_add_f32 v54, v54, v74
    v_add_f32 v55, v55, v75
    v_mfma_f32_16x16x32_bf16 v[84:87], a[240:243], a[156:159], v[84:87]
    v_add_f32 v12, v12, v52
    v_add_f32 v13, v13, v53
    v_add_f32 v14, v14, v54
    v_mfma_f32_16x16x32_bf16 v[88:91], a[240:243], a[160:163], v[88:91]
    v_add_f32 v15, v15, v55
    v_cvt_pk_bf16_f32 v12, v12, v13
    v_cvt_pk_bf16_f32 v13, v14, v15
    v_mfma_f32_16x16x32_bf16 v[112:115], a[244:247], a[160:163], v[112:115]
    ds_write_b64 v177, v[12:13] offset:14336
    v_mfma_f32_16x16x32_bf16 v[136:139], a[248:251], a[160:163], v[136:139]
    v_mfma_f32_16x16x32_bf16 v[160:163], a[252:255], a[160:163], v[160:163]
    v_mfma_f32_16x16x32_bf16 v[164:167], a[252:255], a[164:167], v[164:167]
    v_mfma_f32_16x16x32_bf16 v[140:143], a[248:251], a[164:167], v[140:143]
    v_mfma_f32_16x16x32_bf16 v[116:119], a[244:247], a[164:167], v[116:119]
    v_mfma_f32_16x16x32_bf16 v[92:95], a[240:243], a[164:167], v[92:95]
    v_mfma_f32_16x16x32_bf16 v[96:99], a[240:243], a[168:171], v[96:99]
    v_mfma_f32_16x16x32_bf16 v[120:123], a[244:247], a[168:171], v[120:123]
    v_mfma_f32_16x16x32_bf16 v[144:147], a[248:251], a[168:171], v[144:147]
    v_mfma_f32_16x16x32_bf16 v[168:171], a[252:255], a[168:171], v[168:171]
    v_mfma_f32_16x16x32_bf16 v[172:175], a[252:255], a[172:175], v[172:175]
    v_mfma_f32_16x16x32_bf16 v[148:151], a[248:251], a[172:175], v[148:151]
    v_mfma_f32_16x16x32_bf16 v[124:127], a[244:247], a[172:175], v[124:127]
    v_mfma_f32_16x16x32_bf16 v[100:103], a[240:243], a[172:175], v[100:103]
    s_waitcnt vmcnt(0)
    s_waitcnt lgkmcnt(2)
    v_mfma_f32_16x16x32_bf16 v[104:107], a[228:231], a[176:179], v[104:107]
    v_mfma_f32_16x16x32_bf16 v[108:111], a[228:231], a[180:183], v[108:111]
    v_mfma_f32_16x16x32_bf16 v[112:115], a[228:231], a[184:187], v[112:115]
    v_mfma_f32_16x16x32_bf16 v[116:119], a[228:231], a[188:191], v[116:119]
    v_mfma_f32_16x16x32_bf16 v[120:123], a[228:231], a[192:195], v[120:123]
    v_mfma_f32_16x16x32_bf16 v[124:127], a[228:231], a[196:199], v[124:127]
    v_mfma_f32_16x16x32_bf16 v[128:131], a[232:235], a[176:179], v[128:131]
    v_mfma_f32_16x16x32_bf16 v[132:135], a[232:235], a[180:183], v[132:135]
    v_mfma_f32_16x16x32_bf16 v[136:139], a[232:235], a[184:187], v[136:139]
    ds_write_b128 v192, v[104:107] offset:20480
    v_mfma_f32_16x16x32_bf16 v[140:143], a[232:235], a[188:191], v[140:143]
    ds_write_b128 v192, v[108:111] offset:21504
    v_mfma_f32_16x16x32_bf16 v[144:147], a[232:235], a[192:195], v[144:147]
    ds_write_b128 v192, v[112:115] offset:22528
    v_mfma_f32_16x16x32_bf16 v[148:151], a[232:235], a[196:199], v[148:151]
    ds_write_b128 v192, v[116:119] offset:23552
    v_mfma_f32_16x16x32_bf16 v[152:155], a[236:239], a[176:179], v[152:155]
    ds_write_b128 v192, v[120:123] offset:24576
    v_mfma_f32_16x16x32_bf16 v[156:159], a[236:239], a[180:183], v[156:159]
    ds_write_b128 v192, v[124:127] offset:25600
    v_mfma_f32_16x16x32_bf16 v[160:163], a[236:239], a[184:187], v[160:163]
    ds_write_b128 v192, v[128:131] offset:26624
    v_mfma_f32_16x16x32_bf16 v[164:167], a[236:239], a[188:191], v[164:167]
    ds_write_b128 v192, v[132:135] offset:27648
    v_mfma_f32_16x16x32_bf16 v[168:171], a[236:239], a[192:195], v[168:171]
    ds_write_b128 v192, v[136:139] offset:28672
    v_mfma_f32_16x16x32_bf16 v[172:175], a[236:239], a[196:199], v[172:175]
    ds_write_b128 v192, v[140:143] offset:29696
    v_mfma_f32_16x16x32_bf16 v[80:83], a[224:227], a[176:179], v[80:83]
    ds_write_b128 v192, v[144:147] offset:30720
    v_mfma_f32_16x16x32_bf16 v[84:87], a[224:227], a[180:183], v[84:87]
    ds_write_b128 v192, v[148:151] offset:31744
    v_mfma_f32_16x16x32_bf16 v[88:91], a[224:227], a[184:187], v[88:91]
    ds_write_b128 v192, v[152:155] offset:32768
    v_mfma_f32_16x16x32_bf16 v[92:95], a[224:227], a[188:191], v[92:95]
    ds_write_b128 v192, v[156:159] offset:33792
    v_mfma_f32_16x16x32_bf16 v[96:99], a[224:227], a[192:195], v[96:99]
    ds_write_b128 v192, v[160:163] offset:34816
    v_mfma_f32_16x16x32_bf16 v[100:103], a[224:227], a[196:199], v[100:103]
    ds_write_b128 v192, v[164:167] offset:35840
    s_nop 1
    ds_write_b128 v192, v[168:171] offset:36864
    ds_write_b128 v192, v[172:175] offset:37888
    s_waitcnt lgkmcnt(0)
    s_barrier
    ds_read_b128 v[20:23], v179 offset:12288
    ds_read_b128 v[24:27], v180 offset:12288
    ds_read_b128 v[104:107], v193 offset:20480
    ds_read_b128 v[128:131], v194 offset:26624
    ds_read_b128 v[152:155], v195 offset:32768
    ds_read_b128 v[108:111], v193 offset:21504
    ds_read_b128 v[132:135], v194 offset:27648
    ds_read_b128 v[156:159], v195 offset:33792
    ds_read_b128 v[112:115], v193 offset:22528
    ds_read_b128 v[136:139], v194 offset:28672
    ds_read_b128 v[160:163], v195 offset:34816
    ds_read_b128 v[116:119], v193 offset:23552
    ds_read_b128 v[140:143], v194 offset:29696
    ds_read_b128 v[164:167], v195 offset:35840
    ds_read_b128 v[120:123], v193 offset:24576
    ds_read_b128 v[144:147], v194 offset:30720
    ds_read_b128 v[168:171], v195 offset:36864
    ds_read_b128 v[124:127], v193 offset:25600
    ds_read_b128 v[148:151], v194 offset:31744
    ds_read_b128 v[172:175], v195 offset:37888
    s_waitcnt lgkmcnt(15)
    buffer_store_dwordx4 v[20:23], v182, s[80:83], s11 offen offset:0 sc1
    buffer_store_dwordx4 v[24:27], v183, s[80:83], s11 offen offset:0 sc1
    v_pk_add_f32 v[80:81], v[80:81], v[104:105]
    v_pk_add_f32 v[82:83], v[82:83], v[106:107]
    v_pk_add_f32 v[128:129], v[128:129], v[152:153]
    v_pk_add_f32 v[130:131], v[130:131], v[154:155]
    v_pk_add_f32 v[80:81], v[80:81], v[128:129]
    v_pk_add_f32 v[82:83], v[82:83], v[130:131]
    v_cvt_pk_bf16_f32 v80, v80, v81
    v_cvt_pk_bf16_f32 v81, v82, v83
    ds_write_b64 v176, v[80:81] offset:0
    s_waitcnt lgkmcnt(13)
    v_pk_add_f32 v[84:85], v[84:85], v[108:109]
    v_pk_add_f32 v[86:87], v[86:87], v[110:111]
    v_pk_add_f32 v[132:133], v[132:133], v[156:157]
    v_pk_add_f32 v[134:135], v[134:135], v[158:159]
    v_pk_add_f32 v[84:85], v[84:85], v[132:133]
    v_pk_add_f32 v[86:87], v[86:87], v[134:135]
    v_cvt_pk_bf16_f32 v84, v84, v85
    v_cvt_pk_bf16_f32 v85, v86, v87
    ds_write_b64 v176, v[84:85] offset:2048
    s_waitcnt lgkmcnt(11)
    v_pk_add_f32 v[88:89], v[88:89], v[112:113]
    v_pk_add_f32 v[90:91], v[90:91], v[114:115]
    v_pk_add_f32 v[136:137], v[136:137], v[160:161]
    v_pk_add_f32 v[138:139], v[138:139], v[162:163]
    v_pk_add_f32 v[88:89], v[88:89], v[136:137]
    v_pk_add_f32 v[90:91], v[90:91], v[138:139]
    v_cvt_pk_bf16_f32 v88, v88, v89
    v_cvt_pk_bf16_f32 v89, v90, v91
    ds_write_b64 v177, v[88:89] offset:0
    s_waitcnt lgkmcnt(9)
    v_pk_add_f32 v[92:93], v[92:93], v[116:117]
    v_pk_add_f32 v[94:95], v[94:95], v[118:119]
    v_pk_add_f32 v[140:141], v[140:141], v[164:165]
    v_pk_add_f32 v[142:143], v[142:143], v[166:167]
    v_pk_add_f32 v[92:93], v[92:93], v[140:141]
    v_pk_add_f32 v[94:95], v[94:95], v[142:143]
    v_cvt_pk_bf16_f32 v92, v92, v93
    v_cvt_pk_bf16_f32 v93, v94, v95
    ds_write_b64 v177, v[92:93] offset:2048
    s_waitcnt lgkmcnt(7)
    v_pk_add_f32 v[96:97], v[96:97], v[120:121]
    v_pk_add_f32 v[98:99], v[98:99], v[122:123]
    v_pk_add_f32 v[144:145], v[144:145], v[168:169]
    v_pk_add_f32 v[146:147], v[146:147], v[170:171]
    v_pk_add_f32 v[96:97], v[96:97], v[144:145]
    v_pk_add_f32 v[98:99], v[98:99], v[146:147]
    v_cvt_pk_bf16_f32 v96, v96, v97
    v_cvt_pk_bf16_f32 v97, v98, v99
    ds_write_b64 v178, v[96:97] offset:0
    s_waitcnt lgkmcnt(5)
    v_pk_add_f32 v[100:101], v[100:101], v[124:125]
    v_pk_add_f32 v[102:103], v[102:103], v[126:127]
    v_pk_add_f32 v[148:149], v[148:149], v[172:173]
    v_pk_add_f32 v[150:151], v[150:151], v[174:175]
    v_pk_add_f32 v[100:101], v[100:101], v[148:149]
    v_pk_add_f32 v[102:103], v[102:103], v[150:151]
    v_cvt_pk_bf16_f32 v100, v100, v101
    v_cvt_pk_bf16_f32 v101, v102, v103
    ds_write_b64 v178, v[100:101] offset:2048
    s_waitcnt lgkmcnt(0)
    s_barrier
    ds_read_b128 v[40:43], v179 offset:0
    ds_read_b128 v[44:47], v180 offset:0
    ds_read_b128 v[48:51], v181 offset:0
    s_waitcnt lgkmcnt(2)
    buffer_store_dwordx4 v[40:43], v185, s[80:83], s12 offen offset:1152 sc1
    s_waitcnt lgkmcnt(1)
    buffer_store_dwordx4 v[44:47], v186, s[80:83], s12 offen offset:1152 sc1
    s_waitcnt lgkmcnt(0)
    buffer_store_dwordx4 v[48:51], v187, s[80:83], s12 offen offset:1152 sc1
L_END:
    s_endpgm
L_SPIN_A:
    s_mov_b32 s88, 0x40000
L_SPIN2_A:
    buffer_load_dword v247, v254, s[84:87], 0 offen sc1
    s_waitcnt vmcnt(0)
    v_cmp_ne_u32 vcc, 1, v247
    s_nop 0
    s_cbranch_vccz L_BACK_A
    s_sub_u32 s88, s88, 1
    s_cmp_lg_u32 s88, 0
    s_cbranch_scc1 L_SPIN2_A
    buffer_store_dword v246, v245, s[84:87], 0 offen offset:60
    s_branch L_BACK_A
L_SPIN_F:
    s_mov_b32 s88, 0x40000
L_SPIN2_F:
    buffer_load_dword v247, v248, s[64:67], s9 offen sc1
    s_waitcnt vmcnt(0)
    v_cmp_ne_u32 vcc, 1, v247
    s_nop 0
    s_cbranch_vccz L_BACK_F
    s_sub_u32 s88, s88, 1
    s_cmp_lg_u32 s88, 0
    s_cbranch_scc1 L_SPIN2_F
    buffer_store_dword v246, v245, s[84:87], 0 offen offset:60
    s_branch L_BACK_F
L_SPIN_B:
    s_mov_b32 s88, 0x40000
L_SPIN2_B:
    buffer_load_dword v247, v248, s[64:67], s8 offen sc1
    s_waitcnt vmcnt(0)
    v_cmp_ne_u32 vcc, 1, v247
    s_nop 0
    s_cbranch_vccz L_BACK_B
    s_sub_u32 s88, s88, 1
    s_cmp_lg_u32 s88, 0
    s_cbranch_scc1 L_SPIN2_B
    buffer_store_dword v246, v245, s[84:87], 0 offen offset:60
    s_branch L_BACK_B
L_SPIN_K:
    s_mov_b32 s88, 0x40000
L_SPIN2_K:
    buffer_load_dword v247, v248, s[64:67], s13 offen sc1
    s_waitcnt vmcnt(0)
    v_cmp_ne_u32 vcc, 1, v247
    s_nop 0
    s_cbranch_vccz L_BACK_K
    s_sub_u32 s88, s88, 1
    s_cmp_lg_u32 s88, 0
    s_cbranch_scc1 L_SPIN2_K
    buffer_store_dword v246, v245, s[84:87], 0 offen offset:60
    s_branch L_BACK_K
L_SPIN_C:
    s_mov_b32 s88, 0x40000
L_SPIN2_C:
    buffer_load_dword v247, v228, s[64:67], s49 offen sc1
    s_waitcnt vmcnt(0)
    v_cmp_ne_u32 vcc, 1, v247
    s_nop 0
    s_cbranch_vccz L_BACK_C
    s_sub_u32 s88, s88, 1
    s_cmp_lg_u32 s88, 0
    s_cbranch_scc1 L_SPIN2_C
    buffer_store_dword v246, v245, s[84:87], 0 offen offset:60
    s_branch L_BACK_C
L_SPIN_S5:
    s_mov_b32 s88, 0x40000
L_SPIN2_S5:
    buffer_load_dwordx4 v[160:163], v223, s[64:67], s99 offen sc1
    s_waitcnt vmcnt(0)
    v_and_b32 v160, v160, v161
    v_and_b32 v162, v162, v163
    v_and_b32 v160, v160, v162
    v_cmp_ne_u32 vcc, 1, v160
    s_nop 0
    s_cbranch_vccz L_BACK_S5
    s_sub_u32 s88, s88, 1
    s_cmp_lg_u32 s88, 0
    s_cbranch_scc1 L_SPIN2_S5
    buffer_store_dword v246, v245, s[84:87], 0 offen offset:60
    s_branch L_BACK_S5
L_SPIN_S4:
    s_mov_b32 s88, 0x40000
L_SPIN2_S4:
    buffer_load_dwordx4 v[160:163], v223, s[64:67], s99 offen sc1
    s_waitcnt vmcnt(0)
    v_and_b32 v160, v160, v161
    v_and_b32 v162, v162, v163
    v_and_b32 v160, v160, v162
    v_cmp_ne_u32 vcc, 1, v160
    s_nop 0
    s_cbranch_vccz L_BACK_S4
    s_sub_u32 s88, s88, 1
    s_cmp_lg_u32 s88, 0
    s_cbranch_scc1 L_SPIN2_S4
    buffer_store_dword v246, v245, s[84:87], 0 offen offset:60
    s_branch L_BACK_S4
L_MASK_P0:
    v_add_f32 v176, v176, v208
    v_add_f32 v177, v177, v209
    v_add_f32 v178, v178, v210
    v_add_f32 v179, v179, v211
    v_add_f32 v188, v188, v208
    v_add_f32 v189, v189, v209
    v_add_f32 v190, v190, v210
    v_add_f32 v191, v191, v211
    v_mov_b32 v180, 0xff800000
    v_mov_b32 v181, 0xff800000
    v_mov_b32 v182, 0xff800000
    v_mov_b32 v183, 0xff800000
    s_branch L_MRET_P0
L_MASK_P1:
    v_add_f32 v176, v176, v208
    v_add_f32 v177, v177, v209
    v_add_f32 v178, v178, v210
    v_add_f32 v179, v179, v211
    v_add_f32 v188, v188, v208
    v_add_f32 v189, v189, v209
    v_add_f32 v190, v190, v210
    v_add_f32 v191, v191, v211
    v_mov_b32 v180, 0xff800000
    v_mov_b32 v181, 0xff800000
    v_mov_b32 v182, 0xff800000
    v_mov_b32 v183, 0xff800000
    s_branch L_MRET_P1
L_MASK_C:
    v_add_f32 v176, v176, v208
    v_add_f32 v177, v177, v209
    v_add_f32 v178, v178, v210
    v_add_f32 v179, v179, v211
    v_add_f32 v188, v188, v208
    v_add_f32 v189, v189, v209
    v_add_f32 v190, v190, v210
    v_add_f32 v191, v191, v211
    v_mov_b32 v180, 0xff800000
    v_mov_b32 v181, 0xff800000
    v_mov_b32 v182, 0xff800000
    v_mov_b32 v183, 0xff800000
    s_branch L_MRET_C
L_MASK_T:
    v_add_f32 v192, v192, v208
    v_add_f32 v193, v193, v209
    v_add_f32 v194, v194, v210
    v_add_f32 v195, v195, v211
    v_add_f32 v204, v204, v208
    v_add_f32 v205, v205, v209
    v_add_f32 v206, v206, v210
    v_add_f32 v207, v207, v211
    v_mov_b32 v196, 0xff800000
    v_mov_b32 v197, 0xff800000
    v_mov_b32 v198, 0xff800000
    v_mov_b32 v199, 0xff800000
    s_branch L_MRET_T
L_MASK_S0:
    v_add_f32 v192, v192, v208
    v_add_f32 v193, v193, v209
    v_add_f32 v194, v194, v210
    v_add_f32 v195, v195, v211
    v_add_f32 v204, v204, v208
    v_add_f32 v205, v205, v209
    v_add_f32 v206, v206, v210
    v_add_f32 v207, v207, v211
    v_mov_b32 v196, 0xff800000
    v_mov_b32 v197, 0xff800000
    v_mov_b32 v198, 0xff800000
    v_mov_b32 v199, 0xff800000
    s_branch L_MRET_S0
L_MASK_S:
    v_add_f32 v192, v192, v208
    v_add_f32 v193, v193, v209
    v_add_f32 v194, v194, v210
    v_add_f32 v195, v195, v211
    v_add_f32 v204, v204, v208
    v_add_f32 v205, v205, v209
    v_add_f32 v206, v206, v210
    v_add_f32 v207, v207, v211
    v_mov_b32 v196, 0xff800000
    v_mov_b32 v197, 0xff800000
    v_mov_b32 v198, 0xff800000
    v_mov_b32 v199, 0xff800000
    s_branch L_MRET_S
L_FB:
    s_waitcnt vmcnt(0) lgkmcnt(0)
    s_barrier
    v_mov_b32 v176, 0
    v_mov_b32 v177, 0
    v_mov_b32 v178, 0
    v_mov_b32 v179, 0
    v_mov_b32 v180, 0
    v_mov_b32 v181, 0
    v_mov_b32 v182, 0
    v_mov_b32 v183, 0
    v_mov_b32 v184, 0
    v_mov_b32 v185, 0
    v_mov_b32 v186, 0
    v_mov_b32 v187, 0
    v_mov_b32 v188, 0
    v_mov_b32 v189, 0
    v_mov_b32 v190, 0
    v_mov_b32 v191, 0
    v_mov_b32 v192, 0
    v_mov_b32 v193, 0
    v_mov_b32 v194, 0
    v_mov_b32 v195, 0
    v_mov_b32 v196, 0
    v_mov_b32 v197, 0
    v_mov_b32 v198, 0
    v_mov_b32 v199, 0
    v_mov_b32 v200, 0
    v_mov_b32 v201, 0
    v_mov_b32 v202, 0
    v_mov_b32 v203, 0
    v_mov_b32 v204, 0
    v_mov_b32 v205, 0
    v_mov_b32 v206, 0
    v_mov_b32 v207, 0
    v_mov_b32 v220, 0xff800000
    v_mov_b32 v221, 0xff800000
    v_mov_b32 v222, 0xff800000
    v_mov_b32 v223, 0xff800000
    s_mov_b32 s34, 0
L_FBL:
    s_mul_i32 s8, s34, 16384
    s_add_u32 s9, s8, 4096
    buffer_load_dwordx4 a[64:67], v224, s[68:71], s8 offen offset:0 sc1
    buffer_load_dwordx4 a[68:71], v224, s[68:71], s8 offen offset:1024 sc1
    buffer_load_dwordx4 a[72:75], v224, s[68:71], s8 offen offset:2048 sc1
    buffer_load_dwordx4 a[76:79], v224, s[68:71], s8 offen offset:3072 sc1
    buffer_load_dwordx4 a[80:83], v224, s[68:71], s9 offen offset:0 sc1
    buffer_load_dwordx4 a[84:87], v224, s[68:71], s9 offen offset:1024 sc1
    buffer_load_dwordx4 a[88:91], v224, s[68:71], s9 offen offset:2048 sc1
    buffer_load_dwordx4 a[92:95], v224, s[68:71], s9 offen offset:3072 sc1
    s_cmp_lg_u32 s34, s32
    s_cbranch_scc1 L_FB1
    v_add_f32 v176, v176, v208
    v_add_f32 v177, v177, v209
    v_add_f32 v178, v178, v210
    v_add_f32 v179, v179, v211
    v_add_f32 v188, v188, v208
    v_add_f32 v189, v189, v209
    v_add_f32 v190, v190, v210
    v_add_f32 v191, v191, v211
    v_mov_b32 v180, 0xff800000
    v_mov_b32 v181, 0xff800000
    v_mov_b32 v182, 0xff800000
    v_mov_b32 v183, 0xff800000
L_FB1:
    s_cmp_lg_u32 s34, s33
    s_cbranch_scc1 L_FB2
    v_add_f32 v192, v192, v208
    v_add_f32 v193, v193, v209
    v_add_f32 v194, v194, v210
    v_add_f32 v195, v195, v211
    v_add_f32 v204, v204, v208
    v_add_f32 v205, v205, v209
    v_add_f32 v206, v206, v210
    v_add_f32 v207, v207, v211
    v_mov_b32 v196, 0xff800000
    v_mov_b32 v197, 0xff800000
    v_mov_b32 v198, 0xff800000
    v_mov_b32 v199, 0xff800000
L_FB2:
    s_waitcnt vmcnt(0)
    v_mfma_f32_16x16x32_bf16 v[128:131], a[64:67], a[0:3], v[176:179]
    v_mfma_f32_16x16x32_bf16 v[128:131], a[68:71], a[4:7], v[128:131]
    v_mfma_f32_16x16x32_bf16 v[128:131], a[72:75], a[8:11], v[128:131]
    v_mfma_f32_16x16x32_bf16 v[128:131], a[76:79], a[12:15], v[128:131]
    v_mfma_f32_16x16x32_bf16 v[136:139], a[76:79], a[28:31], v[184:187]
    v_mfma_f32_16x16x32_bf16 v[136:139], a[72:75], a[24:27], v[136:139]
    v_mfma_f32_16x16x32_bf16 v[136:139], a[68:71], a[20:23], v[136:139]
    v_mfma_f32_16x16x32_bf16 v[136:139], a[64:67], a[16:19], v[136:139]
    v_mfma_f32_16x16x32_bf16 v[140:143], a[80:83], a[16:19], v[188:191]
    v_mfma_f32_16x16x32_bf16 v[140:143], a[84:87], a[20:23], v[140:143]
    v_mfma_f32_16x16x32_bf16 v[140:143], a[88:91], a[24:27], v[140:143]
    v_mfma_f32_16x16x32_bf16 v[140:143], a[92:95], a[28:31], v[140:143]
    v_mfma_f32_16x16x32_bf16 v[132:135], a[92:95], a[12:15], v[180:183]
    v_mfma_f32_16x16x32_bf16 v[132:135], a[88:91], a[8:11], v[132:135]
    v_mfma_f32_16x16x32_bf16 v[132:135], a[84:87], a[4:7], v[132:135]
    v_mfma_f32_16x16x32_bf16 v[132:135], a[80:83], a[0:3], v[132:135]
    v_mfma_f32_16x16x32_bf16 v[144:147], a[64:67], a[32:35], v[192:195]
    v_mfma_f32_16x16x32_bf16 v[144:147], a[68:71], a[36:39], v[144:147]
    v_mfma_f32_16x16x32_bf16 v[144:147], a[72:75], a[40:43], v[144:147]
    v_mfma_f32_16x16x32_bf16 v[144:147], a[76:79], a[44:47], v[144:147]
    v_mfma_f32_16x16x32_bf16 v[152:155], a[76:79], a[60:63], v[200:203]
    v_mfma_f32_16x16x32_bf16 v[152:155], a[72:75], a[56:59], v[152:155]
    v_mfma_f32_16x16x32_bf16 v[152:155], a[68:71], a[52:55], v[152:155]
    v_mfma_f32_16x16x32_bf16 v[152:155], a[64:67], a[48:51], v[152:155]
    v_mfma_f32_16x16x32_bf16 v[156:159], a[80:83], a[48:51], v[204:207]
    v_mfma_f32_16x16x32_bf16 v[156:159], a[84:87], a[52:55], v[156:159]
    v_mfma_f32_16x16x32_bf16 v[156:159], a[88:91], a[56:59], v[156:159]
    v_mfma_f32_16x16x32_bf16 v[156:159], a[92:95], a[60:63], v[156:159]
    v_mfma_f32_16x16x32_bf16 v[148:151], a[92:95], a[44:47], v[196:199]
    v_mfma_f32_16x16x32_bf16 v[148:151], a[88:91], a[40:43], v[148:151]
    v_mfma_f32_16x16x32_bf16 v[148:151], a[84:87], a[36:39], v[148:151]
    v_mfma_f32_16x16x32_bf16 v[148:151], a[80:83], a[32:35], v[148:151]
    s_nop 7
    v_max3_f32 v248, v144, v145, v146
    v_max3_f32 v248, v248, v147, v148
    v_max3_f32 v248, v248, v149, v150
    v_max_f32 v248, v248, v151
    v_max3_f32 v249, v152, v153, v154
    v_max3_f32 v249, v249, v155, v156
    v_max3_f32 v249, v249, v157, v158
    v_max_f32 v249, v249, v159
    v_max_f32 v222, v222, v248
    v_max_f32 v223, v223, v249
    s_cmp_gt_u32 s34, s32
    s_cbranch_scc1 L_FB3
    v_max3_f32 v248, v128, v129, v130
    v_max3_f32 v248, v248, v131, v132
    v_max3_f32 v248, v248, v133, v134
    v_max_f32 v248, v248, v135
    v_max3_f32 v249, v136, v137, v138
    v_max3_f32 v249, v249, v139, v140
    v_max3_f32 v249, v249, v141, v142
    v_max_f32 v249, v249, v143
    v_max_f32 v220, v220, v248
    v_max_f32 v221, v221, v249
L_FB3:
    s_add_u32 s34, s34, 1
    s_cmp_le_u32 s34, s33
    s_cbranch_scc1 L_FBL
    v_mov_b32 v248, v220
    v_mov_b32 v249, v221
    s_nop 0
    v_permlane16_swap_b32 v248, v220
    v_permlane16_swap_b32 v249, v221
    v_max_f32 v220, v220, v248
    v_max_f32 v221, v221, v249
    v_mov_b32 v248, v220
    v_mov_b32 v249, v221
    s_nop 0
    v_permlane32_swap_b32 v248, v220
    v_permlane32_swap_b32 v249, v221
    v_max_f32 v220, v220, v248
    v_max_f32 v221, v221, v249
    v_mov_b32 v248, v222
    v_mov_b32 v249, v223
    s_nop 0
    v_permlane16_swap_b32 v248, v222
    v_permlane16_swap_b32 v249, v223
    v_max_f32 v222, v222, v248
    v_max_f32 v223, v223, v249
    v_mov_b32 v248, v222
    v_mov_b32 v249, v223
    s_nop 0
    v_permlane32_swap_b32 v248, v222
    v_permlane32_swap_b32 v249, v223
    v_max_f32 v222, v222, v248
    v_max_f32 v223, v223, v249
    s_mov_b32 s39, 1
    s_add_u32 m0, s16, 0
    s_mov_b32 s35, 0
    buffer_load_dwordx4 v225, s[68:71], s35 offen offset:0 lds
    buffer_load_dwordx4 v225, s[68:71], s35 offen offset:1024 lds
    buffer_load_dwordx4 v225, s[68:71], s35 offen offset:2048 lds
    buffer_load_dwordx4 v225, s[68:71], s35 offen offset:3072 lds
    s_add_u32 m0, s16, 16384
    s_mov_b32 s35, 16384
    buffer_load_dwordx4 v225, s[68:71], s35 offen offset:0 lds
    buffer_load_dwordx4 v225, s[68:71], s35 offen offset:1024 lds
    buffer_load_dwordx4 v225, s[68:71], s35 offen offset:2048 lds
    buffer_load_dwordx4 v225, s[68:71], s35 offen offset:3072 lds
    s_add_u32 m0, s16, 32768
    s_mov_b32 s35, 32768
    buffer_load_dwordx4 v225, s[68:71], s35 offen offset:0 lds
    buffer_load_dwordx4 v225, s[68:71], s35 offen offset:1024 lds
    buffer_load_dwordx4 v225, s[68:71], s35 offen offset:2048 lds
    buffer_load_dwordx4 v225, s[68:71], s35 offen offset:3072 lds
    s_add_u32 m0, s16, 49152
    s_mov_b32 s35, 49152
    buffer_load_dwordx4 v225, s[68:71], s35 offen offset:0 lds
    buffer_load_dwordx4 v225, s[68:71], s35 offen offset:1024 lds
    buffer_load_dwordx4 v225, s[68:71], s35 offen offset:2048 lds
    buffer_load_dwordx4 v225, s[68:71], s35 offen offset:3072 lds
    s_add_u32 m0, s16, 65536
    s_mov_b32 s35, 65536
    buffer_load_dwordx4 v225, s[68:71], s35 offen offset:0 lds
    buffer_load_dwordx4 v225, s[68:71], s35 offen offset:1024 lds
    buffer_load_dwordx4 v225, s[68:71], s35 offen offset:2048 lds
    buffer_load_dwordx4 v225, s[68:71], s35 offen offset:3072 lds
    s_add_u32 m0, s16, 81920
    s_mov_b32 s35, 81920
    buffer_load_dwordx4 v225, s[68:71], s35 offen offset:0 lds
    buffer_load_dwordx4 v225, s[68:71], s35 offen offset:1024 lds
    buffer_load_dwordx4 v225, s[68:71], s35 offen offset:2048 lds
    buffer_load_dwordx4 v225, s[68:71], s35 offen offset:3072 lds
    s_branch L_ATT
L_LAST:
.section .rodata,"a"
.p2align 6
.amdhsa_kernel concat_heads__compressed_kv_cla__linear_attn_block__prompt_kernel
  .amdhsa_next_free_vgpr 512
  .amdhsa_next_free_sgpr 102
  .amdhsa_accum_offset 256
  .amdhsa_group_segment_fixed_size 0
  .amdhsa_kernarg_size 96
  .amdhsa_user_sgpr_count 2
  .amdhsa_user_sgpr_kernarg_segment_ptr 1
  .amdhsa_system_sgpr_workgroup_id_x 1
.end_amdhsa_kernel
```
